```python
import torch

def _softmax(x, axis=-1):
    return torch.softmax(x, dim=axis)

def _gelu(x):
    return torch.nn.functional.gelu(x, approximate='tanh')

def _silu(x):
    return torch.nn.functional.silu(x)

def _sigmoid(x):
    return torch.sigmoid(x)

def _layernorm(x, axis=-1, eps=1e-05):
    m = x.mean(dim=axis, keepdim=True)
    v = x.var(dim=axis, keepdim=True, unbiased=False)
    return (x - m) / torch.sqrt(v + eps)

def _scatter_add(tgt, idx, src, axis=0):
    return tgt.clone().index_add_(axis, idx, src)

def _segment_sum(src, seg, n):
    out = torch.zeros((n,) + src.shape[1:], dtype=src.dtype)
    return out.index_add_(0, seg, src)

def _pad(x, pw):
    flat = tuple((v for pair in reversed(pw) for v in pair))
    return torch.nn.functional.pad(x, flat)
kernel_name = 'adaLN_cond__memory_aug_recurrent_mem_tr__moe_arch_mod__prompt'

def setup_inputs():

    _w = lambda a: (lambda t: t.to(torch.bfloat16) if t.is_floating_point() else t)(torch.as_tensor(a))

    def _A_setup():
        B, S, Dm = (1, 2048, 448)
        H, Dh = (16, 256)
        M, seg = (8, 32)
        seg = min(seg, S)
        S = S // seg * seg
        return {'x': _w((lambda *s: torch.randn(*s, dtype=torch.bfloat16) * 0.05)(B, S, Dm)), 'mem0': _w((lambda *s: torch.randn(*s, dtype=torch.bfloat16) * 0.4)(B, M, Dm)), 'Wq': _w((lambda *s: torch.randn(*s, dtype=torch.bfloat16) * 3.2)(Dm, H, Dh) * Dm ** (-0.5)), 'Wk': _w((lambda *s: torch.randn(*s, dtype=torch.bfloat16) * 3.2)(Dm, H, Dh) * Dm ** (-0.5)), 'Wv': _w((lambda *s: torch.randn(*s, dtype=torch.bfloat16) * 0.4)(Dm, H, Dh) * Dm ** (-0.5)), 'Wo': _w((lambda *s: torch.randn(*s, dtype=torch.bfloat16) * 0.4)(H, Dh, Dm) * (H * Dh) ** (-0.5)), 'seg_len': seg}
    _A_in = _A_setup()

    def _B_setup():
        B, S, D, F, C = (1, 2048, 448, 1792, 2)
        return {'x': _w((lambda *s: torch.randn(*s, dtype=torch.bfloat16) * 0.05)(B, S, D)), 'w_r': _w((lambda *s: torch.randn(*s, dtype=torch.bfloat16) * 3.2)(D)), 'w_gate': _w((lambda *s: torch.randn(*s, dtype=torch.bfloat16) * 0.1)(D, F)), 'w_up': _w((lambda *s: torch.randn(*s, dtype=torch.bfloat16) * 0.1)(D, F)), 'w_down': _w((lambda *s: torch.randn(*s, dtype=torch.bfloat16) * 0.1)(F, D))}
    _B_in = _B_setup()
    return {'A_x': _A_in['x'], 'A_mem0': _A_in['mem0'], 'A_Wq': _A_in['Wq'], 'A_Wk': _A_in['Wk'], 'A_Wv': _A_in['Wv'], 'A_Wo': _A_in['Wo'], 'A_seg_len': _A_in['seg_len'], 'B_x': _B_in['x'], 'B_w_r': _B_in['w_r'], 'B_w_gate': _B_in['w_gate'], 'B_w_up': _B_in['w_up'], 'B_w_down': _B_in['w_down'], 'c': _w((lambda *s: torch.randn(*s, dtype=torch.bfloat16) * 0.1)(1, 448) * 8.0), 'w_mod': _w((lambda *s: torch.randn(*s, dtype=torch.bfloat16) * 0.1)(448, 6 * 448) * 448 ** (-0.5) * 8.0)}

def reference(A_x, A_mem0, A_Wq, A_Wk, A_Wv, A_Wo, A_seg_len, B_x, B_w_r, B_w_gate, B_w_up, B_w_down, c, w_mod):

    def _A_ref(x, mem0, Wq, Wk, Wv, Wo, seg_len):
        B, S, Dm = x.shape
        H, Dh = (Wq.shape[1], Wq.shape[2])
        M = mem0.shape[1]
        scale = Dh ** (-0.5)
        n_seg = S // seg_len
        L = M + seg_len
        idx = torch.arange(L)
        mask = (idx[:, None] < M) | (idx[:, None] >= idx[None, :])
        mem = mem0
        outs = []
        for s in range(n_seg):
            xs = x[:, s * seg_len:(s + 1) * seg_len, :].clone()
            h = torch.concatenate([mem, xs], axis=1)
            q = torch.einsum('btd,dhe->bhte', h, Wq)
            k = torch.einsum('btd,dhe->bhte', h, Wk)
            v = torch.einsum('btd,dhe->bhte', h, Wv)
            scores = torch.einsum('bhqe,bhke->bhqk', q, k) * scale
            scores = torch.where(mask[None, None], scores, -1000000000.0)
            p = _softmax(scores, axis=-1)
            o = torch.einsum('bhqk,bhke->bhqe', p, v)
            o = torch.einsum('bhte,hed->btd', o, Wo)
            mem = o[:, :M, :].clone()
            outs.append(o[:, M:, :])
        return torch.concatenate(outs, axis=1)

    def _B_ref(x, w_r, w_gate, w_up, w_down):
        B, S, D = x.shape
        C = 2
        r = x @ w_r
        idx = torch.argsort(-r, axis=-1)[:, :C]
        idx_e = (lambda x, n, axis: torch.repeat_interleave(x, n, dim=axis))(idx.reshape(B, C, 1), D, axis=2)
        x_sel = (lambda x, i, axis: torch.take_along_dim(x, i, dim=axis))(x, idx_e, axis=1)
        g = _silu(x_sel @ w_gate)
        u = x_sel @ w_up
        y = g * u @ w_down
        r_sel = _sigmoid((lambda x, i, axis: torch.take_along_dim(x, i, dim=axis))(r, idx, axis=1))
        y = y * r_sel.reshape(B, C, 1)
        b_off = (torch.arange(B) * S).reshape(B, 1)
        flat_idx = (idx + b_off).reshape(B * C)
        zero = (x * 0.0).reshape(B * S, D)
        upd = _scatter_add(zero, flat_idx, y.reshape(B * C, D), axis=0)
        return x + upd.reshape(B, S, D)
    x = A_x
    mod = (_silu(c) @ w_mod).reshape(c.shape[0], 6, 1, -1)
    sa, ca, ga, sb, cb, gb = (mod[:, 0].clone(), mod[:, 1].clone(), mod[:, 2].clone(), mod[:, 3].clone(), mod[:, 4].clone(), mod[:, 5].clone())
    h = _layernorm(x, axis=-1) * (1 + ca) + sa
    x = x + ga * _A_ref(h, A_mem0, A_Wq, A_Wk, A_Wv, A_Wo, A_seg_len)
    h = _layernorm(x, axis=-1) * (1 + cb) + sb
    x = x + gb * _B_ref(h, B_w_r, B_w_gate, B_w_up, B_w_down)
    return x
```

```asm
; @launch kernel=k_main_kernel grid=(256,1,1) block=(256,1,1) lds=163840
.amdgcn_target "amdgcn-amd-amdhsa--gfx950"
.text
    .p2align 8
    .type k_main_kernel,@function
k_main_kernel:
    s_cmp_ge_u32 s2, 256
    s_cbranch_scc1 L_done
    s_load_dwordx2 s[4:5], s[0:1], 128
    s_load_dwordx2 s[20:21], s[0:1], 120
    s_load_dwordx2 s[22:23], s[0:1], 8
    v_lshrrev_b32 v1, 6, v0
    s_nop 0
    v_readfirstlane_b32 s87, v1
    s_waitcnt lgkmcnt(0)
    s_and_b32 s5, s5, 0xffff
    s_mov_b32 s6, 0x10000000
    s_mov_b32 s7, 0x20000
    s_getpc_b64 s[8:9]
L_pc_ref:
    s_lshr_b32 s10, s2, 3
    s_lshl_b32 s10, s10, 5
    v_and_b32 v1, 31, v0
    v_add_u32 v1, s10, v1
    v_lshlrev_b32 v1, 7, v1
    v_min_u32 v1, (L_code_end - L_pc_ref - 4), v1
    v_and_b32 v1, 0xfffffffc, v1
    s_cmp_lg_u32 s87, 0
    s_cbranch_scc1 cpf_1
    global_load_dword v200, v1, s[8:9]
cpf_1:
    v_lshlrev_b32 v1, 4, v0
    v_mov_b32 v4, -1
    v_mov_b32 v5, -1
    v_mov_b32 v6, -1
    v_mov_b32 v7, -1
    s_lshl_b32 s3, s2, 12
    s_cmp_ge_u32 s3, 1122304
    s_cbranch_scc1 pz_2
    s_add_u32 s8, s3, 44044288
    buffer_store_dwordx4 v[4:7], v1, s[4:7], s8 offen sc1
    s_nop 1
pz_2:
    s_add_u32 s3, s3, 1048576
    s_cmp_ge_u32 s3, 1122304
    s_cbranch_scc1 pz_3
    s_add_u32 s8, s3, 44044288
    buffer_store_dwordx4 v[4:7], v1, s[4:7], s8 offen sc1
    s_nop 1
pz_3:
    s_add_u32 s3, s3, 1048576
    v_mov_b32 v4, -1
    v_mov_b32 v5, -1
    v_mov_b32 v6, -1
    v_mov_b32 v7, -1
    s_lshl_b32 s3, s2, 12
    s_cmp_ge_u32 s3, 466944
    s_cbranch_scc1 pz_4
    s_add_u32 s8, s3, 52506624
    buffer_store_dwordx4 v[4:7], v1, s[4:7], s8 offen sc1
    s_nop 1
pz_4:
    s_add_u32 s3, s3, 1048576
    v_mov_b32 v4, -1
    v_mov_b32 v5, -1
    v_mov_b32 v6, -1
    v_mov_b32 v7, -1
    s_lshl_b32 s3, s2, 12
    s_cmp_ge_u32 s3, 4096
    s_cbranch_scc1 pz_5
    s_add_u32 s8, s3, 87068672
    buffer_store_dwordx4 v[4:7], v1, s[4:7], s8 offen sc1
    s_nop 1
pz_5:
    s_add_u32 s3, s3, 1048576
    v_mov_b32 v4, 0
    v_mov_b32 v5, 0
    v_mov_b32 v6, 0
    v_mov_b32 v7, 0
    s_lshl_b32 s3, s2, 12
    s_cmp_ge_u32 s3, 24576
    s_cbranch_scc1 pz_6
    s_add_u32 s8, s3, 90972160
    buffer_store_dwordx4 v[4:7], v1, s[4:7], s8 offen sc1
    s_nop 1
pz_6:
    s_add_u32 s3, s3, 1048576
    s_and_b32 s3, s2, 7
    s_lshr_b32 s75, s2, 3
    s_sub_u32 s8, s3, 1
    s_lshl_b32 s8, s8, 5
    s_add_u32 s75, s75, s8
    s_cmp_eq_u32 s3, 0
    s_cselect_b32 s75, 256, s75
    s_min_u32 s3, s75, 255
    s_load_dwordx2 s[8:9], s[0:1], 0
    s_waitcnt lgkmcnt(0)
    s_and_b32 s9, s9, 0xffff
    s_mov_b32 s10, 1835008
    s_mov_b32 s11, 0x20000
    v_and_b32 v1, 63, v0
    v_lshrrev_b32 v2, 6, v0
    s_nop 0
    v_readfirstlane_b32 s16, v2
    v_min_u32 v3, 55, v1
    v_lshrrev_b32 v4, 1, v3
    v_lshlrev_b32 v4, 4, v4
    v_and_b32 v5, 1, v3
    v_lshl_add_u32 v4, v5, 2, v4
    v_mul_u32_u24 v4, 2, v4
    s_lshl_b32 s17, s3, 3
    s_lshl_b32 s16, s16, 1
    s_add_u32 s17, s17, s16
    s_mul_i32 s18, s17, 896
    buffer_load_dwordx2 a[248:249], v4, s[8:11], s18 offen offset:0
    buffer_load_dwordx2 a[250:251], v4, s[8:11], s18 offen offset:16
    buffer_load_dwordx2 a[252:253], v4, s[8:11], s18 offen offset:896
    buffer_load_dwordx2 a[254:255], v4, s[8:11], s18 offen offset:912
    s_waitcnt vmcnt(4)
    s_barrier
    s_getreg_b32 s89, hwreg(HW_REG_XCC_ID, 0, 4)
    s_and_b32 s89, s89, 7
    s_cmp_lg_u32 s87, 0
    s_cbranch_scc1 notk_7
    v_mov_b32 v2, s89
    v_lshlrev_b32 v2, 2, v2
    v_mov_b32 v3, 1
    s_mov_b64 exec, 1
    global_atomic_add v4, v2, v3, s[20:21] sc0
    s_waitcnt vmcnt(0)
    v_mov_b32 v2, 163824
    ds_write_b32 v2, v4
    s_waitcnt lgkmcnt(0)
    s_mov_b64 exec, -1
notk_7:
    s_and_b32 s3, s2, 7
    s_cmp_lg_u32 s3, 2
    s_cbranch_scc1 nomod_8
    s_lshr_b32 s3, s2, 3
    s_cmp_ge_u32 s3, 14
    s_cbranch_scc1 nomod_8
    s_load_dwordx2 s[8:9], s[0:1], 104
    s_waitcnt lgkmcnt(0)
    s_and_b32 s9, s9, 0xffff
    s_mov_b32 s10, 2408448
    s_mov_b32 s11, 0x20000
    s_load_dwordx2 s[12:13], s[0:1], 96
    s_waitcnt lgkmcnt(0)
    s_and_b32 s13, s13, 0xffff
    s_mov_b32 s14, 896
    s_mov_b32 s15, 0x20000
    v_and_b32 v1, 7, v0
    v_lshrrev_b32 v2, 3, v0
    v_mul_u32_u24 v3, 14, v2
    v_mul_u32_u24 v4, 5376, v3
    v_lshl_add_u32 v4, v1, 4, v4
    s_lshl_b32 s16, s3, 7
    v_add_u32 v4, s16, v4
    v_lshlrev_b32 v5, 1, v3
    s_mov_b32 s17, 0
    buffer_load_dwordx4 v[32:35], v4, s[8:11], s17 offen
    s_mov_b32 s17, 5376
    buffer_load_dwordx4 v[36:39], v4, s[8:11], s17 offen
    s_mov_b32 s17, 10752
    buffer_load_dwordx4 v[40:43], v4, s[8:11], s17 offen
    s_mov_b32 s17, 16128
    buffer_load_dwordx4 v[44:47], v4, s[8:11], s17 offen
    s_mov_b32 s17, 21504
    buffer_load_dwordx4 v[48:51], v4, s[8:11], s17 offen
    s_mov_b32 s17, 26880
    buffer_load_dwordx4 v[52:55], v4, s[8:11], s17 offen
    s_mov_b32 s17, 32256
    buffer_load_dwordx4 v[56:59], v4, s[8:11], s17 offen
    s_mov_b32 s17, 37632
    buffer_load_dwordx4 v[60:63], v4, s[8:11], s17 offen
    s_mov_b32 s17, 43008
    buffer_load_dwordx4 v[64:67], v4, s[8:11], s17 offen
    s_mov_b32 s17, 48384
    buffer_load_dwordx4 v[68:71], v4, s[8:11], s17 offen
    s_mov_b32 s17, 53760
    buffer_load_dwordx4 v[72:75], v4, s[8:11], s17 offen
    s_mov_b32 s17, 59136
    buffer_load_dwordx4 v[76:79], v4, s[8:11], s17 offen
    s_mov_b32 s17, 64512
    buffer_load_dwordx4 v[80:83], v4, s[8:11], s17 offen
    s_mov_b32 s17, 69888
    buffer_load_dwordx4 v[84:87], v4, s[8:11], s17 offen
    buffer_load_ushort v8, v5, s[12:15], 0 offen offset:0
    buffer_load_ushort v9, v5, s[12:15], 0 offen offset:2
    buffer_load_ushort v10, v5, s[12:15], 0 offen offset:4
    buffer_load_ushort v11, v5, s[12:15], 0 offen offset:6
    buffer_load_ushort v12, v5, s[12:15], 0 offen offset:8
    buffer_load_ushort v13, v5, s[12:15], 0 offen offset:10
    buffer_load_ushort v14, v5, s[12:15], 0 offen offset:12
    buffer_load_ushort v15, v5, s[12:15], 0 offen offset:14
    buffer_load_ushort v16, v5, s[12:15], 0 offen offset:16
    buffer_load_ushort v17, v5, s[12:15], 0 offen offset:18
    buffer_load_ushort v18, v5, s[12:15], 0 offen offset:20
    buffer_load_ushort v19, v5, s[12:15], 0 offen offset:22
    buffer_load_ushort v20, v5, s[12:15], 0 offen offset:24
    buffer_load_ushort v21, v5, s[12:15], 0 offen offset:26
    s_waitcnt vmcnt(0)
    v_lshlrev_b32 v8, 16, v8
    v_lshlrev_b32 v9, 16, v9
    v_lshlrev_b32 v10, 16, v10
    v_lshlrev_b32 v11, 16, v11
    v_lshlrev_b32 v12, 16, v12
    v_lshlrev_b32 v13, 16, v13
    v_lshlrev_b32 v14, 16, v14
    v_lshlrev_b32 v15, 16, v15
    v_lshlrev_b32 v16, 16, v16
    v_lshlrev_b32 v17, 16, v17
    v_lshlrev_b32 v18, 16, v18
    v_lshlrev_b32 v19, 16, v19
    v_lshlrev_b32 v20, 16, v20
    v_lshlrev_b32 v21, 16, v21
    v_mul_f32 v6, 0xbfb8aa3b, v8
    v_exp_f32 v6, v6
    s_nop 0
    v_add_f32 v6, 1.0, v6
    v_rcp_f32 v6, v6
    s_nop 0
    v_mul_f32 v8, v8, v6
    v_cvt_pk_bf16_f32 v6, v8, v8
    v_lshlrev_b32 v8, 16, v6
    v_mul_f32 v6, 0xbfb8aa3b, v9
    v_exp_f32 v6, v6
    s_nop 0
    v_add_f32 v6, 1.0, v6
    v_rcp_f32 v6, v6
    s_nop 0
    v_mul_f32 v9, v9, v6
    v_cvt_pk_bf16_f32 v6, v9, v9
    v_lshlrev_b32 v9, 16, v6
    v_mul_f32 v6, 0xbfb8aa3b, v10
    v_exp_f32 v6, v6
    s_nop 0
    v_add_f32 v6, 1.0, v6
    v_rcp_f32 v6, v6
    s_nop 0
    v_mul_f32 v10, v10, v6
    v_cvt_pk_bf16_f32 v6, v10, v10
    v_lshlrev_b32 v10, 16, v6
    v_mul_f32 v6, 0xbfb8aa3b, v11
    v_exp_f32 v6, v6
    s_nop 0
    v_add_f32 v6, 1.0, v6
    v_rcp_f32 v6, v6
    s_nop 0
    v_mul_f32 v11, v11, v6
    v_cvt_pk_bf16_f32 v6, v11, v11
    v_lshlrev_b32 v11, 16, v6
    v_mul_f32 v6, 0xbfb8aa3b, v12
    v_exp_f32 v6, v6
    s_nop 0
    v_add_f32 v6, 1.0, v6
    v_rcp_f32 v6, v6
    s_nop 0
    v_mul_f32 v12, v12, v6
    v_cvt_pk_bf16_f32 v6, v12, v12
    v_lshlrev_b32 v12, 16, v6
    v_mul_f32 v6, 0xbfb8aa3b, v13
    v_exp_f32 v6, v6
    s_nop 0
    v_add_f32 v6, 1.0, v6
    v_rcp_f32 v6, v6
    s_nop 0
    v_mul_f32 v13, v13, v6
    v_cvt_pk_bf16_f32 v6, v13, v13
    v_lshlrev_b32 v13, 16, v6
    v_mul_f32 v6, 0xbfb8aa3b, v14
    v_exp_f32 v6, v6
    s_nop 0
    v_add_f32 v6, 1.0, v6
    v_rcp_f32 v6, v6
    s_nop 0
    v_mul_f32 v14, v14, v6
    v_cvt_pk_bf16_f32 v6, v14, v14
    v_lshlrev_b32 v14, 16, v6
    v_mul_f32 v6, 0xbfb8aa3b, v15
    v_exp_f32 v6, v6
    s_nop 0
    v_add_f32 v6, 1.0, v6
    v_rcp_f32 v6, v6
    s_nop 0
    v_mul_f32 v15, v15, v6
    v_cvt_pk_bf16_f32 v6, v15, v15
    v_lshlrev_b32 v15, 16, v6
    v_mul_f32 v6, 0xbfb8aa3b, v16
    v_exp_f32 v6, v6
    s_nop 0
    v_add_f32 v6, 1.0, v6
    v_rcp_f32 v6, v6
    s_nop 0
    v_mul_f32 v16, v16, v6
    v_cvt_pk_bf16_f32 v6, v16, v16
    v_lshlrev_b32 v16, 16, v6
    v_mul_f32 v6, 0xbfb8aa3b, v17
    v_exp_f32 v6, v6
    s_nop 0
    v_add_f32 v6, 1.0, v6
    v_rcp_f32 v6, v6
    s_nop 0
    v_mul_f32 v17, v17, v6
    v_cvt_pk_bf16_f32 v6, v17, v17
    v_lshlrev_b32 v17, 16, v6
    v_mul_f32 v6, 0xbfb8aa3b, v18
    v_exp_f32 v6, v6
    s_nop 0
    v_add_f32 v6, 1.0, v6
    v_rcp_f32 v6, v6
    s_nop 0
    v_mul_f32 v18, v18, v6
    v_cvt_pk_bf16_f32 v6, v18, v18
    v_lshlrev_b32 v18, 16, v6
    v_mul_f32 v6, 0xbfb8aa3b, v19
    v_exp_f32 v6, v6
    s_nop 0
    v_add_f32 v6, 1.0, v6
    v_rcp_f32 v6, v6
    s_nop 0
    v_mul_f32 v19, v19, v6
    v_cvt_pk_bf16_f32 v6, v19, v19
    v_lshlrev_b32 v19, 16, v6
    v_mul_f32 v6, 0xbfb8aa3b, v20
    v_exp_f32 v6, v6
    s_nop 0
    v_add_f32 v6, 1.0, v6
    v_rcp_f32 v6, v6
    s_nop 0
    v_mul_f32 v20, v20, v6
    v_cvt_pk_bf16_f32 v6, v20, v20
    v_lshlrev_b32 v20, 16, v6
    v_mul_f32 v6, 0xbfb8aa3b, v21
    v_exp_f32 v6, v6
    s_nop 0
    v_add_f32 v6, 1.0, v6
    v_rcp_f32 v6, v6
    s_nop 0
    v_mul_f32 v21, v21, v6
    v_cvt_pk_bf16_f32 v6, v21, v21
    v_lshlrev_b32 v21, 16, v6
    v_mov_b32 v24, 0
    v_mov_b32 v25, 0
    v_mov_b32 v26, 0
    v_mov_b32 v27, 0
    v_mov_b32 v28, 0
    v_mov_b32 v29, 0
    v_mov_b32 v30, 0
    v_mov_b32 v31, 0
    v_lshlrev_b32 v6, 16, v32
    v_and_b32 v7, 0xffff0000, v32
    v_fmac_f32 v24, v8, v6
    v_fmac_f32 v25, v8, v7
    v_lshlrev_b32 v6, 16, v33
    v_and_b32 v7, 0xffff0000, v33
    v_fmac_f32 v26, v8, v6
    v_fmac_f32 v27, v8, v7
    v_lshlrev_b32 v6, 16, v34
    v_and_b32 v7, 0xffff0000, v34
    v_fmac_f32 v28, v8, v6
    v_fmac_f32 v29, v8, v7
    v_lshlrev_b32 v6, 16, v35
    v_and_b32 v7, 0xffff0000, v35
    v_fmac_f32 v30, v8, v6
    v_fmac_f32 v31, v8, v7
    v_lshlrev_b32 v6, 16, v36
    v_and_b32 v7, 0xffff0000, v36
    v_fmac_f32 v24, v9, v6
    v_fmac_f32 v25, v9, v7
    v_lshlrev_b32 v6, 16, v37
    v_and_b32 v7, 0xffff0000, v37
    v_fmac_f32 v26, v9, v6
    v_fmac_f32 v27, v9, v7
    v_lshlrev_b32 v6, 16, v38
    v_and_b32 v7, 0xffff0000, v38
    v_fmac_f32 v28, v9, v6
    v_fmac_f32 v29, v9, v7
    v_lshlrev_b32 v6, 16, v39
    v_and_b32 v7, 0xffff0000, v39
    v_fmac_f32 v30, v9, v6
    v_fmac_f32 v31, v9, v7
    v_lshlrev_b32 v6, 16, v40
    v_and_b32 v7, 0xffff0000, v40
    v_fmac_f32 v24, v10, v6
    v_fmac_f32 v25, v10, v7
    v_lshlrev_b32 v6, 16, v41
    v_and_b32 v7, 0xffff0000, v41
    v_fmac_f32 v26, v10, v6
    v_fmac_f32 v27, v10, v7
    v_lshlrev_b32 v6, 16, v42
    v_and_b32 v7, 0xffff0000, v42
    v_fmac_f32 v28, v10, v6
    v_fmac_f32 v29, v10, v7
    v_lshlrev_b32 v6, 16, v43
    v_and_b32 v7, 0xffff0000, v43
    v_fmac_f32 v30, v10, v6
    v_fmac_f32 v31, v10, v7
    v_lshlrev_b32 v6, 16, v44
    v_and_b32 v7, 0xffff0000, v44
    v_fmac_f32 v24, v11, v6
    v_fmac_f32 v25, v11, v7
    v_lshlrev_b32 v6, 16, v45
    v_and_b32 v7, 0xffff0000, v45
    v_fmac_f32 v26, v11, v6
    v_fmac_f32 v27, v11, v7
    v_lshlrev_b32 v6, 16, v46
    v_and_b32 v7, 0xffff0000, v46
    v_fmac_f32 v28, v11, v6
    v_fmac_f32 v29, v11, v7
    v_lshlrev_b32 v6, 16, v47
    v_and_b32 v7, 0xffff0000, v47
    v_fmac_f32 v30, v11, v6
    v_fmac_f32 v31, v11, v7
    v_lshlrev_b32 v6, 16, v48
    v_and_b32 v7, 0xffff0000, v48
    v_fmac_f32 v24, v12, v6
    v_fmac_f32 v25, v12, v7
    v_lshlrev_b32 v6, 16, v49
    v_and_b32 v7, 0xffff0000, v49
    v_fmac_f32 v26, v12, v6
    v_fmac_f32 v27, v12, v7
    v_lshlrev_b32 v6, 16, v50
    v_and_b32 v7, 0xffff0000, v50
    v_fmac_f32 v28, v12, v6
    v_fmac_f32 v29, v12, v7
    v_lshlrev_b32 v6, 16, v51
    v_and_b32 v7, 0xffff0000, v51
    v_fmac_f32 v30, v12, v6
    v_fmac_f32 v31, v12, v7
    v_lshlrev_b32 v6, 16, v52
    v_and_b32 v7, 0xffff0000, v52
    v_fmac_f32 v24, v13, v6
    v_fmac_f32 v25, v13, v7
    v_lshlrev_b32 v6, 16, v53
    v_and_b32 v7, 0xffff0000, v53
    v_fmac_f32 v26, v13, v6
    v_fmac_f32 v27, v13, v7
    v_lshlrev_b32 v6, 16, v54
    v_and_b32 v7, 0xffff0000, v54
    v_fmac_f32 v28, v13, v6
    v_fmac_f32 v29, v13, v7
    v_lshlrev_b32 v6, 16, v55
    v_and_b32 v7, 0xffff0000, v55
    v_fmac_f32 v30, v13, v6
    v_fmac_f32 v31, v13, v7
    v_lshlrev_b32 v6, 16, v56
    v_and_b32 v7, 0xffff0000, v56
    v_fmac_f32 v24, v14, v6
    v_fmac_f32 v25, v14, v7
    v_lshlrev_b32 v6, 16, v57
    v_and_b32 v7, 0xffff0000, v57
    v_fmac_f32 v26, v14, v6
    v_fmac_f32 v27, v14, v7
    v_lshlrev_b32 v6, 16, v58
    v_and_b32 v7, 0xffff0000, v58
    v_fmac_f32 v28, v14, v6
    v_fmac_f32 v29, v14, v7
    v_lshlrev_b32 v6, 16, v59
    v_and_b32 v7, 0xffff0000, v59
    v_fmac_f32 v30, v14, v6
    v_fmac_f32 v31, v14, v7
    v_lshlrev_b32 v6, 16, v60
    v_and_b32 v7, 0xffff0000, v60
    v_fmac_f32 v24, v15, v6
    v_fmac_f32 v25, v15, v7
    v_lshlrev_b32 v6, 16, v61
    v_and_b32 v7, 0xffff0000, v61
    v_fmac_f32 v26, v15, v6
    v_fmac_f32 v27, v15, v7
    v_lshlrev_b32 v6, 16, v62
    v_and_b32 v7, 0xffff0000, v62
    v_fmac_f32 v28, v15, v6
    v_fmac_f32 v29, v15, v7
    v_lshlrev_b32 v6, 16, v63
    v_and_b32 v7, 0xffff0000, v63
    v_fmac_f32 v30, v15, v6
    v_fmac_f32 v31, v15, v7
    v_lshlrev_b32 v6, 16, v64
    v_and_b32 v7, 0xffff0000, v64
    v_fmac_f32 v24, v16, v6
    v_fmac_f32 v25, v16, v7
    v_lshlrev_b32 v6, 16, v65
    v_and_b32 v7, 0xffff0000, v65
    v_fmac_f32 v26, v16, v6
    v_fmac_f32 v27, v16, v7
    v_lshlrev_b32 v6, 16, v66
    v_and_b32 v7, 0xffff0000, v66
    v_fmac_f32 v28, v16, v6
    v_fmac_f32 v29, v16, v7
    v_lshlrev_b32 v6, 16, v67
    v_and_b32 v7, 0xffff0000, v67
    v_fmac_f32 v30, v16, v6
    v_fmac_f32 v31, v16, v7
    v_lshlrev_b32 v6, 16, v68
    v_and_b32 v7, 0xffff0000, v68
    v_fmac_f32 v24, v17, v6
    v_fmac_f32 v25, v17, v7
    v_lshlrev_b32 v6, 16, v69
    v_and_b32 v7, 0xffff0000, v69
    v_fmac_f32 v26, v17, v6
    v_fmac_f32 v27, v17, v7
    v_lshlrev_b32 v6, 16, v70
    v_and_b32 v7, 0xffff0000, v70
    v_fmac_f32 v28, v17, v6
    v_fmac_f32 v29, v17, v7
    v_lshlrev_b32 v6, 16, v71
    v_and_b32 v7, 0xffff0000, v71
    v_fmac_f32 v30, v17, v6
    v_fmac_f32 v31, v17, v7
    v_lshlrev_b32 v6, 16, v72
    v_and_b32 v7, 0xffff0000, v72
    v_fmac_f32 v24, v18, v6
    v_fmac_f32 v25, v18, v7
    v_lshlrev_b32 v6, 16, v73
    v_and_b32 v7, 0xffff0000, v73
    v_fmac_f32 v26, v18, v6
    v_fmac_f32 v27, v18, v7
    v_lshlrev_b32 v6, 16, v74
    v_and_b32 v7, 0xffff0000, v74
    v_fmac_f32 v28, v18, v6
    v_fmac_f32 v29, v18, v7
    v_lshlrev_b32 v6, 16, v75
    v_and_b32 v7, 0xffff0000, v75
    v_fmac_f32 v30, v18, v6
    v_fmac_f32 v31, v18, v7
    v_lshlrev_b32 v6, 16, v76
    v_and_b32 v7, 0xffff0000, v76
    v_fmac_f32 v24, v19, v6
    v_fmac_f32 v25, v19, v7
    v_lshlrev_b32 v6, 16, v77
    v_and_b32 v7, 0xffff0000, v77
    v_fmac_f32 v26, v19, v6
    v_fmac_f32 v27, v19, v7
    v_lshlrev_b32 v6, 16, v78
    v_and_b32 v7, 0xffff0000, v78
    v_fmac_f32 v28, v19, v6
    v_fmac_f32 v29, v19, v7
    v_lshlrev_b32 v6, 16, v79
    v_and_b32 v7, 0xffff0000, v79
    v_fmac_f32 v30, v19, v6
    v_fmac_f32 v31, v19, v7
    v_lshlrev_b32 v6, 16, v80
    v_and_b32 v7, 0xffff0000, v80
    v_fmac_f32 v24, v20, v6
    v_fmac_f32 v25, v20, v7
    v_lshlrev_b32 v6, 16, v81
    v_and_b32 v7, 0xffff0000, v81
    v_fmac_f32 v26, v20, v6
    v_fmac_f32 v27, v20, v7
    v_lshlrev_b32 v6, 16, v82
    v_and_b32 v7, 0xffff0000, v82
    v_fmac_f32 v28, v20, v6
    v_fmac_f32 v29, v20, v7
    v_lshlrev_b32 v6, 16, v83
    v_and_b32 v7, 0xffff0000, v83
    v_fmac_f32 v30, v20, v6
    v_fmac_f32 v31, v20, v7
    v_lshlrev_b32 v6, 16, v84
    v_and_b32 v7, 0xffff0000, v84
    v_fmac_f32 v24, v21, v6
    v_fmac_f32 v25, v21, v7
    v_lshlrev_b32 v6, 16, v85
    v_and_b32 v7, 0xffff0000, v85
    v_fmac_f32 v26, v21, v6
    v_fmac_f32 v27, v21, v7
    v_lshlrev_b32 v6, 16, v86
    v_and_b32 v7, 0xffff0000, v86
    v_fmac_f32 v28, v21, v6
    v_fmac_f32 v29, v21, v7
    v_lshlrev_b32 v6, 16, v87
    v_and_b32 v7, 0xffff0000, v87
    v_fmac_f32 v30, v21, v6
    v_fmac_f32 v31, v21, v7
    v_lshlrev_b32 v6, 8, v2
    v_lshl_add_u32 v6, v1, 5, v6
    ds_write_b128 v6, v[24:27]
    ds_write_b128 v6, v[28:31] offset:16
    s_waitcnt lgkmcnt(0)
    s_barrier
    v_cmp_gt_u32 vcc, 64, v0
    s_and_saveexec_b64 s[18:19], vcc
    s_cbranch_execz modskip_9
    v_lshlrev_b32 v6, 2, v0
    ds_read_b32 v32, v6 offset:0
    ds_read_b32 v33, v6 offset:256
    ds_read_b32 v34, v6 offset:512
    ds_read_b32 v35, v6 offset:768
    ds_read_b32 v36, v6 offset:1024
    ds_read_b32 v37, v6 offset:1280
    ds_read_b32 v38, v6 offset:1536
    ds_read_b32 v39, v6 offset:1792
    s_waitcnt lgkmcnt(0)
    ds_read_b32 v40, v6 offset:2048
    ds_read_b32 v41, v6 offset:2304
    ds_read_b32 v42, v6 offset:2560
    ds_read_b32 v43, v6 offset:2816
    ds_read_b32 v44, v6 offset:3072
    ds_read_b32 v45, v6 offset:3328
    ds_read_b32 v46, v6 offset:3584
    ds_read_b32 v47, v6 offset:3840
    s_waitcnt lgkmcnt(0)
    ds_read_b32 v48, v6 offset:4096
    ds_read_b32 v49, v6 offset:4352
    ds_read_b32 v50, v6 offset:4608
    ds_read_b32 v51, v6 offset:4864
    ds_read_b32 v52, v6 offset:5120
    ds_read_b32 v53, v6 offset:5376
    ds_read_b32 v54, v6 offset:5632
    ds_read_b32 v55, v6 offset:5888
    s_waitcnt lgkmcnt(0)
    ds_read_b32 v56, v6 offset:6144
    ds_read_b32 v57, v6 offset:6400
    ds_read_b32 v58, v6 offset:6656
    ds_read_b32 v59, v6 offset:6912
    ds_read_b32 v60, v6 offset:7168
    ds_read_b32 v61, v6 offset:7424
    ds_read_b32 v62, v6 offset:7680
    ds_read_b32 v63, v6 offset:7936
    s_waitcnt lgkmcnt(0)
    v_add_f32 v32, v32, v48
    v_add_f32 v33, v33, v49
    v_add_f32 v34, v34, v50
    v_add_f32 v35, v35, v51
    v_add_f32 v36, v36, v52
    v_add_f32 v37, v37, v53
    v_add_f32 v38, v38, v54
    v_add_f32 v39, v39, v55
    v_add_f32 v40, v40, v56
    v_add_f32 v41, v41, v57
    v_add_f32 v42, v42, v58
    v_add_f32 v43, v43, v59
    v_add_f32 v44, v44, v60
    v_add_f32 v45, v45, v61
    v_add_f32 v46, v46, v62
    v_add_f32 v47, v47, v63
    v_add_f32 v32, v32, v40
    v_add_f32 v33, v33, v41
    v_add_f32 v34, v34, v42
    v_add_f32 v35, v35, v43
    v_add_f32 v36, v36, v44
    v_add_f32 v37, v37, v45
    v_add_f32 v38, v38, v46
    v_add_f32 v39, v39, v47
    v_add_f32 v32, v32, v36
    v_add_f32 v33, v33, v37
    v_add_f32 v34, v34, v38
    v_add_f32 v35, v35, v39
    v_add_f32 v32, v32, v34
    v_add_f32 v33, v33, v35
    v_add_f32 v32, v32, v33
    v_cvt_pk_bf16_f32 v7, v32, v32
    v_lshlrev_b32 v32, 16, v7
    s_lshl_b32 s16, s3, 8
    s_add_u32 s16, s16, 87052288
    buffer_store_dword v32, v6, s[4:7], s16 offen sc1
modskip_9:
    s_mov_b64 exec, s[18:19]
    s_waitcnt vmcnt(0)
    s_barrier
    s_cmp_lg_u32 s87, 0
    s_cbranch_scc1 sigd_10
    s_load_dwordx2 s[96:97], s[0:1], 120
    v_mov_b32 v250, 64
    v_mov_b32 v251, 1
    s_waitcnt lgkmcnt(0)
    s_mov_b64 exec, 1
    global_atomic_add v250, v251, s[96:97]
    s_mov_b64 exec, -1
sigd_10:
nomod_8:
    s_add_u32 s84, s2, 128
    s_and_b32 s84, s84, 255
    s_lshr_b32 s28, s84, 7
    s_and_b32 s24, s84, 15
    s_bfe_u32 s25, s84, 0x20004
    v_lshrrev_b32 v2, 6, v0
    s_nop 0
    v_readfirstlane_b32 s27, v2
    s_bfe_u32 s26, s84, 0x10006
    s_lshl_b32 s26, s26, 2
    s_add_u32 s26, s26, s27
    v_and_b32 v1, 63, v0
    v_and_b32 v3, 15, v1
    v_lshrrev_b32 v4, 4, v1
    v_lshrrev_b32 v5, 5, v1
    v_and_b32 v6, 31, v1
    s_cmp_eq_u32 s28, 1
    s_cselect_b32 s16, 32, 16
    s_cselect_b32 s17, 40, 24
    s_load_dwordx2 s[8:9], s[0:1], s16
    s_load_dwordx2 s[12:13], s[0:1], s17
    s_waitcnt lgkmcnt(0)
    s_and_b32 s9, s9, 0xffff
    s_mov_b32 s10, 3670016
    s_mov_b32 s11, 0x20000
    s_and_b32 s13, s13, 0xffff
    s_mov_b32 s14, 3670016
    s_mov_b32 s15, 0x20000
    s_barrier
    s_min_u32 s16, s26, 6
    s_lshl_b32 s16, s16, 19
    s_lshl_b32 s17, s24, 9
    s_add_u32 s29, s16, s17
    s_lshl_b32 s30, s27, 14
    s_add_u32 s30, s30, 65536
    v_lshrrev_b32 v7, 2, v6
    v_sub_u32 v7, v7, v5
    v_subrev_u32 v7, 0, v7
    v_and_b32 v7, 7, v7
    v_lshlrev_b32 v7, 6, v7
    v_and_b32 v8, 3, v6
    v_lshl_add_u32 v7, v8, 4, v7
    v_lshl_add_u32 v7, v5, 13, v7
    s_add_u32 m0, s30, 0
    s_add_u32 s18, s29, 0
    buffer_load_dwordx4 v7, s[8:11], s18 offen lds
    v_lshrrev_b32 v7, 2, v6
    v_sub_u32 v7, v7, v5
    v_subrev_u32 v7, 0, v7
    v_and_b32 v7, 7, v7
    v_lshlrev_b32 v7, 6, v7
    v_and_b32 v8, 3, v6
    v_lshl_add_u32 v7, v8, 4, v7
    v_lshl_add_u32 v7, v5, 13, v7
    s_add_u32 m0, s30, 1024
    s_add_u32 s18, s29, 16384
    buffer_load_dwordx4 v7, s[8:11], s18 offen lds
    v_lshrrev_b32 v7, 2, v6
    v_sub_u32 v7, v7, v5
    v_subrev_u32 v7, 2, v7
    v_and_b32 v7, 7, v7
    v_lshlrev_b32 v7, 6, v7
    v_and_b32 v8, 3, v6
    v_lshl_add_u32 v7, v8, 4, v7
    v_lshl_add_u32 v7, v5, 13, v7
    s_add_u32 m0, s30, 2048
    s_add_u32 s18, s29, 32768
    buffer_load_dwordx4 v7, s[8:11], s18 offen lds
    v_lshrrev_b32 v7, 2, v6
    v_sub_u32 v7, v7, v5
    v_subrev_u32 v7, 2, v7
    v_and_b32 v7, 7, v7
    v_lshlrev_b32 v7, 6, v7
    v_and_b32 v8, 3, v6
    v_lshl_add_u32 v7, v8, 4, v7
    v_lshl_add_u32 v7, v5, 13, v7
    s_add_u32 m0, s30, 3072
    s_add_u32 s18, s29, 49152
    buffer_load_dwordx4 v7, s[8:11], s18 offen lds
    v_lshrrev_b32 v7, 2, v6
    v_sub_u32 v7, v7, v5
    v_subrev_u32 v7, 4, v7
    v_and_b32 v7, 7, v7
    v_lshlrev_b32 v7, 6, v7
    v_and_b32 v8, 3, v6
    v_lshl_add_u32 v7, v8, 4, v7
    v_lshl_add_u32 v7, v5, 13, v7
    s_add_u32 m0, s30, 4096
    s_add_u32 s18, s29, 65536
    buffer_load_dwordx4 v7, s[8:11], s18 offen lds
    v_lshrrev_b32 v7, 2, v6
    v_sub_u32 v7, v7, v5
    v_subrev_u32 v7, 4, v7
    v_and_b32 v7, 7, v7
    v_lshlrev_b32 v7, 6, v7
    v_and_b32 v8, 3, v6
    v_lshl_add_u32 v7, v8, 4, v7
    v_lshl_add_u32 v7, v5, 13, v7
    s_add_u32 m0, s30, 5120
    s_add_u32 s18, s29, 81920
    buffer_load_dwordx4 v7, s[8:11], s18 offen lds
    v_lshrrev_b32 v7, 2, v6
    v_sub_u32 v7, v7, v5
    v_subrev_u32 v7, 6, v7
    v_and_b32 v7, 7, v7
    v_lshlrev_b32 v7, 6, v7
    v_and_b32 v8, 3, v6
    v_lshl_add_u32 v7, v8, 4, v7
    v_lshl_add_u32 v7, v5, 13, v7
    s_add_u32 m0, s30, 6144
    s_add_u32 s18, s29, 98304
    buffer_load_dwordx4 v7, s[8:11], s18 offen lds
    v_lshrrev_b32 v7, 2, v6
    v_sub_u32 v7, v7, v5
    v_subrev_u32 v7, 6, v7
    v_and_b32 v7, 7, v7
    v_lshlrev_b32 v7, 6, v7
    v_and_b32 v8, 3, v6
    v_lshl_add_u32 v7, v8, 4, v7
    v_lshl_add_u32 v7, v5, 13, v7
    s_add_u32 m0, s30, 7168
    s_add_u32 s18, s29, 114688
    buffer_load_dwordx4 v7, s[8:11], s18 offen lds
    v_lshrrev_b32 v7, 2, v6
    v_sub_u32 v7, v7, v5
    v_subrev_u32 v7, 8, v7
    v_and_b32 v7, 7, v7
    v_lshlrev_b32 v7, 6, v7
    v_and_b32 v8, 3, v6
    v_lshl_add_u32 v7, v8, 4, v7
    v_lshl_add_u32 v7, v5, 13, v7
    s_add_u32 m0, s30, 8192
    s_add_u32 s18, s29, 131072
    buffer_load_dwordx4 v7, s[8:11], s18 offen lds
    v_lshrrev_b32 v7, 2, v6
    v_sub_u32 v7, v7, v5
    v_subrev_u32 v7, 8, v7
    v_and_b32 v7, 7, v7
    v_lshlrev_b32 v7, 6, v7
    v_and_b32 v8, 3, v6
    v_lshl_add_u32 v7, v8, 4, v7
    v_lshl_add_u32 v7, v5, 13, v7
    s_add_u32 m0, s30, 9216
    s_add_u32 s18, s29, 147456
    buffer_load_dwordx4 v7, s[8:11], s18 offen lds
    v_lshrrev_b32 v7, 2, v6
    v_sub_u32 v7, v7, v5
    v_subrev_u32 v7, 10, v7
    v_and_b32 v7, 7, v7
    v_lshlrev_b32 v7, 6, v7
    v_and_b32 v8, 3, v6
    v_lshl_add_u32 v7, v8, 4, v7
    v_lshl_add_u32 v7, v5, 13, v7
    s_add_u32 m0, s30, 10240
    s_add_u32 s18, s29, 163840
    buffer_load_dwordx4 v7, s[8:11], s18 offen lds
    v_lshrrev_b32 v7, 2, v6
    v_sub_u32 v7, v7, v5
    v_subrev_u32 v7, 10, v7
    v_and_b32 v7, 7, v7
    v_lshlrev_b32 v7, 6, v7
    v_and_b32 v8, 3, v6
    v_lshl_add_u32 v7, v8, 4, v7
    v_lshl_add_u32 v7, v5, 13, v7
    s_add_u32 m0, s30, 11264
    s_add_u32 s18, s29, 180224
    buffer_load_dwordx4 v7, s[8:11], s18 offen lds
    v_lshrrev_b32 v7, 2, v6
    v_sub_u32 v7, v7, v5
    v_subrev_u32 v7, 12, v7
    v_and_b32 v7, 7, v7
    v_lshlrev_b32 v7, 6, v7
    v_and_b32 v8, 3, v6
    v_lshl_add_u32 v7, v8, 4, v7
    v_lshl_add_u32 v7, v5, 13, v7
    s_add_u32 m0, s30, 12288
    s_add_u32 s18, s29, 196608
    buffer_load_dwordx4 v7, s[8:11], s18 offen lds
    v_lshrrev_b32 v7, 2, v6
    v_sub_u32 v7, v7, v5
    v_subrev_u32 v7, 12, v7
    v_and_b32 v7, 7, v7
    v_lshlrev_b32 v7, 6, v7
    v_and_b32 v8, 3, v6
    v_lshl_add_u32 v7, v8, 4, v7
    v_lshl_add_u32 v7, v5, 13, v7
    s_add_u32 m0, s30, 13312
    s_add_u32 s18, s29, 212992
    buffer_load_dwordx4 v7, s[8:11], s18 offen lds
    v_lshrrev_b32 v7, 2, v6
    v_sub_u32 v7, v7, v5
    v_subrev_u32 v7, 14, v7
    v_and_b32 v7, 7, v7
    v_lshlrev_b32 v7, 6, v7
    v_and_b32 v8, 3, v6
    v_lshl_add_u32 v7, v8, 4, v7
    v_lshl_add_u32 v7, v5, 13, v7
    s_add_u32 m0, s30, 14336
    s_add_u32 s18, s29, 229376
    buffer_load_dwordx4 v7, s[8:11], s18 offen lds
    v_lshrrev_b32 v7, 2, v6
    v_sub_u32 v7, v7, v5
    v_subrev_u32 v7, 14, v7
    v_and_b32 v7, 7, v7
    v_lshlrev_b32 v7, 6, v7
    v_and_b32 v8, 3, v6
    v_lshl_add_u32 v7, v8, 4, v7
    v_lshl_add_u32 v7, v5, 13, v7
    s_add_u32 m0, s30, 15360
    s_add_u32 s18, s29, 245760
    buffer_load_dwordx4 v7, s[8:11], s18 offen lds
    v_lshrrev_b32 v7, 2, v1
    v_lshlrev_b32 v7, 13, v7
    v_and_b32 v8, 3, v1
    v_lshl_add_u32 v7, v8, 7, v7
    s_add_u32 s18, s29, 262144
    buffer_load_dword v10, v7, s[8:11], s18 offen
    s_add_u32 s18, s29, 393216
    buffer_load_dword v11, v7, s[8:11], s18 offen
    s_cmp_eq_u32 s28, 1
    s_cbranch_scc1 guU_11
    s_mul_i32 s16, s25, 917504
    s_add_u32 s16, s16, s17
    s_mul_i32 s18, s27, 229376
    s_add_u32 s16, s16, s18
    s_mul_i32 s19, s27, 14336
    s_mul_i32 s20, s27, 28
    s_add_u32 s21, s20, 0
    v_add_u32 v8, s21, v5
    v_lshrrev_b32 v7, 2, v6
    v_sub_u32 v7, v7, v8
    v_and_b32 v7, 7, v7
    v_lshlrev_b32 v7, 6, v7
    v_and_b32 v8, 3, v6
    v_lshl_add_u32 v7, v8, 4, v7
    v_lshl_add_u32 v7, v5, 13, v7
    s_add_u32 m0, s19, 0
    s_add_u32 s18, s16, 0
    buffer_load_dwordx4 v7, s[12:15], s18 offen lds
    s_add_u32 s21, s20, 2
    v_add_u32 v8, s21, v5
    v_lshrrev_b32 v7, 2, v6
    v_sub_u32 v7, v7, v8
    v_and_b32 v7, 7, v7
    v_lshlrev_b32 v7, 6, v7
    v_and_b32 v8, 3, v6
    v_lshl_add_u32 v7, v8, 4, v7
    v_lshl_add_u32 v7, v5, 13, v7
    s_add_u32 m0, s19, 1024
    s_add_u32 s18, s16, 16384
    buffer_load_dwordx4 v7, s[12:15], s18 offen lds
    s_add_u32 s21, s20, 4
    v_add_u32 v8, s21, v5
    v_lshrrev_b32 v7, 2, v6
    v_sub_u32 v7, v7, v8
    v_and_b32 v7, 7, v7
    v_lshlrev_b32 v7, 6, v7
    v_and_b32 v8, 3, v6
    v_lshl_add_u32 v7, v8, 4, v7
    v_lshl_add_u32 v7, v5, 13, v7
    s_add_u32 m0, s19, 2048
    s_add_u32 s18, s16, 32768
    buffer_load_dwordx4 v7, s[12:15], s18 offen lds
    s_add_u32 s21, s20, 6
    v_add_u32 v8, s21, v5
    v_lshrrev_b32 v7, 2, v6
    v_sub_u32 v7, v7, v8
    v_and_b32 v7, 7, v7
    v_lshlrev_b32 v7, 6, v7
    v_and_b32 v8, 3, v6
    v_lshl_add_u32 v7, v8, 4, v7
    v_lshl_add_u32 v7, v5, 13, v7
    s_add_u32 m0, s19, 3072
    s_add_u32 s18, s16, 49152
    buffer_load_dwordx4 v7, s[12:15], s18 offen lds
    s_add_u32 s21, s20, 8
    v_add_u32 v8, s21, v5
    v_lshrrev_b32 v7, 2, v6
    v_sub_u32 v7, v7, v8
    v_and_b32 v7, 7, v7
    v_lshlrev_b32 v7, 6, v7
    v_and_b32 v8, 3, v6
    v_lshl_add_u32 v7, v8, 4, v7
    v_lshl_add_u32 v7, v5, 13, v7
    s_add_u32 m0, s19, 4096
    s_add_u32 s18, s16, 65536
    buffer_load_dwordx4 v7, s[12:15], s18 offen lds
    s_add_u32 s21, s20, 10
    v_add_u32 v8, s21, v5
    v_lshrrev_b32 v7, 2, v6
    v_sub_u32 v7, v7, v8
    v_and_b32 v7, 7, v7
    v_lshlrev_b32 v7, 6, v7
    v_and_b32 v8, 3, v6
    v_lshl_add_u32 v7, v8, 4, v7
    v_lshl_add_u32 v7, v5, 13, v7
    s_add_u32 m0, s19, 5120
    s_add_u32 s18, s16, 81920
    buffer_load_dwordx4 v7, s[12:15], s18 offen lds
    s_add_u32 s21, s20, 12
    v_add_u32 v8, s21, v5
    v_lshrrev_b32 v7, 2, v6
    v_sub_u32 v7, v7, v8
    v_and_b32 v7, 7, v7
    v_lshlrev_b32 v7, 6, v7
    v_and_b32 v8, 3, v6
    v_lshl_add_u32 v7, v8, 4, v7
    v_lshl_add_u32 v7, v5, 13, v7
    s_add_u32 m0, s19, 6144
    s_add_u32 s18, s16, 98304
    buffer_load_dwordx4 v7, s[12:15], s18 offen lds
    s_add_u32 s21, s20, 14
    v_add_u32 v8, s21, v5
    v_lshrrev_b32 v7, 2, v6
    v_sub_u32 v7, v7, v8
    v_and_b32 v7, 7, v7
    v_lshlrev_b32 v7, 6, v7
    v_and_b32 v8, 3, v6
    v_lshl_add_u32 v7, v8, 4, v7
    v_lshl_add_u32 v7, v5, 13, v7
    s_add_u32 m0, s19, 7168
    s_add_u32 s18, s16, 114688
    buffer_load_dwordx4 v7, s[12:15], s18 offen lds
    s_add_u32 s21, s20, 16
    v_add_u32 v8, s21, v5
    v_lshrrev_b32 v7, 2, v6
    v_sub_u32 v7, v7, v8
    v_and_b32 v7, 7, v7
    v_lshlrev_b32 v7, 6, v7
    v_and_b32 v8, 3, v6
    v_lshl_add_u32 v7, v8, 4, v7
    v_lshl_add_u32 v7, v5, 13, v7
    s_add_u32 m0, s19, 8192
    s_add_u32 s18, s16, 131072
    buffer_load_dwordx4 v7, s[12:15], s18 offen lds
    s_add_u32 s21, s20, 18
    v_add_u32 v8, s21, v5
    v_lshrrev_b32 v7, 2, v6
    v_sub_u32 v7, v7, v8
    v_and_b32 v7, 7, v7
    v_lshlrev_b32 v7, 6, v7
    v_and_b32 v8, 3, v6
    v_lshl_add_u32 v7, v8, 4, v7
    v_lshl_add_u32 v7, v5, 13, v7
    s_add_u32 m0, s19, 9216
    s_add_u32 s18, s16, 147456
    buffer_load_dwordx4 v7, s[12:15], s18 offen lds
    s_add_u32 s21, s20, 20
    v_add_u32 v8, s21, v5
    v_lshrrev_b32 v7, 2, v6
    v_sub_u32 v7, v7, v8
    v_and_b32 v7, 7, v7
    v_lshlrev_b32 v7, 6, v7
    v_and_b32 v8, 3, v6
    v_lshl_add_u32 v7, v8, 4, v7
    v_lshl_add_u32 v7, v5, 13, v7
    s_add_u32 m0, s19, 10240
    s_add_u32 s18, s16, 163840
    buffer_load_dwordx4 v7, s[12:15], s18 offen lds
    s_add_u32 s21, s20, 22
    v_add_u32 v8, s21, v5
    v_lshrrev_b32 v7, 2, v6
    v_sub_u32 v7, v7, v8
    v_and_b32 v7, 7, v7
    v_lshlrev_b32 v7, 6, v7
    v_and_b32 v8, 3, v6
    v_lshl_add_u32 v7, v8, 4, v7
    v_lshl_add_u32 v7, v5, 13, v7
    s_add_u32 m0, s19, 11264
    s_add_u32 s18, s16, 180224
    buffer_load_dwordx4 v7, s[12:15], s18 offen lds
    s_add_u32 s21, s20, 24
    v_add_u32 v8, s21, v5
    v_lshrrev_b32 v7, 2, v6
    v_sub_u32 v7, v7, v8
    v_and_b32 v7, 7, v7
    v_lshlrev_b32 v7, 6, v7
    v_and_b32 v8, 3, v6
    v_lshl_add_u32 v7, v8, 4, v7
    v_lshl_add_u32 v7, v5, 13, v7
    s_add_u32 m0, s19, 12288
    s_add_u32 s18, s16, 196608
    buffer_load_dwordx4 v7, s[12:15], s18 offen lds
    s_add_u32 s21, s20, 26
    v_add_u32 v8, s21, v5
    v_lshrrev_b32 v7, 2, v6
    v_sub_u32 v7, v7, v8
    v_and_b32 v7, 7, v7
    v_lshlrev_b32 v7, 6, v7
    v_and_b32 v8, 3, v6
    v_lshl_add_u32 v7, v8, 4, v7
    v_lshl_add_u32 v7, v5, 13, v7
    s_add_u32 m0, s19, 13312
    s_add_u32 s18, s16, 212992
    buffer_load_dwordx4 v7, s[12:15], s18 offen lds
    s_cmp_ge_u32 s75, 32
    s_cbranch_scc1 nolnh_13
    s_load_dwordx2 s[96:97], s[0:1], 120
    s_mov_b32 s90, 0
    v_and_b32 v60, 7, v0
    v_lshlrev_b32 v60, 2, v60
    s_waitcnt lgkmcnt(0)
reg0_14:
    global_load_dword v61, v60, s[96:97] sc1
    s_waitcnt vmcnt(0)
    v_readlane_b32 s64, v61, 0
    v_readlane_b32 s65, v61, 1
    v_readlane_b32 s66, v61, 2
    v_readlane_b32 s67, v61, 3
    v_readlane_b32 s68, v61, 4
    v_readlane_b32 s69, v61, 5
    v_readlane_b32 s70, v61, 6
    v_readlane_b32 s71, v61, 7
    s_nop 3
    s_add_u32 s91, s64, s65
    s_add_u32 s91, s91, s66
    s_add_u32 s91, s91, s67
    s_add_u32 s91, s91, s68
    s_add_u32 s91, s91, s69
    s_add_u32 s91, s91, s70
    s_add_u32 s91, s91, s71
    s_cmp_ge_u32 s91, 256
    s_cbranch_scc1 reg0ok_15
    s_sleep 2
    s_add_u32 s90, s90, 1
    s_cmp_lt_u32 s90, 400000
    s_cbranch_scc1 reg0_14
    s_branch L_abort
reg0ok_15:
    s_cmp_ge_u32 s75, 256
    s_cbranch_scc1 noln_16
    s_mov_b32 s91, 64
    s_cmp_lg_u32 s87, 0
    s_cbranch_scc1 wsk_19
    s_load_dwordx2 s[96:97], s[0:1], 120
    s_waitcnt lgkmcnt(0)
    s_mov_b32 s90, 0
    v_mov_b32 v60, s91
wge_17:
    global_load_dword v61, v60, s[96:97] sc1
    s_waitcnt vmcnt(0)
    v_readfirstlane_b32 s92, v61
    s_nop 3
    s_cmp_ge_u32 s92, 14
    s_cbranch_scc1 wok_18
    s_sleep 2
    s_add_u32 s90, s90, 1
    s_cmp_lt_u32 s90, 400000
    s_cbranch_scc1 wge_17
    s_branch L_abort
wok_18:
wsk_19:
    s_barrier
    s_mov_b32 s3, s75
    v_and_b32 v1, 63, v0
    v_lshrrev_b32 v2, 6, v0
    s_nop 0
    v_readfirstlane_b32 s16, v2
    v_min_u32 v3, 55, v1
    v_lshrrev_b32 v4, 1, v3
    v_lshlrev_b32 v4, 4, v4
    v_and_b32 v5, 1, v3
    v_lshl_add_u32 v4, v5, 2, v4
    v_mul_u32_u24 v4, 2, v4
    v_lshlrev_b32 v5, 1, v4
    s_mov_b32 s21, 87054080
    buffer_load_dwordx4 v[40:43], v5, s[4:7], s21 offen sc1
    buffer_load_dwordx4 v[44:47], v5, s[4:7], s21 offen offset:32 sc1
    s_mov_b32 s21, 87052288
    buffer_load_dwordx4 v[48:51], v5, s[4:7], s21 offen sc1
    buffer_load_dwordx4 v[52:55], v5, s[4:7], s21 offen offset:32 sc1
    s_lshl_b32 s17, s3, 3
    s_lshl_b32 s16, s16, 1
    s_add_u32 s17, s17, s16
    s_mul_i32 s18, s17, 896
    v_accvgpr_read_b32 v8, a248
    v_accvgpr_read_b32 v9, a249
    v_accvgpr_read_b32 v10, a250
    v_accvgpr_read_b32 v11, a251
    v_accvgpr_read_b32 v12, a252
    v_accvgpr_read_b32 v13, a253
    v_accvgpr_read_b32 v14, a254
    v_accvgpr_read_b32 v15, a255
    s_mov_b32 s22, -1
    s_mov_b32 s23, 0x00ffffff
    s_waitcnt vmcnt(0)
    v_lshlrev_b32 v16, 16, v8
    v_and_b32 v17, 0xffff0000, v8
    v_lshlrev_b32 v18, 16, v9
    v_and_b32 v19, 0xffff0000, v9
    v_lshlrev_b32 v20, 16, v10
    v_and_b32 v21, 0xffff0000, v10
    v_lshlrev_b32 v22, 16, v11
    v_and_b32 v23, 0xffff0000, v11
    v_cndmask_b32 v16, 0, v16, s[22:23]
    v_cndmask_b32 v17, 0, v17, s[22:23]
    v_cndmask_b32 v18, 0, v18, s[22:23]
    v_cndmask_b32 v19, 0, v19, s[22:23]
    v_cndmask_b32 v20, 0, v20, s[22:23]
    v_cndmask_b32 v21, 0, v21, s[22:23]
    v_cndmask_b32 v22, 0, v22, s[22:23]
    v_cndmask_b32 v23, 0, v23, s[22:23]
    v_lshlrev_b32 v24, 16, v12
    v_and_b32 v25, 0xffff0000, v12
    v_lshlrev_b32 v26, 16, v13
    v_and_b32 v27, 0xffff0000, v13
    v_lshlrev_b32 v28, 16, v14
    v_and_b32 v29, 0xffff0000, v14
    v_lshlrev_b32 v30, 16, v15
    v_and_b32 v31, 0xffff0000, v15
    v_cndmask_b32 v24, 0, v24, s[22:23]
    v_cndmask_b32 v25, 0, v25, s[22:23]
    v_cndmask_b32 v26, 0, v26, s[22:23]
    v_cndmask_b32 v27, 0, v27, s[22:23]
    v_cndmask_b32 v28, 0, v28, s[22:23]
    v_cndmask_b32 v29, 0, v29, s[22:23]
    v_cndmask_b32 v30, 0, v30, s[22:23]
    v_cndmask_b32 v31, 0, v31, s[22:23]
    v_add_f32 v40, 1.0, v40
    v_add_f32 v41, 1.0, v41
    v_cvt_pk_bf16_f32 v6, v40, v41
    v_lshlrev_b32 v40, 16, v6
    v_and_b32 v41, 0xffff0000, v6
    v_add_f32 v42, 1.0, v42
    v_add_f32 v43, 1.0, v43
    v_cvt_pk_bf16_f32 v6, v42, v43
    v_lshlrev_b32 v42, 16, v6
    v_and_b32 v43, 0xffff0000, v6
    v_add_f32 v44, 1.0, v44
    v_add_f32 v45, 1.0, v45
    v_cvt_pk_bf16_f32 v6, v44, v45
    v_lshlrev_b32 v44, 16, v6
    v_and_b32 v45, 0xffff0000, v6
    v_add_f32 v46, 1.0, v46
    v_add_f32 v47, 1.0, v47
    v_cvt_pk_bf16_f32 v6, v46, v47
    v_lshlrev_b32 v46, 16, v6
    v_and_b32 v47, 0xffff0000, v6
    v_add_f32 v32, v16, v17
    v_add_f32 v32, v32, v18
    v_add_f32 v32, v32, v19
    v_add_f32 v32, v32, v20
    v_add_f32 v32, v32, v21
    v_add_f32 v32, v32, v22
    v_add_f32 v32, v32, v23
    v_add_f32 v33, v24, v25
    v_add_f32 v33, v33, v26
    v_add_f32 v33, v33, v27
    v_add_f32 v33, v33, v28
    v_add_f32 v33, v33, v29
    v_add_f32 v33, v33, v30
    v_add_f32 v33, v33, v31
    s_nop 1
    v_add_f32_dpp v32, v32, v32 quad_perm:[1,0,3,2] row_mask:0xf bank_mask:0xf
    v_add_f32_dpp v33, v33, v33 quad_perm:[1,0,3,2] row_mask:0xf bank_mask:0xf
    s_nop 1
    v_add_f32_dpp v32, v32, v32 quad_perm:[2,3,0,1] row_mask:0xf bank_mask:0xf
    v_add_f32_dpp v33, v33, v33 quad_perm:[2,3,0,1] row_mask:0xf bank_mask:0xf
    s_nop 1
    v_add_f32_dpp v32, v32, v32 row_half_mirror row_mask:0xf bank_mask:0xf
    v_add_f32_dpp v33, v33, v33 row_half_mirror row_mask:0xf bank_mask:0xf
    s_nop 1
    v_add_f32_dpp v32, v32, v32 row_mirror row_mask:0xf bank_mask:0xf
    v_add_f32_dpp v33, v33, v33 row_mirror row_mask:0xf bank_mask:0xf
    v_mov_b32 v56, v32
    v_mov_b32 v57, v33
    s_nop 1
    v_permlane16_swap_b32 v32, v56
    v_permlane16_swap_b32 v33, v57
    s_nop 1
    v_add_f32 v32, v32, v56
    v_add_f32 v33, v33, v57
    v_mov_b32 v56, v32
    v_mov_b32 v57, v33
    s_nop 1
    v_permlane32_swap_b32 v32, v56
    v_permlane32_swap_b32 v33, v57
    s_nop 1
    v_add_f32 v32, v32, v56
    v_add_f32 v33, v33, v57
    s_mov_b32 s20, 0x3b124925
    v_mul_f32 v32, s20, v32
    v_mul_f32 v33, s20, v33
    v_sub_f32 v56, v16, v32
    v_mul_f32 v34, v56, v56
    v_sub_f32 v56, v17, v32
    v_fmac_f32 v34, v56, v56
    v_sub_f32 v56, v18, v32
    v_fmac_f32 v34, v56, v56
    v_sub_f32 v56, v19, v32
    v_fmac_f32 v34, v56, v56
    v_sub_f32 v56, v20, v32
    v_fmac_f32 v34, v56, v56
    v_sub_f32 v56, v21, v32
    v_fmac_f32 v34, v56, v56
    v_sub_f32 v56, v22, v32
    v_fmac_f32 v34, v56, v56
    v_sub_f32 v56, v23, v32
    v_fmac_f32 v34, v56, v56
    v_cndmask_b32 v34, 0, v34, s[22:23]
    v_sub_f32 v56, v24, v33
    v_mul_f32 v35, v56, v56
    v_sub_f32 v56, v25, v33
    v_fmac_f32 v35, v56, v56
    v_sub_f32 v56, v26, v33
    v_fmac_f32 v35, v56, v56
    v_sub_f32 v56, v27, v33
    v_fmac_f32 v35, v56, v56
    v_sub_f32 v56, v28, v33
    v_fmac_f32 v35, v56, v56
    v_sub_f32 v56, v29, v33
    v_fmac_f32 v35, v56, v56
    v_sub_f32 v56, v30, v33
    v_fmac_f32 v35, v56, v56
    v_sub_f32 v56, v31, v33
    v_fmac_f32 v35, v56, v56
    v_cndmask_b32 v35, 0, v35, s[22:23]
    s_nop 1
    v_add_f32_dpp v34, v34, v34 quad_perm:[1,0,3,2] row_mask:0xf bank_mask:0xf
    v_add_f32_dpp v35, v35, v35 quad_perm:[1,0,3,2] row_mask:0xf bank_mask:0xf
    s_nop 1
    v_add_f32_dpp v34, v34, v34 quad_perm:[2,3,0,1] row_mask:0xf bank_mask:0xf
    v_add_f32_dpp v35, v35, v35 quad_perm:[2,3,0,1] row_mask:0xf bank_mask:0xf
    s_nop 1
    v_add_f32_dpp v34, v34, v34 row_half_mirror row_mask:0xf bank_mask:0xf
    v_add_f32_dpp v35, v35, v35 row_half_mirror row_mask:0xf bank_mask:0xf
    s_nop 1
    v_add_f32_dpp v34, v34, v34 row_mirror row_mask:0xf bank_mask:0xf
    v_add_f32_dpp v35, v35, v35 row_mirror row_mask:0xf bank_mask:0xf
    v_mov_b32 v56, v34
    v_mov_b32 v57, v35
    s_nop 1
    v_permlane16_swap_b32 v34, v56
    v_permlane16_swap_b32 v35, v57
    s_nop 1
    v_add_f32 v34, v34, v56
    v_add_f32 v35, v35, v57
    v_mov_b32 v56, v34
    v_mov_b32 v57, v35
    s_nop 1
    v_permlane32_swap_b32 v34, v56
    v_permlane32_swap_b32 v35, v57
    s_nop 1
    v_add_f32 v34, v34, v56
    v_add_f32 v35, v35, v57
    v_mul_f32 v34, s20, v34
    v_cvt_pk_bf16_f32 v56, v32, v34
    v_lshlrev_b32 v32, 16, v56
    v_and_b32 v34, 0xffff0000, v56
    v_add_f32 v34, 0x3727c5ac, v34
    v_cvt_pk_bf16_f32 v56, v34, v34
    v_lshlrev_b32 v34, 16, v56
    v_sqrt_f32 v34, v34
    s_nop 0
    v_cvt_pk_bf16_f32 v56, v34, v34
    v_lshlrev_b32 v34, 16, v56
    v_rcp_f32 v34, v34
    s_nop 0
    v_mul_f32 v35, s20, v35
    v_cvt_pk_bf16_f32 v56, v33, v35
    v_lshlrev_b32 v33, 16, v56
    v_and_b32 v35, 0xffff0000, v56
    v_add_f32 v35, 0x3727c5ac, v35
    v_cvt_pk_bf16_f32 v56, v35, v35
    v_lshlrev_b32 v35, 16, v56
    v_sqrt_f32 v35, v35
    s_nop 0
    v_cvt_pk_bf16_f32 v56, v35, v35
    v_lshlrev_b32 v35, 16, v56
    v_rcp_f32 v35, v35
    s_nop 0
    v_sub_f32 v16, v16, v32
    v_sub_f32 v17, v17, v32
    v_cvt_pk_bf16_f32 v56, v16, v17
    v_lshlrev_b32 v16, 16, v56
    v_and_b32 v17, 0xffff0000, v56
    v_mul_f32 v16, v16, v34
    v_mul_f32 v17, v17, v34
    v_cvt_pk_bf16_f32 v56, v16, v17
    v_lshlrev_b32 v16, 16, v56
    v_and_b32 v17, 0xffff0000, v56
    v_mul_f32 v16, v16, v40
    v_mul_f32 v17, v17, v41
    v_cvt_pk_bf16_f32 v56, v16, v17
    v_lshlrev_b32 v16, 16, v56
    v_and_b32 v17, 0xffff0000, v56
    v_add_f32 v16, v16, v48
    v_add_f32 v17, v17, v49
    v_sub_f32 v18, v18, v32
    v_sub_f32 v19, v19, v32
    v_cvt_pk_bf16_f32 v56, v18, v19
    v_lshlrev_b32 v18, 16, v56
    v_and_b32 v19, 0xffff0000, v56
    v_mul_f32 v18, v18, v34
    v_mul_f32 v19, v19, v34
    v_cvt_pk_bf16_f32 v56, v18, v19
    v_lshlrev_b32 v18, 16, v56
    v_and_b32 v19, 0xffff0000, v56
    v_mul_f32 v18, v18, v42
    v_mul_f32 v19, v19, v43
    v_cvt_pk_bf16_f32 v56, v18, v19
    v_lshlrev_b32 v18, 16, v56
    v_and_b32 v19, 0xffff0000, v56
    v_add_f32 v18, v18, v50
    v_add_f32 v19, v19, v51
    v_sub_f32 v20, v20, v32
    v_sub_f32 v21, v21, v32
    v_cvt_pk_bf16_f32 v56, v20, v21
    v_lshlrev_b32 v20, 16, v56
    v_and_b32 v21, 0xffff0000, v56
    v_mul_f32 v20, v20, v34
    v_mul_f32 v21, v21, v34
    v_cvt_pk_bf16_f32 v56, v20, v21
    v_lshlrev_b32 v20, 16, v56
    v_and_b32 v21, 0xffff0000, v56
    v_mul_f32 v20, v20, v44
    v_mul_f32 v21, v21, v45
    v_cvt_pk_bf16_f32 v56, v20, v21
    v_lshlrev_b32 v20, 16, v56
    v_and_b32 v21, 0xffff0000, v56
    v_add_f32 v20, v20, v52
    v_add_f32 v21, v21, v53
    v_sub_f32 v22, v22, v32
    v_sub_f32 v23, v23, v32
    v_cvt_pk_bf16_f32 v56, v22, v23
    v_lshlrev_b32 v22, 16, v56
    v_and_b32 v23, 0xffff0000, v56
    v_mul_f32 v22, v22, v34
    v_mul_f32 v23, v23, v34
    v_cvt_pk_bf16_f32 v56, v22, v23
    v_lshlrev_b32 v22, 16, v56
    v_and_b32 v23, 0xffff0000, v56
    v_mul_f32 v22, v22, v46
    v_mul_f32 v23, v23, v47
    v_cvt_pk_bf16_f32 v56, v22, v23
    v_lshlrev_b32 v22, 16, v56
    v_and_b32 v23, 0xffff0000, v56
    v_add_f32 v22, v22, v54
    v_add_f32 v23, v23, v55
    v_sub_f32 v24, v24, v33
    v_sub_f32 v25, v25, v33
    v_cvt_pk_bf16_f32 v56, v24, v25
    v_lshlrev_b32 v24, 16, v56
    v_and_b32 v25, 0xffff0000, v56
    v_mul_f32 v24, v24, v35
    v_mul_f32 v25, v25, v35
    v_cvt_pk_bf16_f32 v56, v24, v25
    v_lshlrev_b32 v24, 16, v56
    v_and_b32 v25, 0xffff0000, v56
    v_mul_f32 v24, v24, v40
    v_mul_f32 v25, v25, v41
    v_cvt_pk_bf16_f32 v56, v24, v25
    v_lshlrev_b32 v24, 16, v56
    v_and_b32 v25, 0xffff0000, v56
    v_add_f32 v24, v24, v48
    v_add_f32 v25, v25, v49
    v_sub_f32 v26, v26, v33
    v_sub_f32 v27, v27, v33
    v_cvt_pk_bf16_f32 v56, v26, v27
    v_lshlrev_b32 v26, 16, v56
    v_and_b32 v27, 0xffff0000, v56
    v_mul_f32 v26, v26, v35
    v_mul_f32 v27, v27, v35
    v_cvt_pk_bf16_f32 v56, v26, v27
    v_lshlrev_b32 v26, 16, v56
    v_and_b32 v27, 0xffff0000, v56
    v_mul_f32 v26, v26, v42
    v_mul_f32 v27, v27, v43
    v_cvt_pk_bf16_f32 v56, v26, v27
    v_lshlrev_b32 v26, 16, v56
    v_and_b32 v27, 0xffff0000, v56
    v_add_f32 v26, v26, v50
    v_add_f32 v27, v27, v51
    v_sub_f32 v28, v28, v33
    v_sub_f32 v29, v29, v33
    v_cvt_pk_bf16_f32 v56, v28, v29
    v_lshlrev_b32 v28, 16, v56
    v_and_b32 v29, 0xffff0000, v56
    v_mul_f32 v28, v28, v35
    v_mul_f32 v29, v29, v35
    v_cvt_pk_bf16_f32 v56, v28, v29
    v_lshlrev_b32 v28, 16, v56
    v_and_b32 v29, 0xffff0000, v56
    v_mul_f32 v28, v28, v44
    v_mul_f32 v29, v29, v45
    v_cvt_pk_bf16_f32 v56, v28, v29
    v_lshlrev_b32 v28, 16, v56
    v_and_b32 v29, 0xffff0000, v56
    v_add_f32 v28, v28, v52
    v_add_f32 v29, v29, v53
    v_sub_f32 v30, v30, v33
    v_sub_f32 v31, v31, v33
    v_cvt_pk_bf16_f32 v56, v30, v31
    v_lshlrev_b32 v30, 16, v56
    v_and_b32 v31, 0xffff0000, v56
    v_mul_f32 v30, v30, v35
    v_mul_f32 v31, v31, v35
    v_cvt_pk_bf16_f32 v56, v30, v31
    v_lshlrev_b32 v30, 16, v56
    v_and_b32 v31, 0xffff0000, v56
    v_mul_f32 v30, v30, v46
    v_mul_f32 v31, v31, v47
    v_cvt_pk_bf16_f32 v56, v30, v31
    v_lshlrev_b32 v30, 16, v56
    v_and_b32 v31, 0xffff0000, v56
    v_add_f32 v30, v30, v54
    v_add_f32 v31, v31, v55
    s_lshr_b32 s18, s17, 5
    s_mul_i32 s18, s18, 28672
    s_and_b32 s19, s17, 31
    s_lshl_b32 s19, s19, 4
    s_add_u32 s18, s18, s19
    s_add_u32 s18, s18, 12845056
    v_lshlrev_b32 v6, 9, v3
    s_mov_b64 exec, s[22:23]
    v_cvt_pk_bf16_f32 v8, v16, v17
    v_cvt_pk_bf16_f32 v9, v18, v19
    v_cvt_pk_bf16_f32 v10, v20, v21
    v_cvt_pk_bf16_f32 v11, v22, v23
    buffer_store_dwordx4 v[8:11], v6, s[4:7], s18 offen offset:0 sc1
    v_cvt_pk_bf16_f32 v12, v24, v25
    v_cvt_pk_bf16_f32 v13, v26, v27
    v_cvt_pk_bf16_f32 v14, v28, v29
    v_cvt_pk_bf16_f32 v15, v30, v31
    buffer_store_dwordx4 v[12:15], v6, s[4:7], s18 offen offset:16 sc1
    s_mov_b64 exec, -1
    s_lshr_b32 s93, s75, 4
    s_lshl_b32 s93, s93, 6
    s_add_u32 s93, s93, 90975232
    s_waitcnt vmcnt(0)
    s_barrier
    s_cmp_lg_u32 s87, 0
    s_cbranch_scc1 sig_20
    v_mov_b32 v250, 0
    v_mov_b32 v251, 1
    s_mov_b64 exec, 1
    buffer_atomic_add v251, v250, s[4:7], s93 offen
    s_mov_b64 exec, -1
sig_20:
noln_16:
    s_mov_b32 s75, 256
nolnh_13:
    v_and_b32 v1, 63, v0
    v_and_b32 v3, 15, v1
    v_lshrrev_b32 v4, 4, v1
    v_lshrrev_b32 v5, 5, v1
    v_and_b32 v6, 31, v1
    s_cmp_eq_u32 s28, 1
    s_cselect_b32 s16, 32, 16
    s_load_dwordx2 s[8:9], s[0:1], s16
    s_waitcnt lgkmcnt(0)
    s_and_b32 s9, s9, 0xffff
    s_mov_b32 s10, 3670016
    s_mov_b32 s11, 0x20000
    s_waitcnt vmcnt(0)
    s_barrier
    v_add_u32 v8, 0, v3
    v_and_b32 v8, 7, v8
    v_lshlrev_b32 v8, 6, v8
    v_lshl_add_u32 v8, v4, 4, v8
    v_lshl_add_u32 v16, v3, 9, v8
    v_add_u32 v8, 1, v3
    v_and_b32 v8, 7, v8
    v_lshlrev_b32 v8, 6, v8
    v_lshl_add_u32 v8, v4, 4, v8
    v_lshl_add_u32 v17, v3, 9, v8
    v_add_u32 v8, 2, v3
    v_and_b32 v8, 7, v8
    v_lshlrev_b32 v8, 6, v8
    v_lshl_add_u32 v8, v4, 4, v8
    v_lshl_add_u32 v18, v3, 9, v8
    v_add_u32 v8, 3, v3
    v_and_b32 v8, 7, v8
    v_lshlrev_b32 v8, 6, v8
    v_lshl_add_u32 v8, v4, 4, v8
    v_lshl_add_u32 v19, v3, 9, v8
    v_add_u32 v8, 4, v3
    v_and_b32 v8, 7, v8
    v_lshlrev_b32 v8, 6, v8
    v_lshl_add_u32 v8, v4, 4, v8
    v_lshl_add_u32 v20, v3, 9, v8
    v_add_u32 v8, 5, v3
    v_and_b32 v8, 7, v8
    v_lshlrev_b32 v8, 6, v8
    v_lshl_add_u32 v8, v4, 4, v8
    v_lshl_add_u32 v21, v3, 9, v8
    v_add_u32 v8, 6, v3
    v_and_b32 v8, 7, v8
    v_lshlrev_b32 v8, 6, v8
    v_lshl_add_u32 v8, v4, 4, v8
    v_lshl_add_u32 v22, v3, 9, v8
    v_add_u32 v8, 7, v3
    v_and_b32 v8, 7, v8
    v_lshlrev_b32 v8, 6, v8
    v_lshl_add_u32 v8, v4, 4, v8
    v_lshl_add_u32 v23, v3, 9, v8
    ds_read_b128 v[32:35], v16 offset:0
    ds_read_b128 v[36:39], v17 offset:0
    ds_read_b128 v[40:43], v18 offset:0
    ds_read_b128 v[44:47], v19 offset:0
    ds_read_b128 v[48:51], v20 offset:0
    ds_read_b128 v[52:55], v21 offset:0
    ds_read_b128 v[56:59], v22 offset:0
    ds_read_b128 v[60:63], v23 offset:0
    s_waitcnt lgkmcnt(6)
    ds_read_b128 v[64:67], v16 offset:8192
    ds_read_b128 v[68:71], v17 offset:8192
    ds_read_b128 v[72:75], v18 offset:8192
    ds_read_b128 v[76:79], v19 offset:8192
    ds_read_b128 v[80:83], v20 offset:8192
    ds_read_b128 v[84:87], v21 offset:8192
    ds_read_b128 v[88:91], v22 offset:8192
    ds_read_b128 v[92:95], v23 offset:8192
    s_waitcnt lgkmcnt(6)
    ds_read_b128 v[96:99], v16 offset:16384
    ds_read_b128 v[100:103], v17 offset:16384
    ds_read_b128 v[104:107], v18 offset:16384
    ds_read_b128 v[108:111], v19 offset:16384
    ds_read_b128 v[112:115], v20 offset:16384
    ds_read_b128 v[116:119], v21 offset:16384
    ds_read_b128 v[120:123], v22 offset:16384
    ds_read_b128 v[124:127], v23 offset:16384
    s_waitcnt lgkmcnt(6)
    ds_read_b128 v[128:131], v16 offset:24576
    ds_read_b128 v[132:135], v17 offset:24576
    ds_read_b128 v[136:139], v18 offset:24576
    ds_read_b128 v[140:143], v19 offset:24576
    ds_read_b128 v[144:147], v20 offset:24576
    ds_read_b128 v[148:151], v21 offset:24576
    ds_read_b128 v[152:155], v22 offset:24576
    ds_read_b128 v[156:159], v23 offset:24576
    s_waitcnt lgkmcnt(6)
    ds_read_b128 v[160:163], v16 offset:32768
    ds_read_b128 v[164:167], v17 offset:32768
    ds_read_b128 v[168:171], v18 offset:32768
    ds_read_b128 v[172:175], v19 offset:32768
    ds_read_b128 v[176:179], v20 offset:32768
    ds_read_b128 v[180:183], v21 offset:32768
    ds_read_b128 v[184:187], v22 offset:32768
    ds_read_b128 v[188:191], v23 offset:32768
    s_waitcnt lgkmcnt(6)
    ds_read_b128 v[192:195], v16 offset:40960
    ds_read_b128 v[196:199], v17 offset:40960
    ds_read_b128 v[200:203], v18 offset:40960
    ds_read_b128 v[204:207], v19 offset:40960
    ds_read_b128 v[208:211], v20 offset:40960
    ds_read_b128 v[212:215], v21 offset:40960
    ds_read_b128 v[216:219], v22 offset:40960
    ds_read_b128 v[220:223], v23 offset:40960
    s_waitcnt lgkmcnt(6)
    ds_read_b128 v[224:227], v16 offset:49152
    ds_read_b128 v[228:231], v17 offset:49152
    ds_read_b128 v[232:235], v18 offset:49152
    ds_read_b128 v[236:239], v19 offset:49152
    ds_read_b128 v[240:243], v20 offset:49152
    ds_read_b128 v[244:247], v21 offset:49152
    ds_read_b128 v[248:251], v22 offset:49152
    ds_read_b128 v[252:255], v23 offset:49152
    s_waitcnt lgkmcnt(6)
    s_branch guB_12
guU_11:
    v_lshrrev_b32 v7, 2, v3
    v_sub_u32 v7, v7, v4
    v_and_b32 v7, 3, v7
    v_lshlrev_b32 v7, 6, v7
    v_and_b32 v8, 3, v3
    v_lshl_add_u32 v7, v8, 4, v7
    v_mul_u32_u24 v8, 896, v4
    v_add_u32 v16, v7, v8
    v_mov_b32 v17, v16
    s_mul_i32 s16, s25, 224
    s_and_b32 s16, s16, 0xffffffc0
    s_mul_i32 s18, s24, 229376
    s_add_u32 s16, s16, s18
    s_mul_i32 s18, s27, 57344
    s_add_u32 s16, s16, s18
    s_lshl_b32 s19, s27, 14
    s_add_u32 m0, s19, 0
    s_add_u32 s18, s16, 0
    buffer_load_dwordx4 v16, s[12:15], s18 offen lds
    s_add_u32 m0, s19, 1024
    s_add_u32 s18, s16, 3584
    buffer_load_dwordx4 v17, s[12:15], s18 offen lds
    s_add_u32 m0, s19, 2048
    s_add_u32 s18, s16, 7168
    buffer_load_dwordx4 v16, s[12:15], s18 offen lds
    s_add_u32 m0, s19, 3072
    s_add_u32 s18, s16, 10752
    buffer_load_dwordx4 v17, s[12:15], s18 offen lds
    s_add_u32 m0, s19, 4096
    s_add_u32 s18, s16, 14336
    buffer_load_dwordx4 v16, s[12:15], s18 offen lds
    s_add_u32 m0, s19, 5120
    s_add_u32 s18, s16, 17920
    buffer_load_dwordx4 v17, s[12:15], s18 offen lds
    s_add_u32 m0, s19, 6144
    s_add_u32 s18, s16, 21504
    buffer_load_dwordx4 v16, s[12:15], s18 offen lds
    s_add_u32 m0, s19, 7168
    s_add_u32 s18, s16, 25088
    buffer_load_dwordx4 v17, s[12:15], s18 offen lds
    s_add_u32 m0, s19, 8192
    s_add_u32 s18, s16, 28672
    buffer_load_dwordx4 v16, s[12:15], s18 offen lds
    s_add_u32 m0, s19, 9216
    s_add_u32 s18, s16, 32256
    buffer_load_dwordx4 v17, s[12:15], s18 offen lds
    s_add_u32 m0, s19, 10240
    s_add_u32 s18, s16, 35840
    buffer_load_dwordx4 v16, s[12:15], s18 offen lds
    s_add_u32 m0, s19, 11264
    s_add_u32 s18, s16, 39424
    buffer_load_dwordx4 v17, s[12:15], s18 offen lds
    s_add_u32 m0, s19, 12288
    s_add_u32 s18, s16, 43008
    buffer_load_dwordx4 v16, s[12:15], s18 offen lds
    s_add_u32 m0, s19, 13312
    s_add_u32 s18, s16, 46592
    buffer_load_dwordx4 v17, s[12:15], s18 offen lds
    s_add_u32 m0, s19, 14336
    s_add_u32 s18, s16, 50176
    buffer_load_dwordx4 v16, s[12:15], s18 offen lds
    s_add_u32 m0, s19, 15360
    s_add_u32 s18, s16, 53760
    buffer_load_dwordx4 v17, s[12:15], s18 offen lds
    s_cmp_ge_u32 s75, 32
    s_cbranch_scc1 nolnh_21
    s_load_dwordx2 s[96:97], s[0:1], 120
    s_mov_b32 s90, 0
    v_and_b32 v60, 7, v0
    v_lshlrev_b32 v60, 2, v60
    s_waitcnt lgkmcnt(0)
reg0_22:
    global_load_dword v61, v60, s[96:97] sc1
    s_waitcnt vmcnt(0)
    v_readlane_b32 s64, v61, 0
    v_readlane_b32 s65, v61, 1
    v_readlane_b32 s66, v61, 2
    v_readlane_b32 s67, v61, 3
    v_readlane_b32 s68, v61, 4
    v_readlane_b32 s69, v61, 5
    v_readlane_b32 s70, v61, 6
    v_readlane_b32 s71, v61, 7
    s_nop 3
    s_add_u32 s91, s64, s65
    s_add_u32 s91, s91, s66
    s_add_u32 s91, s91, s67
    s_add_u32 s91, s91, s68
    s_add_u32 s91, s91, s69
    s_add_u32 s91, s91, s70
    s_add_u32 s91, s91, s71
    s_cmp_ge_u32 s91, 256
    s_cbranch_scc1 reg0ok_23
    s_sleep 2
    s_add_u32 s90, s90, 1
    s_cmp_lt_u32 s90, 400000
    s_cbranch_scc1 reg0_22
    s_branch L_abort
reg0ok_23:
    s_cmp_ge_u32 s75, 256
    s_cbranch_scc1 noln_24
    s_mov_b32 s91, 64
    s_cmp_lg_u32 s87, 0
    s_cbranch_scc1 wsk_27
    s_load_dwordx2 s[96:97], s[0:1], 120
    s_waitcnt lgkmcnt(0)
    s_mov_b32 s90, 0
    v_mov_b32 v60, s91
wge_25:
    global_load_dword v61, v60, s[96:97] sc1
    s_waitcnt vmcnt(0)
    v_readfirstlane_b32 s92, v61
    s_nop 3
    s_cmp_ge_u32 s92, 14
    s_cbranch_scc1 wok_26
    s_sleep 2
    s_add_u32 s90, s90, 1
    s_cmp_lt_u32 s90, 400000
    s_cbranch_scc1 wge_25
    s_branch L_abort
wok_26:
wsk_27:
    s_barrier
    s_mov_b32 s3, s75
    v_and_b32 v1, 63, v0
    v_lshrrev_b32 v2, 6, v0
    s_nop 0
    v_readfirstlane_b32 s16, v2
    v_min_u32 v3, 55, v1
    v_lshrrev_b32 v4, 1, v3
    v_lshlrev_b32 v4, 4, v4
    v_and_b32 v5, 1, v3
    v_lshl_add_u32 v4, v5, 2, v4
    v_mul_u32_u24 v4, 2, v4
    v_lshlrev_b32 v5, 1, v4
    s_mov_b32 s21, 87054080
    buffer_load_dwordx4 v[40:43], v5, s[4:7], s21 offen sc1
    buffer_load_dwordx4 v[44:47], v5, s[4:7], s21 offen offset:32 sc1
    s_mov_b32 s21, 87052288
    buffer_load_dwordx4 v[48:51], v5, s[4:7], s21 offen sc1
    buffer_load_dwordx4 v[52:55], v5, s[4:7], s21 offen offset:32 sc1
    s_lshl_b32 s17, s3, 3
    s_lshl_b32 s16, s16, 1
    s_add_u32 s17, s17, s16
    s_mul_i32 s18, s17, 896
    v_accvgpr_read_b32 v8, a248
    v_accvgpr_read_b32 v9, a249
    v_accvgpr_read_b32 v10, a250
    v_accvgpr_read_b32 v11, a251
    v_accvgpr_read_b32 v12, a252
    v_accvgpr_read_b32 v13, a253
    v_accvgpr_read_b32 v14, a254
    v_accvgpr_read_b32 v15, a255
    s_mov_b32 s22, -1
    s_mov_b32 s23, 0x00ffffff
    s_waitcnt vmcnt(0)
    v_lshlrev_b32 v16, 16, v8
    v_and_b32 v17, 0xffff0000, v8
    v_lshlrev_b32 v18, 16, v9
    v_and_b32 v19, 0xffff0000, v9
    v_lshlrev_b32 v20, 16, v10
    v_and_b32 v21, 0xffff0000, v10
    v_lshlrev_b32 v22, 16, v11
    v_and_b32 v23, 0xffff0000, v11
    v_cndmask_b32 v16, 0, v16, s[22:23]
    v_cndmask_b32 v17, 0, v17, s[22:23]
    v_cndmask_b32 v18, 0, v18, s[22:23]
    v_cndmask_b32 v19, 0, v19, s[22:23]
    v_cndmask_b32 v20, 0, v20, s[22:23]
    v_cndmask_b32 v21, 0, v21, s[22:23]
    v_cndmask_b32 v22, 0, v22, s[22:23]
    v_cndmask_b32 v23, 0, v23, s[22:23]
    v_lshlrev_b32 v24, 16, v12
    v_and_b32 v25, 0xffff0000, v12
    v_lshlrev_b32 v26, 16, v13
    v_and_b32 v27, 0xffff0000, v13
    v_lshlrev_b32 v28, 16, v14
    v_and_b32 v29, 0xffff0000, v14
    v_lshlrev_b32 v30, 16, v15
    v_and_b32 v31, 0xffff0000, v15
    v_cndmask_b32 v24, 0, v24, s[22:23]
    v_cndmask_b32 v25, 0, v25, s[22:23]
    v_cndmask_b32 v26, 0, v26, s[22:23]
    v_cndmask_b32 v27, 0, v27, s[22:23]
    v_cndmask_b32 v28, 0, v28, s[22:23]
    v_cndmask_b32 v29, 0, v29, s[22:23]
    v_cndmask_b32 v30, 0, v30, s[22:23]
    v_cndmask_b32 v31, 0, v31, s[22:23]
    v_add_f32 v40, 1.0, v40
    v_add_f32 v41, 1.0, v41
    v_cvt_pk_bf16_f32 v6, v40, v41
    v_lshlrev_b32 v40, 16, v6
    v_and_b32 v41, 0xffff0000, v6
    v_add_f32 v42, 1.0, v42
    v_add_f32 v43, 1.0, v43
    v_cvt_pk_bf16_f32 v6, v42, v43
    v_lshlrev_b32 v42, 16, v6
    v_and_b32 v43, 0xffff0000, v6
    v_add_f32 v44, 1.0, v44
    v_add_f32 v45, 1.0, v45
    v_cvt_pk_bf16_f32 v6, v44, v45
    v_lshlrev_b32 v44, 16, v6
    v_and_b32 v45, 0xffff0000, v6
    v_add_f32 v46, 1.0, v46
    v_add_f32 v47, 1.0, v47
    v_cvt_pk_bf16_f32 v6, v46, v47
    v_lshlrev_b32 v46, 16, v6
    v_and_b32 v47, 0xffff0000, v6
    v_add_f32 v32, v16, v17
    v_add_f32 v32, v32, v18
    v_add_f32 v32, v32, v19
    v_add_f32 v32, v32, v20
    v_add_f32 v32, v32, v21
    v_add_f32 v32, v32, v22
    v_add_f32 v32, v32, v23
    v_add_f32 v33, v24, v25
    v_add_f32 v33, v33, v26
    v_add_f32 v33, v33, v27
    v_add_f32 v33, v33, v28
    v_add_f32 v33, v33, v29
    v_add_f32 v33, v33, v30
    v_add_f32 v33, v33, v31
    s_nop 1
    v_add_f32_dpp v32, v32, v32 quad_perm:[1,0,3,2] row_mask:0xf bank_mask:0xf
    v_add_f32_dpp v33, v33, v33 quad_perm:[1,0,3,2] row_mask:0xf bank_mask:0xf
    s_nop 1
    v_add_f32_dpp v32, v32, v32 quad_perm:[2,3,0,1] row_mask:0xf bank_mask:0xf
    v_add_f32_dpp v33, v33, v33 quad_perm:[2,3,0,1] row_mask:0xf bank_mask:0xf
    s_nop 1
    v_add_f32_dpp v32, v32, v32 row_half_mirror row_mask:0xf bank_mask:0xf
    v_add_f32_dpp v33, v33, v33 row_half_mirror row_mask:0xf bank_mask:0xf
    s_nop 1
    v_add_f32_dpp v32, v32, v32 row_mirror row_mask:0xf bank_mask:0xf
    v_add_f32_dpp v33, v33, v33 row_mirror row_mask:0xf bank_mask:0xf
    v_mov_b32 v56, v32
    v_mov_b32 v57, v33
    s_nop 1
    v_permlane16_swap_b32 v32, v56
    v_permlane16_swap_b32 v33, v57
    s_nop 1
    v_add_f32 v32, v32, v56
    v_add_f32 v33, v33, v57
    v_mov_b32 v56, v32
    v_mov_b32 v57, v33
    s_nop 1
    v_permlane32_swap_b32 v32, v56
    v_permlane32_swap_b32 v33, v57
    s_nop 1
    v_add_f32 v32, v32, v56
    v_add_f32 v33, v33, v57
    s_mov_b32 s20, 0x3b124925
    v_mul_f32 v32, s20, v32
    v_mul_f32 v33, s20, v33
    v_sub_f32 v56, v16, v32
    v_mul_f32 v34, v56, v56
    v_sub_f32 v56, v17, v32
    v_fmac_f32 v34, v56, v56
    v_sub_f32 v56, v18, v32
    v_fmac_f32 v34, v56, v56
    v_sub_f32 v56, v19, v32
    v_fmac_f32 v34, v56, v56
    v_sub_f32 v56, v20, v32
    v_fmac_f32 v34, v56, v56
    v_sub_f32 v56, v21, v32
    v_fmac_f32 v34, v56, v56
    v_sub_f32 v56, v22, v32
    v_fmac_f32 v34, v56, v56
    v_sub_f32 v56, v23, v32
    v_fmac_f32 v34, v56, v56
    v_cndmask_b32 v34, 0, v34, s[22:23]
    v_sub_f32 v56, v24, v33
    v_mul_f32 v35, v56, v56
    v_sub_f32 v56, v25, v33
    v_fmac_f32 v35, v56, v56
    v_sub_f32 v56, v26, v33
    v_fmac_f32 v35, v56, v56
    v_sub_f32 v56, v27, v33
    v_fmac_f32 v35, v56, v56
    v_sub_f32 v56, v28, v33
    v_fmac_f32 v35, v56, v56
    v_sub_f32 v56, v29, v33
    v_fmac_f32 v35, v56, v56
    v_sub_f32 v56, v30, v33
    v_fmac_f32 v35, v56, v56
    v_sub_f32 v56, v31, v33
    v_fmac_f32 v35, v56, v56
    v_cndmask_b32 v35, 0, v35, s[22:23]
    s_nop 1
    v_add_f32_dpp v34, v34, v34 quad_perm:[1,0,3,2] row_mask:0xf bank_mask:0xf
    v_add_f32_dpp v35, v35, v35 quad_perm:[1,0,3,2] row_mask:0xf bank_mask:0xf
    s_nop 1
    v_add_f32_dpp v34, v34, v34 quad_perm:[2,3,0,1] row_mask:0xf bank_mask:0xf
    v_add_f32_dpp v35, v35, v35 quad_perm:[2,3,0,1] row_mask:0xf bank_mask:0xf
    s_nop 1
    v_add_f32_dpp v34, v34, v34 row_half_mirror row_mask:0xf bank_mask:0xf
    v_add_f32_dpp v35, v35, v35 row_half_mirror row_mask:0xf bank_mask:0xf
    s_nop 1
    v_add_f32_dpp v34, v34, v34 row_mirror row_mask:0xf bank_mask:0xf
    v_add_f32_dpp v35, v35, v35 row_mirror row_mask:0xf bank_mask:0xf
    v_mov_b32 v56, v34
    v_mov_b32 v57, v35
    s_nop 1
    v_permlane16_swap_b32 v34, v56
    v_permlane16_swap_b32 v35, v57
    s_nop 1
    v_add_f32 v34, v34, v56
    v_add_f32 v35, v35, v57
    v_mov_b32 v56, v34
    v_mov_b32 v57, v35
    s_nop 1
    v_permlane32_swap_b32 v34, v56
    v_permlane32_swap_b32 v35, v57
    s_nop 1
    v_add_f32 v34, v34, v56
    v_add_f32 v35, v35, v57
    v_mul_f32 v34, s20, v34
    v_cvt_pk_bf16_f32 v56, v32, v34
    v_lshlrev_b32 v32, 16, v56
    v_and_b32 v34, 0xffff0000, v56
    v_add_f32 v34, 0x3727c5ac, v34
    v_cvt_pk_bf16_f32 v56, v34, v34
    v_lshlrev_b32 v34, 16, v56
    v_sqrt_f32 v34, v34
    s_nop 0
    v_cvt_pk_bf16_f32 v56, v34, v34
    v_lshlrev_b32 v34, 16, v56
    v_rcp_f32 v34, v34
    s_nop 0
    v_mul_f32 v35, s20, v35
    v_cvt_pk_bf16_f32 v56, v33, v35
    v_lshlrev_b32 v33, 16, v56
    v_and_b32 v35, 0xffff0000, v56
    v_add_f32 v35, 0x3727c5ac, v35
    v_cvt_pk_bf16_f32 v56, v35, v35
    v_lshlrev_b32 v35, 16, v56
    v_sqrt_f32 v35, v35
    s_nop 0
    v_cvt_pk_bf16_f32 v56, v35, v35
    v_lshlrev_b32 v35, 16, v56
    v_rcp_f32 v35, v35
    s_nop 0
    v_sub_f32 v16, v16, v32
    v_sub_f32 v17, v17, v32
    v_cvt_pk_bf16_f32 v56, v16, v17
    v_lshlrev_b32 v16, 16, v56
    v_and_b32 v17, 0xffff0000, v56
    v_mul_f32 v16, v16, v34
    v_mul_f32 v17, v17, v34
    v_cvt_pk_bf16_f32 v56, v16, v17
    v_lshlrev_b32 v16, 16, v56
    v_and_b32 v17, 0xffff0000, v56
    v_mul_f32 v16, v16, v40
    v_mul_f32 v17, v17, v41
    v_cvt_pk_bf16_f32 v56, v16, v17
    v_lshlrev_b32 v16, 16, v56
    v_and_b32 v17, 0xffff0000, v56
    v_add_f32 v16, v16, v48
    v_add_f32 v17, v17, v49
    v_sub_f32 v18, v18, v32
    v_sub_f32 v19, v19, v32
    v_cvt_pk_bf16_f32 v56, v18, v19
    v_lshlrev_b32 v18, 16, v56
    v_and_b32 v19, 0xffff0000, v56
    v_mul_f32 v18, v18, v34
    v_mul_f32 v19, v19, v34
    v_cvt_pk_bf16_f32 v56, v18, v19
    v_lshlrev_b32 v18, 16, v56
    v_and_b32 v19, 0xffff0000, v56
    v_mul_f32 v18, v18, v42
    v_mul_f32 v19, v19, v43
    v_cvt_pk_bf16_f32 v56, v18, v19
    v_lshlrev_b32 v18, 16, v56
    v_and_b32 v19, 0xffff0000, v56
    v_add_f32 v18, v18, v50
    v_add_f32 v19, v19, v51
    v_sub_f32 v20, v20, v32
    v_sub_f32 v21, v21, v32
    v_cvt_pk_bf16_f32 v56, v20, v21
    v_lshlrev_b32 v20, 16, v56
    v_and_b32 v21, 0xffff0000, v56
    v_mul_f32 v20, v20, v34
    v_mul_f32 v21, v21, v34
    v_cvt_pk_bf16_f32 v56, v20, v21
    v_lshlrev_b32 v20, 16, v56
    v_and_b32 v21, 0xffff0000, v56
    v_mul_f32 v20, v20, v44
    v_mul_f32 v21, v21, v45
    v_cvt_pk_bf16_f32 v56, v20, v21
    v_lshlrev_b32 v20, 16, v56
    v_and_b32 v21, 0xffff0000, v56
    v_add_f32 v20, v20, v52
    v_add_f32 v21, v21, v53
    v_sub_f32 v22, v22, v32
    v_sub_f32 v23, v23, v32
    v_cvt_pk_bf16_f32 v56, v22, v23
    v_lshlrev_b32 v22, 16, v56
    v_and_b32 v23, 0xffff0000, v56
    v_mul_f32 v22, v22, v34
    v_mul_f32 v23, v23, v34
    v_cvt_pk_bf16_f32 v56, v22, v23
    v_lshlrev_b32 v22, 16, v56
    v_and_b32 v23, 0xffff0000, v56
    v_mul_f32 v22, v22, v46
    v_mul_f32 v23, v23, v47
    v_cvt_pk_bf16_f32 v56, v22, v23
    v_lshlrev_b32 v22, 16, v56
    v_and_b32 v23, 0xffff0000, v56
    v_add_f32 v22, v22, v54
    v_add_f32 v23, v23, v55
    v_sub_f32 v24, v24, v33
    v_sub_f32 v25, v25, v33
    v_cvt_pk_bf16_f32 v56, v24, v25
    v_lshlrev_b32 v24, 16, v56
    v_and_b32 v25, 0xffff0000, v56
    v_mul_f32 v24, v24, v35
    v_mul_f32 v25, v25, v35
    v_cvt_pk_bf16_f32 v56, v24, v25
    v_lshlrev_b32 v24, 16, v56
    v_and_b32 v25, 0xffff0000, v56
    v_mul_f32 v24, v24, v40
    v_mul_f32 v25, v25, v41
    v_cvt_pk_bf16_f32 v56, v24, v25
    v_lshlrev_b32 v24, 16, v56
    v_and_b32 v25, 0xffff0000, v56
    v_add_f32 v24, v24, v48
    v_add_f32 v25, v25, v49
    v_sub_f32 v26, v26, v33
    v_sub_f32 v27, v27, v33
    v_cvt_pk_bf16_f32 v56, v26, v27
    v_lshlrev_b32 v26, 16, v56
    v_and_b32 v27, 0xffff0000, v56
    v_mul_f32 v26, v26, v35
    v_mul_f32 v27, v27, v35
    v_cvt_pk_bf16_f32 v56, v26, v27
    v_lshlrev_b32 v26, 16, v56
    v_and_b32 v27, 0xffff0000, v56
    v_mul_f32 v26, v26, v42
    v_mul_f32 v27, v27, v43
    v_cvt_pk_bf16_f32 v56, v26, v27
    v_lshlrev_b32 v26, 16, v56
    v_and_b32 v27, 0xffff0000, v56
    v_add_f32 v26, v26, v50
    v_add_f32 v27, v27, v51
    v_sub_f32 v28, v28, v33
    v_sub_f32 v29, v29, v33
    v_cvt_pk_bf16_f32 v56, v28, v29
    v_lshlrev_b32 v28, 16, v56
    v_and_b32 v29, 0xffff0000, v56
    v_mul_f32 v28, v28, v35
    v_mul_f32 v29, v29, v35
    v_cvt_pk_bf16_f32 v56, v28, v29
    v_lshlrev_b32 v28, 16, v56
    v_and_b32 v29, 0xffff0000, v56
    v_mul_f32 v28, v28, v44
    v_mul_f32 v29, v29, v45
    v_cvt_pk_bf16_f32 v56, v28, v29
    v_lshlrev_b32 v28, 16, v56
    v_and_b32 v29, 0xffff0000, v56
    v_add_f32 v28, v28, v52
    v_add_f32 v29, v29, v53
    v_sub_f32 v30, v30, v33
    v_sub_f32 v31, v31, v33
    v_cvt_pk_bf16_f32 v56, v30, v31
    v_lshlrev_b32 v30, 16, v56
    v_and_b32 v31, 0xffff0000, v56
    v_mul_f32 v30, v30, v35
    v_mul_f32 v31, v31, v35
    v_cvt_pk_bf16_f32 v56, v30, v31
    v_lshlrev_b32 v30, 16, v56
    v_and_b32 v31, 0xffff0000, v56
    v_mul_f32 v30, v30, v46
    v_mul_f32 v31, v31, v47
    v_cvt_pk_bf16_f32 v56, v30, v31
    v_lshlrev_b32 v30, 16, v56
    v_and_b32 v31, 0xffff0000, v56
    v_add_f32 v30, v30, v54
    v_add_f32 v31, v31, v55
    s_lshr_b32 s18, s17, 5
    s_mul_i32 s18, s18, 28672
    s_and_b32 s19, s17, 31
    s_lshl_b32 s19, s19, 4
    s_add_u32 s18, s18, s19
    s_add_u32 s18, s18, 12845056
    v_lshlrev_b32 v6, 9, v3
    s_mov_b64 exec, s[22:23]
    v_cvt_pk_bf16_f32 v8, v16, v17
    v_cvt_pk_bf16_f32 v9, v18, v19
    v_cvt_pk_bf16_f32 v10, v20, v21
    v_cvt_pk_bf16_f32 v11, v22, v23
    buffer_store_dwordx4 v[8:11], v6, s[4:7], s18 offen offset:0 sc1
    v_cvt_pk_bf16_f32 v12, v24, v25
    v_cvt_pk_bf16_f32 v13, v26, v27
    v_cvt_pk_bf16_f32 v14, v28, v29
    v_cvt_pk_bf16_f32 v15, v30, v31
    buffer_store_dwordx4 v[12:15], v6, s[4:7], s18 offen offset:16 sc1
    s_mov_b64 exec, -1
    s_lshr_b32 s93, s75, 4
    s_lshl_b32 s93, s93, 6
    s_add_u32 s93, s93, 90975232
    s_waitcnt vmcnt(0)
    s_barrier
    s_cmp_lg_u32 s87, 0
    s_cbranch_scc1 sig_28
    v_mov_b32 v250, 0
    v_mov_b32 v251, 1
    s_mov_b64 exec, 1
    buffer_atomic_add v251, v250, s[4:7], s93 offen
    s_mov_b64 exec, -1
sig_28:
noln_24:
    s_mov_b32 s75, 256
nolnh_21:
    v_and_b32 v1, 63, v0
    v_and_b32 v3, 15, v1
    v_lshrrev_b32 v4, 4, v1
    v_lshrrev_b32 v5, 5, v1
    v_and_b32 v6, 31, v1
    s_cmp_eq_u32 s28, 1
    s_cselect_b32 s16, 32, 16
    s_load_dwordx2 s[8:9], s[0:1], s16
    s_waitcnt lgkmcnt(0)
    s_and_b32 s9, s9, 0xffff
    s_mov_b32 s10, 3670016
    s_mov_b32 s11, 0x20000
    s_waitcnt vmcnt(0)
    s_barrier
    v_bfe_u32 v7, v1, 2, 2
    v_lshlrev_b32 v8, 3, v4
    v_add_u32 v8, v8, v7
    v_lshlrev_b32 v8, 8, v8
    v_and_b32 v9, 1, v1
    v_lshl_add_u32 v8, v9, 3, v8
    v_bfe_u32 v9, v1, 1, 1
    s_and_b32 s16, s25, 1
    s_lshl_b32 s16, s16, 1
    v_add_u32 v9, s16, v9
    v_add_u32 v10, 0, v9
    v_lshrrev_b32 v11, 2, v10
    v_add_u32 v11, v11, v7
    v_and_b32 v11, 3, v11
    v_lshlrev_b32 v11, 6, v11
    v_and_b32 v10, 3, v10
    v_lshl_add_u32 v11, v10, 4, v11
    v_add_u32 v16, v11, v8
    v_add_u32 v10, 2, v9
    v_lshrrev_b32 v11, 2, v10
    v_add_u32 v11, v11, v7
    v_and_b32 v11, 3, v11
    v_lshlrev_b32 v11, 6, v11
    v_and_b32 v10, 3, v10
    v_lshl_add_u32 v11, v10, 4, v11
    v_add_u32 v17, v11, v8
    v_add_u32 v10, 4, v9
    v_lshrrev_b32 v11, 2, v10
    v_add_u32 v11, v11, v7
    v_and_b32 v11, 3, v11
    v_lshlrev_b32 v11, 6, v11
    v_and_b32 v10, 3, v10
    v_lshl_add_u32 v11, v10, 4, v11
    v_add_u32 v18, v11, v8
    v_add_u32 v10, 6, v9
    v_lshrrev_b32 v11, 2, v10
    v_add_u32 v11, v11, v7
    v_and_b32 v11, 3, v11
    v_lshlrev_b32 v11, 6, v11
    v_and_b32 v10, 3, v10
    v_lshl_add_u32 v11, v10, 4, v11
    v_add_u32 v19, v11, v8
    v_add_u32 v10, 8, v9
    v_lshrrev_b32 v11, 2, v10
    v_add_u32 v11, v11, v7
    v_and_b32 v11, 3, v11
    v_lshlrev_b32 v11, 6, v11
    v_and_b32 v10, 3, v10
    v_lshl_add_u32 v11, v10, 4, v11
    v_add_u32 v20, v11, v8
    v_add_u32 v10, 10, v9
    v_lshrrev_b32 v11, 2, v10
    v_add_u32 v11, v11, v7
    v_and_b32 v11, 3, v11
    v_lshlrev_b32 v11, 6, v11
    v_and_b32 v10, 3, v10
    v_lshl_add_u32 v11, v10, 4, v11
    v_add_u32 v21, v11, v8
    v_add_u32 v10, 12, v9
    v_lshrrev_b32 v11, 2, v10
    v_add_u32 v11, v11, v7
    v_and_b32 v11, 3, v11
    v_lshlrev_b32 v11, 6, v11
    v_and_b32 v10, 3, v10
    v_lshl_add_u32 v11, v10, 4, v11
    v_add_u32 v22, v11, v8
    ds_read_b64_tr_b16 v[32:33], v16 offset:0
    ds_read_b64_tr_b16 v[34:35], v16 offset:1024
    ds_read_b64_tr_b16 v[36:37], v16 offset:8192
    ds_read_b64_tr_b16 v[38:39], v16 offset:9216
    ds_read_b64_tr_b16 v[40:41], v16 offset:16384
    ds_read_b64_tr_b16 v[42:43], v16 offset:17408
    ds_read_b64_tr_b16 v[44:45], v16 offset:24576
    ds_read_b64_tr_b16 v[46:47], v16 offset:25600
    s_waitcnt lgkmcnt(6)
    ds_read_b64_tr_b16 v[48:49], v16 offset:32768
    ds_read_b64_tr_b16 v[50:51], v16 offset:33792
    ds_read_b64_tr_b16 v[52:53], v16 offset:40960
    ds_read_b64_tr_b16 v[54:55], v16 offset:41984
    ds_read_b64_tr_b16 v[56:57], v16 offset:49152
    ds_read_b64_tr_b16 v[58:59], v16 offset:50176
    ds_read_b64_tr_b16 v[60:61], v16 offset:57344
    ds_read_b64_tr_b16 v[62:63], v16 offset:58368
    s_waitcnt lgkmcnt(6)
    ds_read_b64_tr_b16 v[64:65], v17 offset:0
    ds_read_b64_tr_b16 v[66:67], v17 offset:1024
    ds_read_b64_tr_b16 v[68:69], v17 offset:8192
    ds_read_b64_tr_b16 v[70:71], v17 offset:9216
    ds_read_b64_tr_b16 v[72:73], v17 offset:16384
    ds_read_b64_tr_b16 v[74:75], v17 offset:17408
    ds_read_b64_tr_b16 v[76:77], v17 offset:24576
    ds_read_b64_tr_b16 v[78:79], v17 offset:25600
    s_waitcnt lgkmcnt(6)
    ds_read_b64_tr_b16 v[80:81], v17 offset:32768
    ds_read_b64_tr_b16 v[82:83], v17 offset:33792
    ds_read_b64_tr_b16 v[84:85], v17 offset:40960
    ds_read_b64_tr_b16 v[86:87], v17 offset:41984
    ds_read_b64_tr_b16 v[88:89], v17 offset:49152
    ds_read_b64_tr_b16 v[90:91], v17 offset:50176
    ds_read_b64_tr_b16 v[92:93], v17 offset:57344
    ds_read_b64_tr_b16 v[94:95], v17 offset:58368
    s_waitcnt lgkmcnt(6)
    ds_read_b64_tr_b16 v[96:97], v18 offset:0
    ds_read_b64_tr_b16 v[98:99], v18 offset:1024
    ds_read_b64_tr_b16 v[100:101], v18 offset:8192
    ds_read_b64_tr_b16 v[102:103], v18 offset:9216
    ds_read_b64_tr_b16 v[104:105], v18 offset:16384
    ds_read_b64_tr_b16 v[106:107], v18 offset:17408
    ds_read_b64_tr_b16 v[108:109], v18 offset:24576
    ds_read_b64_tr_b16 v[110:111], v18 offset:25600
    s_waitcnt lgkmcnt(6)
    ds_read_b64_tr_b16 v[112:113], v18 offset:32768
    ds_read_b64_tr_b16 v[114:115], v18 offset:33792
    ds_read_b64_tr_b16 v[116:117], v18 offset:40960
    ds_read_b64_tr_b16 v[118:119], v18 offset:41984
    ds_read_b64_tr_b16 v[120:121], v18 offset:49152
    ds_read_b64_tr_b16 v[122:123], v18 offset:50176
    ds_read_b64_tr_b16 v[124:125], v18 offset:57344
    ds_read_b64_tr_b16 v[126:127], v18 offset:58368
    s_waitcnt lgkmcnt(6)
    ds_read_b64_tr_b16 v[128:129], v19 offset:0
    ds_read_b64_tr_b16 v[130:131], v19 offset:1024
    ds_read_b64_tr_b16 v[132:133], v19 offset:8192
    ds_read_b64_tr_b16 v[134:135], v19 offset:9216
    ds_read_b64_tr_b16 v[136:137], v19 offset:16384
    ds_read_b64_tr_b16 v[138:139], v19 offset:17408
    ds_read_b64_tr_b16 v[140:141], v19 offset:24576
    ds_read_b64_tr_b16 v[142:143], v19 offset:25600
    s_waitcnt lgkmcnt(6)
    ds_read_b64_tr_b16 v[144:145], v19 offset:32768
    ds_read_b64_tr_b16 v[146:147], v19 offset:33792
    ds_read_b64_tr_b16 v[148:149], v19 offset:40960
    ds_read_b64_tr_b16 v[150:151], v19 offset:41984
    ds_read_b64_tr_b16 v[152:153], v19 offset:49152
    ds_read_b64_tr_b16 v[154:155], v19 offset:50176
    ds_read_b64_tr_b16 v[156:157], v19 offset:57344
    ds_read_b64_tr_b16 v[158:159], v19 offset:58368
    s_waitcnt lgkmcnt(6)
    ds_read_b64_tr_b16 v[160:161], v20 offset:0
    ds_read_b64_tr_b16 v[162:163], v20 offset:1024
    ds_read_b64_tr_b16 v[164:165], v20 offset:8192
    ds_read_b64_tr_b16 v[166:167], v20 offset:9216
    ds_read_b64_tr_b16 v[168:169], v20 offset:16384
    ds_read_b64_tr_b16 v[170:171], v20 offset:17408
    ds_read_b64_tr_b16 v[172:173], v20 offset:24576
    ds_read_b64_tr_b16 v[174:175], v20 offset:25600
    s_waitcnt lgkmcnt(6)
    ds_read_b64_tr_b16 v[176:177], v20 offset:32768
    ds_read_b64_tr_b16 v[178:179], v20 offset:33792
    ds_read_b64_tr_b16 v[180:181], v20 offset:40960
    ds_read_b64_tr_b16 v[182:183], v20 offset:41984
    ds_read_b64_tr_b16 v[184:185], v20 offset:49152
    ds_read_b64_tr_b16 v[186:187], v20 offset:50176
    ds_read_b64_tr_b16 v[188:189], v20 offset:57344
    ds_read_b64_tr_b16 v[190:191], v20 offset:58368
    s_waitcnt lgkmcnt(6)
    ds_read_b64_tr_b16 v[192:193], v21 offset:0
    ds_read_b64_tr_b16 v[194:195], v21 offset:1024
    ds_read_b64_tr_b16 v[196:197], v21 offset:8192
    ds_read_b64_tr_b16 v[198:199], v21 offset:9216
    ds_read_b64_tr_b16 v[200:201], v21 offset:16384
    ds_read_b64_tr_b16 v[202:203], v21 offset:17408
    ds_read_b64_tr_b16 v[204:205], v21 offset:24576
    ds_read_b64_tr_b16 v[206:207], v21 offset:25600
    s_waitcnt lgkmcnt(6)
    ds_read_b64_tr_b16 v[208:209], v21 offset:32768
    ds_read_b64_tr_b16 v[210:211], v21 offset:33792
    ds_read_b64_tr_b16 v[212:213], v21 offset:40960
    ds_read_b64_tr_b16 v[214:215], v21 offset:41984
    ds_read_b64_tr_b16 v[216:217], v21 offset:49152
    ds_read_b64_tr_b16 v[218:219], v21 offset:50176
    ds_read_b64_tr_b16 v[220:221], v21 offset:57344
    ds_read_b64_tr_b16 v[222:223], v21 offset:58368
    s_waitcnt lgkmcnt(6)
    ds_read_b64_tr_b16 v[224:225], v22 offset:0
    ds_read_b64_tr_b16 v[226:227], v22 offset:1024
    ds_read_b64_tr_b16 v[228:229], v22 offset:8192
    ds_read_b64_tr_b16 v[230:231], v22 offset:9216
    ds_read_b64_tr_b16 v[232:233], v22 offset:16384
    ds_read_b64_tr_b16 v[234:235], v22 offset:17408
    ds_read_b64_tr_b16 v[236:237], v22 offset:24576
    ds_read_b64_tr_b16 v[238:239], v22 offset:25600
    s_waitcnt lgkmcnt(6)
    ds_read_b64_tr_b16 v[240:241], v22 offset:32768
    ds_read_b64_tr_b16 v[242:243], v22 offset:33792
    ds_read_b64_tr_b16 v[244:245], v22 offset:40960
    ds_read_b64_tr_b16 v[246:247], v22 offset:41984
    ds_read_b64_tr_b16 v[248:249], v22 offset:49152
    ds_read_b64_tr_b16 v[250:251], v22 offset:50176
    ds_read_b64_tr_b16 v[252:253], v22 offset:57344
    ds_read_b64_tr_b16 v[254:255], v22 offset:58368
    s_waitcnt lgkmcnt(6)
guB_12:
    v_lshrrev_b32 v5, 2, v3
    v_lshlrev_b32 v5, 3, v5
    v_and_b32 v6, 1, v3
    v_add_u32 v5, v5, v6
    v_bfe_u32 v6, v3, 1, 1
    v_lshl_add_u32 v5, v6, 2, v5
    v_lshlrev_b32 v5, 9, v5
    v_add_u32 v5, s30, v5
    v_add_u32 v8, 0, v3
    v_and_b32 v8, 7, v8
    v_lshlrev_b32 v8, 6, v8
    v_lshl_add_u32 v8, v4, 4, v8
    v_add_u32 v16, v8, v5
    v_add_u32 v8, 1, v3
    v_and_b32 v8, 7, v8
    v_lshlrev_b32 v8, 6, v8
    v_lshl_add_u32 v8, v4, 4, v8
    v_add_u32 v17, v8, v5
    v_add_u32 v8, 2, v3
    v_and_b32 v8, 7, v8
    v_lshlrev_b32 v8, 6, v8
    v_lshl_add_u32 v8, v4, 4, v8
    v_add_u32 v18, v8, v5
    v_add_u32 v8, 3, v3
    v_and_b32 v8, 7, v8
    v_lshlrev_b32 v8, 6, v8
    v_lshl_add_u32 v8, v4, 4, v8
    v_add_u32 v19, v8, v5
    v_add_u32 v8, 4, v3
    v_and_b32 v8, 7, v8
    v_lshlrev_b32 v8, 6, v8
    v_lshl_add_u32 v8, v4, 4, v8
    v_add_u32 v20, v8, v5
    v_add_u32 v8, 5, v3
    v_and_b32 v8, 7, v8
    v_lshlrev_b32 v8, 6, v8
    v_lshl_add_u32 v8, v4, 4, v8
    v_add_u32 v21, v8, v5
    v_add_u32 v8, 6, v3
    v_and_b32 v8, 7, v8
    v_lshlrev_b32 v8, 6, v8
    v_lshl_add_u32 v8, v4, 4, v8
    v_add_u32 v22, v8, v5
    v_add_u32 v8, 7, v3
    v_and_b32 v8, 7, v8
    v_lshlrev_b32 v8, 6, v8
    v_lshl_add_u32 v8, v4, 4, v8
    v_add_u32 v23, v8, v5
    ds_read_b128 a[0:3], v16 offset:0
    ds_read_b128 a[4:7], v17 offset:0
    ds_read_b128 a[8:11], v18 offset:0
    ds_read_b128 a[12:15], v19 offset:0
    ds_read_b128 a[16:19], v20 offset:0
    ds_read_b128 a[20:23], v21 offset:0
    ds_read_b128 a[24:27], v22 offset:0
    ds_read_b128 a[28:31], v23 offset:0
    s_waitcnt lgkmcnt(0)
    ds_read_b128 a[32:35], v16 offset:1024
    ds_read_b128 a[36:39], v17 offset:1024
    ds_read_b128 a[40:43], v18 offset:1024
    ds_read_b128 a[44:47], v19 offset:1024
    ds_read_b128 a[48:51], v20 offset:1024
    ds_read_b128 a[52:55], v21 offset:1024
    ds_read_b128 a[56:59], v22 offset:1024
    ds_read_b128 a[60:63], v23 offset:1024
    s_waitcnt lgkmcnt(0)
    v_lshrrev_b32 v5, 5, v1
    v_and_b32 v6, 31, v1
    v_lshrrev_b32 v7, 2, v6
    v_sub_u32 v7, v7, v5
    v_subrev_u32 v7, 0, v7
    v_and_b32 v7, 7, v7
    v_lshlrev_b32 v7, 6, v7
    v_and_b32 v8, 3, v6
    v_lshl_add_u32 v7, v8, 4, v7
    v_lshl_add_u32 v7, v5, 13, v7
    s_add_u32 m0, s30, 0
    s_add_u32 s18, s29, 262144
    buffer_load_dwordx4 v7, s[8:11], s18 offen lds
    v_lshrrev_b32 v7, 2, v6
    v_sub_u32 v7, v7, v5
    v_subrev_u32 v7, 0, v7
    v_and_b32 v7, 7, v7
    v_lshlrev_b32 v7, 6, v7
    v_and_b32 v8, 3, v6
    v_lshl_add_u32 v7, v8, 4, v7
    v_lshl_add_u32 v7, v5, 13, v7
    s_add_u32 m0, s30, 1024
    s_add_u32 s18, s29, 278528
    buffer_load_dwordx4 v7, s[8:11], s18 offen lds
    v_lshrrev_b32 v7, 2, v6
    v_sub_u32 v7, v7, v5
    v_subrev_u32 v7, 2, v7
    v_and_b32 v7, 7, v7
    v_lshlrev_b32 v7, 6, v7
    v_and_b32 v8, 3, v6
    v_lshl_add_u32 v7, v8, 4, v7
    v_lshl_add_u32 v7, v5, 13, v7
    s_add_u32 m0, s30, 2048
    s_add_u32 s18, s29, 294912
    buffer_load_dwordx4 v7, s[8:11], s18 offen lds
    v_lshrrev_b32 v7, 2, v6
    v_sub_u32 v7, v7, v5
    v_subrev_u32 v7, 2, v7
    v_and_b32 v7, 7, v7
    v_lshlrev_b32 v7, 6, v7
    v_and_b32 v8, 3, v6
    v_lshl_add_u32 v7, v8, 4, v7
    v_lshl_add_u32 v7, v5, 13, v7
    s_add_u32 m0, s30, 3072
    s_add_u32 s18, s29, 311296
    buffer_load_dwordx4 v7, s[8:11], s18 offen lds
    v_lshrrev_b32 v7, 2, v6
    v_sub_u32 v7, v7, v5
    v_subrev_u32 v7, 4, v7
    v_and_b32 v7, 7, v7
    v_lshlrev_b32 v7, 6, v7
    v_and_b32 v8, 3, v6
    v_lshl_add_u32 v7, v8, 4, v7
    v_lshl_add_u32 v7, v5, 13, v7
    s_add_u32 m0, s30, 4096
    s_add_u32 s18, s29, 327680
    buffer_load_dwordx4 v7, s[8:11], s18 offen lds
    v_lshrrev_b32 v7, 2, v6
    v_sub_u32 v7, v7, v5
    v_subrev_u32 v7, 4, v7
    v_and_b32 v7, 7, v7
    v_lshlrev_b32 v7, 6, v7
    v_and_b32 v8, 3, v6
    v_lshl_add_u32 v7, v8, 4, v7
    v_lshl_add_u32 v7, v5, 13, v7
    s_add_u32 m0, s30, 5120
    s_add_u32 s18, s29, 344064
    buffer_load_dwordx4 v7, s[8:11], s18 offen lds
    v_lshrrev_b32 v7, 2, v6
    v_sub_u32 v7, v7, v5
    v_subrev_u32 v7, 6, v7
    v_and_b32 v7, 7, v7
    v_lshlrev_b32 v7, 6, v7
    v_and_b32 v8, 3, v6
    v_lshl_add_u32 v7, v8, 4, v7
    v_lshl_add_u32 v7, v5, 13, v7
    s_add_u32 m0, s30, 6144
    s_add_u32 s18, s29, 360448
    buffer_load_dwordx4 v7, s[8:11], s18 offen lds
    v_lshrrev_b32 v7, 2, v6
    v_sub_u32 v7, v7, v5
    v_subrev_u32 v7, 6, v7
    v_and_b32 v7, 7, v7
    v_lshlrev_b32 v7, 6, v7
    v_and_b32 v8, 3, v6
    v_lshl_add_u32 v7, v8, 4, v7
    v_lshl_add_u32 v7, v5, 13, v7
    s_add_u32 m0, s30, 7168
    s_add_u32 s18, s29, 376832
    buffer_load_dwordx4 v7, s[8:11], s18 offen lds
    v_lshrrev_b32 v7, 2, v6
    v_sub_u32 v7, v7, v5
    v_subrev_u32 v7, 8, v7
    v_and_b32 v7, 7, v7
    v_lshlrev_b32 v7, 6, v7
    v_and_b32 v8, 3, v6
    v_lshl_add_u32 v7, v8, 4, v7
    v_lshl_add_u32 v7, v5, 13, v7
    s_add_u32 m0, s30, 8192
    s_add_u32 s18, s29, 393216
    buffer_load_dwordx4 v7, s[8:11], s18 offen lds
    v_lshrrev_b32 v7, 2, v6
    v_sub_u32 v7, v7, v5
    v_subrev_u32 v7, 8, v7
    v_and_b32 v7, 7, v7
    v_lshlrev_b32 v7, 6, v7
    v_and_b32 v8, 3, v6
    v_lshl_add_u32 v7, v8, 4, v7
    v_lshl_add_u32 v7, v5, 13, v7
    s_add_u32 m0, s30, 9216
    s_add_u32 s18, s29, 409600
    buffer_load_dwordx4 v7, s[8:11], s18 offen lds
    v_lshrrev_b32 v7, 2, v6
    v_sub_u32 v7, v7, v5
    v_subrev_u32 v7, 10, v7
    v_and_b32 v7, 7, v7
    v_lshlrev_b32 v7, 6, v7
    v_and_b32 v8, 3, v6
    v_lshl_add_u32 v7, v8, 4, v7
    v_lshl_add_u32 v7, v5, 13, v7
    s_add_u32 m0, s30, 10240
    s_add_u32 s18, s29, 425984
    buffer_load_dwordx4 v7, s[8:11], s18 offen lds
    v_lshrrev_b32 v7, 2, v6
    v_sub_u32 v7, v7, v5
    v_subrev_u32 v7, 10, v7
    v_and_b32 v7, 7, v7
    v_lshlrev_b32 v7, 6, v7
    v_and_b32 v8, 3, v6
    v_lshl_add_u32 v7, v8, 4, v7
    v_lshl_add_u32 v7, v5, 13, v7
    s_add_u32 m0, s30, 11264
    s_add_u32 s18, s29, 442368
    buffer_load_dwordx4 v7, s[8:11], s18 offen lds
    v_lshrrev_b32 v7, 2, v6
    v_sub_u32 v7, v7, v5
    v_subrev_u32 v7, 12, v7
    v_and_b32 v7, 7, v7
    v_lshlrev_b32 v7, 6, v7
    v_and_b32 v8, 3, v6
    v_lshl_add_u32 v7, v8, 4, v7
    v_lshl_add_u32 v7, v5, 13, v7
    s_add_u32 m0, s30, 12288
    s_add_u32 s18, s29, 458752
    buffer_load_dwordx4 v7, s[8:11], s18 offen lds
    v_lshrrev_b32 v7, 2, v6
    v_sub_u32 v7, v7, v5
    v_subrev_u32 v7, 12, v7
    v_and_b32 v7, 7, v7
    v_lshlrev_b32 v7, 6, v7
    v_and_b32 v8, 3, v6
    v_lshl_add_u32 v7, v8, 4, v7
    v_lshl_add_u32 v7, v5, 13, v7
    s_add_u32 m0, s30, 13312
    s_add_u32 s18, s29, 475136
    buffer_load_dwordx4 v7, s[8:11], s18 offen lds
    v_lshrrev_b32 v7, 2, v6
    v_sub_u32 v7, v7, v5
    v_subrev_u32 v7, 14, v7
    v_and_b32 v7, 7, v7
    v_lshlrev_b32 v7, 6, v7
    v_and_b32 v8, 3, v6
    v_lshl_add_u32 v7, v8, 4, v7
    v_lshl_add_u32 v7, v5, 13, v7
    s_add_u32 m0, s30, 14336
    s_add_u32 s18, s29, 491520
    buffer_load_dwordx4 v7, s[8:11], s18 offen lds
    v_lshrrev_b32 v7, 2, v6
    v_sub_u32 v7, v7, v5
    v_subrev_u32 v7, 14, v7
    v_and_b32 v7, 7, v7
    v_lshlrev_b32 v7, 6, v7
    v_and_b32 v8, 3, v6
    v_lshl_add_u32 v7, v8, 4, v7
    v_lshl_add_u32 v7, v5, 13, v7
    s_add_u32 m0, s30, 15360
    s_add_u32 s18, s29, 507904
    buffer_load_dwordx4 v7, s[8:11], s18 offen lds
    v_lshlrev_b32 v7, 4, v1
    s_lshl_b32 s29, s24, 2
    s_add_u32 s29, s29, s25
    s_mul_i32 s29, s29, 49
    s_add_u32 s29, s29, s26
    s_and_b32 s21, s24, 1
    s_lshl_b32 s21, s21, 1
    s_bfe_u32 s31, s24, 0x10001
    s_add_u32 s21, s21, s31
    s_lshr_b32 s31, s24, 2
    s_lshl_b32 s31, s31, 3
    s_add_u32 s21, s21, s31
    s_mul_i32 s31, s25, 7
    s_cmp_ge_u32 s26, 7
    s_cbranch_scc1 gudone_29
    s_add_u32 s18, s31, 0
    s_lshr_b32 s19, s18, 1
    s_lshl_b32 s19, s19, 5
    s_and_b32 s18, s18, 1
    s_lshl_b32 s18, s18, 2
    s_add_u32 s19, s19, s18
    s_add_u32 s19, s19, s21
    s_mul_i32 s19, s19, 7
    s_add_u32 s19, s19, s26
    s_lshl_b32 s19, s19, 11
    s_add_u32 s19, s19, 6422528
    s_add_u32 s18, s29, 0
    s_lshl_b32 s18, s18, 11
    s_add_u32 s18, s18, 0
    s_cmp_eq_u32 s28, 1
    s_cselect_b32 s18, s19, s18
    v_mfma_f32_16x16x32_bf16 v[8:11], a[0:3], v[32:35], 0
    v_mfma_f32_16x16x32_bf16 v[8:11], a[4:7], v[36:39], v[8:11]
    v_mfma_f32_16x16x32_bf16 v[8:11], a[8:11], v[40:43], v[8:11]
    v_mfma_f32_16x16x32_bf16 v[8:11], a[12:15], v[44:47], v[8:11]
    v_mfma_f32_16x16x32_bf16 v[8:11], a[16:19], v[48:51], v[8:11]
    v_mfma_f32_16x16x32_bf16 v[8:11], a[20:23], v[52:55], v[8:11]
    v_mfma_f32_16x16x32_bf16 v[8:11], a[24:27], v[56:59], v[8:11]
    v_mfma_f32_16x16x32_bf16 v[8:11], a[28:31], v[60:63], v[8:11]
    v_mfma_f32_16x16x32_bf16 v[12:15], a[32:35], v[32:35], 0
    v_mfma_f32_16x16x32_bf16 v[12:15], a[36:39], v[36:39], v[12:15]
    v_mfma_f32_16x16x32_bf16 v[12:15], a[40:43], v[40:43], v[12:15]
    v_mfma_f32_16x16x32_bf16 v[12:15], a[44:47], v[44:47], v[12:15]
    v_mfma_f32_16x16x32_bf16 v[12:15], a[48:51], v[48:51], v[12:15]
    v_mfma_f32_16x16x32_bf16 v[12:15], a[52:55], v[52:55], v[12:15]
    v_mfma_f32_16x16x32_bf16 v[12:15], a[56:59], v[56:59], v[12:15]
    v_mfma_f32_16x16x32_bf16 v[12:15], a[60:63], v[60:63], v[12:15]
    s_nop 7
    v_cvt_pk_bf16_f32 v24, v8, v9
    v_cvt_pk_bf16_f32 v25, v10, v11
    v_cvt_pk_bf16_f32 v26, v12, v13
    v_cvt_pk_bf16_f32 v27, v14, v15
    buffer_store_dwordx4 v[24:27], v7, s[4:7], s18 offen offset:0 sc1
    s_add_u32 s18, s31, 1
    s_lshr_b32 s19, s18, 1
    s_lshl_b32 s19, s19, 5
    s_and_b32 s18, s18, 1
    s_lshl_b32 s18, s18, 2
    s_add_u32 s19, s19, s18
    s_add_u32 s19, s19, s21
    s_mul_i32 s19, s19, 7
    s_add_u32 s19, s19, s26
    s_lshl_b32 s19, s19, 11
    s_add_u32 s19, s19, 6422528
    s_add_u32 s18, s29, 7
    s_lshl_b32 s18, s18, 11
    s_add_u32 s18, s18, 0
    s_cmp_eq_u32 s28, 1
    s_cselect_b32 s18, s19, s18
    v_mfma_f32_16x16x32_bf16 v[8:11], a[0:3], v[64:67], 0
    v_mfma_f32_16x16x32_bf16 v[8:11], a[4:7], v[68:71], v[8:11]
    v_mfma_f32_16x16x32_bf16 v[8:11], a[8:11], v[72:75], v[8:11]
    v_mfma_f32_16x16x32_bf16 v[8:11], a[12:15], v[76:79], v[8:11]
    v_mfma_f32_16x16x32_bf16 v[8:11], a[16:19], v[80:83], v[8:11]
    v_mfma_f32_16x16x32_bf16 v[8:11], a[20:23], v[84:87], v[8:11]
    v_mfma_f32_16x16x32_bf16 v[8:11], a[24:27], v[88:91], v[8:11]
    v_mfma_f32_16x16x32_bf16 v[8:11], a[28:31], v[92:95], v[8:11]
    v_mfma_f32_16x16x32_bf16 v[12:15], a[32:35], v[64:67], 0
    v_mfma_f32_16x16x32_bf16 v[12:15], a[36:39], v[68:71], v[12:15]
    v_mfma_f32_16x16x32_bf16 v[12:15], a[40:43], v[72:75], v[12:15]
    v_mfma_f32_16x16x32_bf16 v[12:15], a[44:47], v[76:79], v[12:15]
    v_mfma_f32_16x16x32_bf16 v[12:15], a[48:51], v[80:83], v[12:15]
    v_mfma_f32_16x16x32_bf16 v[12:15], a[52:55], v[84:87], v[12:15]
    v_mfma_f32_16x16x32_bf16 v[12:15], a[56:59], v[88:91], v[12:15]
    v_mfma_f32_16x16x32_bf16 v[12:15], a[60:63], v[92:95], v[12:15]
    s_nop 7
    v_cvt_pk_bf16_f32 v28, v8, v9
    v_cvt_pk_bf16_f32 v29, v10, v11
    v_cvt_pk_bf16_f32 v30, v12, v13
    v_cvt_pk_bf16_f32 v31, v14, v15
    buffer_store_dwordx4 v[28:31], v7, s[4:7], s18 offen offset:0 sc1
    s_add_u32 s18, s31, 2
    s_lshr_b32 s19, s18, 1
    s_lshl_b32 s19, s19, 5
    s_and_b32 s18, s18, 1
    s_lshl_b32 s18, s18, 2
    s_add_u32 s19, s19, s18
    s_add_u32 s19, s19, s21
    s_mul_i32 s19, s19, 7
    s_add_u32 s19, s19, s26
    s_lshl_b32 s19, s19, 11
    s_add_u32 s19, s19, 6422528
    s_add_u32 s18, s29, 14
    s_lshl_b32 s18, s18, 11
    s_add_u32 s18, s18, 0
    s_cmp_eq_u32 s28, 1
    s_cselect_b32 s18, s19, s18
    v_mfma_f32_16x16x32_bf16 v[8:11], a[0:3], v[96:99], 0
    v_mfma_f32_16x16x32_bf16 v[8:11], a[4:7], v[100:103], v[8:11]
    v_mfma_f32_16x16x32_bf16 v[8:11], a[8:11], v[104:107], v[8:11]
    v_mfma_f32_16x16x32_bf16 v[8:11], a[12:15], v[108:111], v[8:11]
    v_mfma_f32_16x16x32_bf16 v[8:11], a[16:19], v[112:115], v[8:11]
    v_mfma_f32_16x16x32_bf16 v[8:11], a[20:23], v[116:119], v[8:11]
    v_mfma_f32_16x16x32_bf16 v[8:11], a[24:27], v[120:123], v[8:11]
    v_mfma_f32_16x16x32_bf16 v[8:11], a[28:31], v[124:127], v[8:11]
    v_mfma_f32_16x16x32_bf16 v[12:15], a[32:35], v[96:99], 0
    v_mfma_f32_16x16x32_bf16 v[12:15], a[36:39], v[100:103], v[12:15]
    v_mfma_f32_16x16x32_bf16 v[12:15], a[40:43], v[104:107], v[12:15]
    v_mfma_f32_16x16x32_bf16 v[12:15], a[44:47], v[108:111], v[12:15]
    v_mfma_f32_16x16x32_bf16 v[12:15], a[48:51], v[112:115], v[12:15]
    v_mfma_f32_16x16x32_bf16 v[12:15], a[52:55], v[116:119], v[12:15]
    v_mfma_f32_16x16x32_bf16 v[12:15], a[56:59], v[120:123], v[12:15]
    v_mfma_f32_16x16x32_bf16 v[12:15], a[60:63], v[124:127], v[12:15]
    s_nop 7
    v_cvt_pk_bf16_f32 v24, v8, v9
    v_cvt_pk_bf16_f32 v25, v10, v11
    v_cvt_pk_bf16_f32 v26, v12, v13
    v_cvt_pk_bf16_f32 v27, v14, v15
    buffer_store_dwordx4 v[24:27], v7, s[4:7], s18 offen offset:0 sc1
    s_add_u32 s18, s31, 3
    s_lshr_b32 s19, s18, 1
    s_lshl_b32 s19, s19, 5
    s_and_b32 s18, s18, 1
    s_lshl_b32 s18, s18, 2
    s_add_u32 s19, s19, s18
    s_add_u32 s19, s19, s21
    s_mul_i32 s19, s19, 7
    s_add_u32 s19, s19, s26
    s_lshl_b32 s19, s19, 11
    s_add_u32 s19, s19, 6422528
    s_add_u32 s18, s29, 21
    s_lshl_b32 s18, s18, 11
    s_add_u32 s18, s18, 0
    s_cmp_eq_u32 s28, 1
    s_cselect_b32 s18, s19, s18
    v_mfma_f32_16x16x32_bf16 v[8:11], a[0:3], v[128:131], 0
    v_mfma_f32_16x16x32_bf16 v[8:11], a[4:7], v[132:135], v[8:11]
    v_mfma_f32_16x16x32_bf16 v[8:11], a[8:11], v[136:139], v[8:11]
    v_mfma_f32_16x16x32_bf16 v[8:11], a[12:15], v[140:143], v[8:11]
    v_mfma_f32_16x16x32_bf16 v[8:11], a[16:19], v[144:147], v[8:11]
    v_mfma_f32_16x16x32_bf16 v[8:11], a[20:23], v[148:151], v[8:11]
    v_mfma_f32_16x16x32_bf16 v[8:11], a[24:27], v[152:155], v[8:11]
    v_mfma_f32_16x16x32_bf16 v[8:11], a[28:31], v[156:159], v[8:11]
    v_mfma_f32_16x16x32_bf16 v[12:15], a[32:35], v[128:131], 0
    v_mfma_f32_16x16x32_bf16 v[12:15], a[36:39], v[132:135], v[12:15]
    v_mfma_f32_16x16x32_bf16 v[12:15], a[40:43], v[136:139], v[12:15]
    v_mfma_f32_16x16x32_bf16 v[12:15], a[44:47], v[140:143], v[12:15]
    v_mfma_f32_16x16x32_bf16 v[12:15], a[48:51], v[144:147], v[12:15]
    v_mfma_f32_16x16x32_bf16 v[12:15], a[52:55], v[148:151], v[12:15]
    v_mfma_f32_16x16x32_bf16 v[12:15], a[56:59], v[152:155], v[12:15]
    v_mfma_f32_16x16x32_bf16 v[12:15], a[60:63], v[156:159], v[12:15]
    s_nop 7
    v_cvt_pk_bf16_f32 v28, v8, v9
    v_cvt_pk_bf16_f32 v29, v10, v11
    v_cvt_pk_bf16_f32 v30, v12, v13
    v_cvt_pk_bf16_f32 v31, v14, v15
    buffer_store_dwordx4 v[28:31], v7, s[4:7], s18 offen offset:0 sc1
    s_add_u32 s18, s31, 4
    s_lshr_b32 s19, s18, 1
    s_lshl_b32 s19, s19, 5
    s_and_b32 s18, s18, 1
    s_lshl_b32 s18, s18, 2
    s_add_u32 s19, s19, s18
    s_add_u32 s19, s19, s21
    s_mul_i32 s19, s19, 7
    s_add_u32 s19, s19, s26
    s_lshl_b32 s19, s19, 11
    s_add_u32 s19, s19, 6422528
    s_add_u32 s18, s29, 28
    s_lshl_b32 s18, s18, 11
    s_add_u32 s18, s18, 0
    s_cmp_eq_u32 s28, 1
    s_cselect_b32 s18, s19, s18
    v_mfma_f32_16x16x32_bf16 v[8:11], a[0:3], v[160:163], 0
    v_mfma_f32_16x16x32_bf16 v[8:11], a[4:7], v[164:167], v[8:11]
    v_mfma_f32_16x16x32_bf16 v[8:11], a[8:11], v[168:171], v[8:11]
    v_mfma_f32_16x16x32_bf16 v[8:11], a[12:15], v[172:175], v[8:11]
    v_mfma_f32_16x16x32_bf16 v[8:11], a[16:19], v[176:179], v[8:11]
    v_mfma_f32_16x16x32_bf16 v[8:11], a[20:23], v[180:183], v[8:11]
    v_mfma_f32_16x16x32_bf16 v[8:11], a[24:27], v[184:187], v[8:11]
    v_mfma_f32_16x16x32_bf16 v[8:11], a[28:31], v[188:191], v[8:11]
    v_mfma_f32_16x16x32_bf16 v[12:15], a[32:35], v[160:163], 0
    v_mfma_f32_16x16x32_bf16 v[12:15], a[36:39], v[164:167], v[12:15]
    v_mfma_f32_16x16x32_bf16 v[12:15], a[40:43], v[168:171], v[12:15]
    v_mfma_f32_16x16x32_bf16 v[12:15], a[44:47], v[172:175], v[12:15]
    v_mfma_f32_16x16x32_bf16 v[12:15], a[48:51], v[176:179], v[12:15]
    v_mfma_f32_16x16x32_bf16 v[12:15], a[52:55], v[180:183], v[12:15]
    v_mfma_f32_16x16x32_bf16 v[12:15], a[56:59], v[184:187], v[12:15]
    v_mfma_f32_16x16x32_bf16 v[12:15], a[60:63], v[188:191], v[12:15]
    s_nop 7
    v_cvt_pk_bf16_f32 v24, v8, v9
    v_cvt_pk_bf16_f32 v25, v10, v11
    v_cvt_pk_bf16_f32 v26, v12, v13
    v_cvt_pk_bf16_f32 v27, v14, v15
    buffer_store_dwordx4 v[24:27], v7, s[4:7], s18 offen offset:0 sc1
    s_add_u32 s18, s31, 5
    s_lshr_b32 s19, s18, 1
    s_lshl_b32 s19, s19, 5
    s_and_b32 s18, s18, 1
    s_lshl_b32 s18, s18, 2
    s_add_u32 s19, s19, s18
    s_add_u32 s19, s19, s21
    s_mul_i32 s19, s19, 7
    s_add_u32 s19, s19, s26
    s_lshl_b32 s19, s19, 11
    s_add_u32 s19, s19, 6422528
    s_add_u32 s18, s29, 35
    s_lshl_b32 s18, s18, 11
    s_add_u32 s18, s18, 0
    s_cmp_eq_u32 s28, 1
    s_cselect_b32 s18, s19, s18
    v_mfma_f32_16x16x32_bf16 v[8:11], a[0:3], v[192:195], 0
    v_mfma_f32_16x16x32_bf16 v[8:11], a[4:7], v[196:199], v[8:11]
    v_mfma_f32_16x16x32_bf16 v[8:11], a[8:11], v[200:203], v[8:11]
    v_mfma_f32_16x16x32_bf16 v[8:11], a[12:15], v[204:207], v[8:11]
    v_mfma_f32_16x16x32_bf16 v[8:11], a[16:19], v[208:211], v[8:11]
    v_mfma_f32_16x16x32_bf16 v[8:11], a[20:23], v[212:215], v[8:11]
    v_mfma_f32_16x16x32_bf16 v[8:11], a[24:27], v[216:219], v[8:11]
    v_mfma_f32_16x16x32_bf16 v[8:11], a[28:31], v[220:223], v[8:11]
    v_mfma_f32_16x16x32_bf16 v[12:15], a[32:35], v[192:195], 0
    v_mfma_f32_16x16x32_bf16 v[12:15], a[36:39], v[196:199], v[12:15]
    v_mfma_f32_16x16x32_bf16 v[12:15], a[40:43], v[200:203], v[12:15]
    v_mfma_f32_16x16x32_bf16 v[12:15], a[44:47], v[204:207], v[12:15]
    v_mfma_f32_16x16x32_bf16 v[12:15], a[48:51], v[208:211], v[12:15]
    v_mfma_f32_16x16x32_bf16 v[12:15], a[52:55], v[212:215], v[12:15]
    v_mfma_f32_16x16x32_bf16 v[12:15], a[56:59], v[216:219], v[12:15]
    v_mfma_f32_16x16x32_bf16 v[12:15], a[60:63], v[220:223], v[12:15]
    s_nop 7
    v_cvt_pk_bf16_f32 v28, v8, v9
    v_cvt_pk_bf16_f32 v29, v10, v11
    v_cvt_pk_bf16_f32 v30, v12, v13
    v_cvt_pk_bf16_f32 v31, v14, v15
    buffer_store_dwordx4 v[28:31], v7, s[4:7], s18 offen offset:0 sc1
    s_add_u32 s18, s31, 6
    s_lshr_b32 s19, s18, 1
    s_lshl_b32 s19, s19, 5
    s_and_b32 s18, s18, 1
    s_lshl_b32 s18, s18, 2
    s_add_u32 s19, s19, s18
    s_add_u32 s19, s19, s21
    s_mul_i32 s19, s19, 7
    s_add_u32 s19, s19, s26
    s_lshl_b32 s19, s19, 11
    s_add_u32 s19, s19, 6422528
    s_add_u32 s18, s29, 42
    s_lshl_b32 s18, s18, 11
    s_add_u32 s18, s18, 0
    s_cmp_eq_u32 s28, 1
    s_cselect_b32 s18, s19, s18
    v_mfma_f32_16x16x32_bf16 v[8:11], a[0:3], v[224:227], 0
    v_mfma_f32_16x16x32_bf16 v[8:11], a[4:7], v[228:231], v[8:11]
    v_mfma_f32_16x16x32_bf16 v[8:11], a[8:11], v[232:235], v[8:11]
    v_mfma_f32_16x16x32_bf16 v[8:11], a[12:15], v[236:239], v[8:11]
    v_mfma_f32_16x16x32_bf16 v[8:11], a[16:19], v[240:243], v[8:11]
    v_mfma_f32_16x16x32_bf16 v[8:11], a[20:23], v[244:247], v[8:11]
    v_mfma_f32_16x16x32_bf16 v[8:11], a[24:27], v[248:251], v[8:11]
    v_mfma_f32_16x16x32_bf16 v[8:11], a[28:31], v[252:255], v[8:11]
    v_mfma_f32_16x16x32_bf16 v[12:15], a[32:35], v[224:227], 0
    v_mfma_f32_16x16x32_bf16 v[12:15], a[36:39], v[228:231], v[12:15]
    v_mfma_f32_16x16x32_bf16 v[12:15], a[40:43], v[232:235], v[12:15]
    v_mfma_f32_16x16x32_bf16 v[12:15], a[44:47], v[236:239], v[12:15]
    v_mfma_f32_16x16x32_bf16 v[12:15], a[48:51], v[240:243], v[12:15]
    v_mfma_f32_16x16x32_bf16 v[12:15], a[52:55], v[244:247], v[12:15]
    v_mfma_f32_16x16x32_bf16 v[12:15], a[56:59], v[248:251], v[12:15]
    v_mfma_f32_16x16x32_bf16 v[12:15], a[60:63], v[252:255], v[12:15]
    s_nop 7
    v_cvt_pk_bf16_f32 v24, v8, v9
    v_cvt_pk_bf16_f32 v25, v10, v11
    v_cvt_pk_bf16_f32 v26, v12, v13
    v_cvt_pk_bf16_f32 v27, v14, v15
    buffer_store_dwordx4 v[24:27], v7, s[4:7], s18 offen offset:0 sc1
    s_waitcnt vmcnt(7)
    ds_read_b128 a[64:67], v16 offset:0
    ds_read_b128 a[68:71], v17 offset:0
    ds_read_b128 a[72:75], v18 offset:0
    ds_read_b128 a[76:79], v19 offset:0
    ds_read_b128 a[80:83], v20 offset:0
    ds_read_b128 a[84:87], v21 offset:0
    ds_read_b128 a[88:91], v22 offset:0
    ds_read_b128 a[92:95], v23 offset:0
    s_waitcnt lgkmcnt(0)
    ds_read_b128 a[96:99], v16 offset:1024
    ds_read_b128 a[100:103], v17 offset:1024
    ds_read_b128 a[104:107], v18 offset:1024
    ds_read_b128 a[108:111], v19 offset:1024
    ds_read_b128 a[112:115], v20 offset:1024
    ds_read_b128 a[116:119], v21 offset:1024
    ds_read_b128 a[120:123], v22 offset:1024
    ds_read_b128 a[124:127], v23 offset:1024
    s_waitcnt lgkmcnt(0)
    s_add_u32 s18, s31, 0
    s_lshr_b32 s19, s18, 1
    s_lshl_b32 s19, s19, 5
    s_and_b32 s18, s18, 1
    s_lshl_b32 s18, s18, 2
    s_add_u32 s19, s19, s18
    s_add_u32 s19, s19, s21
    s_mul_i32 s19, s19, 7
    s_add_u32 s19, s19, s26
    s_lshl_b32 s19, s19, 11
    s_add_u32 s19, s19, 6422528
    s_add_u32 s18, s29, 0
    s_lshl_b32 s18, s18, 11
    s_add_u32 s18, s18, 0
    s_cmp_eq_u32 s28, 1
    s_cselect_b32 s18, s19, s18
    v_mfma_f32_16x16x32_bf16 v[8:11], a[64:67], v[32:35], 0
    v_mfma_f32_16x16x32_bf16 v[8:11], a[68:71], v[36:39], v[8:11]
    v_mfma_f32_16x16x32_bf16 v[8:11], a[72:75], v[40:43], v[8:11]
    v_mfma_f32_16x16x32_bf16 v[8:11], a[76:79], v[44:47], v[8:11]
    v_mfma_f32_16x16x32_bf16 v[8:11], a[80:83], v[48:51], v[8:11]
    v_mfma_f32_16x16x32_bf16 v[8:11], a[84:87], v[52:55], v[8:11]
    v_mfma_f32_16x16x32_bf16 v[8:11], a[88:91], v[56:59], v[8:11]
    v_mfma_f32_16x16x32_bf16 v[8:11], a[92:95], v[60:63], v[8:11]
    v_mfma_f32_16x16x32_bf16 v[12:15], a[96:99], v[32:35], 0
    v_mfma_f32_16x16x32_bf16 v[12:15], a[100:103], v[36:39], v[12:15]
    v_mfma_f32_16x16x32_bf16 v[12:15], a[104:107], v[40:43], v[12:15]
    v_mfma_f32_16x16x32_bf16 v[12:15], a[108:111], v[44:47], v[12:15]
    v_mfma_f32_16x16x32_bf16 v[12:15], a[112:115], v[48:51], v[12:15]
    v_mfma_f32_16x16x32_bf16 v[12:15], a[116:119], v[52:55], v[12:15]
    v_mfma_f32_16x16x32_bf16 v[12:15], a[120:123], v[56:59], v[12:15]
    v_mfma_f32_16x16x32_bf16 v[12:15], a[124:127], v[60:63], v[12:15]
    s_nop 7
    v_cvt_pk_bf16_f32 v24, v8, v9
    v_cvt_pk_bf16_f32 v25, v10, v11
    v_cvt_pk_bf16_f32 v26, v12, v13
    v_cvt_pk_bf16_f32 v27, v14, v15
    buffer_store_dwordx4 v[24:27], v7, s[4:7], s18 offen offset:1024 sc1
    s_add_u32 s18, s31, 1
    s_lshr_b32 s19, s18, 1
    s_lshl_b32 s19, s19, 5
    s_and_b32 s18, s18, 1
    s_lshl_b32 s18, s18, 2
    s_add_u32 s19, s19, s18
    s_add_u32 s19, s19, s21
    s_mul_i32 s19, s19, 7
    s_add_u32 s19, s19, s26
    s_lshl_b32 s19, s19, 11
    s_add_u32 s19, s19, 6422528
    s_add_u32 s18, s29, 7
    s_lshl_b32 s18, s18, 11
    s_add_u32 s18, s18, 0
    s_cmp_eq_u32 s28, 1
    s_cselect_b32 s18, s19, s18
    v_mfma_f32_16x16x32_bf16 v[8:11], a[64:67], v[64:67], 0
    v_mfma_f32_16x16x32_bf16 v[8:11], a[68:71], v[68:71], v[8:11]
    v_mfma_f32_16x16x32_bf16 v[8:11], a[72:75], v[72:75], v[8:11]
    v_mfma_f32_16x16x32_bf16 v[8:11], a[76:79], v[76:79], v[8:11]
    v_mfma_f32_16x16x32_bf16 v[8:11], a[80:83], v[80:83], v[8:11]
    v_mfma_f32_16x16x32_bf16 v[8:11], a[84:87], v[84:87], v[8:11]
    v_mfma_f32_16x16x32_bf16 v[8:11], a[88:91], v[88:91], v[8:11]
    v_mfma_f32_16x16x32_bf16 v[8:11], a[92:95], v[92:95], v[8:11]
    v_mfma_f32_16x16x32_bf16 v[12:15], a[96:99], v[64:67], 0
    v_mfma_f32_16x16x32_bf16 v[12:15], a[100:103], v[68:71], v[12:15]
    v_mfma_f32_16x16x32_bf16 v[12:15], a[104:107], v[72:75], v[12:15]
    v_mfma_f32_16x16x32_bf16 v[12:15], a[108:111], v[76:79], v[12:15]
    v_mfma_f32_16x16x32_bf16 v[12:15], a[112:115], v[80:83], v[12:15]
    v_mfma_f32_16x16x32_bf16 v[12:15], a[116:119], v[84:87], v[12:15]
    v_mfma_f32_16x16x32_bf16 v[12:15], a[120:123], v[88:91], v[12:15]
    v_mfma_f32_16x16x32_bf16 v[12:15], a[124:127], v[92:95], v[12:15]
    s_nop 7
    v_cvt_pk_bf16_f32 v28, v8, v9
    v_cvt_pk_bf16_f32 v29, v10, v11
    v_cvt_pk_bf16_f32 v30, v12, v13
    v_cvt_pk_bf16_f32 v31, v14, v15
    buffer_store_dwordx4 v[28:31], v7, s[4:7], s18 offen offset:1024 sc1
    s_add_u32 s18, s31, 2
    s_lshr_b32 s19, s18, 1
    s_lshl_b32 s19, s19, 5
    s_and_b32 s18, s18, 1
    s_lshl_b32 s18, s18, 2
    s_add_u32 s19, s19, s18
    s_add_u32 s19, s19, s21
    s_mul_i32 s19, s19, 7
    s_add_u32 s19, s19, s26
    s_lshl_b32 s19, s19, 11
    s_add_u32 s19, s19, 6422528
    s_add_u32 s18, s29, 14
    s_lshl_b32 s18, s18, 11
    s_add_u32 s18, s18, 0
    s_cmp_eq_u32 s28, 1
    s_cselect_b32 s18, s19, s18
    v_mfma_f32_16x16x32_bf16 v[8:11], a[64:67], v[96:99], 0
    v_mfma_f32_16x16x32_bf16 v[8:11], a[68:71], v[100:103], v[8:11]
    v_mfma_f32_16x16x32_bf16 v[8:11], a[72:75], v[104:107], v[8:11]
    v_mfma_f32_16x16x32_bf16 v[8:11], a[76:79], v[108:111], v[8:11]
    v_mfma_f32_16x16x32_bf16 v[8:11], a[80:83], v[112:115], v[8:11]
    v_mfma_f32_16x16x32_bf16 v[8:11], a[84:87], v[116:119], v[8:11]
    v_mfma_f32_16x16x32_bf16 v[8:11], a[88:91], v[120:123], v[8:11]
    v_mfma_f32_16x16x32_bf16 v[8:11], a[92:95], v[124:127], v[8:11]
    v_mfma_f32_16x16x32_bf16 v[12:15], a[96:99], v[96:99], 0
    v_mfma_f32_16x16x32_bf16 v[12:15], a[100:103], v[100:103], v[12:15]
    v_mfma_f32_16x16x32_bf16 v[12:15], a[104:107], v[104:107], v[12:15]
    v_mfma_f32_16x16x32_bf16 v[12:15], a[108:111], v[108:111], v[12:15]
    v_mfma_f32_16x16x32_bf16 v[12:15], a[112:115], v[112:115], v[12:15]
    v_mfma_f32_16x16x32_bf16 v[12:15], a[116:119], v[116:119], v[12:15]
    v_mfma_f32_16x16x32_bf16 v[12:15], a[120:123], v[120:123], v[12:15]
    v_mfma_f32_16x16x32_bf16 v[12:15], a[124:127], v[124:127], v[12:15]
    s_nop 7
    v_cvt_pk_bf16_f32 v24, v8, v9
    v_cvt_pk_bf16_f32 v25, v10, v11
    v_cvt_pk_bf16_f32 v26, v12, v13
    v_cvt_pk_bf16_f32 v27, v14, v15
    buffer_store_dwordx4 v[24:27], v7, s[4:7], s18 offen offset:1024 sc1
    s_add_u32 s18, s31, 3
    s_lshr_b32 s19, s18, 1
    s_lshl_b32 s19, s19, 5
    s_and_b32 s18, s18, 1
    s_lshl_b32 s18, s18, 2
    s_add_u32 s19, s19, s18
    s_add_u32 s19, s19, s21
    s_mul_i32 s19, s19, 7
    s_add_u32 s19, s19, s26
    s_lshl_b32 s19, s19, 11
    s_add_u32 s19, s19, 6422528
    s_add_u32 s18, s29, 21
    s_lshl_b32 s18, s18, 11
    s_add_u32 s18, s18, 0
    s_cmp_eq_u32 s28, 1
    s_cselect_b32 s18, s19, s18
    v_mfma_f32_16x16x32_bf16 v[8:11], a[64:67], v[128:131], 0
    v_mfma_f32_16x16x32_bf16 v[8:11], a[68:71], v[132:135], v[8:11]
    v_mfma_f32_16x16x32_bf16 v[8:11], a[72:75], v[136:139], v[8:11]
    v_mfma_f32_16x16x32_bf16 v[8:11], a[76:79], v[140:143], v[8:11]
    v_mfma_f32_16x16x32_bf16 v[8:11], a[80:83], v[144:147], v[8:11]
    v_mfma_f32_16x16x32_bf16 v[8:11], a[84:87], v[148:151], v[8:11]
    v_mfma_f32_16x16x32_bf16 v[8:11], a[88:91], v[152:155], v[8:11]
    v_mfma_f32_16x16x32_bf16 v[8:11], a[92:95], v[156:159], v[8:11]
    v_mfma_f32_16x16x32_bf16 v[12:15], a[96:99], v[128:131], 0
    v_mfma_f32_16x16x32_bf16 v[12:15], a[100:103], v[132:135], v[12:15]
    v_mfma_f32_16x16x32_bf16 v[12:15], a[104:107], v[136:139], v[12:15]
    v_mfma_f32_16x16x32_bf16 v[12:15], a[108:111], v[140:143], v[12:15]
    v_mfma_f32_16x16x32_bf16 v[12:15], a[112:115], v[144:147], v[12:15]
    v_mfma_f32_16x16x32_bf16 v[12:15], a[116:119], v[148:151], v[12:15]
    v_mfma_f32_16x16x32_bf16 v[12:15], a[120:123], v[152:155], v[12:15]
    v_mfma_f32_16x16x32_bf16 v[12:15], a[124:127], v[156:159], v[12:15]
    s_nop 7
    v_cvt_pk_bf16_f32 v28, v8, v9
    v_cvt_pk_bf16_f32 v29, v10, v11
    v_cvt_pk_bf16_f32 v30, v12, v13
    v_cvt_pk_bf16_f32 v31, v14, v15
    buffer_store_dwordx4 v[28:31], v7, s[4:7], s18 offen offset:1024 sc1
    s_add_u32 s18, s31, 4
    s_lshr_b32 s19, s18, 1
    s_lshl_b32 s19, s19, 5
    s_and_b32 s18, s18, 1
    s_lshl_b32 s18, s18, 2
    s_add_u32 s19, s19, s18
    s_add_u32 s19, s19, s21
    s_mul_i32 s19, s19, 7
    s_add_u32 s19, s19, s26
    s_lshl_b32 s19, s19, 11
    s_add_u32 s19, s19, 6422528
    s_add_u32 s18, s29, 28
    s_lshl_b32 s18, s18, 11
    s_add_u32 s18, s18, 0
    s_cmp_eq_u32 s28, 1
    s_cselect_b32 s18, s19, s18
    v_mfma_f32_16x16x32_bf16 v[8:11], a[64:67], v[160:163], 0
    v_mfma_f32_16x16x32_bf16 v[8:11], a[68:71], v[164:167], v[8:11]
    v_mfma_f32_16x16x32_bf16 v[8:11], a[72:75], v[168:171], v[8:11]
    v_mfma_f32_16x16x32_bf16 v[8:11], a[76:79], v[172:175], v[8:11]
    v_mfma_f32_16x16x32_bf16 v[8:11], a[80:83], v[176:179], v[8:11]
    v_mfma_f32_16x16x32_bf16 v[8:11], a[84:87], v[180:183], v[8:11]
    v_mfma_f32_16x16x32_bf16 v[8:11], a[88:91], v[184:187], v[8:11]
    v_mfma_f32_16x16x32_bf16 v[8:11], a[92:95], v[188:191], v[8:11]
    v_mfma_f32_16x16x32_bf16 v[12:15], a[96:99], v[160:163], 0
    v_mfma_f32_16x16x32_bf16 v[12:15], a[100:103], v[164:167], v[12:15]
    v_mfma_f32_16x16x32_bf16 v[12:15], a[104:107], v[168:171], v[12:15]
    v_mfma_f32_16x16x32_bf16 v[12:15], a[108:111], v[172:175], v[12:15]
    v_mfma_f32_16x16x32_bf16 v[12:15], a[112:115], v[176:179], v[12:15]
    v_mfma_f32_16x16x32_bf16 v[12:15], a[116:119], v[180:183], v[12:15]
    v_mfma_f32_16x16x32_bf16 v[12:15], a[120:123], v[184:187], v[12:15]
    v_mfma_f32_16x16x32_bf16 v[12:15], a[124:127], v[188:191], v[12:15]
    s_nop 7
    v_cvt_pk_bf16_f32 v24, v8, v9
    v_cvt_pk_bf16_f32 v25, v10, v11
    v_cvt_pk_bf16_f32 v26, v12, v13
    v_cvt_pk_bf16_f32 v27, v14, v15
    buffer_store_dwordx4 v[24:27], v7, s[4:7], s18 offen offset:1024 sc1
    s_add_u32 s18, s31, 5
    s_lshr_b32 s19, s18, 1
    s_lshl_b32 s19, s19, 5
    s_and_b32 s18, s18, 1
    s_lshl_b32 s18, s18, 2
    s_add_u32 s19, s19, s18
    s_add_u32 s19, s19, s21
    s_mul_i32 s19, s19, 7
    s_add_u32 s19, s19, s26
    s_lshl_b32 s19, s19, 11
    s_add_u32 s19, s19, 6422528
    s_add_u32 s18, s29, 35
    s_lshl_b32 s18, s18, 11
    s_add_u32 s18, s18, 0
    s_cmp_eq_u32 s28, 1
    s_cselect_b32 s18, s19, s18
    v_mfma_f32_16x16x32_bf16 v[8:11], a[64:67], v[192:195], 0
    v_mfma_f32_16x16x32_bf16 v[8:11], a[68:71], v[196:199], v[8:11]
    v_mfma_f32_16x16x32_bf16 v[8:11], a[72:75], v[200:203], v[8:11]
    v_mfma_f32_16x16x32_bf16 v[8:11], a[76:79], v[204:207], v[8:11]
    v_mfma_f32_16x16x32_bf16 v[8:11], a[80:83], v[208:211], v[8:11]
    v_mfma_f32_16x16x32_bf16 v[8:11], a[84:87], v[212:215], v[8:11]
    v_mfma_f32_16x16x32_bf16 v[8:11], a[88:91], v[216:219], v[8:11]
    v_mfma_f32_16x16x32_bf16 v[8:11], a[92:95], v[220:223], v[8:11]
    v_mfma_f32_16x16x32_bf16 v[12:15], a[96:99], v[192:195], 0
    v_mfma_f32_16x16x32_bf16 v[12:15], a[100:103], v[196:199], v[12:15]
    v_mfma_f32_16x16x32_bf16 v[12:15], a[104:107], v[200:203], v[12:15]
    v_mfma_f32_16x16x32_bf16 v[12:15], a[108:111], v[204:207], v[12:15]
    v_mfma_f32_16x16x32_bf16 v[12:15], a[112:115], v[208:211], v[12:15]
    v_mfma_f32_16x16x32_bf16 v[12:15], a[116:119], v[212:215], v[12:15]
    v_mfma_f32_16x16x32_bf16 v[12:15], a[120:123], v[216:219], v[12:15]
    v_mfma_f32_16x16x32_bf16 v[12:15], a[124:127], v[220:223], v[12:15]
    s_nop 7
    v_cvt_pk_bf16_f32 v28, v8, v9
    v_cvt_pk_bf16_f32 v29, v10, v11
    v_cvt_pk_bf16_f32 v30, v12, v13
    v_cvt_pk_bf16_f32 v31, v14, v15
    buffer_store_dwordx4 v[28:31], v7, s[4:7], s18 offen offset:1024 sc1
    s_add_u32 s18, s31, 6
    s_lshr_b32 s19, s18, 1
    s_lshl_b32 s19, s19, 5
    s_and_b32 s18, s18, 1
    s_lshl_b32 s18, s18, 2
    s_add_u32 s19, s19, s18
    s_add_u32 s19, s19, s21
    s_mul_i32 s19, s19, 7
    s_add_u32 s19, s19, s26
    s_lshl_b32 s19, s19, 11
    s_add_u32 s19, s19, 6422528
    s_add_u32 s18, s29, 42
    s_lshl_b32 s18, s18, 11
    s_add_u32 s18, s18, 0
    s_cmp_eq_u32 s28, 1
    s_cselect_b32 s18, s19, s18
    v_mfma_f32_16x16x32_bf16 v[8:11], a[64:67], v[224:227], 0
    v_mfma_f32_16x16x32_bf16 v[8:11], a[68:71], v[228:231], v[8:11]
    v_mfma_f32_16x16x32_bf16 v[8:11], a[72:75], v[232:235], v[8:11]
    v_mfma_f32_16x16x32_bf16 v[8:11], a[76:79], v[236:239], v[8:11]
    v_mfma_f32_16x16x32_bf16 v[8:11], a[80:83], v[240:243], v[8:11]
    v_mfma_f32_16x16x32_bf16 v[8:11], a[84:87], v[244:247], v[8:11]
    v_mfma_f32_16x16x32_bf16 v[8:11], a[88:91], v[248:251], v[8:11]
    v_mfma_f32_16x16x32_bf16 v[8:11], a[92:95], v[252:255], v[8:11]
    v_mfma_f32_16x16x32_bf16 v[12:15], a[96:99], v[224:227], 0
    v_mfma_f32_16x16x32_bf16 v[12:15], a[100:103], v[228:231], v[12:15]
    v_mfma_f32_16x16x32_bf16 v[12:15], a[104:107], v[232:235], v[12:15]
    v_mfma_f32_16x16x32_bf16 v[12:15], a[108:111], v[236:239], v[12:15]
    v_mfma_f32_16x16x32_bf16 v[12:15], a[112:115], v[240:243], v[12:15]
    v_mfma_f32_16x16x32_bf16 v[12:15], a[116:119], v[244:247], v[12:15]
    v_mfma_f32_16x16x32_bf16 v[12:15], a[120:123], v[248:251], v[12:15]
    v_mfma_f32_16x16x32_bf16 v[12:15], a[124:127], v[252:255], v[12:15]
    s_nop 7
    v_cvt_pk_bf16_f32 v24, v8, v9
    v_cvt_pk_bf16_f32 v25, v10, v11
    v_cvt_pk_bf16_f32 v26, v12, v13
    v_cvt_pk_bf16_f32 v27, v14, v15
    buffer_store_dwordx4 v[24:27], v7, s[4:7], s18 offen offset:1024 sc1
gudone_29:
    s_load_dwordx2 s[20:21], s[0:1], 120
    s_load_dwordx2 s[22:23], s[0:1], 8
    s_barrier
    v_mov_b32 v2, 163824
    ds_read_b32 v4, v2
    s_waitcnt lgkmcnt(0)
    v_readfirstlane_b32 s88, v4
    s_mov_b32 s90, 0
    v_and_b32 v2, 7, v0
    v_lshlrev_b32 v2, 2, v2
reg_30:
    global_load_dword v4, v2, s[20:21] sc1
    s_waitcnt vmcnt(0)
    v_readlane_b32 s64, v4, 0
    v_readlane_b32 s65, v4, 1
    v_readlane_b32 s66, v4, 2
    v_readlane_b32 s67, v4, 3
    v_readlane_b32 s68, v4, 4
    v_readlane_b32 s69, v4, 5
    v_readlane_b32 s70, v4, 6
    v_readlane_b32 s71, v4, 7
    s_nop 3
    s_add_u32 s91, s64, s65
    s_add_u32 s91, s91, s66
    s_add_u32 s91, s91, s67
    s_add_u32 s91, s91, s68
    s_add_u32 s91, s91, s69
    s_add_u32 s91, s91, s70
    s_add_u32 s91, s91, s71
    s_cmp_ge_u32 s91, 256
    s_cbranch_scc1 regok_31
    s_sleep 2
    s_add_u32 s90, s90, 1
    s_cmp_lt_u32 s90, 400000
    s_cbranch_scc1 reg_30
    s_branch L_abort
regok_31:
    s_mov_b32 s91, 8
    s_cmp_ge_u32 s71, 30
    s_cselect_b32 s91, 7, s91
    s_cmp_ge_u32 s70, 30
    s_cselect_b32 s91, 6, s91
    s_cmp_ge_u32 s69, 30
    s_cselect_b32 s91, 5, s91
    s_cmp_ge_u32 s68, 30
    s_cselect_b32 s91, 4, s91
    s_cmp_ge_u32 s67, 30
    s_cselect_b32 s91, 3, s91
    s_cmp_ge_u32 s66, 30
    s_cselect_b32 s91, 2, s91
    s_cmp_ge_u32 s65, 30
    s_cselect_b32 s91, 1, s91
    s_cmp_ge_u32 s64, 30
    s_cselect_b32 s91, 0, s91
    s_mov_b32 s92, 0
    s_mov_b32 s93, 0
    s_cmp_le_u32 s89, 0
    s_cbranch_scc1 pf_32
    s_add_u32 s93, s93, s64
    s_cmp_eq_u32 s91, 0
    s_cbranch_scc1 pf_32
    s_add_u32 s92, s92, s64
pf_32:
    s_cmp_le_u32 s89, 1
    s_cbranch_scc1 pf_33
    s_add_u32 s93, s93, s65
    s_cmp_eq_u32 s91, 1
    s_cbranch_scc1 pf_33
    s_add_u32 s92, s92, s65
pf_33:
    s_cmp_le_u32 s89, 2
    s_cbranch_scc1 pf_34
    s_add_u32 s93, s93, s66
    s_cmp_eq_u32 s91, 2
    s_cbranch_scc1 pf_34
    s_add_u32 s92, s92, s66
pf_34:
    s_cmp_le_u32 s89, 3
    s_cbranch_scc1 pf_35
    s_add_u32 s93, s93, s67
    s_cmp_eq_u32 s91, 3
    s_cbranch_scc1 pf_35
    s_add_u32 s92, s92, s67
pf_35:
    s_cmp_le_u32 s89, 4
    s_cbranch_scc1 pf_36
    s_add_u32 s93, s93, s68
    s_cmp_eq_u32 s91, 4
    s_cbranch_scc1 pf_36
    s_add_u32 s92, s92, s68
pf_36:
    s_cmp_le_u32 s89, 5
    s_cbranch_scc1 pf_37
    s_add_u32 s93, s93, s69
    s_cmp_eq_u32 s91, 5
    s_cbranch_scc1 pf_37
    s_add_u32 s92, s92, s69
pf_37:
    s_cmp_le_u32 s89, 6
    s_cbranch_scc1 pf_38
    s_add_u32 s93, s93, s70
    s_cmp_eq_u32 s91, 6
    s_cbranch_scc1 pf_38
    s_add_u32 s92, s92, s70
pf_38:
    s_cmp_le_u32 s89, 7
    s_cbranch_scc1 pf_39
    s_add_u32 s93, s93, s71
    s_cmp_eq_u32 s91, 7
    s_cbranch_scc1 pf_39
    s_add_u32 s92, s92, s71
pf_39:
    s_cmp_eq_u32 s91, 8
    s_cselect_b32 s74, 0, s91
    s_cmp_eq_u32 s91, 8
    s_cbranch_scc1 slow_40
    s_mov_b32 s83, 0
    s_cmp_lg_u32 s89, s91
    s_cbranch_scc1 isx_42
    s_cmp_lt_u32 s88, 30
    s_cbranch_scc1 L_R_entry
    s_mov_b32 s82, 256
    s_cmp_eq_u32 s91, 0
    s_cselect_b32 s92, s64, 0
    s_sub_u32 s82, s82, s92
    s_cmp_eq_u32 s91, 1
    s_cselect_b32 s92, s65, 0
    s_sub_u32 s82, s82, s92
    s_cmp_eq_u32 s91, 2
    s_cselect_b32 s92, s66, 0
    s_sub_u32 s82, s82, s92
    s_cmp_eq_u32 s91, 3
    s_cselect_b32 s92, s67, 0
    s_sub_u32 s82, s82, s92
    s_cmp_eq_u32 s91, 4
    s_cselect_b32 s92, s68, 0
    s_sub_u32 s82, s82, s92
    s_cmp_eq_u32 s91, 5
    s_cselect_b32 s92, s69, 0
    s_sub_u32 s82, s82, s92
    s_cmp_eq_u32 s91, 6
    s_cselect_b32 s92, s70, 0
    s_sub_u32 s82, s82, s92
    s_cmp_eq_u32 s91, 7
    s_cselect_b32 s92, s71, 0
    s_sub_u32 s82, s82, s92
    s_add_u32 s82, s82, s88
    s_sub_u32 s82, s82, 30
    s_branch dec_41
isx_42:
    s_add_u32 s82, s92, s88
    s_branch dec_41
slow_40:
    s_mov_b32 s83, 1
    s_add_u32 s88, s93, s88
    s_cmp_lt_u32 s88, 30
    s_cbranch_scc1 L_R_entry
    s_sub_u32 s82, s88, 30
dec_41:
    s_and_b32 s93, s84, 15
    s_lshl_b32 s93, s93, 6
    s_cmp_ge_u32 s84, 128
    s_cselect_b32 s93, 1024, s93
    s_add_u32 s93, s93, 90976256
    s_waitcnt vmcnt(0)
    s_barrier
    s_cmp_lg_u32 s87, 0
    s_cbranch_scc1 sig_43
    v_mov_b32 v250, 0
    v_mov_b32 v251, 1
    s_mov_b64 exec, 1
    buffer_atomic_add v251, v250, s[4:7], s93 offen
    s_mov_b64 exec, -1
sig_43:
    s_lshr_b32 s80, s82, 5
    s_and_b32 s81, s82, 31
    s_cmp_lt_u32 s80, 2
    s_cselect_b32 s85, 3, 2
    s_cmp_lg_u32 s87, 0
    s_cbranch_scc1 arr_44
    s_min_u32 s93, s80, 7
    s_lshl_b32 s93, s93, 6
    s_add_u32 s93, s93, 90978304
    v_accvgpr_write_b32 a246, 1
    v_mov_b32 v2, 0
    s_mov_b64 exec, 1
    s_nop 0
    buffer_atomic_add a246, v2, s[4:7], s93 offen sc0
    s_mov_b64 exec, -1
arr_44:
    s_mov_b32 s73, 0
    s_lshl_b32 s91, s85, 3
    s_cmp_lt_u32 s81, s91
    s_cselect_b32 s73, 1, 0
    s_cmp_lt_u32 s75, 256
    s_cselect_b32 s73, 0, s73
    s_cmp_ge_u32 s82, 224
    s_cselect_b32 s73, 0, s73
    s_cmp_lg_u32 s73, 0
    s_cbranch_scc1 lndefer_45
    s_cmp_ge_u32 s75, 256
    s_cbranch_scc1 noln_46
    s_mov_b32 s91, 64
    s_cmp_lg_u32 s87, 0
    s_cbranch_scc1 wsk_49
    s_load_dwordx2 s[96:97], s[0:1], 120
    s_waitcnt lgkmcnt(0)
    s_mov_b32 s90, 0
    v_mov_b32 v60, s91
wge_47:
    global_load_dword v61, v60, s[96:97] sc1
    s_waitcnt vmcnt(0)
    v_readfirstlane_b32 s92, v61
    s_nop 3
    s_cmp_ge_u32 s92, 14
    s_cbranch_scc1 wok_48
    s_sleep 2
    s_add_u32 s90, s90, 1
    s_cmp_lt_u32 s90, 400000
    s_cbranch_scc1 wge_47
    s_branch L_abort
wok_48:
wsk_49:
    s_barrier
    s_mov_b32 s3, s75
    v_and_b32 v1, 63, v0
    v_lshrrev_b32 v2, 6, v0
    s_nop 0
    v_readfirstlane_b32 s16, v2
    v_min_u32 v3, 55, v1
    v_lshrrev_b32 v4, 1, v3
    v_lshlrev_b32 v4, 4, v4
    v_and_b32 v5, 1, v3
    v_lshl_add_u32 v4, v5, 2, v4
    v_mul_u32_u24 v4, 2, v4
    v_lshlrev_b32 v5, 1, v4
    s_mov_b32 s21, 87054080
    buffer_load_dwordx4 v[40:43], v5, s[4:7], s21 offen sc1
    buffer_load_dwordx4 v[44:47], v5, s[4:7], s21 offen offset:32 sc1
    s_mov_b32 s21, 87052288
    buffer_load_dwordx4 v[48:51], v5, s[4:7], s21 offen sc1
    buffer_load_dwordx4 v[52:55], v5, s[4:7], s21 offen offset:32 sc1
    s_lshl_b32 s17, s3, 3
    s_lshl_b32 s16, s16, 1
    s_add_u32 s17, s17, s16
    s_mul_i32 s18, s17, 896
    v_accvgpr_read_b32 v8, a248
    v_accvgpr_read_b32 v9, a249
    v_accvgpr_read_b32 v10, a250
    v_accvgpr_read_b32 v11, a251
    v_accvgpr_read_b32 v12, a252
    v_accvgpr_read_b32 v13, a253
    v_accvgpr_read_b32 v14, a254
    v_accvgpr_read_b32 v15, a255
    s_mov_b32 s22, -1
    s_mov_b32 s23, 0x00ffffff
    s_waitcnt vmcnt(0)
    v_lshlrev_b32 v16, 16, v8
    v_and_b32 v17, 0xffff0000, v8
    v_lshlrev_b32 v18, 16, v9
    v_and_b32 v19, 0xffff0000, v9
    v_lshlrev_b32 v20, 16, v10
    v_and_b32 v21, 0xffff0000, v10
    v_lshlrev_b32 v22, 16, v11
    v_and_b32 v23, 0xffff0000, v11
    v_cndmask_b32 v16, 0, v16, s[22:23]
    v_cndmask_b32 v17, 0, v17, s[22:23]
    v_cndmask_b32 v18, 0, v18, s[22:23]
    v_cndmask_b32 v19, 0, v19, s[22:23]
    v_cndmask_b32 v20, 0, v20, s[22:23]
    v_cndmask_b32 v21, 0, v21, s[22:23]
    v_cndmask_b32 v22, 0, v22, s[22:23]
    v_cndmask_b32 v23, 0, v23, s[22:23]
    v_lshlrev_b32 v24, 16, v12
    v_and_b32 v25, 0xffff0000, v12
    v_lshlrev_b32 v26, 16, v13
    v_and_b32 v27, 0xffff0000, v13
    v_lshlrev_b32 v28, 16, v14
    v_and_b32 v29, 0xffff0000, v14
    v_lshlrev_b32 v30, 16, v15
    v_and_b32 v31, 0xffff0000, v15
    v_cndmask_b32 v24, 0, v24, s[22:23]
    v_cndmask_b32 v25, 0, v25, s[22:23]
    v_cndmask_b32 v26, 0, v26, s[22:23]
    v_cndmask_b32 v27, 0, v27, s[22:23]
    v_cndmask_b32 v28, 0, v28, s[22:23]
    v_cndmask_b32 v29, 0, v29, s[22:23]
    v_cndmask_b32 v30, 0, v30, s[22:23]
    v_cndmask_b32 v31, 0, v31, s[22:23]
    v_add_f32 v40, 1.0, v40
    v_add_f32 v41, 1.0, v41
    v_cvt_pk_bf16_f32 v6, v40, v41
    v_lshlrev_b32 v40, 16, v6
    v_and_b32 v41, 0xffff0000, v6
    v_add_f32 v42, 1.0, v42
    v_add_f32 v43, 1.0, v43
    v_cvt_pk_bf16_f32 v6, v42, v43
    v_lshlrev_b32 v42, 16, v6
    v_and_b32 v43, 0xffff0000, v6
    v_add_f32 v44, 1.0, v44
    v_add_f32 v45, 1.0, v45
    v_cvt_pk_bf16_f32 v6, v44, v45
    v_lshlrev_b32 v44, 16, v6
    v_and_b32 v45, 0xffff0000, v6
    v_add_f32 v46, 1.0, v46
    v_add_f32 v47, 1.0, v47
    v_cvt_pk_bf16_f32 v6, v46, v47
    v_lshlrev_b32 v46, 16, v6
    v_and_b32 v47, 0xffff0000, v6
    v_add_f32 v32, v16, v17
    v_add_f32 v32, v32, v18
    v_add_f32 v32, v32, v19
    v_add_f32 v32, v32, v20
    v_add_f32 v32, v32, v21
    v_add_f32 v32, v32, v22
    v_add_f32 v32, v32, v23
    v_add_f32 v33, v24, v25
    v_add_f32 v33, v33, v26
    v_add_f32 v33, v33, v27
    v_add_f32 v33, v33, v28
    v_add_f32 v33, v33, v29
    v_add_f32 v33, v33, v30
    v_add_f32 v33, v33, v31
    s_nop 1
    v_add_f32_dpp v32, v32, v32 quad_perm:[1,0,3,2] row_mask:0xf bank_mask:0xf
    v_add_f32_dpp v33, v33, v33 quad_perm:[1,0,3,2] row_mask:0xf bank_mask:0xf
    s_nop 1
    v_add_f32_dpp v32, v32, v32 quad_perm:[2,3,0,1] row_mask:0xf bank_mask:0xf
    v_add_f32_dpp v33, v33, v33 quad_perm:[2,3,0,1] row_mask:0xf bank_mask:0xf
    s_nop 1
    v_add_f32_dpp v32, v32, v32 row_half_mirror row_mask:0xf bank_mask:0xf
    v_add_f32_dpp v33, v33, v33 row_half_mirror row_mask:0xf bank_mask:0xf
    s_nop 1
    v_add_f32_dpp v32, v32, v32 row_mirror row_mask:0xf bank_mask:0xf
    v_add_f32_dpp v33, v33, v33 row_mirror row_mask:0xf bank_mask:0xf
    v_mov_b32 v56, v32
    v_mov_b32 v57, v33
    s_nop 1
    v_permlane16_swap_b32 v32, v56
    v_permlane16_swap_b32 v33, v57
    s_nop 1
    v_add_f32 v32, v32, v56
    v_add_f32 v33, v33, v57
    v_mov_b32 v56, v32
    v_mov_b32 v57, v33
    s_nop 1
    v_permlane32_swap_b32 v32, v56
    v_permlane32_swap_b32 v33, v57
    s_nop 1
    v_add_f32 v32, v32, v56
    v_add_f32 v33, v33, v57
    s_mov_b32 s20, 0x3b124925
    v_mul_f32 v32, s20, v32
    v_mul_f32 v33, s20, v33
    v_sub_f32 v56, v16, v32
    v_mul_f32 v34, v56, v56
    v_sub_f32 v56, v17, v32
    v_fmac_f32 v34, v56, v56
    v_sub_f32 v56, v18, v32
    v_fmac_f32 v34, v56, v56
    v_sub_f32 v56, v19, v32
    v_fmac_f32 v34, v56, v56
    v_sub_f32 v56, v20, v32
    v_fmac_f32 v34, v56, v56
    v_sub_f32 v56, v21, v32
    v_fmac_f32 v34, v56, v56
    v_sub_f32 v56, v22, v32
    v_fmac_f32 v34, v56, v56
    v_sub_f32 v56, v23, v32
    v_fmac_f32 v34, v56, v56
    v_cndmask_b32 v34, 0, v34, s[22:23]
    v_sub_f32 v56, v24, v33
    v_mul_f32 v35, v56, v56
    v_sub_f32 v56, v25, v33
    v_fmac_f32 v35, v56, v56
    v_sub_f32 v56, v26, v33
    v_fmac_f32 v35, v56, v56
    v_sub_f32 v56, v27, v33
    v_fmac_f32 v35, v56, v56
    v_sub_f32 v56, v28, v33
    v_fmac_f32 v35, v56, v56
    v_sub_f32 v56, v29, v33
    v_fmac_f32 v35, v56, v56
    v_sub_f32 v56, v30, v33
    v_fmac_f32 v35, v56, v56
    v_sub_f32 v56, v31, v33
    v_fmac_f32 v35, v56, v56
    v_cndmask_b32 v35, 0, v35, s[22:23]
    s_nop 1
    v_add_f32_dpp v34, v34, v34 quad_perm:[1,0,3,2] row_mask:0xf bank_mask:0xf
    v_add_f32_dpp v35, v35, v35 quad_perm:[1,0,3,2] row_mask:0xf bank_mask:0xf
    s_nop 1
    v_add_f32_dpp v34, v34, v34 quad_perm:[2,3,0,1] row_mask:0xf bank_mask:0xf
    v_add_f32_dpp v35, v35, v35 quad_perm:[2,3,0,1] row_mask:0xf bank_mask:0xf
    s_nop 1
    v_add_f32_dpp v34, v34, v34 row_half_mirror row_mask:0xf bank_mask:0xf
    v_add_f32_dpp v35, v35, v35 row_half_mirror row_mask:0xf bank_mask:0xf
    s_nop 1
    v_add_f32_dpp v34, v34, v34 row_mirror row_mask:0xf bank_mask:0xf
    v_add_f32_dpp v35, v35, v35 row_mirror row_mask:0xf bank_mask:0xf
    v_mov_b32 v56, v34
    v_mov_b32 v57, v35
    s_nop 1
    v_permlane16_swap_b32 v34, v56
    v_permlane16_swap_b32 v35, v57
    s_nop 1
    v_add_f32 v34, v34, v56
    v_add_f32 v35, v35, v57
    v_mov_b32 v56, v34
    v_mov_b32 v57, v35
    s_nop 1
    v_permlane32_swap_b32 v34, v56
    v_permlane32_swap_b32 v35, v57
    s_nop 1
    v_add_f32 v34, v34, v56
    v_add_f32 v35, v35, v57
    v_mul_f32 v34, s20, v34
    v_cvt_pk_bf16_f32 v56, v32, v34
    v_lshlrev_b32 v32, 16, v56
    v_and_b32 v34, 0xffff0000, v56
    v_add_f32 v34, 0x3727c5ac, v34
    v_cvt_pk_bf16_f32 v56, v34, v34
    v_lshlrev_b32 v34, 16, v56
    v_sqrt_f32 v34, v34
    s_nop 0
    v_cvt_pk_bf16_f32 v56, v34, v34
    v_lshlrev_b32 v34, 16, v56
    v_rcp_f32 v34, v34
    s_nop 0
    v_mul_f32 v35, s20, v35
    v_cvt_pk_bf16_f32 v56, v33, v35
    v_lshlrev_b32 v33, 16, v56
    v_and_b32 v35, 0xffff0000, v56
    v_add_f32 v35, 0x3727c5ac, v35
    v_cvt_pk_bf16_f32 v56, v35, v35
    v_lshlrev_b32 v35, 16, v56
    v_sqrt_f32 v35, v35
    s_nop 0
    v_cvt_pk_bf16_f32 v56, v35, v35
    v_lshlrev_b32 v35, 16, v56
    v_rcp_f32 v35, v35
    s_nop 0
    v_sub_f32 v16, v16, v32
    v_sub_f32 v17, v17, v32
    v_cvt_pk_bf16_f32 v56, v16, v17
    v_lshlrev_b32 v16, 16, v56
    v_and_b32 v17, 0xffff0000, v56
    v_mul_f32 v16, v16, v34
    v_mul_f32 v17, v17, v34
    v_cvt_pk_bf16_f32 v56, v16, v17
    v_lshlrev_b32 v16, 16, v56
    v_and_b32 v17, 0xffff0000, v56
    v_mul_f32 v16, v16, v40
    v_mul_f32 v17, v17, v41
    v_cvt_pk_bf16_f32 v56, v16, v17
    v_lshlrev_b32 v16, 16, v56
    v_and_b32 v17, 0xffff0000, v56
    v_add_f32 v16, v16, v48
    v_add_f32 v17, v17, v49
    v_sub_f32 v18, v18, v32
    v_sub_f32 v19, v19, v32
    v_cvt_pk_bf16_f32 v56, v18, v19
    v_lshlrev_b32 v18, 16, v56
    v_and_b32 v19, 0xffff0000, v56
    v_mul_f32 v18, v18, v34
    v_mul_f32 v19, v19, v34
    v_cvt_pk_bf16_f32 v56, v18, v19
    v_lshlrev_b32 v18, 16, v56
    v_and_b32 v19, 0xffff0000, v56
    v_mul_f32 v18, v18, v42
    v_mul_f32 v19, v19, v43
    v_cvt_pk_bf16_f32 v56, v18, v19
    v_lshlrev_b32 v18, 16, v56
    v_and_b32 v19, 0xffff0000, v56
    v_add_f32 v18, v18, v50
    v_add_f32 v19, v19, v51
    v_sub_f32 v20, v20, v32
    v_sub_f32 v21, v21, v32
    v_cvt_pk_bf16_f32 v56, v20, v21
    v_lshlrev_b32 v20, 16, v56
    v_and_b32 v21, 0xffff0000, v56
    v_mul_f32 v20, v20, v34
    v_mul_f32 v21, v21, v34
    v_cvt_pk_bf16_f32 v56, v20, v21
    v_lshlrev_b32 v20, 16, v56
    v_and_b32 v21, 0xffff0000, v56
    v_mul_f32 v20, v20, v44
    v_mul_f32 v21, v21, v45
    v_cvt_pk_bf16_f32 v56, v20, v21
    v_lshlrev_b32 v20, 16, v56
    v_and_b32 v21, 0xffff0000, v56
    v_add_f32 v20, v20, v52
    v_add_f32 v21, v21, v53
    v_sub_f32 v22, v22, v32
    v_sub_f32 v23, v23, v32
    v_cvt_pk_bf16_f32 v56, v22, v23
    v_lshlrev_b32 v22, 16, v56
    v_and_b32 v23, 0xffff0000, v56
    v_mul_f32 v22, v22, v34
    v_mul_f32 v23, v23, v34
    v_cvt_pk_bf16_f32 v56, v22, v23
    v_lshlrev_b32 v22, 16, v56
    v_and_b32 v23, 0xffff0000, v56
    v_mul_f32 v22, v22, v46
    v_mul_f32 v23, v23, v47
    v_cvt_pk_bf16_f32 v56, v22, v23
    v_lshlrev_b32 v22, 16, v56
    v_and_b32 v23, 0xffff0000, v56
    v_add_f32 v22, v22, v54
    v_add_f32 v23, v23, v55
    v_sub_f32 v24, v24, v33
    v_sub_f32 v25, v25, v33
    v_cvt_pk_bf16_f32 v56, v24, v25
    v_lshlrev_b32 v24, 16, v56
    v_and_b32 v25, 0xffff0000, v56
    v_mul_f32 v24, v24, v35
    v_mul_f32 v25, v25, v35
    v_cvt_pk_bf16_f32 v56, v24, v25
    v_lshlrev_b32 v24, 16, v56
    v_and_b32 v25, 0xffff0000, v56
    v_mul_f32 v24, v24, v40
    v_mul_f32 v25, v25, v41
    v_cvt_pk_bf16_f32 v56, v24, v25
    v_lshlrev_b32 v24, 16, v56
    v_and_b32 v25, 0xffff0000, v56
    v_add_f32 v24, v24, v48
    v_add_f32 v25, v25, v49
    v_sub_f32 v26, v26, v33
    v_sub_f32 v27, v27, v33
    v_cvt_pk_bf16_f32 v56, v26, v27
    v_lshlrev_b32 v26, 16, v56
    v_and_b32 v27, 0xffff0000, v56
    v_mul_f32 v26, v26, v35
    v_mul_f32 v27, v27, v35
    v_cvt_pk_bf16_f32 v56, v26, v27
    v_lshlrev_b32 v26, 16, v56
    v_and_b32 v27, 0xffff0000, v56
    v_mul_f32 v26, v26, v42
    v_mul_f32 v27, v27, v43
    v_cvt_pk_bf16_f32 v56, v26, v27
    v_lshlrev_b32 v26, 16, v56
    v_and_b32 v27, 0xffff0000, v56
    v_add_f32 v26, v26, v50
    v_add_f32 v27, v27, v51
    v_sub_f32 v28, v28, v33
    v_sub_f32 v29, v29, v33
    v_cvt_pk_bf16_f32 v56, v28, v29
    v_lshlrev_b32 v28, 16, v56
    v_and_b32 v29, 0xffff0000, v56
    v_mul_f32 v28, v28, v35
    v_mul_f32 v29, v29, v35
    v_cvt_pk_bf16_f32 v56, v28, v29
    v_lshlrev_b32 v28, 16, v56
    v_and_b32 v29, 0xffff0000, v56
    v_mul_f32 v28, v28, v44
    v_mul_f32 v29, v29, v45
    v_cvt_pk_bf16_f32 v56, v28, v29
    v_lshlrev_b32 v28, 16, v56
    v_and_b32 v29, 0xffff0000, v56
    v_add_f32 v28, v28, v52
    v_add_f32 v29, v29, v53
    v_sub_f32 v30, v30, v33
    v_sub_f32 v31, v31, v33
    v_cvt_pk_bf16_f32 v56, v30, v31
    v_lshlrev_b32 v30, 16, v56
    v_and_b32 v31, 0xffff0000, v56
    v_mul_f32 v30, v30, v35
    v_mul_f32 v31, v31, v35
    v_cvt_pk_bf16_f32 v56, v30, v31
    v_lshlrev_b32 v30, 16, v56
    v_and_b32 v31, 0xffff0000, v56
    v_mul_f32 v30, v30, v46
    v_mul_f32 v31, v31, v47
    v_cvt_pk_bf16_f32 v56, v30, v31
    v_lshlrev_b32 v30, 16, v56
    v_and_b32 v31, 0xffff0000, v56
    v_add_f32 v30, v30, v54
    v_add_f32 v31, v31, v55
    s_lshr_b32 s18, s17, 5
    s_mul_i32 s18, s18, 28672
    s_and_b32 s19, s17, 31
    s_lshl_b32 s19, s19, 4
    s_add_u32 s18, s18, s19
    s_add_u32 s18, s18, 12845056
    v_lshlrev_b32 v6, 9, v3
    s_mov_b64 exec, s[22:23]
    v_cvt_pk_bf16_f32 v8, v16, v17
    v_cvt_pk_bf16_f32 v9, v18, v19
    v_cvt_pk_bf16_f32 v10, v20, v21
    v_cvt_pk_bf16_f32 v11, v22, v23
    buffer_store_dwordx4 v[8:11], v6, s[4:7], s18 offen offset:0 sc1
    v_cvt_pk_bf16_f32 v12, v24, v25
    v_cvt_pk_bf16_f32 v13, v26, v27
    v_cvt_pk_bf16_f32 v14, v28, v29
    v_cvt_pk_bf16_f32 v15, v30, v31
    buffer_store_dwordx4 v[12:15], v6, s[4:7], s18 offen offset:16 sc1
    s_mov_b64 exec, -1
    s_lshr_b32 s93, s75, 4
    s_lshl_b32 s93, s93, 6
    s_add_u32 s93, s93, 90975232
    s_waitcnt vmcnt(0)
    s_barrier
    s_cmp_lg_u32 s87, 0
    s_cbranch_scc1 sig_50
    v_mov_b32 v250, 0
    v_mov_b32 v251, 1
    s_mov_b64 exec, 1
    buffer_atomic_add v251, v250, s[4:7], s93 offen
    s_mov_b64 exec, -1
sig_50:
noln_46:
lndefer_45:
    s_cmp_ge_u32 s82, 224
    s_cbranch_scc1 L_done
    s_cmp_lg_u32 s87, 0
    s_cbranch_scc1 arr2_51
    s_waitcnt vmcnt(0)
    v_accvgpr_read_b32 v4, a246
    v_mov_b32 v2, 163824
    s_mov_b64 exec, 1
    ds_write_b32 v2, v4
    s_mov_b64 exec, -1
    s_waitcnt lgkmcnt(0)
arr2_51:
    s_barrier
    v_mov_b32 v2, 163824
    ds_read_b32 v4, v2
    s_waitcnt lgkmcnt(0)
    v_readfirstlane_b32 s81, v4
    s_nop 3
    s_and_b32 s81, s81, 31
    s_lshl_b32 s91, s85, 3
    s_cmp_ge_u32 s81, s91
    s_cbranch_scc1 nofast_52
    s_lshr_b32 s27, s81, 1
    s_mul_i32 s16, s81, 43
    s_lshr_b32 s16, s16, 7
    s_cmp_eq_u32 s85, 3
    s_cselect_b32 s27, s16, s27
    s_mul_i32 s16, s27, s85
    s_sub_u32 s17, s81, s16
    s_cmp_ge_u32 s80, s74
    s_cselect_b32 s18, 1, 0
    s_add_u32 s18, s18, s80
    s_lshl_b32 s19, s17, 3
    s_add_u32 s18, s18, s19
    s_lshl_b32 s19, s80, 3
    s_add_u32 s19, s19, s74
    s_cmp_eq_u32 s17, 2
    s_cselect_b32 s24, s19, s18
    s_lshr_b32 s25, s27, 2
    s_lshl_b32 s93, s25, 6
    s_add_u32 s93, s93, 90975232
    s_cmp_lg_u32 s87, 0
    s_cbranch_scc1 wsk_55
    s_mov_b32 s90, 0
    v_mov_b32 v250, 0
wge_53:
    buffer_load_dword v251, v250, s[4:7], s93 offen sc1
    s_waitcnt vmcnt(0)
    v_readfirstlane_b32 s92, v251
    s_nop 3
    s_cmp_ge_u32 s92, 16
    s_cbranch_scc1 wok_54
    s_sleep 2
    s_add_u32 s90, s90, 1
    s_cmp_lt_u32 s90, 400000
    s_cbranch_scc1 wge_53
    s_branch L_abort
wok_54:
wsk_55:
    s_barrier
    v_and_b32 v1, 63, v0
    v_lshrrev_b32 v8, 6, v0
    s_nop 0
    v_readfirstlane_b32 s26, v8
    v_lshrrev_b32 v8, 5, v1
    v_lshlrev_b32 v2, 8, v8
    v_bfe_u32 v9, v1, 2, 2
    v_lshl_add_u32 v2, v9, 6, v2
    v_bfe_u32 v10, v1, 4, 1
    v_lshl_add_u32 v2, v10, 5, v2
    v_and_b32 v11, 1, v1
    v_lshl_add_u32 v2, v11, 4, v2
    v_bfe_u32 v11, v1, 1, 1
    v_lshl_add_u32 v2, v11, 3, v2
    v_lshlrev_b32 v3, 10, v8
    v_lshl_add_u32 v3, v9, 6, v3
    v_lshl_add_u32 v3, v10, 5, v3
    v_and_b32 v11, 3, v1
    v_lshl_add_u32 v3, v11, 3, v3
    v_bfe_u32 v9, v1, 2, 3
    v_lshlrev_b32 v4, 13, v9
    v_lshl_add_u32 v4, v8, 6, v4
    v_lshl_add_u32 v4, v11, 4, v4
    v_mul_u32_u24 v5, 896, v9
    v_lshl_add_u32 v5, v8, 6, v5
    v_lshl_add_u32 v5, v11, 4, v5
    v_and_b32 v9, 31, v1
    v_lshlrev_b32 v6, 13, v9
    v_lshl_add_u32 v6, v8, 4, v6
    v_lshlrev_b32 v7, 10, v10
    v_lshl_add_u32 v7, v8, 8, v7
    v_and_b32 v9, 15, v1
    v_lshl_add_u32 v7, v9, 4, v7
    v_add_u32 v12, 57344, v2
    v_add_u32 v13, 57344, v3
    v_lshlrev_b32 v14, 4, v1
    v_add_u32 v15, 57344, v14
    s_load_dwordx2 s[8:9], s[0:1], 32
    s_waitcnt lgkmcnt(0)
    s_and_b32 s9, s9, 0xffff
    s_mov_b32 s10, 3670016
    s_mov_b32 s11, 0x20000
    s_load_dwordx2 s[12:13], s[0:1], 40
    s_waitcnt lgkmcnt(0)
    s_and_b32 s13, s13, 0xffff
    s_mov_b32 s14, 3670016
    s_mov_b32 s15, 0x20000
    s_barrier
    s_cmp_ge_u32 s26, 2
    s_cbranch_scc1 zld_56
    s_mul_i32 s16, s27, 28672
    s_add_u32 s16, s16, 12845056
    buffer_load_dwordx4 a[0:3], v14, s[4:7], s16 offen offset:0 sc1
    buffer_load_dwordx4 a[4:7], v14, s[4:7], s16 offen offset:1024 sc1
    buffer_load_dwordx4 a[8:11], v14, s[4:7], s16 offen offset:2048 sc1
    buffer_load_dwordx4 a[12:15], v14, s[4:7], s16 offen offset:3072 sc1
    s_add_u32 s16, s16, 4096
    buffer_load_dwordx4 a[16:19], v14, s[4:7], s16 offen offset:0 sc1
    buffer_load_dwordx4 a[20:23], v14, s[4:7], s16 offen offset:1024 sc1
    buffer_load_dwordx4 a[24:27], v14, s[4:7], s16 offen offset:2048 sc1
    buffer_load_dwordx4 a[28:31], v14, s[4:7], s16 offen offset:3072 sc1
    s_add_u32 s16, s16, 4096
    buffer_load_dwordx4 a[32:35], v14, s[4:7], s16 offen offset:0 sc1
    buffer_load_dwordx4 a[36:39], v14, s[4:7], s16 offen offset:1024 sc1
    buffer_load_dwordx4 a[40:43], v14, s[4:7], s16 offen offset:2048 sc1
    buffer_load_dwordx4 a[44:47], v14, s[4:7], s16 offen offset:3072 sc1
    s_add_u32 s16, s16, 4096
    buffer_load_dwordx4 a[48:51], v14, s[4:7], s16 offen offset:0 sc1
    buffer_load_dwordx4 a[52:55], v14, s[4:7], s16 offen offset:1024 sc1
    buffer_load_dwordx4 a[56:59], v14, s[4:7], s16 offen offset:2048 sc1
    buffer_load_dwordx4 a[60:63], v14, s[4:7], s16 offen offset:3072 sc1
    s_add_u32 s16, s16, 4096
    buffer_load_dwordx4 a[64:67], v14, s[4:7], s16 offen offset:0 sc1
    buffer_load_dwordx4 a[68:71], v14, s[4:7], s16 offen offset:1024 sc1
    buffer_load_dwordx4 a[72:75], v14, s[4:7], s16 offen offset:2048 sc1
    buffer_load_dwordx4 a[76:79], v14, s[4:7], s16 offen offset:3072 sc1
    s_add_u32 s16, s16, 4096
    buffer_load_dwordx4 a[80:83], v14, s[4:7], s16 offen offset:0 sc1
    buffer_load_dwordx4 a[84:87], v14, s[4:7], s16 offen offset:1024 sc1
    buffer_load_dwordx4 a[88:91], v14, s[4:7], s16 offen offset:2048 sc1
    buffer_load_dwordx4 a[92:95], v14, s[4:7], s16 offen offset:3072 sc1
    s_add_u32 s16, s16, 4096
    buffer_load_dwordx4 a[96:99], v14, s[4:7], s16 offen offset:0 sc1
    buffer_load_dwordx4 a[100:103], v14, s[4:7], s16 offen offset:1024 sc1
    buffer_load_dwordx4 a[104:107], v14, s[4:7], s16 offen offset:2048 sc1
    buffer_load_dwordx4 a[108:111], v14, s[4:7], s16 offen offset:3072 sc1
    s_add_u32 s16, s16, 4096
    s_lshl_b32 s18, s26, 9
    v_add_u32 v2, s18, v2
    v_add_u32 v3, s18, v3
    v_add_u32 v12, 57344, v2
    v_add_u32 v13, 65536, v3
    s_lshl_b32 s16, s26, 11
    s_add_u32 s16, s16, 122880
    v_add_u32 v8, s16, v14
    s_waitcnt vmcnt(0)
    s_barrier
    ds_read_b64_tr_b16 v[48:49], v2 offset:0
    ds_read_b64_tr_b16 v[50:51], v2 offset:1024
    ds_read_b64_tr_b16 v[56:57], v2 offset:2048
    ds_read_b64_tr_b16 v[58:59], v2 offset:3072
    ds_read_b64_tr_b16 v[64:65], v2 offset:4096
    ds_read_b64_tr_b16 v[66:67], v2 offset:5120
    s_waitcnt lgkmcnt(4)
    v_mfma_f32_32x32x16_bf16 v[16:31], v[48:51], a[0:3], 0
    ds_read_b64_tr_b16 v[48:49], v2 offset:6144
    ds_read_b64_tr_b16 v[50:51], v2 offset:7168
    s_waitcnt lgkmcnt(4)
    v_mfma_f32_32x32x16_bf16 v[16:31], v[56:59], a[4:7], v[16:31]
    ds_read_b64_tr_b16 v[56:57], v2 offset:8192
    ds_read_b64_tr_b16 v[58:59], v2 offset:9216
    s_waitcnt lgkmcnt(4)
    v_mfma_f32_32x32x16_bf16 v[16:31], v[64:67], a[8:11], v[16:31]
    ds_read_b64_tr_b16 v[64:65], v2 offset:10240
    ds_read_b64_tr_b16 v[66:67], v2 offset:11264
    s_waitcnt lgkmcnt(4)
    v_mfma_f32_32x32x16_bf16 v[16:31], v[48:51], a[12:15], v[16:31]
    ds_read_b64_tr_b16 v[48:49], v2 offset:12288
    ds_read_b64_tr_b16 v[50:51], v2 offset:13312
    s_waitcnt lgkmcnt(4)
    v_mfma_f32_32x32x16_bf16 v[16:31], v[56:59], a[16:19], v[16:31]
    ds_read_b64_tr_b16 v[56:57], v2 offset:14336
    ds_read_b64_tr_b16 v[58:59], v2 offset:15360
    s_waitcnt lgkmcnt(4)
    v_mfma_f32_32x32x16_bf16 v[16:31], v[64:67], a[20:23], v[16:31]
    ds_read_b64_tr_b16 v[64:65], v2 offset:16384
    ds_read_b64_tr_b16 v[66:67], v2 offset:17408
    s_waitcnt lgkmcnt(4)
    v_mfma_f32_32x32x16_bf16 v[16:31], v[48:51], a[24:27], v[16:31]
    ds_read_b64_tr_b16 v[48:49], v2 offset:18432
    ds_read_b64_tr_b16 v[50:51], v2 offset:19456
    s_waitcnt lgkmcnt(4)
    v_mfma_f32_32x32x16_bf16 v[16:31], v[56:59], a[28:31], v[16:31]
    ds_read_b64_tr_b16 v[56:57], v2 offset:20480
    ds_read_b64_tr_b16 v[58:59], v2 offset:21504
    s_waitcnt lgkmcnt(4)
    v_mfma_f32_32x32x16_bf16 v[16:31], v[64:67], a[32:35], v[16:31]
    ds_read_b64_tr_b16 v[64:65], v2 offset:22528
    ds_read_b64_tr_b16 v[66:67], v2 offset:23552
    s_waitcnt lgkmcnt(4)
    v_mfma_f32_32x32x16_bf16 v[16:31], v[48:51], a[36:39], v[16:31]
    ds_read_b64_tr_b16 v[48:49], v2 offset:24576
    ds_read_b64_tr_b16 v[50:51], v2 offset:25600
    s_waitcnt lgkmcnt(4)
    v_mfma_f32_32x32x16_bf16 v[16:31], v[56:59], a[40:43], v[16:31]
    ds_read_b64_tr_b16 v[56:57], v2 offset:26624
    ds_read_b64_tr_b16 v[58:59], v2 offset:27648
    s_waitcnt lgkmcnt(4)
    v_mfma_f32_32x32x16_bf16 v[16:31], v[64:67], a[44:47], v[16:31]
    s_waitcnt lgkmcnt(2)
    v_mfma_f32_32x32x16_bf16 v[16:31], v[48:51], a[48:51], v[16:31]
    s_waitcnt lgkmcnt(0)
    v_mfma_f32_32x32x16_bf16 v[16:31], v[56:59], a[52:55], v[16:31]
    s_barrier
    ds_read_b64_tr_b16 v[48:49], v2 offset:28672
    ds_read_b64_tr_b16 v[50:51], v2 offset:29696
    ds_read_b64_tr_b16 v[56:57], v2 offset:30720
    ds_read_b64_tr_b16 v[58:59], v2 offset:31744
    ds_read_b64_tr_b16 v[64:65], v2 offset:32768
    ds_read_b64_tr_b16 v[66:67], v2 offset:33792
    s_waitcnt lgkmcnt(4)
    v_mfma_f32_32x32x16_bf16 v[16:31], v[48:51], a[56:59], v[16:31]
    ds_read_b64_tr_b16 v[48:49], v2 offset:34816
    ds_read_b64_tr_b16 v[50:51], v2 offset:35840
    s_waitcnt lgkmcnt(4)
    v_mfma_f32_32x32x16_bf16 v[16:31], v[56:59], a[60:63], v[16:31]
    ds_read_b64_tr_b16 v[56:57], v2 offset:36864
    ds_read_b64_tr_b16 v[58:59], v2 offset:37888
    s_waitcnt lgkmcnt(4)
    v_mfma_f32_32x32x16_bf16 v[16:31], v[64:67], a[64:67], v[16:31]
    ds_read_b64_tr_b16 v[64:65], v2 offset:38912
    ds_read_b64_tr_b16 v[66:67], v2 offset:39936
    s_waitcnt lgkmcnt(4)
    v_mfma_f32_32x32x16_bf16 v[16:31], v[48:51], a[68:71], v[16:31]
    ds_read_b64_tr_b16 v[48:49], v2 offset:40960
    ds_read_b64_tr_b16 v[50:51], v2 offset:41984
    s_waitcnt lgkmcnt(4)
    v_mfma_f32_32x32x16_bf16 v[16:31], v[56:59], a[72:75], v[16:31]
    ds_read_b64_tr_b16 v[56:57], v2 offset:43008
    ds_read_b64_tr_b16 v[58:59], v2 offset:44032
    s_waitcnt lgkmcnt(4)
    v_mfma_f32_32x32x16_bf16 v[16:31], v[64:67], a[76:79], v[16:31]
    ds_read_b64_tr_b16 v[64:65], v2 offset:45056
    ds_read_b64_tr_b16 v[66:67], v2 offset:46080
    s_waitcnt lgkmcnt(4)
    v_mfma_f32_32x32x16_bf16 v[16:31], v[48:51], a[80:83], v[16:31]
    ds_read_b64_tr_b16 v[48:49], v2 offset:47104
    ds_read_b64_tr_b16 v[50:51], v2 offset:48128
    s_waitcnt lgkmcnt(4)
    v_mfma_f32_32x32x16_bf16 v[16:31], v[56:59], a[84:87], v[16:31]
    ds_read_b64_tr_b16 v[56:57], v2 offset:49152
    ds_read_b64_tr_b16 v[58:59], v2 offset:50176
    s_waitcnt lgkmcnt(4)
    v_mfma_f32_32x32x16_bf16 v[16:31], v[64:67], a[88:91], v[16:31]
    ds_read_b64_tr_b16 v[64:65], v2 offset:51200
    ds_read_b64_tr_b16 v[66:67], v2 offset:52224
    s_waitcnt lgkmcnt(4)
    v_mfma_f32_32x32x16_bf16 v[16:31], v[48:51], a[92:95], v[16:31]
    ds_read_b64_tr_b16 v[48:49], v2 offset:53248
    ds_read_b64_tr_b16 v[50:51], v2 offset:54272
    s_waitcnt lgkmcnt(4)
    v_mfma_f32_32x32x16_bf16 v[16:31], v[56:59], a[96:99], v[16:31]
    ds_read_b64_tr_b16 v[56:57], v2 offset:55296
    ds_read_b64_tr_b16 v[58:59], v2 offset:56320
    s_waitcnt lgkmcnt(4)
    v_mfma_f32_32x32x16_bf16 v[16:31], v[64:67], a[100:103], v[16:31]
    s_waitcnt lgkmcnt(2)
    v_mfma_f32_32x32x16_bf16 v[16:31], v[48:51], a[104:107], v[16:31]
    s_waitcnt lgkmcnt(0)
    v_mfma_f32_32x32x16_bf16 v[16:31], v[56:59], a[108:111], v[16:31]
    s_nop 11
    v_cvt_pk_bf16_f32 v72, v16, v17
    v_cvt_pk_bf16_f32 v73, v18, v19
    v_cvt_pk_bf16_f32 v74, v20, v21
    v_cvt_pk_bf16_f32 v75, v22, v23
    v_cvt_pk_bf16_f32 v76, v24, v25
    v_cvt_pk_bf16_f32 v77, v26, v27
    v_cvt_pk_bf16_f32 v78, v28, v29
    v_cvt_pk_bf16_f32 v79, v30, v31
    ds_write_b128 v8, v[72:75] offset:0
    ds_write_b128 v8, v[76:79] offset:1024
    s_barrier
    ds_read_b64_tr_b16 v[48:49], v12 offset:0
    ds_read_b64_tr_b16 v[50:51], v12 offset:1024
    ds_read_b64_tr_b16 v[56:57], v12 offset:2048
    ds_read_b64_tr_b16 v[58:59], v12 offset:3072
    ds_read_b64_tr_b16 v[64:65], v12 offset:4096
    ds_read_b64_tr_b16 v[66:67], v12 offset:5120
    s_waitcnt lgkmcnt(4)
    v_mfma_f32_32x32x16_bf16 v[16:31], v[48:51], a[0:3], 0
    ds_read_b64_tr_b16 v[48:49], v12 offset:6144
    ds_read_b64_tr_b16 v[50:51], v12 offset:7168
    s_waitcnt lgkmcnt(4)
    v_mfma_f32_32x32x16_bf16 v[16:31], v[56:59], a[4:7], v[16:31]
    ds_read_b64_tr_b16 v[56:57], v12 offset:8192
    ds_read_b64_tr_b16 v[58:59], v12 offset:9216
    s_waitcnt lgkmcnt(4)
    v_mfma_f32_32x32x16_bf16 v[16:31], v[64:67], a[8:11], v[16:31]
    ds_read_b64_tr_b16 v[64:65], v12 offset:10240
    ds_read_b64_tr_b16 v[66:67], v12 offset:11264
    s_waitcnt lgkmcnt(4)
    v_mfma_f32_32x32x16_bf16 v[16:31], v[48:51], a[12:15], v[16:31]
    ds_read_b64_tr_b16 v[48:49], v12 offset:12288
    ds_read_b64_tr_b16 v[50:51], v12 offset:13312
    s_waitcnt lgkmcnt(4)
    v_mfma_f32_32x32x16_bf16 v[16:31], v[56:59], a[16:19], v[16:31]
    ds_read_b64_tr_b16 v[56:57], v12 offset:14336
    ds_read_b64_tr_b16 v[58:59], v12 offset:15360
    s_waitcnt lgkmcnt(4)
    v_mfma_f32_32x32x16_bf16 v[16:31], v[64:67], a[20:23], v[16:31]
    ds_read_b64_tr_b16 v[64:65], v12 offset:16384
    ds_read_b64_tr_b16 v[66:67], v12 offset:17408
    s_waitcnt lgkmcnt(4)
    v_mfma_f32_32x32x16_bf16 v[16:31], v[48:51], a[24:27], v[16:31]
    ds_read_b64_tr_b16 v[48:49], v12 offset:18432
    ds_read_b64_tr_b16 v[50:51], v12 offset:19456
    s_waitcnt lgkmcnt(4)
    v_mfma_f32_32x32x16_bf16 v[16:31], v[56:59], a[28:31], v[16:31]
    ds_read_b64_tr_b16 v[56:57], v12 offset:20480
    ds_read_b64_tr_b16 v[58:59], v12 offset:21504
    s_waitcnt lgkmcnt(4)
    v_mfma_f32_32x32x16_bf16 v[16:31], v[64:67], a[32:35], v[16:31]
    ds_read_b64_tr_b16 v[64:65], v12 offset:22528
    ds_read_b64_tr_b16 v[66:67], v12 offset:23552
    s_waitcnt lgkmcnt(4)
    v_mfma_f32_32x32x16_bf16 v[16:31], v[48:51], a[36:39], v[16:31]
    ds_read_b64_tr_b16 v[48:49], v12 offset:24576
    ds_read_b64_tr_b16 v[50:51], v12 offset:25600
    s_waitcnt lgkmcnt(4)
    v_mfma_f32_32x32x16_bf16 v[16:31], v[56:59], a[40:43], v[16:31]
    ds_read_b64_tr_b16 v[56:57], v12 offset:26624
    ds_read_b64_tr_b16 v[58:59], v12 offset:27648
    s_waitcnt lgkmcnt(4)
    v_mfma_f32_32x32x16_bf16 v[16:31], v[64:67], a[44:47], v[16:31]
    s_waitcnt lgkmcnt(2)
    v_mfma_f32_32x32x16_bf16 v[16:31], v[48:51], a[48:51], v[16:31]
    s_waitcnt lgkmcnt(0)
    v_mfma_f32_32x32x16_bf16 v[16:31], v[56:59], a[52:55], v[16:31]
    s_barrier
    ds_read_b64_tr_b16 v[48:49], v12 offset:28672
    ds_read_b64_tr_b16 v[50:51], v12 offset:29696
    ds_read_b64_tr_b16 v[56:57], v12 offset:30720
    ds_read_b64_tr_b16 v[58:59], v12 offset:31744
    ds_read_b64_tr_b16 v[64:65], v12 offset:32768
    ds_read_b64_tr_b16 v[66:67], v12 offset:33792
    s_waitcnt lgkmcnt(4)
    v_mfma_f32_32x32x16_bf16 v[16:31], v[48:51], a[56:59], v[16:31]
    ds_read_b64_tr_b16 v[48:49], v12 offset:34816
    ds_read_b64_tr_b16 v[50:51], v12 offset:35840
    s_waitcnt lgkmcnt(4)
    v_mfma_f32_32x32x16_bf16 v[16:31], v[56:59], a[60:63], v[16:31]
    ds_read_b64_tr_b16 v[56:57], v12 offset:36864
    ds_read_b64_tr_b16 v[58:59], v12 offset:37888
    s_waitcnt lgkmcnt(4)
    v_mfma_f32_32x32x16_bf16 v[16:31], v[64:67], a[64:67], v[16:31]
    ds_read_b64_tr_b16 v[64:65], v12 offset:38912
    ds_read_b64_tr_b16 v[66:67], v12 offset:39936
    s_waitcnt lgkmcnt(4)
    v_mfma_f32_32x32x16_bf16 v[16:31], v[48:51], a[68:71], v[16:31]
    ds_read_b64_tr_b16 v[48:49], v12 offset:40960
    ds_read_b64_tr_b16 v[50:51], v12 offset:41984
    s_waitcnt lgkmcnt(4)
    v_mfma_f32_32x32x16_bf16 v[16:31], v[56:59], a[72:75], v[16:31]
    ds_read_b64_tr_b16 v[56:57], v12 offset:43008
    ds_read_b64_tr_b16 v[58:59], v12 offset:44032
    s_waitcnt lgkmcnt(4)
    v_mfma_f32_32x32x16_bf16 v[16:31], v[64:67], a[76:79], v[16:31]
    ds_read_b64_tr_b16 v[64:65], v12 offset:45056
    ds_read_b64_tr_b16 v[66:67], v12 offset:46080
    s_waitcnt lgkmcnt(4)
    v_mfma_f32_32x32x16_bf16 v[16:31], v[48:51], a[80:83], v[16:31]
    ds_read_b64_tr_b16 v[48:49], v12 offset:47104
    ds_read_b64_tr_b16 v[50:51], v12 offset:48128
    s_waitcnt lgkmcnt(4)
    v_mfma_f32_32x32x16_bf16 v[16:31], v[56:59], a[84:87], v[16:31]
    ds_read_b64_tr_b16 v[56:57], v12 offset:49152
    ds_read_b64_tr_b16 v[58:59], v12 offset:50176
    s_waitcnt lgkmcnt(4)
    v_mfma_f32_32x32x16_bf16 v[16:31], v[64:67], a[88:91], v[16:31]
    ds_read_b64_tr_b16 v[64:65], v12 offset:51200
    ds_read_b64_tr_b16 v[66:67], v12 offset:52224
    s_waitcnt lgkmcnt(4)
    v_mfma_f32_32x32x16_bf16 v[16:31], v[48:51], a[92:95], v[16:31]
    ds_read_b64_tr_b16 v[48:49], v12 offset:53248
    ds_read_b64_tr_b16 v[50:51], v12 offset:54272
    s_waitcnt lgkmcnt(4)
    v_mfma_f32_32x32x16_bf16 v[16:31], v[56:59], a[96:99], v[16:31]
    ds_read_b64_tr_b16 v[56:57], v12 offset:55296
    ds_read_b64_tr_b16 v[58:59], v12 offset:56320
    s_waitcnt lgkmcnt(4)
    v_mfma_f32_32x32x16_bf16 v[16:31], v[64:67], a[100:103], v[16:31]
    s_waitcnt lgkmcnt(2)
    v_mfma_f32_32x32x16_bf16 v[16:31], v[48:51], a[104:107], v[16:31]
    s_waitcnt lgkmcnt(0)
    v_mfma_f32_32x32x16_bf16 v[16:31], v[56:59], a[108:111], v[16:31]
    s_nop 11
    v_cvt_pk_bf16_f32 v72, v16, v17
    v_cvt_pk_bf16_f32 v73, v18, v19
    v_cvt_pk_bf16_f32 v74, v20, v21
    v_cvt_pk_bf16_f32 v75, v22, v23
    v_cvt_pk_bf16_f32 v76, v24, v25
    v_cvt_pk_bf16_f32 v77, v26, v27
    v_cvt_pk_bf16_f32 v78, v28, v29
    v_cvt_pk_bf16_f32 v79, v30, v31
    ds_write_b128 v8, v[72:75] offset:4096
    ds_write_b128 v8, v[76:79] offset:5120
    s_barrier
    ds_read_b64_tr_b16 v[48:49], v2 offset:0
    ds_read_b64_tr_b16 v[50:51], v2 offset:1024
    ds_read_b64_tr_b16 v[56:57], v2 offset:2048
    ds_read_b64_tr_b16 v[58:59], v2 offset:3072
    ds_read_b64_tr_b16 v[64:65], v2 offset:4096
    ds_read_b64_tr_b16 v[66:67], v2 offset:5120
    s_waitcnt lgkmcnt(4)
    v_mfma_f32_32x32x16_bf16 v[16:31], v[48:51], a[0:3], 0
    ds_read_b64_tr_b16 v[48:49], v2 offset:6144
    ds_read_b64_tr_b16 v[50:51], v2 offset:7168
    s_waitcnt lgkmcnt(4)
    v_mfma_f32_32x32x16_bf16 v[16:31], v[56:59], a[4:7], v[16:31]
    ds_read_b64_tr_b16 v[56:57], v2 offset:8192
    ds_read_b64_tr_b16 v[58:59], v2 offset:9216
    s_waitcnt lgkmcnt(4)
    v_mfma_f32_32x32x16_bf16 v[16:31], v[64:67], a[8:11], v[16:31]
    ds_read_b64_tr_b16 v[64:65], v2 offset:10240
    ds_read_b64_tr_b16 v[66:67], v2 offset:11264
    s_waitcnt lgkmcnt(4)
    v_mfma_f32_32x32x16_bf16 v[16:31], v[48:51], a[12:15], v[16:31]
    ds_read_b64_tr_b16 v[48:49], v2 offset:12288
    ds_read_b64_tr_b16 v[50:51], v2 offset:13312
    s_waitcnt lgkmcnt(4)
    v_mfma_f32_32x32x16_bf16 v[16:31], v[56:59], a[16:19], v[16:31]
    ds_read_b64_tr_b16 v[56:57], v2 offset:14336
    ds_read_b64_tr_b16 v[58:59], v2 offset:15360
    s_waitcnt lgkmcnt(4)
    v_mfma_f32_32x32x16_bf16 v[16:31], v[64:67], a[20:23], v[16:31]
    ds_read_b64_tr_b16 v[64:65], v2 offset:16384
    ds_read_b64_tr_b16 v[66:67], v2 offset:17408
    s_waitcnt lgkmcnt(4)
    v_mfma_f32_32x32x16_bf16 v[16:31], v[48:51], a[24:27], v[16:31]
    ds_read_b64_tr_b16 v[48:49], v2 offset:18432
    ds_read_b64_tr_b16 v[50:51], v2 offset:19456
    s_waitcnt lgkmcnt(4)
    v_mfma_f32_32x32x16_bf16 v[16:31], v[56:59], a[28:31], v[16:31]
    ds_read_b64_tr_b16 v[56:57], v2 offset:20480
    ds_read_b64_tr_b16 v[58:59], v2 offset:21504
    s_waitcnt lgkmcnt(4)
    v_mfma_f32_32x32x16_bf16 v[16:31], v[64:67], a[32:35], v[16:31]
    ds_read_b64_tr_b16 v[64:65], v2 offset:22528
    ds_read_b64_tr_b16 v[66:67], v2 offset:23552
    s_waitcnt lgkmcnt(4)
    v_mfma_f32_32x32x16_bf16 v[16:31], v[48:51], a[36:39], v[16:31]
    ds_read_b64_tr_b16 v[48:49], v2 offset:24576
    ds_read_b64_tr_b16 v[50:51], v2 offset:25600
    s_waitcnt lgkmcnt(4)
    v_mfma_f32_32x32x16_bf16 v[16:31], v[56:59], a[40:43], v[16:31]
    ds_read_b64_tr_b16 v[56:57], v2 offset:26624
    ds_read_b64_tr_b16 v[58:59], v2 offset:27648
    s_waitcnt lgkmcnt(4)
    v_mfma_f32_32x32x16_bf16 v[16:31], v[64:67], a[44:47], v[16:31]
    s_waitcnt lgkmcnt(2)
    v_mfma_f32_32x32x16_bf16 v[16:31], v[48:51], a[48:51], v[16:31]
    s_waitcnt lgkmcnt(0)
    v_mfma_f32_32x32x16_bf16 v[16:31], v[56:59], a[52:55], v[16:31]
    s_barrier
    ds_read_b64_tr_b16 v[48:49], v2 offset:28672
    ds_read_b64_tr_b16 v[50:51], v2 offset:29696
    ds_read_b64_tr_b16 v[56:57], v2 offset:30720
    ds_read_b64_tr_b16 v[58:59], v2 offset:31744
    ds_read_b64_tr_b16 v[64:65], v2 offset:32768
    ds_read_b64_tr_b16 v[66:67], v2 offset:33792
    s_waitcnt lgkmcnt(4)
    v_mfma_f32_32x32x16_bf16 v[16:31], v[48:51], a[56:59], v[16:31]
    ds_read_b64_tr_b16 v[48:49], v2 offset:34816
    ds_read_b64_tr_b16 v[50:51], v2 offset:35840
    s_waitcnt lgkmcnt(4)
    v_mfma_f32_32x32x16_bf16 v[16:31], v[56:59], a[60:63], v[16:31]
    ds_read_b64_tr_b16 v[56:57], v2 offset:36864
    ds_read_b64_tr_b16 v[58:59], v2 offset:37888
    s_waitcnt lgkmcnt(4)
    v_mfma_f32_32x32x16_bf16 v[16:31], v[64:67], a[64:67], v[16:31]
    ds_read_b64_tr_b16 v[64:65], v2 offset:38912
    ds_read_b64_tr_b16 v[66:67], v2 offset:39936
    s_waitcnt lgkmcnt(4)
    v_mfma_f32_32x32x16_bf16 v[16:31], v[48:51], a[68:71], v[16:31]
    ds_read_b64_tr_b16 v[48:49], v2 offset:40960
    ds_read_b64_tr_b16 v[50:51], v2 offset:41984
    s_waitcnt lgkmcnt(4)
    v_mfma_f32_32x32x16_bf16 v[16:31], v[56:59], a[72:75], v[16:31]
    ds_read_b64_tr_b16 v[56:57], v2 offset:43008
    ds_read_b64_tr_b16 v[58:59], v2 offset:44032
    s_waitcnt lgkmcnt(4)
    v_mfma_f32_32x32x16_bf16 v[16:31], v[64:67], a[76:79], v[16:31]
    ds_read_b64_tr_b16 v[64:65], v2 offset:45056
    ds_read_b64_tr_b16 v[66:67], v2 offset:46080
    s_waitcnt lgkmcnt(4)
    v_mfma_f32_32x32x16_bf16 v[16:31], v[48:51], a[80:83], v[16:31]
    ds_read_b64_tr_b16 v[48:49], v2 offset:47104
    ds_read_b64_tr_b16 v[50:51], v2 offset:48128
    s_waitcnt lgkmcnt(4)
    v_mfma_f32_32x32x16_bf16 v[16:31], v[56:59], a[84:87], v[16:31]
    ds_read_b64_tr_b16 v[56:57], v2 offset:49152
    ds_read_b64_tr_b16 v[58:59], v2 offset:50176
    s_waitcnt lgkmcnt(4)
    v_mfma_f32_32x32x16_bf16 v[16:31], v[64:67], a[88:91], v[16:31]
    ds_read_b64_tr_b16 v[64:65], v2 offset:51200
    ds_read_b64_tr_b16 v[66:67], v2 offset:52224
    s_waitcnt lgkmcnt(4)
    v_mfma_f32_32x32x16_bf16 v[16:31], v[48:51], a[92:95], v[16:31]
    ds_read_b64_tr_b16 v[48:49], v2 offset:53248
    ds_read_b64_tr_b16 v[50:51], v2 offset:54272
    s_waitcnt lgkmcnt(4)
    v_mfma_f32_32x32x16_bf16 v[16:31], v[56:59], a[96:99], v[16:31]
    ds_read_b64_tr_b16 v[56:57], v2 offset:55296
    ds_read_b64_tr_b16 v[58:59], v2 offset:56320
    s_waitcnt lgkmcnt(4)
    v_mfma_f32_32x32x16_bf16 v[16:31], v[64:67], a[100:103], v[16:31]
    s_waitcnt lgkmcnt(2)
    v_mfma_f32_32x32x16_bf16 v[16:31], v[48:51], a[104:107], v[16:31]
    s_waitcnt lgkmcnt(0)
    v_mfma_f32_32x32x16_bf16 v[16:31], v[56:59], a[108:111], v[16:31]
    s_nop 11
    v_cvt_pk_bf16_f32 v72, v16, v17
    v_cvt_pk_bf16_f32 v73, v18, v19
    v_cvt_pk_bf16_f32 v74, v20, v21
    v_cvt_pk_bf16_f32 v75, v22, v23
    v_cvt_pk_bf16_f32 v76, v24, v25
    v_cvt_pk_bf16_f32 v77, v26, v27
    v_cvt_pk_bf16_f32 v78, v28, v29
    v_cvt_pk_bf16_f32 v79, v30, v31
    ds_write_b128 v8, v[72:75] offset:8192
    ds_write_b128 v8, v[76:79] offset:9216
    s_barrier
    ds_read_b64_tr_b16 v[48:49], v12 offset:0
    ds_read_b64_tr_b16 v[50:51], v12 offset:1024
    ds_read_b64_tr_b16 v[56:57], v12 offset:2048
    ds_read_b64_tr_b16 v[58:59], v12 offset:3072
    ds_read_b64_tr_b16 v[64:65], v12 offset:4096
    ds_read_b64_tr_b16 v[66:67], v12 offset:5120
    s_waitcnt lgkmcnt(4)
    v_mfma_f32_32x32x16_bf16 v[16:31], v[48:51], a[0:3], 0
    ds_read_b64_tr_b16 v[48:49], v12 offset:6144
    ds_read_b64_tr_b16 v[50:51], v12 offset:7168
    s_waitcnt lgkmcnt(4)
    v_mfma_f32_32x32x16_bf16 v[16:31], v[56:59], a[4:7], v[16:31]
    ds_read_b64_tr_b16 v[56:57], v12 offset:8192
    ds_read_b64_tr_b16 v[58:59], v12 offset:9216
    s_waitcnt lgkmcnt(4)
    v_mfma_f32_32x32x16_bf16 v[16:31], v[64:67], a[8:11], v[16:31]
    ds_read_b64_tr_b16 v[64:65], v12 offset:10240
    ds_read_b64_tr_b16 v[66:67], v12 offset:11264
    s_waitcnt lgkmcnt(4)
    v_mfma_f32_32x32x16_bf16 v[16:31], v[48:51], a[12:15], v[16:31]
    ds_read_b64_tr_b16 v[48:49], v12 offset:12288
    ds_read_b64_tr_b16 v[50:51], v12 offset:13312
    s_waitcnt lgkmcnt(4)
    v_mfma_f32_32x32x16_bf16 v[16:31], v[56:59], a[16:19], v[16:31]
    ds_read_b64_tr_b16 v[56:57], v12 offset:14336
    ds_read_b64_tr_b16 v[58:59], v12 offset:15360
    s_waitcnt lgkmcnt(4)
    v_mfma_f32_32x32x16_bf16 v[16:31], v[64:67], a[20:23], v[16:31]
    ds_read_b64_tr_b16 v[64:65], v12 offset:16384
    ds_read_b64_tr_b16 v[66:67], v12 offset:17408
    s_waitcnt lgkmcnt(4)
    v_mfma_f32_32x32x16_bf16 v[16:31], v[48:51], a[24:27], v[16:31]
    ds_read_b64_tr_b16 v[48:49], v12 offset:18432
    ds_read_b64_tr_b16 v[50:51], v12 offset:19456
    s_waitcnt lgkmcnt(4)
    v_mfma_f32_32x32x16_bf16 v[16:31], v[56:59], a[28:31], v[16:31]
    ds_read_b64_tr_b16 v[56:57], v12 offset:20480
    ds_read_b64_tr_b16 v[58:59], v12 offset:21504
    s_waitcnt lgkmcnt(4)
    v_mfma_f32_32x32x16_bf16 v[16:31], v[64:67], a[32:35], v[16:31]
    ds_read_b64_tr_b16 v[64:65], v12 offset:22528
    ds_read_b64_tr_b16 v[66:67], v12 offset:23552
    s_waitcnt lgkmcnt(4)
    v_mfma_f32_32x32x16_bf16 v[16:31], v[48:51], a[36:39], v[16:31]
    ds_read_b64_tr_b16 v[48:49], v12 offset:24576
    ds_read_b64_tr_b16 v[50:51], v12 offset:25600
    s_waitcnt lgkmcnt(4)
    v_mfma_f32_32x32x16_bf16 v[16:31], v[56:59], a[40:43], v[16:31]
    ds_read_b64_tr_b16 v[56:57], v12 offset:26624
    ds_read_b64_tr_b16 v[58:59], v12 offset:27648
    s_waitcnt lgkmcnt(4)
    v_mfma_f32_32x32x16_bf16 v[16:31], v[64:67], a[44:47], v[16:31]
    s_waitcnt lgkmcnt(2)
    v_mfma_f32_32x32x16_bf16 v[16:31], v[48:51], a[48:51], v[16:31]
    s_waitcnt lgkmcnt(0)
    v_mfma_f32_32x32x16_bf16 v[16:31], v[56:59], a[52:55], v[16:31]
    s_barrier
    ds_read_b64_tr_b16 v[48:49], v12 offset:28672
    ds_read_b64_tr_b16 v[50:51], v12 offset:29696
    ds_read_b64_tr_b16 v[56:57], v12 offset:30720
    ds_read_b64_tr_b16 v[58:59], v12 offset:31744
    ds_read_b64_tr_b16 v[64:65], v12 offset:32768
    ds_read_b64_tr_b16 v[66:67], v12 offset:33792
    s_waitcnt lgkmcnt(4)
    v_mfma_f32_32x32x16_bf16 v[16:31], v[48:51], a[56:59], v[16:31]
    ds_read_b64_tr_b16 v[48:49], v12 offset:34816
    ds_read_b64_tr_b16 v[50:51], v12 offset:35840
    s_waitcnt lgkmcnt(4)
    v_mfma_f32_32x32x16_bf16 v[16:31], v[56:59], a[60:63], v[16:31]
    ds_read_b64_tr_b16 v[56:57], v12 offset:36864
    ds_read_b64_tr_b16 v[58:59], v12 offset:37888
    s_waitcnt lgkmcnt(4)
    v_mfma_f32_32x32x16_bf16 v[16:31], v[64:67], a[64:67], v[16:31]
    ds_read_b64_tr_b16 v[64:65], v12 offset:38912
    ds_read_b64_tr_b16 v[66:67], v12 offset:39936
    s_waitcnt lgkmcnt(4)
    v_mfma_f32_32x32x16_bf16 v[16:31], v[48:51], a[68:71], v[16:31]
    ds_read_b64_tr_b16 v[48:49], v12 offset:40960
    ds_read_b64_tr_b16 v[50:51], v12 offset:41984
    s_waitcnt lgkmcnt(4)
    v_mfma_f32_32x32x16_bf16 v[16:31], v[56:59], a[72:75], v[16:31]
    ds_read_b64_tr_b16 v[56:57], v12 offset:43008
    ds_read_b64_tr_b16 v[58:59], v12 offset:44032
    s_waitcnt lgkmcnt(4)
    v_mfma_f32_32x32x16_bf16 v[16:31], v[64:67], a[76:79], v[16:31]
    ds_read_b64_tr_b16 v[64:65], v12 offset:45056
    ds_read_b64_tr_b16 v[66:67], v12 offset:46080
    s_waitcnt lgkmcnt(4)
    v_mfma_f32_32x32x16_bf16 v[16:31], v[48:51], a[80:83], v[16:31]
    ds_read_b64_tr_b16 v[48:49], v12 offset:47104
    ds_read_b64_tr_b16 v[50:51], v12 offset:48128
    s_waitcnt lgkmcnt(4)
    v_mfma_f32_32x32x16_bf16 v[16:31], v[56:59], a[84:87], v[16:31]
    ds_read_b64_tr_b16 v[56:57], v12 offset:49152
    ds_read_b64_tr_b16 v[58:59], v12 offset:50176
    s_waitcnt lgkmcnt(4)
    v_mfma_f32_32x32x16_bf16 v[16:31], v[64:67], a[88:91], v[16:31]
    ds_read_b64_tr_b16 v[64:65], v12 offset:51200
    ds_read_b64_tr_b16 v[66:67], v12 offset:52224
    s_waitcnt lgkmcnt(4)
    v_mfma_f32_32x32x16_bf16 v[16:31], v[48:51], a[92:95], v[16:31]
    ds_read_b64_tr_b16 v[48:49], v12 offset:53248
    ds_read_b64_tr_b16 v[50:51], v12 offset:54272
    s_waitcnt lgkmcnt(4)
    v_mfma_f32_32x32x16_bf16 v[16:31], v[56:59], a[96:99], v[16:31]
    ds_read_b64_tr_b16 v[56:57], v12 offset:55296
    ds_read_b64_tr_b16 v[58:59], v12 offset:56320
    s_waitcnt lgkmcnt(4)
    v_mfma_f32_32x32x16_bf16 v[16:31], v[64:67], a[100:103], v[16:31]
    s_waitcnt lgkmcnt(2)
    v_mfma_f32_32x32x16_bf16 v[16:31], v[48:51], a[104:107], v[16:31]
    s_waitcnt lgkmcnt(0)
    v_mfma_f32_32x32x16_bf16 v[16:31], v[56:59], a[108:111], v[16:31]
    s_nop 11
    v_cvt_pk_bf16_f32 v72, v16, v17
    v_cvt_pk_bf16_f32 v73, v18, v19
    v_cvt_pk_bf16_f32 v74, v20, v21
    v_cvt_pk_bf16_f32 v75, v22, v23
    v_cvt_pk_bf16_f32 v76, v24, v25
    v_cvt_pk_bf16_f32 v77, v26, v27
    v_cvt_pk_bf16_f32 v78, v28, v29
    v_cvt_pk_bf16_f32 v79, v30, v31
    ds_write_b128 v8, v[72:75] offset:12288
    ds_write_b128 v8, v[76:79] offset:13312
    s_waitcnt lgkmcnt(0)
    s_barrier
    v_add_u32 v8, 122880, v14
    ds_read_b128 v[96:99], v8 offset:0
    ds_read_b128 v[100:103], v8 offset:1024
    ds_read_b128 v[104:107], v8 offset:2048
    ds_read_b128 v[108:111], v8 offset:3072
    ds_read_b128 v[112:115], v8 offset:4096
    ds_read_b128 v[116:119], v8 offset:5120
    ds_read_b128 v[120:123], v8 offset:6144
    ds_read_b128 v[124:127], v8 offset:7168
    ds_read_b128 v[128:131], v8 offset:8192
    ds_read_b128 v[132:135], v8 offset:9216
    ds_read_b128 v[136:139], v8 offset:10240
    ds_read_b128 v[140:143], v8 offset:11264
    ds_read_b128 v[144:147], v8 offset:12288
    ds_read_b128 v[148:151], v8 offset:13312
    ds_read_b128 v[152:155], v8 offset:14336
    ds_read_b128 v[156:159], v8 offset:15360
    s_lshl_b32 s30, s27, 4
    s_add_u32 s30, s30, s24
    s_mul_i32 s30, s30, 28672
    s_add_u32 s30, s30, 14684160
    s_lshl_b32 s17, s26, 11
    s_add_u32 s30, s30, s17
    s_waitcnt lgkmcnt(0)
    s_barrier
    ds_read_b64_tr_b16 v[48:49], v3 offset:0
    ds_read_b64_tr_b16 v[50:51], v3 offset:256
    ds_read_b64_tr_b16 v[56:57], v3 offset:2048
    ds_read_b64_tr_b16 v[58:59], v3 offset:2304
    ds_read_b64_tr_b16 v[64:65], v3 offset:4096
    ds_read_b64_tr_b16 v[66:67], v3 offset:4352
    s_waitcnt lgkmcnt(4)
    v_mfma_f32_32x32x16_bf16 v[16:31], v[96:99], v[48:51], 0
    ds_read_b64_tr_b16 v[48:49], v3 offset:6144
    ds_read_b64_tr_b16 v[50:51], v3 offset:6400
    s_waitcnt lgkmcnt(4)
    v_mfma_f32_32x32x16_bf16 v[16:31], v[100:103], v[56:59], v[16:31]
    ds_read_b64_tr_b16 v[56:57], v3 offset:8192
    ds_read_b64_tr_b16 v[58:59], v3 offset:8448
    s_waitcnt lgkmcnt(4)
    v_mfma_f32_32x32x16_bf16 v[16:31], v[104:107], v[64:67], v[16:31]
    ds_read_b64_tr_b16 v[64:65], v3 offset:10240
    ds_read_b64_tr_b16 v[66:67], v3 offset:10496
    s_waitcnt lgkmcnt(4)
    v_mfma_f32_32x32x16_bf16 v[16:31], v[108:111], v[48:51], v[16:31]
    ds_read_b64_tr_b16 v[48:49], v3 offset:12288
    ds_read_b64_tr_b16 v[50:51], v3 offset:12544
    s_waitcnt lgkmcnt(4)
    v_mfma_f32_32x32x16_bf16 v[16:31], v[112:115], v[56:59], v[16:31]
    ds_read_b64_tr_b16 v[56:57], v3 offset:14336
    ds_read_b64_tr_b16 v[58:59], v3 offset:14592
    s_waitcnt lgkmcnt(4)
    v_mfma_f32_32x32x16_bf16 v[16:31], v[116:119], v[64:67], v[16:31]
    ds_read_b64_tr_b16 v[64:65], v3 offset:16384
    ds_read_b64_tr_b16 v[66:67], v3 offset:16640
    s_waitcnt lgkmcnt(4)
    v_mfma_f32_32x32x16_bf16 v[16:31], v[120:123], v[48:51], v[16:31]
    ds_read_b64_tr_b16 v[48:49], v3 offset:18432
    ds_read_b64_tr_b16 v[50:51], v3 offset:18688
    s_waitcnt lgkmcnt(4)
    v_mfma_f32_32x32x16_bf16 v[16:31], v[124:127], v[56:59], v[16:31]
    ds_read_b64_tr_b16 v[56:57], v3 offset:20480
    ds_read_b64_tr_b16 v[58:59], v3 offset:20736
    s_waitcnt lgkmcnt(4)
    v_mfma_f32_32x32x16_bf16 v[16:31], v[128:131], v[64:67], v[16:31]
    ds_read_b64_tr_b16 v[64:65], v3 offset:22528
    ds_read_b64_tr_b16 v[66:67], v3 offset:22784
    s_waitcnt lgkmcnt(4)
    v_mfma_f32_32x32x16_bf16 v[16:31], v[132:135], v[48:51], v[16:31]
    ds_read_b64_tr_b16 v[48:49], v3 offset:24576
    ds_read_b64_tr_b16 v[50:51], v3 offset:24832
    s_waitcnt lgkmcnt(4)
    v_mfma_f32_32x32x16_bf16 v[16:31], v[136:139], v[56:59], v[16:31]
    ds_read_b64_tr_b16 v[56:57], v3 offset:26624
    ds_read_b64_tr_b16 v[58:59], v3 offset:26880
    s_waitcnt lgkmcnt(4)
    v_mfma_f32_32x32x16_bf16 v[16:31], v[140:143], v[64:67], v[16:31]
    ds_read_b64_tr_b16 v[64:65], v3 offset:28672
    ds_read_b64_tr_b16 v[66:67], v3 offset:28928
    s_waitcnt lgkmcnt(4)
    v_mfma_f32_32x32x16_bf16 v[16:31], v[144:147], v[48:51], v[16:31]
    ds_read_b64_tr_b16 v[48:49], v3 offset:30720
    ds_read_b64_tr_b16 v[50:51], v3 offset:30976
    s_waitcnt lgkmcnt(4)
    v_mfma_f32_32x32x16_bf16 v[16:31], v[148:151], v[56:59], v[16:31]
    s_waitcnt lgkmcnt(2)
    v_mfma_f32_32x32x16_bf16 v[16:31], v[152:155], v[64:67], v[16:31]
    s_waitcnt lgkmcnt(0)
    v_mfma_f32_32x32x16_bf16 v[16:31], v[156:159], v[48:51], v[16:31]
    s_nop 11
    v_cvt_pk_bf16_f32 v72, v16, v17
    v_cvt_pk_bf16_f32 v73, v18, v19
    v_cvt_pk_bf16_f32 v74, v20, v21
    v_cvt_pk_bf16_f32 v75, v22, v23
    v_cvt_pk_bf16_f32 v76, v24, v25
    v_cvt_pk_bf16_f32 v77, v26, v27
    v_cvt_pk_bf16_f32 v78, v28, v29
    v_cvt_pk_bf16_f32 v79, v30, v31
    buffer_store_dwordx4 v[72:75], v7, s[4:7], s30 offen offset:0 sc1
    buffer_store_dwordx4 v[76:79], v7, s[4:7], s30 offen offset:512 sc1
    s_add_u32 s30, s30, 4096
    s_barrier
    ds_read_b64_tr_b16 v[48:49], v3 offset:32768
    ds_read_b64_tr_b16 v[50:51], v3 offset:33024
    ds_read_b64_tr_b16 v[56:57], v3 offset:34816
    ds_read_b64_tr_b16 v[58:59], v3 offset:35072
    ds_read_b64_tr_b16 v[64:65], v3 offset:36864
    ds_read_b64_tr_b16 v[66:67], v3 offset:37120
    s_waitcnt lgkmcnt(4)
    v_mfma_f32_32x32x16_bf16 v[16:31], v[96:99], v[48:51], 0
    ds_read_b64_tr_b16 v[48:49], v3 offset:38912
    ds_read_b64_tr_b16 v[50:51], v3 offset:39168
    s_waitcnt lgkmcnt(4)
    v_mfma_f32_32x32x16_bf16 v[16:31], v[100:103], v[56:59], v[16:31]
    ds_read_b64_tr_b16 v[56:57], v3 offset:40960
    ds_read_b64_tr_b16 v[58:59], v3 offset:41216
    s_waitcnt lgkmcnt(4)
    v_mfma_f32_32x32x16_bf16 v[16:31], v[104:107], v[64:67], v[16:31]
    ds_read_b64_tr_b16 v[64:65], v3 offset:43008
    ds_read_b64_tr_b16 v[66:67], v3 offset:43264
    s_waitcnt lgkmcnt(4)
    v_mfma_f32_32x32x16_bf16 v[16:31], v[108:111], v[48:51], v[16:31]
    ds_read_b64_tr_b16 v[48:49], v3 offset:45056
    ds_read_b64_tr_b16 v[50:51], v3 offset:45312
    s_waitcnt lgkmcnt(4)
    v_mfma_f32_32x32x16_bf16 v[16:31], v[112:115], v[56:59], v[16:31]
    ds_read_b64_tr_b16 v[56:57], v3 offset:47104
    ds_read_b64_tr_b16 v[58:59], v3 offset:47360
    s_waitcnt lgkmcnt(4)
    v_mfma_f32_32x32x16_bf16 v[16:31], v[116:119], v[64:67], v[16:31]
    ds_read_b64_tr_b16 v[64:65], v3 offset:49152
    ds_read_b64_tr_b16 v[66:67], v3 offset:49408
    s_waitcnt lgkmcnt(4)
    v_mfma_f32_32x32x16_bf16 v[16:31], v[120:123], v[48:51], v[16:31]
    ds_read_b64_tr_b16 v[48:49], v3 offset:51200
    ds_read_b64_tr_b16 v[50:51], v3 offset:51456
    s_waitcnt lgkmcnt(4)
    v_mfma_f32_32x32x16_bf16 v[16:31], v[124:127], v[56:59], v[16:31]
    ds_read_b64_tr_b16 v[56:57], v3 offset:53248
    ds_read_b64_tr_b16 v[58:59], v3 offset:53504
    s_waitcnt lgkmcnt(4)
    v_mfma_f32_32x32x16_bf16 v[16:31], v[128:131], v[64:67], v[16:31]
    ds_read_b64_tr_b16 v[64:65], v3 offset:55296
    ds_read_b64_tr_b16 v[66:67], v3 offset:55552
    s_waitcnt lgkmcnt(4)
    v_mfma_f32_32x32x16_bf16 v[16:31], v[132:135], v[48:51], v[16:31]
    ds_read_b64_tr_b16 v[48:49], v3 offset:57344
    ds_read_b64_tr_b16 v[50:51], v3 offset:57600
    s_waitcnt lgkmcnt(4)
    v_mfma_f32_32x32x16_bf16 v[16:31], v[136:139], v[56:59], v[16:31]
    ds_read_b64_tr_b16 v[56:57], v3 offset:59392
    ds_read_b64_tr_b16 v[58:59], v3 offset:59648
    s_waitcnt lgkmcnt(4)
    v_mfma_f32_32x32x16_bf16 v[16:31], v[140:143], v[64:67], v[16:31]
    ds_read_b64_tr_b16 v[64:65], v3 offset:61440
    ds_read_b64_tr_b16 v[66:67], v3 offset:61696
    s_waitcnt lgkmcnt(4)
    v_mfma_f32_32x32x16_bf16 v[16:31], v[144:147], v[48:51], v[16:31]
    ds_read_b64_tr_b16 v[48:49], v3 offset:63488
    ds_read_b64_tr_b16 v[50:51], v3 offset:63744
    s_waitcnt lgkmcnt(4)
    v_mfma_f32_32x32x16_bf16 v[16:31], v[148:151], v[56:59], v[16:31]
    s_waitcnt lgkmcnt(2)
    v_mfma_f32_32x32x16_bf16 v[16:31], v[152:155], v[64:67], v[16:31]
    s_waitcnt lgkmcnt(0)
    v_mfma_f32_32x32x16_bf16 v[16:31], v[156:159], v[48:51], v[16:31]
    s_nop 11
    v_cvt_pk_bf16_f32 v72, v16, v17
    v_cvt_pk_bf16_f32 v73, v18, v19
    v_cvt_pk_bf16_f32 v74, v20, v21
    v_cvt_pk_bf16_f32 v75, v22, v23
    v_cvt_pk_bf16_f32 v76, v24, v25
    v_cvt_pk_bf16_f32 v77, v26, v27
    v_cvt_pk_bf16_f32 v78, v28, v29
    v_cvt_pk_bf16_f32 v79, v30, v31
    buffer_store_dwordx4 v[72:75], v7, s[4:7], s30 offen offset:0 sc1
    buffer_store_dwordx4 v[76:79], v7, s[4:7], s30 offen offset:512 sc1
    s_add_u32 s30, s30, 4096
    s_barrier
    ds_read_b64_tr_b16 v[48:49], v13 offset:0
    ds_read_b64_tr_b16 v[50:51], v13 offset:256
    ds_read_b64_tr_b16 v[56:57], v13 offset:2048
    ds_read_b64_tr_b16 v[58:59], v13 offset:2304
    ds_read_b64_tr_b16 v[64:65], v13 offset:4096
    ds_read_b64_tr_b16 v[66:67], v13 offset:4352
    s_waitcnt lgkmcnt(4)
    v_mfma_f32_32x32x16_bf16 v[16:31], v[96:99], v[48:51], 0
    ds_read_b64_tr_b16 v[48:49], v13 offset:6144
    ds_read_b64_tr_b16 v[50:51], v13 offset:6400
    s_waitcnt lgkmcnt(4)
    v_mfma_f32_32x32x16_bf16 v[16:31], v[100:103], v[56:59], v[16:31]
    ds_read_b64_tr_b16 v[56:57], v13 offset:8192
    ds_read_b64_tr_b16 v[58:59], v13 offset:8448
    s_waitcnt lgkmcnt(4)
    v_mfma_f32_32x32x16_bf16 v[16:31], v[104:107], v[64:67], v[16:31]
    ds_read_b64_tr_b16 v[64:65], v13 offset:10240
    ds_read_b64_tr_b16 v[66:67], v13 offset:10496
    s_waitcnt lgkmcnt(4)
    v_mfma_f32_32x32x16_bf16 v[16:31], v[108:111], v[48:51], v[16:31]
    ds_read_b64_tr_b16 v[48:49], v13 offset:12288
    ds_read_b64_tr_b16 v[50:51], v13 offset:12544
    s_waitcnt lgkmcnt(4)
    v_mfma_f32_32x32x16_bf16 v[16:31], v[112:115], v[56:59], v[16:31]
    ds_read_b64_tr_b16 v[56:57], v13 offset:14336
    ds_read_b64_tr_b16 v[58:59], v13 offset:14592
    s_waitcnt lgkmcnt(4)
    v_mfma_f32_32x32x16_bf16 v[16:31], v[116:119], v[64:67], v[16:31]
    ds_read_b64_tr_b16 v[64:65], v13 offset:16384
    ds_read_b64_tr_b16 v[66:67], v13 offset:16640
    s_waitcnt lgkmcnt(4)
    v_mfma_f32_32x32x16_bf16 v[16:31], v[120:123], v[48:51], v[16:31]
    ds_read_b64_tr_b16 v[48:49], v13 offset:18432
    ds_read_b64_tr_b16 v[50:51], v13 offset:18688
    s_waitcnt lgkmcnt(4)
    v_mfma_f32_32x32x16_bf16 v[16:31], v[124:127], v[56:59], v[16:31]
    ds_read_b64_tr_b16 v[56:57], v13 offset:20480
    ds_read_b64_tr_b16 v[58:59], v13 offset:20736
    s_waitcnt lgkmcnt(4)
    v_mfma_f32_32x32x16_bf16 v[16:31], v[128:131], v[64:67], v[16:31]
    ds_read_b64_tr_b16 v[64:65], v13 offset:22528
    ds_read_b64_tr_b16 v[66:67], v13 offset:22784
    s_waitcnt lgkmcnt(4)
    v_mfma_f32_32x32x16_bf16 v[16:31], v[132:135], v[48:51], v[16:31]
    ds_read_b64_tr_b16 v[48:49], v13 offset:24576
    ds_read_b64_tr_b16 v[50:51], v13 offset:24832
    s_waitcnt lgkmcnt(4)
    v_mfma_f32_32x32x16_bf16 v[16:31], v[136:139], v[56:59], v[16:31]
    ds_read_b64_tr_b16 v[56:57], v13 offset:26624
    ds_read_b64_tr_b16 v[58:59], v13 offset:26880
    s_waitcnt lgkmcnt(4)
    v_mfma_f32_32x32x16_bf16 v[16:31], v[140:143], v[64:67], v[16:31]
    ds_read_b64_tr_b16 v[64:65], v13 offset:28672
    ds_read_b64_tr_b16 v[66:67], v13 offset:28928
    s_waitcnt lgkmcnt(4)
    v_mfma_f32_32x32x16_bf16 v[16:31], v[144:147], v[48:51], v[16:31]
    ds_read_b64_tr_b16 v[48:49], v13 offset:30720
    ds_read_b64_tr_b16 v[50:51], v13 offset:30976
    s_waitcnt lgkmcnt(4)
    v_mfma_f32_32x32x16_bf16 v[16:31], v[148:151], v[56:59], v[16:31]
    s_waitcnt lgkmcnt(2)
    v_mfma_f32_32x32x16_bf16 v[16:31], v[152:155], v[64:67], v[16:31]
    s_waitcnt lgkmcnt(0)
    v_mfma_f32_32x32x16_bf16 v[16:31], v[156:159], v[48:51], v[16:31]
    s_nop 11
    v_cvt_pk_bf16_f32 v72, v16, v17
    v_cvt_pk_bf16_f32 v73, v18, v19
    v_cvt_pk_bf16_f32 v74, v20, v21
    v_cvt_pk_bf16_f32 v75, v22, v23
    v_cvt_pk_bf16_f32 v76, v24, v25
    v_cvt_pk_bf16_f32 v77, v26, v27
    v_cvt_pk_bf16_f32 v78, v28, v29
    v_cvt_pk_bf16_f32 v79, v30, v31
    buffer_store_dwordx4 v[72:75], v7, s[4:7], s30 offen offset:0 sc1
    buffer_store_dwordx4 v[76:79], v7, s[4:7], s30 offen offset:512 sc1
    s_add_u32 s30, s30, 4096
    s_barrier
    ds_read_b64_tr_b16 v[48:49], v3 offset:0
    ds_read_b64_tr_b16 v[50:51], v3 offset:256
    ds_read_b64_tr_b16 v[56:57], v3 offset:2048
    ds_read_b64_tr_b16 v[58:59], v3 offset:2304
    ds_read_b64_tr_b16 v[64:65], v3 offset:4096
    ds_read_b64_tr_b16 v[66:67], v3 offset:4352
    s_waitcnt lgkmcnt(4)
    v_mfma_f32_32x32x16_bf16 v[16:31], v[96:99], v[48:51], 0
    ds_read_b64_tr_b16 v[48:49], v3 offset:6144
    ds_read_b64_tr_b16 v[50:51], v3 offset:6400
    s_waitcnt lgkmcnt(4)
    v_mfma_f32_32x32x16_bf16 v[16:31], v[100:103], v[56:59], v[16:31]
    ds_read_b64_tr_b16 v[56:57], v3 offset:8192
    ds_read_b64_tr_b16 v[58:59], v3 offset:8448
    s_waitcnt lgkmcnt(4)
    v_mfma_f32_32x32x16_bf16 v[16:31], v[104:107], v[64:67], v[16:31]
    ds_read_b64_tr_b16 v[64:65], v3 offset:10240
    ds_read_b64_tr_b16 v[66:67], v3 offset:10496
    s_waitcnt lgkmcnt(4)
    v_mfma_f32_32x32x16_bf16 v[16:31], v[108:111], v[48:51], v[16:31]
    ds_read_b64_tr_b16 v[48:49], v3 offset:12288
    ds_read_b64_tr_b16 v[50:51], v3 offset:12544
    s_waitcnt lgkmcnt(4)
    v_mfma_f32_32x32x16_bf16 v[16:31], v[112:115], v[56:59], v[16:31]
    ds_read_b64_tr_b16 v[56:57], v3 offset:14336
    ds_read_b64_tr_b16 v[58:59], v3 offset:14592
    s_waitcnt lgkmcnt(4)
    v_mfma_f32_32x32x16_bf16 v[16:31], v[116:119], v[64:67], v[16:31]
    ds_read_b64_tr_b16 v[64:65], v3 offset:16384
    ds_read_b64_tr_b16 v[66:67], v3 offset:16640
    s_waitcnt lgkmcnt(4)
    v_mfma_f32_32x32x16_bf16 v[16:31], v[120:123], v[48:51], v[16:31]
    ds_read_b64_tr_b16 v[48:49], v3 offset:18432
    ds_read_b64_tr_b16 v[50:51], v3 offset:18688
    s_waitcnt lgkmcnt(4)
    v_mfma_f32_32x32x16_bf16 v[16:31], v[124:127], v[56:59], v[16:31]
    ds_read_b64_tr_b16 v[56:57], v3 offset:20480
    ds_read_b64_tr_b16 v[58:59], v3 offset:20736
    s_waitcnt lgkmcnt(4)
    v_mfma_f32_32x32x16_bf16 v[16:31], v[128:131], v[64:67], v[16:31]
    ds_read_b64_tr_b16 v[64:65], v3 offset:22528
    ds_read_b64_tr_b16 v[66:67], v3 offset:22784
    s_waitcnt lgkmcnt(4)
    v_mfma_f32_32x32x16_bf16 v[16:31], v[132:135], v[48:51], v[16:31]
    ds_read_b64_tr_b16 v[48:49], v3 offset:24576
    ds_read_b64_tr_b16 v[50:51], v3 offset:24832
    s_waitcnt lgkmcnt(4)
    v_mfma_f32_32x32x16_bf16 v[16:31], v[136:139], v[56:59], v[16:31]
    ds_read_b64_tr_b16 v[56:57], v3 offset:26624
    ds_read_b64_tr_b16 v[58:59], v3 offset:26880
    s_waitcnt lgkmcnt(4)
    v_mfma_f32_32x32x16_bf16 v[16:31], v[140:143], v[64:67], v[16:31]
    ds_read_b64_tr_b16 v[64:65], v3 offset:28672
    ds_read_b64_tr_b16 v[66:67], v3 offset:28928
    s_waitcnt lgkmcnt(4)
    v_mfma_f32_32x32x16_bf16 v[16:31], v[144:147], v[48:51], v[16:31]
    ds_read_b64_tr_b16 v[48:49], v3 offset:30720
    ds_read_b64_tr_b16 v[50:51], v3 offset:30976
    s_waitcnt lgkmcnt(4)
    v_mfma_f32_32x32x16_bf16 v[16:31], v[148:151], v[56:59], v[16:31]
    s_waitcnt lgkmcnt(2)
    v_mfma_f32_32x32x16_bf16 v[16:31], v[152:155], v[64:67], v[16:31]
    s_waitcnt lgkmcnt(0)
    v_mfma_f32_32x32x16_bf16 v[16:31], v[156:159], v[48:51], v[16:31]
    s_nop 11
    v_cvt_pk_bf16_f32 v72, v16, v17
    v_cvt_pk_bf16_f32 v73, v18, v19
    v_cvt_pk_bf16_f32 v74, v20, v21
    v_cvt_pk_bf16_f32 v75, v22, v23
    v_cvt_pk_bf16_f32 v76, v24, v25
    v_cvt_pk_bf16_f32 v77, v26, v27
    v_cvt_pk_bf16_f32 v78, v28, v29
    v_cvt_pk_bf16_f32 v79, v30, v31
    buffer_store_dwordx4 v[72:75], v7, s[4:7], s30 offen offset:0 sc1
    buffer_store_dwordx4 v[76:79], v7, s[4:7], s30 offen offset:512 sc1
    s_add_u32 s30, s30, 4096
    s_barrier
    ds_read_b64_tr_b16 v[48:49], v3 offset:32768
    ds_read_b64_tr_b16 v[50:51], v3 offset:33024
    ds_read_b64_tr_b16 v[56:57], v3 offset:34816
    ds_read_b64_tr_b16 v[58:59], v3 offset:35072
    ds_read_b64_tr_b16 v[64:65], v3 offset:36864
    ds_read_b64_tr_b16 v[66:67], v3 offset:37120
    s_waitcnt lgkmcnt(4)
    v_mfma_f32_32x32x16_bf16 v[16:31], v[96:99], v[48:51], 0
    ds_read_b64_tr_b16 v[48:49], v3 offset:38912
    ds_read_b64_tr_b16 v[50:51], v3 offset:39168
    s_waitcnt lgkmcnt(4)
    v_mfma_f32_32x32x16_bf16 v[16:31], v[100:103], v[56:59], v[16:31]
    ds_read_b64_tr_b16 v[56:57], v3 offset:40960
    ds_read_b64_tr_b16 v[58:59], v3 offset:41216
    s_waitcnt lgkmcnt(4)
    v_mfma_f32_32x32x16_bf16 v[16:31], v[104:107], v[64:67], v[16:31]
    ds_read_b64_tr_b16 v[64:65], v3 offset:43008
    ds_read_b64_tr_b16 v[66:67], v3 offset:43264
    s_waitcnt lgkmcnt(4)
    v_mfma_f32_32x32x16_bf16 v[16:31], v[108:111], v[48:51], v[16:31]
    ds_read_b64_tr_b16 v[48:49], v3 offset:45056
    ds_read_b64_tr_b16 v[50:51], v3 offset:45312
    s_waitcnt lgkmcnt(4)
    v_mfma_f32_32x32x16_bf16 v[16:31], v[112:115], v[56:59], v[16:31]
    ds_read_b64_tr_b16 v[56:57], v3 offset:47104
    ds_read_b64_tr_b16 v[58:59], v3 offset:47360
    s_waitcnt lgkmcnt(4)
    v_mfma_f32_32x32x16_bf16 v[16:31], v[116:119], v[64:67], v[16:31]
    ds_read_b64_tr_b16 v[64:65], v3 offset:49152
    ds_read_b64_tr_b16 v[66:67], v3 offset:49408
    s_waitcnt lgkmcnt(4)
    v_mfma_f32_32x32x16_bf16 v[16:31], v[120:123], v[48:51], v[16:31]
    ds_read_b64_tr_b16 v[48:49], v3 offset:51200
    ds_read_b64_tr_b16 v[50:51], v3 offset:51456
    s_waitcnt lgkmcnt(4)
    v_mfma_f32_32x32x16_bf16 v[16:31], v[124:127], v[56:59], v[16:31]
    ds_read_b64_tr_b16 v[56:57], v3 offset:53248
    ds_read_b64_tr_b16 v[58:59], v3 offset:53504
    s_waitcnt lgkmcnt(4)
    v_mfma_f32_32x32x16_bf16 v[16:31], v[128:131], v[64:67], v[16:31]
    ds_read_b64_tr_b16 v[64:65], v3 offset:55296
    ds_read_b64_tr_b16 v[66:67], v3 offset:55552
    s_waitcnt lgkmcnt(4)
    v_mfma_f32_32x32x16_bf16 v[16:31], v[132:135], v[48:51], v[16:31]
    ds_read_b64_tr_b16 v[48:49], v3 offset:57344
    ds_read_b64_tr_b16 v[50:51], v3 offset:57600
    s_waitcnt lgkmcnt(4)
    v_mfma_f32_32x32x16_bf16 v[16:31], v[136:139], v[56:59], v[16:31]
    ds_read_b64_tr_b16 v[56:57], v3 offset:59392
    ds_read_b64_tr_b16 v[58:59], v3 offset:59648
    s_waitcnt lgkmcnt(4)
    v_mfma_f32_32x32x16_bf16 v[16:31], v[140:143], v[64:67], v[16:31]
    ds_read_b64_tr_b16 v[64:65], v3 offset:61440
    ds_read_b64_tr_b16 v[66:67], v3 offset:61696
    s_waitcnt lgkmcnt(4)
    v_mfma_f32_32x32x16_bf16 v[16:31], v[144:147], v[48:51], v[16:31]
    ds_read_b64_tr_b16 v[48:49], v3 offset:63488
    ds_read_b64_tr_b16 v[50:51], v3 offset:63744
    s_waitcnt lgkmcnt(4)
    v_mfma_f32_32x32x16_bf16 v[16:31], v[148:151], v[56:59], v[16:31]
    s_waitcnt lgkmcnt(2)
    v_mfma_f32_32x32x16_bf16 v[16:31], v[152:155], v[64:67], v[16:31]
    s_waitcnt lgkmcnt(0)
    v_mfma_f32_32x32x16_bf16 v[16:31], v[156:159], v[48:51], v[16:31]
    s_nop 11
    v_cvt_pk_bf16_f32 v72, v16, v17
    v_cvt_pk_bf16_f32 v73, v18, v19
    v_cvt_pk_bf16_f32 v74, v20, v21
    v_cvt_pk_bf16_f32 v75, v22, v23
    v_cvt_pk_bf16_f32 v76, v24, v25
    v_cvt_pk_bf16_f32 v77, v26, v27
    v_cvt_pk_bf16_f32 v78, v28, v29
    v_cvt_pk_bf16_f32 v79, v30, v31
    buffer_store_dwordx4 v[72:75], v7, s[4:7], s30 offen offset:0 sc1
    buffer_store_dwordx4 v[76:79], v7, s[4:7], s30 offen offset:512 sc1
    s_add_u32 s30, s30, 4096
    s_barrier
    ds_read_b64_tr_b16 v[48:49], v13 offset:0
    ds_read_b64_tr_b16 v[50:51], v13 offset:256
    ds_read_b64_tr_b16 v[56:57], v13 offset:2048
    ds_read_b64_tr_b16 v[58:59], v13 offset:2304
    ds_read_b64_tr_b16 v[64:65], v13 offset:4096
    ds_read_b64_tr_b16 v[66:67], v13 offset:4352
    s_waitcnt lgkmcnt(4)
    v_mfma_f32_32x32x16_bf16 v[16:31], v[96:99], v[48:51], 0
    ds_read_b64_tr_b16 v[48:49], v13 offset:6144
    ds_read_b64_tr_b16 v[50:51], v13 offset:6400
    s_waitcnt lgkmcnt(4)
    v_mfma_f32_32x32x16_bf16 v[16:31], v[100:103], v[56:59], v[16:31]
    ds_read_b64_tr_b16 v[56:57], v13 offset:8192
    ds_read_b64_tr_b16 v[58:59], v13 offset:8448
    s_waitcnt lgkmcnt(4)
    v_mfma_f32_32x32x16_bf16 v[16:31], v[104:107], v[64:67], v[16:31]
    ds_read_b64_tr_b16 v[64:65], v13 offset:10240
    ds_read_b64_tr_b16 v[66:67], v13 offset:10496
    s_waitcnt lgkmcnt(4)
    v_mfma_f32_32x32x16_bf16 v[16:31], v[108:111], v[48:51], v[16:31]
    ds_read_b64_tr_b16 v[48:49], v13 offset:12288
    ds_read_b64_tr_b16 v[50:51], v13 offset:12544
    s_waitcnt lgkmcnt(4)
    v_mfma_f32_32x32x16_bf16 v[16:31], v[112:115], v[56:59], v[16:31]
    ds_read_b64_tr_b16 v[56:57], v13 offset:14336
    ds_read_b64_tr_b16 v[58:59], v13 offset:14592
    s_waitcnt lgkmcnt(4)
    v_mfma_f32_32x32x16_bf16 v[16:31], v[116:119], v[64:67], v[16:31]
    ds_read_b64_tr_b16 v[64:65], v13 offset:16384
    ds_read_b64_tr_b16 v[66:67], v13 offset:16640
    s_waitcnt lgkmcnt(4)
    v_mfma_f32_32x32x16_bf16 v[16:31], v[120:123], v[48:51], v[16:31]
    ds_read_b64_tr_b16 v[48:49], v13 offset:18432
    ds_read_b64_tr_b16 v[50:51], v13 offset:18688
    s_waitcnt lgkmcnt(4)
    v_mfma_f32_32x32x16_bf16 v[16:31], v[124:127], v[56:59], v[16:31]
    ds_read_b64_tr_b16 v[56:57], v13 offset:20480
    ds_read_b64_tr_b16 v[58:59], v13 offset:20736
    s_waitcnt lgkmcnt(4)
    v_mfma_f32_32x32x16_bf16 v[16:31], v[128:131], v[64:67], v[16:31]
    ds_read_b64_tr_b16 v[64:65], v13 offset:22528
    ds_read_b64_tr_b16 v[66:67], v13 offset:22784
    s_waitcnt lgkmcnt(4)
    v_mfma_f32_32x32x16_bf16 v[16:31], v[132:135], v[48:51], v[16:31]
    ds_read_b64_tr_b16 v[48:49], v13 offset:24576
    ds_read_b64_tr_b16 v[50:51], v13 offset:24832
    s_waitcnt lgkmcnt(4)
    v_mfma_f32_32x32x16_bf16 v[16:31], v[136:139], v[56:59], v[16:31]
    ds_read_b64_tr_b16 v[56:57], v13 offset:26624
    ds_read_b64_tr_b16 v[58:59], v13 offset:26880
    s_waitcnt lgkmcnt(4)
    v_mfma_f32_32x32x16_bf16 v[16:31], v[140:143], v[64:67], v[16:31]
    ds_read_b64_tr_b16 v[64:65], v13 offset:28672
    ds_read_b64_tr_b16 v[66:67], v13 offset:28928
    s_waitcnt lgkmcnt(4)
    v_mfma_f32_32x32x16_bf16 v[16:31], v[144:147], v[48:51], v[16:31]
    ds_read_b64_tr_b16 v[48:49], v13 offset:30720
    ds_read_b64_tr_b16 v[50:51], v13 offset:30976
    s_waitcnt lgkmcnt(4)
    v_mfma_f32_32x32x16_bf16 v[16:31], v[148:151], v[56:59], v[16:31]
    s_waitcnt lgkmcnt(2)
    v_mfma_f32_32x32x16_bf16 v[16:31], v[152:155], v[64:67], v[16:31]
    s_waitcnt lgkmcnt(0)
    v_mfma_f32_32x32x16_bf16 v[16:31], v[156:159], v[48:51], v[16:31]
    s_nop 11
    v_cvt_pk_bf16_f32 v72, v16, v17
    v_cvt_pk_bf16_f32 v73, v18, v19
    v_cvt_pk_bf16_f32 v74, v20, v21
    v_cvt_pk_bf16_f32 v75, v22, v23
    v_cvt_pk_bf16_f32 v76, v24, v25
    v_cvt_pk_bf16_f32 v77, v26, v27
    v_cvt_pk_bf16_f32 v78, v28, v29
    v_cvt_pk_bf16_f32 v79, v30, v31
    buffer_store_dwordx4 v[72:75], v7, s[4:7], s30 offen offset:0 sc1
    buffer_store_dwordx4 v[76:79], v7, s[4:7], s30 offen offset:512 sc1
    s_add_u32 s30, s30, 4096
    s_barrier
    ds_read_b64_tr_b16 v[48:49], v3 offset:0
    ds_read_b64_tr_b16 v[50:51], v3 offset:256
    ds_read_b64_tr_b16 v[56:57], v3 offset:2048
    ds_read_b64_tr_b16 v[58:59], v3 offset:2304
    ds_read_b64_tr_b16 v[64:65], v3 offset:4096
    ds_read_b64_tr_b16 v[66:67], v3 offset:4352
    s_waitcnt lgkmcnt(4)
    v_mfma_f32_32x32x16_bf16 v[16:31], v[96:99], v[48:51], 0
    ds_read_b64_tr_b16 v[48:49], v3 offset:6144
    ds_read_b64_tr_b16 v[50:51], v3 offset:6400
    s_waitcnt lgkmcnt(4)
    v_mfma_f32_32x32x16_bf16 v[16:31], v[100:103], v[56:59], v[16:31]
    ds_read_b64_tr_b16 v[56:57], v3 offset:8192
    ds_read_b64_tr_b16 v[58:59], v3 offset:8448
    s_waitcnt lgkmcnt(4)
    v_mfma_f32_32x32x16_bf16 v[16:31], v[104:107], v[64:67], v[16:31]
    ds_read_b64_tr_b16 v[64:65], v3 offset:10240
    ds_read_b64_tr_b16 v[66:67], v3 offset:10496
    s_waitcnt lgkmcnt(4)
    v_mfma_f32_32x32x16_bf16 v[16:31], v[108:111], v[48:51], v[16:31]
    ds_read_b64_tr_b16 v[48:49], v3 offset:12288
    ds_read_b64_tr_b16 v[50:51], v3 offset:12544
    s_waitcnt lgkmcnt(4)
    v_mfma_f32_32x32x16_bf16 v[16:31], v[112:115], v[56:59], v[16:31]
    ds_read_b64_tr_b16 v[56:57], v3 offset:14336
    ds_read_b64_tr_b16 v[58:59], v3 offset:14592
    s_waitcnt lgkmcnt(4)
    v_mfma_f32_32x32x16_bf16 v[16:31], v[116:119], v[64:67], v[16:31]
    ds_read_b64_tr_b16 v[64:65], v3 offset:16384
    ds_read_b64_tr_b16 v[66:67], v3 offset:16640
    s_waitcnt lgkmcnt(4)
    v_mfma_f32_32x32x16_bf16 v[16:31], v[120:123], v[48:51], v[16:31]
    ds_read_b64_tr_b16 v[48:49], v3 offset:18432
    ds_read_b64_tr_b16 v[50:51], v3 offset:18688
    s_waitcnt lgkmcnt(4)
    v_mfma_f32_32x32x16_bf16 v[16:31], v[124:127], v[56:59], v[16:31]
    ds_read_b64_tr_b16 v[56:57], v3 offset:20480
    ds_read_b64_tr_b16 v[58:59], v3 offset:20736
    s_waitcnt lgkmcnt(4)
    v_mfma_f32_32x32x16_bf16 v[16:31], v[128:131], v[64:67], v[16:31]
    ds_read_b64_tr_b16 v[64:65], v3 offset:22528
    ds_read_b64_tr_b16 v[66:67], v3 offset:22784
    s_waitcnt lgkmcnt(4)
    v_mfma_f32_32x32x16_bf16 v[16:31], v[132:135], v[48:51], v[16:31]
    ds_read_b64_tr_b16 v[48:49], v3 offset:24576
    ds_read_b64_tr_b16 v[50:51], v3 offset:24832
    s_waitcnt lgkmcnt(4)
    v_mfma_f32_32x32x16_bf16 v[16:31], v[136:139], v[56:59], v[16:31]
    ds_read_b64_tr_b16 v[56:57], v3 offset:26624
    ds_read_b64_tr_b16 v[58:59], v3 offset:26880
    s_waitcnt lgkmcnt(4)
    v_mfma_f32_32x32x16_bf16 v[16:31], v[140:143], v[64:67], v[16:31]
    ds_read_b64_tr_b16 v[64:65], v3 offset:28672
    ds_read_b64_tr_b16 v[66:67], v3 offset:28928
    s_waitcnt lgkmcnt(4)
    v_mfma_f32_32x32x16_bf16 v[16:31], v[144:147], v[48:51], v[16:31]
    ds_read_b64_tr_b16 v[48:49], v3 offset:30720
    ds_read_b64_tr_b16 v[50:51], v3 offset:30976
    s_waitcnt lgkmcnt(4)
    v_mfma_f32_32x32x16_bf16 v[16:31], v[148:151], v[56:59], v[16:31]
    s_waitcnt lgkmcnt(2)
    v_mfma_f32_32x32x16_bf16 v[16:31], v[152:155], v[64:67], v[16:31]
    s_waitcnt lgkmcnt(0)
    v_mfma_f32_32x32x16_bf16 v[16:31], v[156:159], v[48:51], v[16:31]
    s_nop 11
    v_cvt_pk_bf16_f32 v72, v16, v17
    v_cvt_pk_bf16_f32 v73, v18, v19
    v_cvt_pk_bf16_f32 v74, v20, v21
    v_cvt_pk_bf16_f32 v75, v22, v23
    v_cvt_pk_bf16_f32 v76, v24, v25
    v_cvt_pk_bf16_f32 v77, v26, v27
    v_cvt_pk_bf16_f32 v78, v28, v29
    v_cvt_pk_bf16_f32 v79, v30, v31
    buffer_store_dwordx4 v[72:75], v7, s[4:7], s30 offen offset:0 sc1
    buffer_store_dwordx4 v[76:79], v7, s[4:7], s30 offen offset:512 sc1
    s_add_u32 s30, s30, 4096
    s_branch zend_57
zld_56:
    s_sub_u32 s16, s26, 2
    s_mul_i32 s19, s16, 14336
    s_mul_i32 s31, s16, 917504
    s_lshl_b32 s17, s24, 9
    s_add_u32 s31, s31, s17
    s_lshl_b32 s29, s16, 14
    s_mul_i32 s32, s24, 229376
    s_mul_i32 s17, s16, 114688
    s_add_u32 s32, s32, s17
    s_add_u32 m0, s19, 0
    s_add_u32 s18, s31, 0
    buffer_load_dwordx4 v4, s[8:11], s18 offen lds
    s_add_u32 m0, s19, 1024
    s_add_u32 s18, s31, 65536
    buffer_load_dwordx4 v4, s[8:11], s18 offen lds
    s_add_u32 m0, s19, 2048
    s_add_u32 s18, s31, 131072
    buffer_load_dwordx4 v4, s[8:11], s18 offen lds
    s_add_u32 m0, s19, 3072
    s_add_u32 s18, s31, 196608
    buffer_load_dwordx4 v4, s[8:11], s18 offen lds
    s_add_u32 m0, s19, 4096
    s_add_u32 s18, s31, 262144
    buffer_load_dwordx4 v4, s[8:11], s18 offen lds
    s_add_u32 m0, s19, 5120
    s_add_u32 s18, s31, 327680
    buffer_load_dwordx4 v4, s[8:11], s18 offen lds
    s_add_u32 m0, s19, 6144
    s_add_u32 s18, s31, 393216
    buffer_load_dwordx4 v4, s[8:11], s18 offen lds
    s_add_u32 m0, s19, 7168
    s_add_u32 s18, s31, 458752
    buffer_load_dwordx4 v4, s[8:11], s18 offen lds
    s_add_u32 m0, s19, 8192
    s_add_u32 s18, s31, 524288
    buffer_load_dwordx4 v4, s[8:11], s18 offen lds
    s_add_u32 m0, s19, 9216
    s_add_u32 s18, s31, 589824
    buffer_load_dwordx4 v4, s[8:11], s18 offen lds
    s_add_u32 m0, s19, 10240
    s_add_u32 s18, s31, 655360
    buffer_load_dwordx4 v4, s[8:11], s18 offen lds
    s_add_u32 m0, s19, 11264
    s_add_u32 s18, s31, 720896
    buffer_load_dwordx4 v4, s[8:11], s18 offen lds
    s_add_u32 m0, s19, 12288
    s_add_u32 s18, s31, 786432
    buffer_load_dwordx4 v4, s[8:11], s18 offen lds
    s_add_u32 m0, s19, 13312
    s_add_u32 s18, s31, 851968
    buffer_load_dwordx4 v4, s[8:11], s18 offen lds
    s_add_u32 m0, s19, 28672
    s_add_u32 s18, s31, 1835008
    buffer_load_dwordx4 v4, s[8:11], s18 offen lds
    s_add_u32 m0, s19, 29696
    s_add_u32 s18, s31, 1900544
    buffer_load_dwordx4 v4, s[8:11], s18 offen lds
    s_add_u32 m0, s19, 30720
    s_add_u32 s18, s31, 1966080
    buffer_load_dwordx4 v4, s[8:11], s18 offen lds
    s_add_u32 m0, s19, 31744
    s_add_u32 s18, s31, 2031616
    buffer_load_dwordx4 v4, s[8:11], s18 offen lds
    s_add_u32 m0, s19, 32768
    s_add_u32 s18, s31, 2097152
    buffer_load_dwordx4 v4, s[8:11], s18 offen lds
    s_add_u32 m0, s19, 33792
    s_add_u32 s18, s31, 2162688
    buffer_load_dwordx4 v4, s[8:11], s18 offen lds
    s_add_u32 m0, s19, 34816
    s_add_u32 s18, s31, 2228224
    buffer_load_dwordx4 v4, s[8:11], s18 offen lds
    s_add_u32 m0, s19, 35840
    s_add_u32 s18, s31, 2293760
    buffer_load_dwordx4 v4, s[8:11], s18 offen lds
    s_add_u32 m0, s19, 36864
    s_add_u32 s18, s31, 2359296
    buffer_load_dwordx4 v4, s[8:11], s18 offen lds
    s_add_u32 m0, s19, 37888
    s_add_u32 s18, s31, 2424832
    buffer_load_dwordx4 v4, s[8:11], s18 offen lds
    s_add_u32 m0, s19, 38912
    s_add_u32 s18, s31, 2490368
    buffer_load_dwordx4 v4, s[8:11], s18 offen lds
    s_add_u32 m0, s19, 39936
    s_add_u32 s18, s31, 2555904
    buffer_load_dwordx4 v4, s[8:11], s18 offen lds
    s_add_u32 m0, s19, 40960
    s_add_u32 s18, s31, 2621440
    buffer_load_dwordx4 v4, s[8:11], s18 offen lds
    s_add_u32 m0, s19, 41984
    s_add_u32 s18, s31, 2686976
    buffer_load_dwordx4 v4, s[8:11], s18 offen lds
    s_add_u32 m0, s19, 57344
    s_add_u32 s18, s31, 128
    buffer_load_dwordx4 v4, s[8:11], s18 offen lds
    s_add_u32 m0, s19, 58368
    s_add_u32 s18, s31, 65664
    buffer_load_dwordx4 v4, s[8:11], s18 offen lds
    s_add_u32 m0, s19, 59392
    s_add_u32 s18, s31, 131200
    buffer_load_dwordx4 v4, s[8:11], s18 offen lds
    s_add_u32 m0, s19, 60416
    s_add_u32 s18, s31, 196736
    buffer_load_dwordx4 v4, s[8:11], s18 offen lds
    s_add_u32 m0, s19, 61440
    s_add_u32 s18, s31, 262272
    buffer_load_dwordx4 v4, s[8:11], s18 offen lds
    s_add_u32 m0, s19, 62464
    s_add_u32 s18, s31, 327808
    buffer_load_dwordx4 v4, s[8:11], s18 offen lds
    s_add_u32 m0, s19, 63488
    s_add_u32 s18, s31, 393344
    buffer_load_dwordx4 v4, s[8:11], s18 offen lds
    s_add_u32 m0, s19, 64512
    s_add_u32 s18, s31, 458880
    buffer_load_dwordx4 v4, s[8:11], s18 offen lds
    s_add_u32 m0, s19, 65536
    s_add_u32 s18, s31, 524416
    buffer_load_dwordx4 v4, s[8:11], s18 offen lds
    s_add_u32 m0, s19, 66560
    s_add_u32 s18, s31, 589952
    buffer_load_dwordx4 v4, s[8:11], s18 offen lds
    s_add_u32 m0, s19, 67584
    s_add_u32 s18, s31, 655488
    buffer_load_dwordx4 v4, s[8:11], s18 offen lds
    s_add_u32 m0, s19, 68608
    s_add_u32 s18, s31, 721024
    buffer_load_dwordx4 v4, s[8:11], s18 offen lds
    s_add_u32 m0, s19, 69632
    s_add_u32 s18, s31, 786560
    buffer_load_dwordx4 v4, s[8:11], s18 offen lds
    s_add_u32 m0, s19, 70656
    s_add_u32 s18, s31, 852096
    buffer_load_dwordx4 v4, s[8:11], s18 offen lds
    s_add_u32 m0, s19, 86016
    s_add_u32 s18, s31, 1835136
    buffer_load_dwordx4 v4, s[8:11], s18 offen lds
    s_add_u32 m0, s19, 87040
    s_add_u32 s18, s31, 1900672
    buffer_load_dwordx4 v4, s[8:11], s18 offen lds
    s_add_u32 m0, s19, 88064
    s_add_u32 s18, s31, 1966208
    buffer_load_dwordx4 v4, s[8:11], s18 offen lds
    s_add_u32 m0, s19, 89088
    s_add_u32 s18, s31, 2031744
    buffer_load_dwordx4 v4, s[8:11], s18 offen lds
    s_add_u32 m0, s19, 90112
    s_add_u32 s18, s31, 2097280
    buffer_load_dwordx4 v4, s[8:11], s18 offen lds
    s_add_u32 m0, s19, 91136
    s_add_u32 s18, s31, 2162816
    buffer_load_dwordx4 v4, s[8:11], s18 offen lds
    s_add_u32 m0, s19, 92160
    s_add_u32 s18, s31, 2228352
    buffer_load_dwordx4 v4, s[8:11], s18 offen lds
    s_add_u32 m0, s19, 93184
    s_add_u32 s18, s31, 2293888
    buffer_load_dwordx4 v4, s[8:11], s18 offen lds
    s_add_u32 m0, s19, 94208
    s_add_u32 s18, s31, 2359424
    buffer_load_dwordx4 v4, s[8:11], s18 offen lds
    s_add_u32 m0, s19, 95232
    s_add_u32 s18, s31, 2424960
    buffer_load_dwordx4 v4, s[8:11], s18 offen lds
    s_add_u32 m0, s19, 96256
    s_add_u32 s18, s31, 2490496
    buffer_load_dwordx4 v4, s[8:11], s18 offen lds
    s_add_u32 m0, s19, 97280
    s_add_u32 s18, s31, 2556032
    buffer_load_dwordx4 v4, s[8:11], s18 offen lds
    s_add_u32 m0, s19, 98304
    s_add_u32 s18, s31, 2621568
    buffer_load_dwordx4 v4, s[8:11], s18 offen lds
    s_add_u32 m0, s19, 99328
    s_add_u32 s18, s31, 2687104
    buffer_load_dwordx4 v4, s[8:11], s18 offen lds
    s_waitcnt vmcnt(42)
    s_barrier
    s_waitcnt vmcnt(28)
    s_barrier
    s_add_u32 m0, s19, 0
    s_add_u32 s18, s31, 256
    buffer_load_dwordx4 v4, s[8:11], s18 offen lds
    s_add_u32 m0, s19, 1024
    s_add_u32 s18, s31, 65792
    buffer_load_dwordx4 v4, s[8:11], s18 offen lds
    s_add_u32 m0, s19, 2048
    s_add_u32 s18, s31, 131328
    buffer_load_dwordx4 v4, s[8:11], s18 offen lds
    s_add_u32 m0, s19, 3072
    s_add_u32 s18, s31, 196864
    buffer_load_dwordx4 v4, s[8:11], s18 offen lds
    s_add_u32 m0, s19, 4096
    s_add_u32 s18, s31, 262400
    buffer_load_dwordx4 v4, s[8:11], s18 offen lds
    s_add_u32 m0, s19, 5120
    s_add_u32 s18, s31, 327936
    buffer_load_dwordx4 v4, s[8:11], s18 offen lds
    s_add_u32 m0, s19, 6144
    s_add_u32 s18, s31, 393472
    buffer_load_dwordx4 v4, s[8:11], s18 offen lds
    s_add_u32 m0, s19, 7168
    s_add_u32 s18, s31, 459008
    buffer_load_dwordx4 v4, s[8:11], s18 offen lds
    s_add_u32 m0, s19, 8192
    s_add_u32 s18, s31, 524544
    buffer_load_dwordx4 v4, s[8:11], s18 offen lds
    s_add_u32 m0, s19, 9216
    s_add_u32 s18, s31, 590080
    buffer_load_dwordx4 v4, s[8:11], s18 offen lds
    s_add_u32 m0, s19, 10240
    s_add_u32 s18, s31, 655616
    buffer_load_dwordx4 v4, s[8:11], s18 offen lds
    s_add_u32 m0, s19, 11264
    s_add_u32 s18, s31, 721152
    buffer_load_dwordx4 v4, s[8:11], s18 offen lds
    s_add_u32 m0, s19, 12288
    s_add_u32 s18, s31, 786688
    buffer_load_dwordx4 v4, s[8:11], s18 offen lds
    s_add_u32 m0, s19, 13312
    s_add_u32 s18, s31, 852224
    buffer_load_dwordx4 v4, s[8:11], s18 offen lds
    s_waitcnt vmcnt(28)
    s_barrier
    s_add_u32 m0, s19, 28672
    s_add_u32 s18, s31, 1835264
    buffer_load_dwordx4 v4, s[8:11], s18 offen lds
    s_add_u32 m0, s19, 29696
    s_add_u32 s18, s31, 1900800
    buffer_load_dwordx4 v4, s[8:11], s18 offen lds
    s_add_u32 m0, s19, 30720
    s_add_u32 s18, s31, 1966336
    buffer_load_dwordx4 v4, s[8:11], s18 offen lds
    s_add_u32 m0, s19, 31744
    s_add_u32 s18, s31, 2031872
    buffer_load_dwordx4 v4, s[8:11], s18 offen lds
    s_add_u32 m0, s19, 32768
    s_add_u32 s18, s31, 2097408
    buffer_load_dwordx4 v4, s[8:11], s18 offen lds
    s_add_u32 m0, s19, 33792
    s_add_u32 s18, s31, 2162944
    buffer_load_dwordx4 v4, s[8:11], s18 offen lds
    s_add_u32 m0, s19, 34816
    s_add_u32 s18, s31, 2228480
    buffer_load_dwordx4 v4, s[8:11], s18 offen lds
    s_add_u32 m0, s19, 35840
    s_add_u32 s18, s31, 2294016
    buffer_load_dwordx4 v4, s[8:11], s18 offen lds
    s_add_u32 m0, s19, 36864
    s_add_u32 s18, s31, 2359552
    buffer_load_dwordx4 v4, s[8:11], s18 offen lds
    s_add_u32 m0, s19, 37888
    s_add_u32 s18, s31, 2425088
    buffer_load_dwordx4 v4, s[8:11], s18 offen lds
    s_add_u32 m0, s19, 38912
    s_add_u32 s18, s31, 2490624
    buffer_load_dwordx4 v4, s[8:11], s18 offen lds
    s_add_u32 m0, s19, 39936
    s_add_u32 s18, s31, 2556160
    buffer_load_dwordx4 v4, s[8:11], s18 offen lds
    s_add_u32 m0, s19, 40960
    s_add_u32 s18, s31, 2621696
    buffer_load_dwordx4 v4, s[8:11], s18 offen lds
    s_add_u32 m0, s19, 41984
    s_add_u32 s18, s31, 2687232
    buffer_load_dwordx4 v4, s[8:11], s18 offen lds
    s_waitcnt vmcnt(28)
    s_barrier
    s_add_u32 m0, s19, 57344
    s_add_u32 s18, s31, 384
    buffer_load_dwordx4 v4, s[8:11], s18 offen lds
    s_add_u32 m0, s19, 58368
    s_add_u32 s18, s31, 65920
    buffer_load_dwordx4 v4, s[8:11], s18 offen lds
    s_add_u32 m0, s19, 59392
    s_add_u32 s18, s31, 131456
    buffer_load_dwordx4 v4, s[8:11], s18 offen lds
    s_add_u32 m0, s19, 60416
    s_add_u32 s18, s31, 196992
    buffer_load_dwordx4 v4, s[8:11], s18 offen lds
    s_add_u32 m0, s19, 61440
    s_add_u32 s18, s31, 262528
    buffer_load_dwordx4 v4, s[8:11], s18 offen lds
    s_add_u32 m0, s19, 62464
    s_add_u32 s18, s31, 328064
    buffer_load_dwordx4 v4, s[8:11], s18 offen lds
    s_add_u32 m0, s19, 63488
    s_add_u32 s18, s31, 393600
    buffer_load_dwordx4 v4, s[8:11], s18 offen lds
    s_add_u32 m0, s19, 64512
    s_add_u32 s18, s31, 459136
    buffer_load_dwordx4 v4, s[8:11], s18 offen lds
    s_add_u32 m0, s19, 65536
    s_add_u32 s18, s31, 524672
    buffer_load_dwordx4 v4, s[8:11], s18 offen lds
    s_add_u32 m0, s19, 66560
    s_add_u32 s18, s31, 590208
    buffer_load_dwordx4 v4, s[8:11], s18 offen lds
    s_add_u32 m0, s19, 67584
    s_add_u32 s18, s31, 655744
    buffer_load_dwordx4 v4, s[8:11], s18 offen lds
    s_add_u32 m0, s19, 68608
    s_add_u32 s18, s31, 721280
    buffer_load_dwordx4 v4, s[8:11], s18 offen lds
    s_add_u32 m0, s19, 69632
    s_add_u32 s18, s31, 786816
    buffer_load_dwordx4 v4, s[8:11], s18 offen lds
    s_add_u32 m0, s19, 70656
    s_add_u32 s18, s31, 852352
    buffer_load_dwordx4 v4, s[8:11], s18 offen lds
    s_waitcnt vmcnt(28)
    s_barrier
    s_add_u32 m0, s19, 86016
    s_add_u32 s18, s31, 1835392
    buffer_load_dwordx4 v4, s[8:11], s18 offen lds
    s_add_u32 m0, s19, 87040
    s_add_u32 s18, s31, 1900928
    buffer_load_dwordx4 v4, s[8:11], s18 offen lds
    s_add_u32 m0, s19, 88064
    s_add_u32 s18, s31, 1966464
    buffer_load_dwordx4 v4, s[8:11], s18 offen lds
    s_add_u32 m0, s19, 89088
    s_add_u32 s18, s31, 2032000
    buffer_load_dwordx4 v4, s[8:11], s18 offen lds
    s_add_u32 m0, s19, 90112
    s_add_u32 s18, s31, 2097536
    buffer_load_dwordx4 v4, s[8:11], s18 offen lds
    s_add_u32 m0, s19, 91136
    s_add_u32 s18, s31, 2163072
    buffer_load_dwordx4 v4, s[8:11], s18 offen lds
    s_add_u32 m0, s19, 92160
    s_add_u32 s18, s31, 2228608
    buffer_load_dwordx4 v4, s[8:11], s18 offen lds
    s_add_u32 m0, s19, 93184
    s_add_u32 s18, s31, 2294144
    buffer_load_dwordx4 v4, s[8:11], s18 offen lds
    s_add_u32 m0, s19, 94208
    s_add_u32 s18, s31, 2359680
    buffer_load_dwordx4 v4, s[8:11], s18 offen lds
    s_add_u32 m0, s19, 95232
    s_add_u32 s18, s31, 2425216
    buffer_load_dwordx4 v4, s[8:11], s18 offen lds
    s_add_u32 m0, s19, 96256
    s_add_u32 s18, s31, 2490752
    buffer_load_dwordx4 v4, s[8:11], s18 offen lds
    s_add_u32 m0, s19, 97280
    s_add_u32 s18, s31, 2556288
    buffer_load_dwordx4 v4, s[8:11], s18 offen lds
    s_add_u32 m0, s19, 98304
    s_add_u32 s18, s31, 2621824
    buffer_load_dwordx4 v4, s[8:11], s18 offen lds
    s_add_u32 m0, s19, 99328
    s_add_u32 s18, s31, 2687360
    buffer_load_dwordx4 v4, s[8:11], s18 offen lds
    s_waitcnt vmcnt(28)
    s_barrier
    s_waitcnt vmcnt(14)
    s_barrier
    s_waitcnt vmcnt(0)
    s_barrier
    s_barrier
    s_add_u32 m0, s29, 0
    s_add_u32 s18, s32, 0
    buffer_load_dwordx4 v5, s[12:15], s18 offen lds
    s_add_u32 m0, s29, 1024
    s_add_u32 s18, s32, 7168
    buffer_load_dwordx4 v5, s[12:15], s18 offen lds
    s_add_u32 m0, s29, 2048
    s_add_u32 s18, s32, 14336
    buffer_load_dwordx4 v5, s[12:15], s18 offen lds
    s_add_u32 m0, s29, 3072
    s_add_u32 s18, s32, 21504
    buffer_load_dwordx4 v5, s[12:15], s18 offen lds
    s_add_u32 m0, s29, 4096
    s_add_u32 s18, s32, 28672
    buffer_load_dwordx4 v5, s[12:15], s18 offen lds
    s_add_u32 m0, s29, 5120
    s_add_u32 s18, s32, 35840
    buffer_load_dwordx4 v5, s[12:15], s18 offen lds
    s_add_u32 m0, s29, 6144
    s_add_u32 s18, s32, 43008
    buffer_load_dwordx4 v5, s[12:15], s18 offen lds
    s_add_u32 m0, s29, 7168
    s_add_u32 s18, s32, 50176
    buffer_load_dwordx4 v5, s[12:15], s18 offen lds
    s_add_u32 m0, s29, 8192
    s_add_u32 s18, s32, 57344
    buffer_load_dwordx4 v5, s[12:15], s18 offen lds
    s_add_u32 m0, s29, 9216
    s_add_u32 s18, s32, 64512
    buffer_load_dwordx4 v5, s[12:15], s18 offen lds
    s_add_u32 m0, s29, 10240
    s_add_u32 s18, s32, 71680
    buffer_load_dwordx4 v5, s[12:15], s18 offen lds
    s_add_u32 m0, s29, 11264
    s_add_u32 s18, s32, 78848
    buffer_load_dwordx4 v5, s[12:15], s18 offen lds
    s_add_u32 m0, s29, 12288
    s_add_u32 s18, s32, 86016
    buffer_load_dwordx4 v5, s[12:15], s18 offen lds
    s_add_u32 m0, s29, 13312
    s_add_u32 s18, s32, 93184
    buffer_load_dwordx4 v5, s[12:15], s18 offen lds
    s_add_u32 m0, s29, 14336
    s_add_u32 s18, s32, 100352
    buffer_load_dwordx4 v5, s[12:15], s18 offen lds
    s_add_u32 m0, s29, 15360
    s_add_u32 s18, s32, 107520
    buffer_load_dwordx4 v5, s[12:15], s18 offen lds
    s_add_u32 m0, s29, 32768
    s_add_u32 s18, s32, 128
    buffer_load_dwordx4 v5, s[12:15], s18 offen lds
    s_add_u32 m0, s29, 33792
    s_add_u32 s18, s32, 7296
    buffer_load_dwordx4 v5, s[12:15], s18 offen lds
    s_add_u32 m0, s29, 34816
    s_add_u32 s18, s32, 14464
    buffer_load_dwordx4 v5, s[12:15], s18 offen lds
    s_add_u32 m0, s29, 35840
    s_add_u32 s18, s32, 21632
    buffer_load_dwordx4 v5, s[12:15], s18 offen lds
    s_add_u32 m0, s29, 36864
    s_add_u32 s18, s32, 28800
    buffer_load_dwordx4 v5, s[12:15], s18 offen lds
    s_add_u32 m0, s29, 37888
    s_add_u32 s18, s32, 35968
    buffer_load_dwordx4 v5, s[12:15], s18 offen lds
    s_add_u32 m0, s29, 38912
    s_add_u32 s18, s32, 43136
    buffer_load_dwordx4 v5, s[12:15], s18 offen lds
    s_add_u32 m0, s29, 39936
    s_add_u32 s18, s32, 50304
    buffer_load_dwordx4 v5, s[12:15], s18 offen lds
    s_add_u32 m0, s29, 40960
    s_add_u32 s18, s32, 57472
    buffer_load_dwordx4 v5, s[12:15], s18 offen lds
    s_add_u32 m0, s29, 41984
    s_add_u32 s18, s32, 64640
    buffer_load_dwordx4 v5, s[12:15], s18 offen lds
    s_add_u32 m0, s29, 43008
    s_add_u32 s18, s32, 71808
    buffer_load_dwordx4 v5, s[12:15], s18 offen lds
    s_add_u32 m0, s29, 44032
    s_add_u32 s18, s32, 78976
    buffer_load_dwordx4 v5, s[12:15], s18 offen lds
    s_add_u32 m0, s29, 45056
    s_add_u32 s18, s32, 86144
    buffer_load_dwordx4 v5, s[12:15], s18 offen lds
    s_add_u32 m0, s29, 46080
    s_add_u32 s18, s32, 93312
    buffer_load_dwordx4 v5, s[12:15], s18 offen lds
    s_add_u32 m0, s29, 47104
    s_add_u32 s18, s32, 100480
    buffer_load_dwordx4 v5, s[12:15], s18 offen lds
    s_add_u32 m0, s29, 48128
    s_add_u32 s18, s32, 107648
    buffer_load_dwordx4 v5, s[12:15], s18 offen lds
    s_add_u32 m0, s29, 65536
    s_add_u32 s18, s32, 256
    buffer_load_dwordx4 v5, s[12:15], s18 offen lds
    s_add_u32 m0, s29, 66560
    s_add_u32 s18, s32, 7424
    buffer_load_dwordx4 v5, s[12:15], s18 offen lds
    s_add_u32 m0, s29, 67584
    s_add_u32 s18, s32, 14592
    buffer_load_dwordx4 v5, s[12:15], s18 offen lds
    s_add_u32 m0, s29, 68608
    s_add_u32 s18, s32, 21760
    buffer_load_dwordx4 v5, s[12:15], s18 offen lds
    s_add_u32 m0, s29, 69632
    s_add_u32 s18, s32, 28928
    buffer_load_dwordx4 v5, s[12:15], s18 offen lds
    s_add_u32 m0, s29, 70656
    s_add_u32 s18, s32, 36096
    buffer_load_dwordx4 v5, s[12:15], s18 offen lds
    s_add_u32 m0, s29, 71680
    s_add_u32 s18, s32, 43264
    buffer_load_dwordx4 v5, s[12:15], s18 offen lds
    s_add_u32 m0, s29, 72704
    s_add_u32 s18, s32, 50432
    buffer_load_dwordx4 v5, s[12:15], s18 offen lds
    s_add_u32 m0, s29, 73728
    s_add_u32 s18, s32, 57600
    buffer_load_dwordx4 v5, s[12:15], s18 offen lds
    s_add_u32 m0, s29, 74752
    s_add_u32 s18, s32, 64768
    buffer_load_dwordx4 v5, s[12:15], s18 offen lds
    s_add_u32 m0, s29, 75776
    s_add_u32 s18, s32, 71936
    buffer_load_dwordx4 v5, s[12:15], s18 offen lds
    s_add_u32 m0, s29, 76800
    s_add_u32 s18, s32, 79104
    buffer_load_dwordx4 v5, s[12:15], s18 offen lds
    s_add_u32 m0, s29, 77824
    s_add_u32 s18, s32, 86272
    buffer_load_dwordx4 v5, s[12:15], s18 offen lds
    s_add_u32 m0, s29, 78848
    s_add_u32 s18, s32, 93440
    buffer_load_dwordx4 v5, s[12:15], s18 offen lds
    s_add_u32 m0, s29, 79872
    s_add_u32 s18, s32, 100608
    buffer_load_dwordx4 v5, s[12:15], s18 offen lds
    s_add_u32 m0, s29, 80896
    s_add_u32 s18, s32, 107776
    buffer_load_dwordx4 v5, s[12:15], s18 offen lds
    s_waitcnt vmcnt(32)
    s_barrier
    s_waitcnt vmcnt(16)
    s_barrier
    s_add_u32 m0, s29, 0
    s_add_u32 s18, s32, 384
    buffer_load_dwordx4 v5, s[12:15], s18 offen lds
    s_add_u32 m0, s29, 1024
    s_add_u32 s18, s32, 7552
    buffer_load_dwordx4 v5, s[12:15], s18 offen lds
    s_add_u32 m0, s29, 2048
    s_add_u32 s18, s32, 14720
    buffer_load_dwordx4 v5, s[12:15], s18 offen lds
    s_add_u32 m0, s29, 3072
    s_add_u32 s18, s32, 21888
    buffer_load_dwordx4 v5, s[12:15], s18 offen lds
    s_add_u32 m0, s29, 4096
    s_add_u32 s18, s32, 29056
    buffer_load_dwordx4 v5, s[12:15], s18 offen lds
    s_add_u32 m0, s29, 5120
    s_add_u32 s18, s32, 36224
    buffer_load_dwordx4 v5, s[12:15], s18 offen lds
    s_add_u32 m0, s29, 6144
    s_add_u32 s18, s32, 43392
    buffer_load_dwordx4 v5, s[12:15], s18 offen lds
    s_add_u32 m0, s29, 7168
    s_add_u32 s18, s32, 50560
    buffer_load_dwordx4 v5, s[12:15], s18 offen lds
    s_add_u32 m0, s29, 8192
    s_add_u32 s18, s32, 57728
    buffer_load_dwordx4 v5, s[12:15], s18 offen lds
    s_add_u32 m0, s29, 9216
    s_add_u32 s18, s32, 64896
    buffer_load_dwordx4 v5, s[12:15], s18 offen lds
    s_add_u32 m0, s29, 10240
    s_add_u32 s18, s32, 72064
    buffer_load_dwordx4 v5, s[12:15], s18 offen lds
    s_add_u32 m0, s29, 11264
    s_add_u32 s18, s32, 79232
    buffer_load_dwordx4 v5, s[12:15], s18 offen lds
    s_add_u32 m0, s29, 12288
    s_add_u32 s18, s32, 86400
    buffer_load_dwordx4 v5, s[12:15], s18 offen lds
    s_add_u32 m0, s29, 13312
    s_add_u32 s18, s32, 93568
    buffer_load_dwordx4 v5, s[12:15], s18 offen lds
    s_add_u32 m0, s29, 14336
    s_add_u32 s18, s32, 100736
    buffer_load_dwordx4 v5, s[12:15], s18 offen lds
    s_add_u32 m0, s29, 15360
    s_add_u32 s18, s32, 107904
    buffer_load_dwordx4 v5, s[12:15], s18 offen lds
    s_waitcnt vmcnt(16)
    s_barrier
    s_add_u32 m0, s29, 32768
    s_add_u32 s18, s32, 512
    buffer_load_dwordx4 v5, s[12:15], s18 offen lds
    s_add_u32 m0, s29, 33792
    s_add_u32 s18, s32, 7680
    buffer_load_dwordx4 v5, s[12:15], s18 offen lds
    s_add_u32 m0, s29, 34816
    s_add_u32 s18, s32, 14848
    buffer_load_dwordx4 v5, s[12:15], s18 offen lds
    s_add_u32 m0, s29, 35840
    s_add_u32 s18, s32, 22016
    buffer_load_dwordx4 v5, s[12:15], s18 offen lds
    s_add_u32 m0, s29, 36864
    s_add_u32 s18, s32, 29184
    buffer_load_dwordx4 v5, s[12:15], s18 offen lds
    s_add_u32 m0, s29, 37888
    s_add_u32 s18, s32, 36352
    buffer_load_dwordx4 v5, s[12:15], s18 offen lds
    s_add_u32 m0, s29, 38912
    s_add_u32 s18, s32, 43520
    buffer_load_dwordx4 v5, s[12:15], s18 offen lds
    s_add_u32 m0, s29, 39936
    s_add_u32 s18, s32, 50688
    buffer_load_dwordx4 v5, s[12:15], s18 offen lds
    s_add_u32 m0, s29, 40960
    s_add_u32 s18, s32, 57856
    buffer_load_dwordx4 v5, s[12:15], s18 offen lds
    s_add_u32 m0, s29, 41984
    s_add_u32 s18, s32, 65024
    buffer_load_dwordx4 v5, s[12:15], s18 offen lds
    s_add_u32 m0, s29, 43008
    s_add_u32 s18, s32, 72192
    buffer_load_dwordx4 v5, s[12:15], s18 offen lds
    s_add_u32 m0, s29, 44032
    s_add_u32 s18, s32, 79360
    buffer_load_dwordx4 v5, s[12:15], s18 offen lds
    s_add_u32 m0, s29, 45056
    s_add_u32 s18, s32, 86528
    buffer_load_dwordx4 v5, s[12:15], s18 offen lds
    s_add_u32 m0, s29, 46080
    s_add_u32 s18, s32, 93696
    buffer_load_dwordx4 v5, s[12:15], s18 offen lds
    s_add_u32 m0, s29, 47104
    s_add_u32 s18, s32, 100864
    buffer_load_dwordx4 v5, s[12:15], s18 offen lds
    s_add_u32 m0, s29, 48128
    s_add_u32 s18, s32, 108032
    buffer_load_dwordx4 v5, s[12:15], s18 offen lds
    s_waitcnt vmcnt(16)
    s_barrier
    s_add_u32 m0, s29, 65536
    s_add_u32 s18, s32, 640
    buffer_load_dwordx4 v5, s[12:15], s18 offen lds
    s_add_u32 m0, s29, 66560
    s_add_u32 s18, s32, 7808
    buffer_load_dwordx4 v5, s[12:15], s18 offen lds
    s_add_u32 m0, s29, 67584
    s_add_u32 s18, s32, 14976
    buffer_load_dwordx4 v5, s[12:15], s18 offen lds
    s_add_u32 m0, s29, 68608
    s_add_u32 s18, s32, 22144
    buffer_load_dwordx4 v5, s[12:15], s18 offen lds
    s_add_u32 m0, s29, 69632
    s_add_u32 s18, s32, 29312
    buffer_load_dwordx4 v5, s[12:15], s18 offen lds
    s_add_u32 m0, s29, 70656
    s_add_u32 s18, s32, 36480
    buffer_load_dwordx4 v5, s[12:15], s18 offen lds
    s_add_u32 m0, s29, 71680
    s_add_u32 s18, s32, 43648
    buffer_load_dwordx4 v5, s[12:15], s18 offen lds
    s_add_u32 m0, s29, 72704
    s_add_u32 s18, s32, 50816
    buffer_load_dwordx4 v5, s[12:15], s18 offen lds
    s_add_u32 m0, s29, 73728
    s_add_u32 s18, s32, 57984
    buffer_load_dwordx4 v5, s[12:15], s18 offen lds
    s_add_u32 m0, s29, 74752
    s_add_u32 s18, s32, 65152
    buffer_load_dwordx4 v5, s[12:15], s18 offen lds
    s_add_u32 m0, s29, 75776
    s_add_u32 s18, s32, 72320
    buffer_load_dwordx4 v5, s[12:15], s18 offen lds
    s_add_u32 m0, s29, 76800
    s_add_u32 s18, s32, 79488
    buffer_load_dwordx4 v5, s[12:15], s18 offen lds
    s_add_u32 m0, s29, 77824
    s_add_u32 s18, s32, 86656
    buffer_load_dwordx4 v5, s[12:15], s18 offen lds
    s_add_u32 m0, s29, 78848
    s_add_u32 s18, s32, 93824
    buffer_load_dwordx4 v5, s[12:15], s18 offen lds
    s_add_u32 m0, s29, 79872
    s_add_u32 s18, s32, 100992
    buffer_load_dwordx4 v5, s[12:15], s18 offen lds
    s_add_u32 m0, s29, 80896
    s_add_u32 s18, s32, 108160
    buffer_load_dwordx4 v5, s[12:15], s18 offen lds
    s_waitcnt vmcnt(16)
    s_barrier
    s_add_u32 m0, s29, 0
    s_add_u32 s18, s32, 768
    buffer_load_dwordx4 v5, s[12:15], s18 offen lds
    s_add_u32 m0, s29, 1024
    s_add_u32 s18, s32, 7936
    buffer_load_dwordx4 v5, s[12:15], s18 offen lds
    s_add_u32 m0, s29, 2048
    s_add_u32 s18, s32, 15104
    buffer_load_dwordx4 v5, s[12:15], s18 offen lds
    s_add_u32 m0, s29, 3072
    s_add_u32 s18, s32, 22272
    buffer_load_dwordx4 v5, s[12:15], s18 offen lds
    s_add_u32 m0, s29, 4096
    s_add_u32 s18, s32, 29440
    buffer_load_dwordx4 v5, s[12:15], s18 offen lds
    s_add_u32 m0, s29, 5120
    s_add_u32 s18, s32, 36608
    buffer_load_dwordx4 v5, s[12:15], s18 offen lds
    s_add_u32 m0, s29, 6144
    s_add_u32 s18, s32, 43776
    buffer_load_dwordx4 v5, s[12:15], s18 offen lds
    s_add_u32 m0, s29, 7168
    s_add_u32 s18, s32, 50944
    buffer_load_dwordx4 v5, s[12:15], s18 offen lds
    s_add_u32 m0, s29, 8192
    s_add_u32 s18, s32, 58112
    buffer_load_dwordx4 v5, s[12:15], s18 offen lds
    s_add_u32 m0, s29, 9216
    s_add_u32 s18, s32, 65280
    buffer_load_dwordx4 v5, s[12:15], s18 offen lds
    s_add_u32 m0, s29, 10240
    s_add_u32 s18, s32, 72448
    buffer_load_dwordx4 v5, s[12:15], s18 offen lds
    s_add_u32 m0, s29, 11264
    s_add_u32 s18, s32, 79616
    buffer_load_dwordx4 v5, s[12:15], s18 offen lds
    s_add_u32 m0, s29, 12288
    s_add_u32 s18, s32, 86784
    buffer_load_dwordx4 v5, s[12:15], s18 offen lds
    s_add_u32 m0, s29, 13312
    s_add_u32 s18, s32, 93952
    buffer_load_dwordx4 v5, s[12:15], s18 offen lds
    s_add_u32 m0, s29, 14336
    s_add_u32 s18, s32, 101120
    buffer_load_dwordx4 v5, s[12:15], s18 offen lds
    s_add_u32 m0, s29, 15360
    s_add_u32 s18, s32, 108288
    buffer_load_dwordx4 v5, s[12:15], s18 offen lds
    s_waitcnt vmcnt(16)
    s_barrier
    s_waitcnt vmcnt(0)
    s_barrier
zend_57:
    s_lshl_b32 s93, s25, 6
    s_add_u32 s93, s93, 90972160
    s_waitcnt vmcnt(0)
    s_barrier
    s_cmp_lg_u32 s87, 0
    s_cbranch_scc1 sig_58
    v_mov_b32 v250, 0
    v_mov_b32 v251, 1
    s_mov_b64 exec, 1
    buffer_atomic_add v251, v250, s[4:7], s93 offen
    s_mov_b64 exec, -1
sig_58:
    s_cmp_eq_u32 s73, 0
    s_cbranch_scc1 lnd_59
    s_barrier
    s_cmp_ge_u32 s75, 256
    s_cbranch_scc1 noln_60
    s_mov_b32 s91, 64
    s_cmp_lg_u32 s87, 0
    s_cbranch_scc1 wsk_63
    s_load_dwordx2 s[96:97], s[0:1], 120
    s_waitcnt lgkmcnt(0)
    s_mov_b32 s90, 0
    v_mov_b32 v60, s91
wge_61:
    global_load_dword v61, v60, s[96:97] sc1
    s_waitcnt vmcnt(0)
    v_readfirstlane_b32 s92, v61
    s_nop 3
    s_cmp_ge_u32 s92, 14
    s_cbranch_scc1 wok_62
    s_sleep 2
    s_add_u32 s90, s90, 1
    s_cmp_lt_u32 s90, 400000
    s_cbranch_scc1 wge_61
    s_branch L_abort
wok_62:
wsk_63:
    s_barrier
    s_mov_b32 s3, s75
    v_and_b32 v1, 63, v0
    v_lshrrev_b32 v2, 6, v0
    s_nop 0
    v_readfirstlane_b32 s16, v2
    v_min_u32 v3, 55, v1
    v_lshrrev_b32 v4, 1, v3
    v_lshlrev_b32 v4, 4, v4
    v_and_b32 v5, 1, v3
    v_lshl_add_u32 v4, v5, 2, v4
    v_mul_u32_u24 v4, 2, v4
    v_lshlrev_b32 v5, 1, v4
    s_mov_b32 s21, 87054080
    buffer_load_dwordx4 v[40:43], v5, s[4:7], s21 offen sc1
    buffer_load_dwordx4 v[44:47], v5, s[4:7], s21 offen offset:32 sc1
    s_mov_b32 s21, 87052288
    buffer_load_dwordx4 v[48:51], v5, s[4:7], s21 offen sc1
    buffer_load_dwordx4 v[52:55], v5, s[4:7], s21 offen offset:32 sc1
    s_lshl_b32 s17, s3, 3
    s_lshl_b32 s16, s16, 1
    s_add_u32 s17, s17, s16
    s_mul_i32 s18, s17, 896
    v_accvgpr_read_b32 v8, a248
    v_accvgpr_read_b32 v9, a249
    v_accvgpr_read_b32 v10, a250
    v_accvgpr_read_b32 v11, a251
    v_accvgpr_read_b32 v12, a252
    v_accvgpr_read_b32 v13, a253
    v_accvgpr_read_b32 v14, a254
    v_accvgpr_read_b32 v15, a255
    s_mov_b32 s22, -1
    s_mov_b32 s23, 0x00ffffff
    s_waitcnt vmcnt(0)
    v_lshlrev_b32 v16, 16, v8
    v_and_b32 v17, 0xffff0000, v8
    v_lshlrev_b32 v18, 16, v9
    v_and_b32 v19, 0xffff0000, v9
    v_lshlrev_b32 v20, 16, v10
    v_and_b32 v21, 0xffff0000, v10
    v_lshlrev_b32 v22, 16, v11
    v_and_b32 v23, 0xffff0000, v11
    v_cndmask_b32 v16, 0, v16, s[22:23]
    v_cndmask_b32 v17, 0, v17, s[22:23]
    v_cndmask_b32 v18, 0, v18, s[22:23]
    v_cndmask_b32 v19, 0, v19, s[22:23]
    v_cndmask_b32 v20, 0, v20, s[22:23]
    v_cndmask_b32 v21, 0, v21, s[22:23]
    v_cndmask_b32 v22, 0, v22, s[22:23]
    v_cndmask_b32 v23, 0, v23, s[22:23]
    v_lshlrev_b32 v24, 16, v12
    v_and_b32 v25, 0xffff0000, v12
    v_lshlrev_b32 v26, 16, v13
    v_and_b32 v27, 0xffff0000, v13
    v_lshlrev_b32 v28, 16, v14
    v_and_b32 v29, 0xffff0000, v14
    v_lshlrev_b32 v30, 16, v15
    v_and_b32 v31, 0xffff0000, v15
    v_cndmask_b32 v24, 0, v24, s[22:23]
    v_cndmask_b32 v25, 0, v25, s[22:23]
    v_cndmask_b32 v26, 0, v26, s[22:23]
    v_cndmask_b32 v27, 0, v27, s[22:23]
    v_cndmask_b32 v28, 0, v28, s[22:23]
    v_cndmask_b32 v29, 0, v29, s[22:23]
    v_cndmask_b32 v30, 0, v30, s[22:23]
    v_cndmask_b32 v31, 0, v31, s[22:23]
    v_add_f32 v40, 1.0, v40
    v_add_f32 v41, 1.0, v41
    v_cvt_pk_bf16_f32 v6, v40, v41
    v_lshlrev_b32 v40, 16, v6
    v_and_b32 v41, 0xffff0000, v6
    v_add_f32 v42, 1.0, v42
    v_add_f32 v43, 1.0, v43
    v_cvt_pk_bf16_f32 v6, v42, v43
    v_lshlrev_b32 v42, 16, v6
    v_and_b32 v43, 0xffff0000, v6
    v_add_f32 v44, 1.0, v44
    v_add_f32 v45, 1.0, v45
    v_cvt_pk_bf16_f32 v6, v44, v45
    v_lshlrev_b32 v44, 16, v6
    v_and_b32 v45, 0xffff0000, v6
    v_add_f32 v46, 1.0, v46
    v_add_f32 v47, 1.0, v47
    v_cvt_pk_bf16_f32 v6, v46, v47
    v_lshlrev_b32 v46, 16, v6
    v_and_b32 v47, 0xffff0000, v6
    v_add_f32 v32, v16, v17
    v_add_f32 v32, v32, v18
    v_add_f32 v32, v32, v19
    v_add_f32 v32, v32, v20
    v_add_f32 v32, v32, v21
    v_add_f32 v32, v32, v22
    v_add_f32 v32, v32, v23
    v_add_f32 v33, v24, v25
    v_add_f32 v33, v33, v26
    v_add_f32 v33, v33, v27
    v_add_f32 v33, v33, v28
    v_add_f32 v33, v33, v29
    v_add_f32 v33, v33, v30
    v_add_f32 v33, v33, v31
    s_nop 1
    v_add_f32_dpp v32, v32, v32 quad_perm:[1,0,3,2] row_mask:0xf bank_mask:0xf
    v_add_f32_dpp v33, v33, v33 quad_perm:[1,0,3,2] row_mask:0xf bank_mask:0xf
    s_nop 1
    v_add_f32_dpp v32, v32, v32 quad_perm:[2,3,0,1] row_mask:0xf bank_mask:0xf
    v_add_f32_dpp v33, v33, v33 quad_perm:[2,3,0,1] row_mask:0xf bank_mask:0xf
    s_nop 1
    v_add_f32_dpp v32, v32, v32 row_half_mirror row_mask:0xf bank_mask:0xf
    v_add_f32_dpp v33, v33, v33 row_half_mirror row_mask:0xf bank_mask:0xf
    s_nop 1
    v_add_f32_dpp v32, v32, v32 row_mirror row_mask:0xf bank_mask:0xf
    v_add_f32_dpp v33, v33, v33 row_mirror row_mask:0xf bank_mask:0xf
    v_mov_b32 v56, v32
    v_mov_b32 v57, v33
    s_nop 1
    v_permlane16_swap_b32 v32, v56
    v_permlane16_swap_b32 v33, v57
    s_nop 1
    v_add_f32 v32, v32, v56
    v_add_f32 v33, v33, v57
    v_mov_b32 v56, v32
    v_mov_b32 v57, v33
    s_nop 1
    v_permlane32_swap_b32 v32, v56
    v_permlane32_swap_b32 v33, v57
    s_nop 1
    v_add_f32 v32, v32, v56
    v_add_f32 v33, v33, v57
    s_mov_b32 s20, 0x3b124925
    v_mul_f32 v32, s20, v32
    v_mul_f32 v33, s20, v33
    v_sub_f32 v56, v16, v32
    v_mul_f32 v34, v56, v56
    v_sub_f32 v56, v17, v32
    v_fmac_f32 v34, v56, v56
    v_sub_f32 v56, v18, v32
    v_fmac_f32 v34, v56, v56
    v_sub_f32 v56, v19, v32
    v_fmac_f32 v34, v56, v56
    v_sub_f32 v56, v20, v32
    v_fmac_f32 v34, v56, v56
    v_sub_f32 v56, v21, v32
    v_fmac_f32 v34, v56, v56
    v_sub_f32 v56, v22, v32
    v_fmac_f32 v34, v56, v56
    v_sub_f32 v56, v23, v32
    v_fmac_f32 v34, v56, v56
    v_cndmask_b32 v34, 0, v34, s[22:23]
    v_sub_f32 v56, v24, v33
    v_mul_f32 v35, v56, v56
    v_sub_f32 v56, v25, v33
    v_fmac_f32 v35, v56, v56
    v_sub_f32 v56, v26, v33
    v_fmac_f32 v35, v56, v56
    v_sub_f32 v56, v27, v33
    v_fmac_f32 v35, v56, v56
    v_sub_f32 v56, v28, v33
    v_fmac_f32 v35, v56, v56
    v_sub_f32 v56, v29, v33
    v_fmac_f32 v35, v56, v56
    v_sub_f32 v56, v30, v33
    v_fmac_f32 v35, v56, v56
    v_sub_f32 v56, v31, v33
    v_fmac_f32 v35, v56, v56
    v_cndmask_b32 v35, 0, v35, s[22:23]
    s_nop 1
    v_add_f32_dpp v34, v34, v34 quad_perm:[1,0,3,2] row_mask:0xf bank_mask:0xf
    v_add_f32_dpp v35, v35, v35 quad_perm:[1,0,3,2] row_mask:0xf bank_mask:0xf
    s_nop 1
    v_add_f32_dpp v34, v34, v34 quad_perm:[2,3,0,1] row_mask:0xf bank_mask:0xf
    v_add_f32_dpp v35, v35, v35 quad_perm:[2,3,0,1] row_mask:0xf bank_mask:0xf
    s_nop 1
    v_add_f32_dpp v34, v34, v34 row_half_mirror row_mask:0xf bank_mask:0xf
    v_add_f32_dpp v35, v35, v35 row_half_mirror row_mask:0xf bank_mask:0xf
    s_nop 1
    v_add_f32_dpp v34, v34, v34 row_mirror row_mask:0xf bank_mask:0xf
    v_add_f32_dpp v35, v35, v35 row_mirror row_mask:0xf bank_mask:0xf
    v_mov_b32 v56, v34
    v_mov_b32 v57, v35
    s_nop 1
    v_permlane16_swap_b32 v34, v56
    v_permlane16_swap_b32 v35, v57
    s_nop 1
    v_add_f32 v34, v34, v56
    v_add_f32 v35, v35, v57
    v_mov_b32 v56, v34
    v_mov_b32 v57, v35
    s_nop 1
    v_permlane32_swap_b32 v34, v56
    v_permlane32_swap_b32 v35, v57
    s_nop 1
    v_add_f32 v34, v34, v56
    v_add_f32 v35, v35, v57
    v_mul_f32 v34, s20, v34
    v_cvt_pk_bf16_f32 v56, v32, v34
    v_lshlrev_b32 v32, 16, v56
    v_and_b32 v34, 0xffff0000, v56
    v_add_f32 v34, 0x3727c5ac, v34
    v_cvt_pk_bf16_f32 v56, v34, v34
    v_lshlrev_b32 v34, 16, v56
    v_sqrt_f32 v34, v34
    s_nop 0
    v_cvt_pk_bf16_f32 v56, v34, v34
    v_lshlrev_b32 v34, 16, v56
    v_rcp_f32 v34, v34
    s_nop 0
    v_mul_f32 v35, s20, v35
    v_cvt_pk_bf16_f32 v56, v33, v35
    v_lshlrev_b32 v33, 16, v56
    v_and_b32 v35, 0xffff0000, v56
    v_add_f32 v35, 0x3727c5ac, v35
    v_cvt_pk_bf16_f32 v56, v35, v35
    v_lshlrev_b32 v35, 16, v56
    v_sqrt_f32 v35, v35
    s_nop 0
    v_cvt_pk_bf16_f32 v56, v35, v35
    v_lshlrev_b32 v35, 16, v56
    v_rcp_f32 v35, v35
    s_nop 0
    v_sub_f32 v16, v16, v32
    v_sub_f32 v17, v17, v32
    v_cvt_pk_bf16_f32 v56, v16, v17
    v_lshlrev_b32 v16, 16, v56
    v_and_b32 v17, 0xffff0000, v56
    v_mul_f32 v16, v16, v34
    v_mul_f32 v17, v17, v34
    v_cvt_pk_bf16_f32 v56, v16, v17
    v_lshlrev_b32 v16, 16, v56
    v_and_b32 v17, 0xffff0000, v56
    v_mul_f32 v16, v16, v40
    v_mul_f32 v17, v17, v41
    v_cvt_pk_bf16_f32 v56, v16, v17
    v_lshlrev_b32 v16, 16, v56
    v_and_b32 v17, 0xffff0000, v56
    v_add_f32 v16, v16, v48
    v_add_f32 v17, v17, v49
    v_sub_f32 v18, v18, v32
    v_sub_f32 v19, v19, v32
    v_cvt_pk_bf16_f32 v56, v18, v19
    v_lshlrev_b32 v18, 16, v56
    v_and_b32 v19, 0xffff0000, v56
    v_mul_f32 v18, v18, v34
    v_mul_f32 v19, v19, v34
    v_cvt_pk_bf16_f32 v56, v18, v19
    v_lshlrev_b32 v18, 16, v56
    v_and_b32 v19, 0xffff0000, v56
    v_mul_f32 v18, v18, v42
    v_mul_f32 v19, v19, v43
    v_cvt_pk_bf16_f32 v56, v18, v19
    v_lshlrev_b32 v18, 16, v56
    v_and_b32 v19, 0xffff0000, v56
    v_add_f32 v18, v18, v50
    v_add_f32 v19, v19, v51
    v_sub_f32 v20, v20, v32
    v_sub_f32 v21, v21, v32
    v_cvt_pk_bf16_f32 v56, v20, v21
    v_lshlrev_b32 v20, 16, v56
    v_and_b32 v21, 0xffff0000, v56
    v_mul_f32 v20, v20, v34
    v_mul_f32 v21, v21, v34
    v_cvt_pk_bf16_f32 v56, v20, v21
    v_lshlrev_b32 v20, 16, v56
    v_and_b32 v21, 0xffff0000, v56
    v_mul_f32 v20, v20, v44
    v_mul_f32 v21, v21, v45
    v_cvt_pk_bf16_f32 v56, v20, v21
    v_lshlrev_b32 v20, 16, v56
    v_and_b32 v21, 0xffff0000, v56
    v_add_f32 v20, v20, v52
    v_add_f32 v21, v21, v53
    v_sub_f32 v22, v22, v32
    v_sub_f32 v23, v23, v32
    v_cvt_pk_bf16_f32 v56, v22, v23
    v_lshlrev_b32 v22, 16, v56
    v_and_b32 v23, 0xffff0000, v56
    v_mul_f32 v22, v22, v34
    v_mul_f32 v23, v23, v34
    v_cvt_pk_bf16_f32 v56, v22, v23
    v_lshlrev_b32 v22, 16, v56
    v_and_b32 v23, 0xffff0000, v56
    v_mul_f32 v22, v22, v46
    v_mul_f32 v23, v23, v47
    v_cvt_pk_bf16_f32 v56, v22, v23
    v_lshlrev_b32 v22, 16, v56
    v_and_b32 v23, 0xffff0000, v56
    v_add_f32 v22, v22, v54
    v_add_f32 v23, v23, v55
    v_sub_f32 v24, v24, v33
    v_sub_f32 v25, v25, v33
    v_cvt_pk_bf16_f32 v56, v24, v25
    v_lshlrev_b32 v24, 16, v56
    v_and_b32 v25, 0xffff0000, v56
    v_mul_f32 v24, v24, v35
    v_mul_f32 v25, v25, v35
    v_cvt_pk_bf16_f32 v56, v24, v25
    v_lshlrev_b32 v24, 16, v56
    v_and_b32 v25, 0xffff0000, v56
    v_mul_f32 v24, v24, v40
    v_mul_f32 v25, v25, v41
    v_cvt_pk_bf16_f32 v56, v24, v25
    v_lshlrev_b32 v24, 16, v56
    v_and_b32 v25, 0xffff0000, v56
    v_add_f32 v24, v24, v48
    v_add_f32 v25, v25, v49
    v_sub_f32 v26, v26, v33
    v_sub_f32 v27, v27, v33
    v_cvt_pk_bf16_f32 v56, v26, v27
    v_lshlrev_b32 v26, 16, v56
    v_and_b32 v27, 0xffff0000, v56
    v_mul_f32 v26, v26, v35
    v_mul_f32 v27, v27, v35
    v_cvt_pk_bf16_f32 v56, v26, v27
    v_lshlrev_b32 v26, 16, v56
    v_and_b32 v27, 0xffff0000, v56
    v_mul_f32 v26, v26, v42
    v_mul_f32 v27, v27, v43
    v_cvt_pk_bf16_f32 v56, v26, v27
    v_lshlrev_b32 v26, 16, v56
    v_and_b32 v27, 0xffff0000, v56
    v_add_f32 v26, v26, v50
    v_add_f32 v27, v27, v51
    v_sub_f32 v28, v28, v33
    v_sub_f32 v29, v29, v33
    v_cvt_pk_bf16_f32 v56, v28, v29
    v_lshlrev_b32 v28, 16, v56
    v_and_b32 v29, 0xffff0000, v56
    v_mul_f32 v28, v28, v35
    v_mul_f32 v29, v29, v35
    v_cvt_pk_bf16_f32 v56, v28, v29
    v_lshlrev_b32 v28, 16, v56
    v_and_b32 v29, 0xffff0000, v56
    v_mul_f32 v28, v28, v44
    v_mul_f32 v29, v29, v45
    v_cvt_pk_bf16_f32 v56, v28, v29
    v_lshlrev_b32 v28, 16, v56
    v_and_b32 v29, 0xffff0000, v56
    v_add_f32 v28, v28, v52
    v_add_f32 v29, v29, v53
    v_sub_f32 v30, v30, v33
    v_sub_f32 v31, v31, v33
    v_cvt_pk_bf16_f32 v56, v30, v31
    v_lshlrev_b32 v30, 16, v56
    v_and_b32 v31, 0xffff0000, v56
    v_mul_f32 v30, v30, v35
    v_mul_f32 v31, v31, v35
    v_cvt_pk_bf16_f32 v56, v30, v31
    v_lshlrev_b32 v30, 16, v56
    v_and_b32 v31, 0xffff0000, v56
    v_mul_f32 v30, v30, v46
    v_mul_f32 v31, v31, v47
    v_cvt_pk_bf16_f32 v56, v30, v31
    v_lshlrev_b32 v30, 16, v56
    v_and_b32 v31, 0xffff0000, v56
    v_add_f32 v30, v30, v54
    v_add_f32 v31, v31, v55
    s_lshr_b32 s18, s17, 5
    s_mul_i32 s18, s18, 28672
    s_and_b32 s19, s17, 31
    s_lshl_b32 s19, s19, 4
    s_add_u32 s18, s18, s19
    s_add_u32 s18, s18, 12845056
    v_lshlrev_b32 v6, 9, v3
    s_mov_b64 exec, s[22:23]
    v_cvt_pk_bf16_f32 v8, v16, v17
    v_cvt_pk_bf16_f32 v9, v18, v19
    v_cvt_pk_bf16_f32 v10, v20, v21
    v_cvt_pk_bf16_f32 v11, v22, v23
    buffer_store_dwordx4 v[8:11], v6, s[4:7], s18 offen offset:0 sc1
    v_cvt_pk_bf16_f32 v12, v24, v25
    v_cvt_pk_bf16_f32 v13, v26, v27
    v_cvt_pk_bf16_f32 v14, v28, v29
    v_cvt_pk_bf16_f32 v15, v30, v31
    buffer_store_dwordx4 v[12:15], v6, s[4:7], s18 offen offset:16 sc1
    s_mov_b64 exec, -1
    s_lshr_b32 s93, s75, 4
    s_lshl_b32 s93, s93, 6
    s_add_u32 s93, s93, 90975232
    s_waitcnt vmcnt(0)
    s_barrier
    s_cmp_lg_u32 s87, 0
    s_cbranch_scc1 sig_64
    v_mov_b32 v250, 0
    v_mov_b32 v251, 1
    s_mov_b64 exec, 1
    buffer_atomic_add v251, v250, s[4:7], s93 offen
    s_mov_b64 exec, -1
sig_64:
noln_60:
lnd_59:
nofast_52:
    s_cmp_ge_u32 s82, 32
    s_cbranch_scc1 noln2_65
    s_add_u32 s3, s82, 224
    s_mov_b32 s91, 64
    s_cmp_lg_u32 s87, 0
    s_cbranch_scc1 wsk_68
    s_load_dwordx2 s[96:97], s[0:1], 120
    s_waitcnt lgkmcnt(0)
    s_mov_b32 s90, 0
    v_mov_b32 v60, s91
wge_66:
    global_load_dword v61, v60, s[96:97] sc1
    s_waitcnt vmcnt(0)
    v_readfirstlane_b32 s92, v61
    s_nop 3
    s_cmp_ge_u32 s92, 14
    s_cbranch_scc1 wok_67
    s_sleep 2
    s_add_u32 s90, s90, 1
    s_cmp_lt_u32 s90, 400000
    s_cbranch_scc1 wge_66
    s_branch L_abort
wok_67:
wsk_68:
    s_barrier
    s_load_dwordx2 s[8:9], s[0:1], 0
    s_waitcnt lgkmcnt(0)
    s_and_b32 s9, s9, 0xffff
    s_mov_b32 s10, 1835008
    s_mov_b32 s11, 0x20000
    v_and_b32 v1, 63, v0
    v_lshrrev_b32 v2, 6, v0
    s_nop 0
    v_readfirstlane_b32 s16, v2
    v_min_u32 v3, 55, v1
    v_lshrrev_b32 v4, 1, v3
    v_lshlrev_b32 v4, 4, v4
    v_and_b32 v5, 1, v3
    v_lshl_add_u32 v4, v5, 2, v4
    v_mul_u32_u24 v4, 2, v4
    v_lshlrev_b32 v5, 1, v4
    s_mov_b32 s21, 87054080
    buffer_load_dwordx4 v[40:43], v5, s[4:7], s21 offen sc1
    buffer_load_dwordx4 v[44:47], v5, s[4:7], s21 offen offset:32 sc1
    s_mov_b32 s21, 87052288
    buffer_load_dwordx4 v[48:51], v5, s[4:7], s21 offen sc1
    buffer_load_dwordx4 v[52:55], v5, s[4:7], s21 offen offset:32 sc1
    s_lshl_b32 s17, s3, 3
    s_lshl_b32 s16, s16, 1
    s_add_u32 s17, s17, s16
    s_mul_i32 s18, s17, 896
    buffer_load_dwordx2 v[8:9], v4, s[8:11], s18 offen offset:0
    buffer_load_dwordx2 v[10:11], v4, s[8:11], s18 offen offset:16
    buffer_load_dwordx2 v[12:13], v4, s[8:11], s18 offen offset:896
    buffer_load_dwordx2 v[14:15], v4, s[8:11], s18 offen offset:912
    s_mov_b32 s22, -1
    s_mov_b32 s23, 0x00ffffff
    s_waitcnt vmcnt(0)
    v_lshlrev_b32 v16, 16, v8
    v_and_b32 v17, 0xffff0000, v8
    v_lshlrev_b32 v18, 16, v9
    v_and_b32 v19, 0xffff0000, v9
    v_lshlrev_b32 v20, 16, v10
    v_and_b32 v21, 0xffff0000, v10
    v_lshlrev_b32 v22, 16, v11
    v_and_b32 v23, 0xffff0000, v11
    v_cndmask_b32 v16, 0, v16, s[22:23]
    v_cndmask_b32 v17, 0, v17, s[22:23]
    v_cndmask_b32 v18, 0, v18, s[22:23]
    v_cndmask_b32 v19, 0, v19, s[22:23]
    v_cndmask_b32 v20, 0, v20, s[22:23]
    v_cndmask_b32 v21, 0, v21, s[22:23]
    v_cndmask_b32 v22, 0, v22, s[22:23]
    v_cndmask_b32 v23, 0, v23, s[22:23]
    v_lshlrev_b32 v24, 16, v12
    v_and_b32 v25, 0xffff0000, v12
    v_lshlrev_b32 v26, 16, v13
    v_and_b32 v27, 0xffff0000, v13
    v_lshlrev_b32 v28, 16, v14
    v_and_b32 v29, 0xffff0000, v14
    v_lshlrev_b32 v30, 16, v15
    v_and_b32 v31, 0xffff0000, v15
    v_cndmask_b32 v24, 0, v24, s[22:23]
    v_cndmask_b32 v25, 0, v25, s[22:23]
    v_cndmask_b32 v26, 0, v26, s[22:23]
    v_cndmask_b32 v27, 0, v27, s[22:23]
    v_cndmask_b32 v28, 0, v28, s[22:23]
    v_cndmask_b32 v29, 0, v29, s[22:23]
    v_cndmask_b32 v30, 0, v30, s[22:23]
    v_cndmask_b32 v31, 0, v31, s[22:23]
    v_add_f32 v40, 1.0, v40
    v_add_f32 v41, 1.0, v41
    v_cvt_pk_bf16_f32 v6, v40, v41
    v_lshlrev_b32 v40, 16, v6
    v_and_b32 v41, 0xffff0000, v6
    v_add_f32 v42, 1.0, v42
    v_add_f32 v43, 1.0, v43
    v_cvt_pk_bf16_f32 v6, v42, v43
    v_lshlrev_b32 v42, 16, v6
    v_and_b32 v43, 0xffff0000, v6
    v_add_f32 v44, 1.0, v44
    v_add_f32 v45, 1.0, v45
    v_cvt_pk_bf16_f32 v6, v44, v45
    v_lshlrev_b32 v44, 16, v6
    v_and_b32 v45, 0xffff0000, v6
    v_add_f32 v46, 1.0, v46
    v_add_f32 v47, 1.0, v47
    v_cvt_pk_bf16_f32 v6, v46, v47
    v_lshlrev_b32 v46, 16, v6
    v_and_b32 v47, 0xffff0000, v6
    v_add_f32 v32, v16, v17
    v_add_f32 v32, v32, v18
    v_add_f32 v32, v32, v19
    v_add_f32 v32, v32, v20
    v_add_f32 v32, v32, v21
    v_add_f32 v32, v32, v22
    v_add_f32 v32, v32, v23
    v_add_f32 v33, v24, v25
    v_add_f32 v33, v33, v26
    v_add_f32 v33, v33, v27
    v_add_f32 v33, v33, v28
    v_add_f32 v33, v33, v29
    v_add_f32 v33, v33, v30
    v_add_f32 v33, v33, v31
    s_nop 1
    v_add_f32_dpp v32, v32, v32 quad_perm:[1,0,3,2] row_mask:0xf bank_mask:0xf
    v_add_f32_dpp v33, v33, v33 quad_perm:[1,0,3,2] row_mask:0xf bank_mask:0xf
    s_nop 1
    v_add_f32_dpp v32, v32, v32 quad_perm:[2,3,0,1] row_mask:0xf bank_mask:0xf
    v_add_f32_dpp v33, v33, v33 quad_perm:[2,3,0,1] row_mask:0xf bank_mask:0xf
    s_nop 1
    v_add_f32_dpp v32, v32, v32 row_half_mirror row_mask:0xf bank_mask:0xf
    v_add_f32_dpp v33, v33, v33 row_half_mirror row_mask:0xf bank_mask:0xf
    s_nop 1
    v_add_f32_dpp v32, v32, v32 row_mirror row_mask:0xf bank_mask:0xf
    v_add_f32_dpp v33, v33, v33 row_mirror row_mask:0xf bank_mask:0xf
    v_mov_b32 v56, v32
    v_mov_b32 v57, v33
    s_nop 1
    v_permlane16_swap_b32 v32, v56
    v_permlane16_swap_b32 v33, v57
    s_nop 1
    v_add_f32 v32, v32, v56
    v_add_f32 v33, v33, v57
    v_mov_b32 v56, v32
    v_mov_b32 v57, v33
    s_nop 1
    v_permlane32_swap_b32 v32, v56
    v_permlane32_swap_b32 v33, v57
    s_nop 1
    v_add_f32 v32, v32, v56
    v_add_f32 v33, v33, v57
    s_mov_b32 s20, 0x3b124925
    v_mul_f32 v32, s20, v32
    v_mul_f32 v33, s20, v33
    v_sub_f32 v56, v16, v32
    v_mul_f32 v34, v56, v56
    v_sub_f32 v56, v17, v32
    v_fmac_f32 v34, v56, v56
    v_sub_f32 v56, v18, v32
    v_fmac_f32 v34, v56, v56
    v_sub_f32 v56, v19, v32
    v_fmac_f32 v34, v56, v56
    v_sub_f32 v56, v20, v32
    v_fmac_f32 v34, v56, v56
    v_sub_f32 v56, v21, v32
    v_fmac_f32 v34, v56, v56
    v_sub_f32 v56, v22, v32
    v_fmac_f32 v34, v56, v56
    v_sub_f32 v56, v23, v32
    v_fmac_f32 v34, v56, v56
    v_cndmask_b32 v34, 0, v34, s[22:23]
    v_sub_f32 v56, v24, v33
    v_mul_f32 v35, v56, v56
    v_sub_f32 v56, v25, v33
    v_fmac_f32 v35, v56, v56
    v_sub_f32 v56, v26, v33
    v_fmac_f32 v35, v56, v56
    v_sub_f32 v56, v27, v33
    v_fmac_f32 v35, v56, v56
    v_sub_f32 v56, v28, v33
    v_fmac_f32 v35, v56, v56
    v_sub_f32 v56, v29, v33
    v_fmac_f32 v35, v56, v56
    v_sub_f32 v56, v30, v33
    v_fmac_f32 v35, v56, v56
    v_sub_f32 v56, v31, v33
    v_fmac_f32 v35, v56, v56
    v_cndmask_b32 v35, 0, v35, s[22:23]
    s_nop 1
    v_add_f32_dpp v34, v34, v34 quad_perm:[1,0,3,2] row_mask:0xf bank_mask:0xf
    v_add_f32_dpp v35, v35, v35 quad_perm:[1,0,3,2] row_mask:0xf bank_mask:0xf
    s_nop 1
    v_add_f32_dpp v34, v34, v34 quad_perm:[2,3,0,1] row_mask:0xf bank_mask:0xf
    v_add_f32_dpp v35, v35, v35 quad_perm:[2,3,0,1] row_mask:0xf bank_mask:0xf
    s_nop 1
    v_add_f32_dpp v34, v34, v34 row_half_mirror row_mask:0xf bank_mask:0xf
    v_add_f32_dpp v35, v35, v35 row_half_mirror row_mask:0xf bank_mask:0xf
    s_nop 1
    v_add_f32_dpp v34, v34, v34 row_mirror row_mask:0xf bank_mask:0xf
    v_add_f32_dpp v35, v35, v35 row_mirror row_mask:0xf bank_mask:0xf
    v_mov_b32 v56, v34
    v_mov_b32 v57, v35
    s_nop 1
    v_permlane16_swap_b32 v34, v56
    v_permlane16_swap_b32 v35, v57
    s_nop 1
    v_add_f32 v34, v34, v56
    v_add_f32 v35, v35, v57
    v_mov_b32 v56, v34
    v_mov_b32 v57, v35
    s_nop 1
    v_permlane32_swap_b32 v34, v56
    v_permlane32_swap_b32 v35, v57
    s_nop 1
    v_add_f32 v34, v34, v56
    v_add_f32 v35, v35, v57
    v_mul_f32 v34, s20, v34
    v_cvt_pk_bf16_f32 v56, v32, v34
    v_lshlrev_b32 v32, 16, v56
    v_and_b32 v34, 0xffff0000, v56
    v_add_f32 v34, 0x3727c5ac, v34
    v_cvt_pk_bf16_f32 v56, v34, v34
    v_lshlrev_b32 v34, 16, v56
    v_sqrt_f32 v34, v34
    s_nop 0
    v_cvt_pk_bf16_f32 v56, v34, v34
    v_lshlrev_b32 v34, 16, v56
    v_rcp_f32 v34, v34
    s_nop 0
    v_mul_f32 v35, s20, v35
    v_cvt_pk_bf16_f32 v56, v33, v35
    v_lshlrev_b32 v33, 16, v56
    v_and_b32 v35, 0xffff0000, v56
    v_add_f32 v35, 0x3727c5ac, v35
    v_cvt_pk_bf16_f32 v56, v35, v35
    v_lshlrev_b32 v35, 16, v56
    v_sqrt_f32 v35, v35
    s_nop 0
    v_cvt_pk_bf16_f32 v56, v35, v35
    v_lshlrev_b32 v35, 16, v56
    v_rcp_f32 v35, v35
    s_nop 0
    v_sub_f32 v16, v16, v32
    v_sub_f32 v17, v17, v32
    v_cvt_pk_bf16_f32 v56, v16, v17
    v_lshlrev_b32 v16, 16, v56
    v_and_b32 v17, 0xffff0000, v56
    v_mul_f32 v16, v16, v34
    v_mul_f32 v17, v17, v34
    v_cvt_pk_bf16_f32 v56, v16, v17
    v_lshlrev_b32 v16, 16, v56
    v_and_b32 v17, 0xffff0000, v56
    v_mul_f32 v16, v16, v40
    v_mul_f32 v17, v17, v41
    v_cvt_pk_bf16_f32 v56, v16, v17
    v_lshlrev_b32 v16, 16, v56
    v_and_b32 v17, 0xffff0000, v56
    v_add_f32 v16, v16, v48
    v_add_f32 v17, v17, v49
    v_sub_f32 v18, v18, v32
    v_sub_f32 v19, v19, v32
    v_cvt_pk_bf16_f32 v56, v18, v19
    v_lshlrev_b32 v18, 16, v56
    v_and_b32 v19, 0xffff0000, v56
    v_mul_f32 v18, v18, v34
    v_mul_f32 v19, v19, v34
    v_cvt_pk_bf16_f32 v56, v18, v19
    v_lshlrev_b32 v18, 16, v56
    v_and_b32 v19, 0xffff0000, v56
    v_mul_f32 v18, v18, v42
    v_mul_f32 v19, v19, v43
    v_cvt_pk_bf16_f32 v56, v18, v19
    v_lshlrev_b32 v18, 16, v56
    v_and_b32 v19, 0xffff0000, v56
    v_add_f32 v18, v18, v50
    v_add_f32 v19, v19, v51
    v_sub_f32 v20, v20, v32
    v_sub_f32 v21, v21, v32
    v_cvt_pk_bf16_f32 v56, v20, v21
    v_lshlrev_b32 v20, 16, v56
    v_and_b32 v21, 0xffff0000, v56
    v_mul_f32 v20, v20, v34
    v_mul_f32 v21, v21, v34
    v_cvt_pk_bf16_f32 v56, v20, v21
    v_lshlrev_b32 v20, 16, v56
    v_and_b32 v21, 0xffff0000, v56
    v_mul_f32 v20, v20, v44
    v_mul_f32 v21, v21, v45
    v_cvt_pk_bf16_f32 v56, v20, v21
    v_lshlrev_b32 v20, 16, v56
    v_and_b32 v21, 0xffff0000, v56
    v_add_f32 v20, v20, v52
    v_add_f32 v21, v21, v53
    v_sub_f32 v22, v22, v32
    v_sub_f32 v23, v23, v32
    v_cvt_pk_bf16_f32 v56, v22, v23
    v_lshlrev_b32 v22, 16, v56
    v_and_b32 v23, 0xffff0000, v56
    v_mul_f32 v22, v22, v34
    v_mul_f32 v23, v23, v34
    v_cvt_pk_bf16_f32 v56, v22, v23
    v_lshlrev_b32 v22, 16, v56
    v_and_b32 v23, 0xffff0000, v56
    v_mul_f32 v22, v22, v46
    v_mul_f32 v23, v23, v47
    v_cvt_pk_bf16_f32 v56, v22, v23
    v_lshlrev_b32 v22, 16, v56
    v_and_b32 v23, 0xffff0000, v56
    v_add_f32 v22, v22, v54
    v_add_f32 v23, v23, v55
    v_sub_f32 v24, v24, v33
    v_sub_f32 v25, v25, v33
    v_cvt_pk_bf16_f32 v56, v24, v25
    v_lshlrev_b32 v24, 16, v56
    v_and_b32 v25, 0xffff0000, v56
    v_mul_f32 v24, v24, v35
    v_mul_f32 v25, v25, v35
    v_cvt_pk_bf16_f32 v56, v24, v25
    v_lshlrev_b32 v24, 16, v56
    v_and_b32 v25, 0xffff0000, v56
    v_mul_f32 v24, v24, v40
    v_mul_f32 v25, v25, v41
    v_cvt_pk_bf16_f32 v56, v24, v25
    v_lshlrev_b32 v24, 16, v56
    v_and_b32 v25, 0xffff0000, v56
    v_add_f32 v24, v24, v48
    v_add_f32 v25, v25, v49
    v_sub_f32 v26, v26, v33
    v_sub_f32 v27, v27, v33
    v_cvt_pk_bf16_f32 v56, v26, v27
    v_lshlrev_b32 v26, 16, v56
    v_and_b32 v27, 0xffff0000, v56
    v_mul_f32 v26, v26, v35
    v_mul_f32 v27, v27, v35
    v_cvt_pk_bf16_f32 v56, v26, v27
    v_lshlrev_b32 v26, 16, v56
    v_and_b32 v27, 0xffff0000, v56
    v_mul_f32 v26, v26, v42
    v_mul_f32 v27, v27, v43
    v_cvt_pk_bf16_f32 v56, v26, v27
    v_lshlrev_b32 v26, 16, v56
    v_and_b32 v27, 0xffff0000, v56
    v_add_f32 v26, v26, v50
    v_add_f32 v27, v27, v51
    v_sub_f32 v28, v28, v33
    v_sub_f32 v29, v29, v33
    v_cvt_pk_bf16_f32 v56, v28, v29
    v_lshlrev_b32 v28, 16, v56
    v_and_b32 v29, 0xffff0000, v56
    v_mul_f32 v28, v28, v35
    v_mul_f32 v29, v29, v35
    v_cvt_pk_bf16_f32 v56, v28, v29
    v_lshlrev_b32 v28, 16, v56
    v_and_b32 v29, 0xffff0000, v56
    v_mul_f32 v28, v28, v44
    v_mul_f32 v29, v29, v45
    v_cvt_pk_bf16_f32 v56, v28, v29
    v_lshlrev_b32 v28, 16, v56
    v_and_b32 v29, 0xffff0000, v56
    v_add_f32 v28, v28, v52
    v_add_f32 v29, v29, v53
    v_sub_f32 v30, v30, v33
    v_sub_f32 v31, v31, v33
    v_cvt_pk_bf16_f32 v56, v30, v31
    v_lshlrev_b32 v30, 16, v56
    v_and_b32 v31, 0xffff0000, v56
    v_mul_f32 v30, v30, v35
    v_mul_f32 v31, v31, v35
    v_cvt_pk_bf16_f32 v56, v30, v31
    v_lshlrev_b32 v30, 16, v56
    v_and_b32 v31, 0xffff0000, v56
    v_mul_f32 v30, v30, v46
    v_mul_f32 v31, v31, v47
    v_cvt_pk_bf16_f32 v56, v30, v31
    v_lshlrev_b32 v30, 16, v56
    v_and_b32 v31, 0xffff0000, v56
    v_add_f32 v30, v30, v54
    v_add_f32 v31, v31, v55
    s_lshr_b32 s18, s17, 5
    s_mul_i32 s18, s18, 28672
    s_and_b32 s19, s17, 31
    s_lshl_b32 s19, s19, 4
    s_add_u32 s18, s18, s19
    s_add_u32 s18, s18, 12845056
    v_lshlrev_b32 v6, 9, v3
    s_mov_b64 exec, s[22:23]
    v_cvt_pk_bf16_f32 v8, v16, v17
    v_cvt_pk_bf16_f32 v9, v18, v19
    v_cvt_pk_bf16_f32 v10, v20, v21
    v_cvt_pk_bf16_f32 v11, v22, v23
    buffer_store_dwordx4 v[8:11], v6, s[4:7], s18 offen offset:0 sc1
    v_cvt_pk_bf16_f32 v12, v24, v25
    v_cvt_pk_bf16_f32 v13, v26, v27
    v_cvt_pk_bf16_f32 v14, v28, v29
    v_cvt_pk_bf16_f32 v15, v30, v31
    buffer_store_dwordx4 v[12:15], v6, s[4:7], s18 offen offset:16 sc1
    s_mov_b64 exec, -1
    s_add_u32 s93, s82, 224
    s_lshr_b32 s93, s93, 4
    s_lshl_b32 s93, s93, 6
    s_add_u32 s93, s93, 90975232
    s_waitcnt vmcnt(0)
    s_barrier
    s_cmp_lg_u32 s87, 0
    s_cbranch_scc1 sig_69
    v_mov_b32 v250, 0
    v_mov_b32 v251, 1
    s_mov_b64 exec, 1
    buffer_atomic_add v251, v250, s[4:7], s93 offen
    s_mov_b64 exec, -1
sig_69:
noln2_65:
    s_cmp_lt_u32 s82, 196
    s_cbranch_scc1 nomod2_70
    s_sub_u32 s3, s82, 182
    s_barrier
    s_load_dwordx2 s[8:9], s[0:1], 104
    s_waitcnt lgkmcnt(0)
    s_and_b32 s9, s9, 0xffff
    s_mov_b32 s10, 2408448
    s_mov_b32 s11, 0x20000
    s_load_dwordx2 s[12:13], s[0:1], 96
    s_waitcnt lgkmcnt(0)
    s_and_b32 s13, s13, 0xffff
    s_mov_b32 s14, 896
    s_mov_b32 s15, 0x20000
    v_and_b32 v1, 7, v0
    v_lshrrev_b32 v2, 3, v0
    v_mul_u32_u24 v3, 14, v2
    v_mul_u32_u24 v4, 5376, v3
    v_lshl_add_u32 v4, v1, 4, v4
    s_lshl_b32 s16, s3, 7
    v_add_u32 v4, s16, v4
    v_lshlrev_b32 v5, 1, v3
    s_mov_b32 s17, 0
    buffer_load_dwordx4 v[32:35], v4, s[8:11], s17 offen
    s_mov_b32 s17, 5376
    buffer_load_dwordx4 v[36:39], v4, s[8:11], s17 offen
    s_mov_b32 s17, 10752
    buffer_load_dwordx4 v[40:43], v4, s[8:11], s17 offen
    s_mov_b32 s17, 16128
    buffer_load_dwordx4 v[44:47], v4, s[8:11], s17 offen
    s_mov_b32 s17, 21504
    buffer_load_dwordx4 v[48:51], v4, s[8:11], s17 offen
    s_mov_b32 s17, 26880
    buffer_load_dwordx4 v[52:55], v4, s[8:11], s17 offen
    s_mov_b32 s17, 32256
    buffer_load_dwordx4 v[56:59], v4, s[8:11], s17 offen
    s_mov_b32 s17, 37632
    buffer_load_dwordx4 v[60:63], v4, s[8:11], s17 offen
    s_mov_b32 s17, 43008
    buffer_load_dwordx4 v[64:67], v4, s[8:11], s17 offen
    s_mov_b32 s17, 48384
    buffer_load_dwordx4 v[68:71], v4, s[8:11], s17 offen
    s_mov_b32 s17, 53760
    buffer_load_dwordx4 v[72:75], v4, s[8:11], s17 offen
    s_mov_b32 s17, 59136
    buffer_load_dwordx4 v[76:79], v4, s[8:11], s17 offen
    s_mov_b32 s17, 64512
    buffer_load_dwordx4 v[80:83], v4, s[8:11], s17 offen
    s_mov_b32 s17, 69888
    buffer_load_dwordx4 v[84:87], v4, s[8:11], s17 offen
    buffer_load_ushort v8, v5, s[12:15], 0 offen offset:0
    buffer_load_ushort v9, v5, s[12:15], 0 offen offset:2
    buffer_load_ushort v10, v5, s[12:15], 0 offen offset:4
    buffer_load_ushort v11, v5, s[12:15], 0 offen offset:6
    buffer_load_ushort v12, v5, s[12:15], 0 offen offset:8
    buffer_load_ushort v13, v5, s[12:15], 0 offen offset:10
    buffer_load_ushort v14, v5, s[12:15], 0 offen offset:12
    buffer_load_ushort v15, v5, s[12:15], 0 offen offset:14
    buffer_load_ushort v16, v5, s[12:15], 0 offen offset:16
    buffer_load_ushort v17, v5, s[12:15], 0 offen offset:18
    buffer_load_ushort v18, v5, s[12:15], 0 offen offset:20
    buffer_load_ushort v19, v5, s[12:15], 0 offen offset:22
    buffer_load_ushort v20, v5, s[12:15], 0 offen offset:24
    buffer_load_ushort v21, v5, s[12:15], 0 offen offset:26
    s_waitcnt vmcnt(0)
    v_lshlrev_b32 v8, 16, v8
    v_lshlrev_b32 v9, 16, v9
    v_lshlrev_b32 v10, 16, v10
    v_lshlrev_b32 v11, 16, v11
    v_lshlrev_b32 v12, 16, v12
    v_lshlrev_b32 v13, 16, v13
    v_lshlrev_b32 v14, 16, v14
    v_lshlrev_b32 v15, 16, v15
    v_lshlrev_b32 v16, 16, v16
    v_lshlrev_b32 v17, 16, v17
    v_lshlrev_b32 v18, 16, v18
    v_lshlrev_b32 v19, 16, v19
    v_lshlrev_b32 v20, 16, v20
    v_lshlrev_b32 v21, 16, v21
    v_mul_f32 v6, 0xbfb8aa3b, v8
    v_exp_f32 v6, v6
    s_nop 0
    v_add_f32 v6, 1.0, v6
    v_rcp_f32 v6, v6
    s_nop 0
    v_mul_f32 v8, v8, v6
    v_cvt_pk_bf16_f32 v6, v8, v8
    v_lshlrev_b32 v8, 16, v6
    v_mul_f32 v6, 0xbfb8aa3b, v9
    v_exp_f32 v6, v6
    s_nop 0
    v_add_f32 v6, 1.0, v6
    v_rcp_f32 v6, v6
    s_nop 0
    v_mul_f32 v9, v9, v6
    v_cvt_pk_bf16_f32 v6, v9, v9
    v_lshlrev_b32 v9, 16, v6
    v_mul_f32 v6, 0xbfb8aa3b, v10
    v_exp_f32 v6, v6
    s_nop 0
    v_add_f32 v6, 1.0, v6
    v_rcp_f32 v6, v6
    s_nop 0
    v_mul_f32 v10, v10, v6
    v_cvt_pk_bf16_f32 v6, v10, v10
    v_lshlrev_b32 v10, 16, v6
    v_mul_f32 v6, 0xbfb8aa3b, v11
    v_exp_f32 v6, v6
    s_nop 0
    v_add_f32 v6, 1.0, v6
    v_rcp_f32 v6, v6
    s_nop 0
    v_mul_f32 v11, v11, v6
    v_cvt_pk_bf16_f32 v6, v11, v11
    v_lshlrev_b32 v11, 16, v6
    v_mul_f32 v6, 0xbfb8aa3b, v12
    v_exp_f32 v6, v6
    s_nop 0
    v_add_f32 v6, 1.0, v6
    v_rcp_f32 v6, v6
    s_nop 0
    v_mul_f32 v12, v12, v6
    v_cvt_pk_bf16_f32 v6, v12, v12
    v_lshlrev_b32 v12, 16, v6
    v_mul_f32 v6, 0xbfb8aa3b, v13
    v_exp_f32 v6, v6
    s_nop 0
    v_add_f32 v6, 1.0, v6
    v_rcp_f32 v6, v6
    s_nop 0
    v_mul_f32 v13, v13, v6
    v_cvt_pk_bf16_f32 v6, v13, v13
    v_lshlrev_b32 v13, 16, v6
    v_mul_f32 v6, 0xbfb8aa3b, v14
    v_exp_f32 v6, v6
    s_nop 0
    v_add_f32 v6, 1.0, v6
    v_rcp_f32 v6, v6
    s_nop 0
    v_mul_f32 v14, v14, v6
    v_cvt_pk_bf16_f32 v6, v14, v14
    v_lshlrev_b32 v14, 16, v6
    v_mul_f32 v6, 0xbfb8aa3b, v15
    v_exp_f32 v6, v6
    s_nop 0
    v_add_f32 v6, 1.0, v6
    v_rcp_f32 v6, v6
    s_nop 0
    v_mul_f32 v15, v15, v6
    v_cvt_pk_bf16_f32 v6, v15, v15
    v_lshlrev_b32 v15, 16, v6
    v_mul_f32 v6, 0xbfb8aa3b, v16
    v_exp_f32 v6, v6
    s_nop 0
    v_add_f32 v6, 1.0, v6
    v_rcp_f32 v6, v6
    s_nop 0
    v_mul_f32 v16, v16, v6
    v_cvt_pk_bf16_f32 v6, v16, v16
    v_lshlrev_b32 v16, 16, v6
    v_mul_f32 v6, 0xbfb8aa3b, v17
    v_exp_f32 v6, v6
    s_nop 0
    v_add_f32 v6, 1.0, v6
    v_rcp_f32 v6, v6
    s_nop 0
    v_mul_f32 v17, v17, v6
    v_cvt_pk_bf16_f32 v6, v17, v17
    v_lshlrev_b32 v17, 16, v6
    v_mul_f32 v6, 0xbfb8aa3b, v18
    v_exp_f32 v6, v6
    s_nop 0
    v_add_f32 v6, 1.0, v6
    v_rcp_f32 v6, v6
    s_nop 0
    v_mul_f32 v18, v18, v6
    v_cvt_pk_bf16_f32 v6, v18, v18
    v_lshlrev_b32 v18, 16, v6
    v_mul_f32 v6, 0xbfb8aa3b, v19
    v_exp_f32 v6, v6
    s_nop 0
    v_add_f32 v6, 1.0, v6
    v_rcp_f32 v6, v6
    s_nop 0
    v_mul_f32 v19, v19, v6
    v_cvt_pk_bf16_f32 v6, v19, v19
    v_lshlrev_b32 v19, 16, v6
    v_mul_f32 v6, 0xbfb8aa3b, v20
    v_exp_f32 v6, v6
    s_nop 0
    v_add_f32 v6, 1.0, v6
    v_rcp_f32 v6, v6
    s_nop 0
    v_mul_f32 v20, v20, v6
    v_cvt_pk_bf16_f32 v6, v20, v20
    v_lshlrev_b32 v20, 16, v6
    v_mul_f32 v6, 0xbfb8aa3b, v21
    v_exp_f32 v6, v6
    s_nop 0
    v_add_f32 v6, 1.0, v6
    v_rcp_f32 v6, v6
    s_nop 0
    v_mul_f32 v21, v21, v6
    v_cvt_pk_bf16_f32 v6, v21, v21
    v_lshlrev_b32 v21, 16, v6
    v_mov_b32 v24, 0
    v_mov_b32 v25, 0
    v_mov_b32 v26, 0
    v_mov_b32 v27, 0
    v_mov_b32 v28, 0
    v_mov_b32 v29, 0
    v_mov_b32 v30, 0
    v_mov_b32 v31, 0
    v_lshlrev_b32 v6, 16, v32
    v_and_b32 v7, 0xffff0000, v32
    v_fmac_f32 v24, v8, v6
    v_fmac_f32 v25, v8, v7
    v_lshlrev_b32 v6, 16, v33
    v_and_b32 v7, 0xffff0000, v33
    v_fmac_f32 v26, v8, v6
    v_fmac_f32 v27, v8, v7
    v_lshlrev_b32 v6, 16, v34
    v_and_b32 v7, 0xffff0000, v34
    v_fmac_f32 v28, v8, v6
    v_fmac_f32 v29, v8, v7
    v_lshlrev_b32 v6, 16, v35
    v_and_b32 v7, 0xffff0000, v35
    v_fmac_f32 v30, v8, v6
    v_fmac_f32 v31, v8, v7
    v_lshlrev_b32 v6, 16, v36
    v_and_b32 v7, 0xffff0000, v36
    v_fmac_f32 v24, v9, v6
    v_fmac_f32 v25, v9, v7
    v_lshlrev_b32 v6, 16, v37
    v_and_b32 v7, 0xffff0000, v37
    v_fmac_f32 v26, v9, v6
    v_fmac_f32 v27, v9, v7
    v_lshlrev_b32 v6, 16, v38
    v_and_b32 v7, 0xffff0000, v38
    v_fmac_f32 v28, v9, v6
    v_fmac_f32 v29, v9, v7
    v_lshlrev_b32 v6, 16, v39
    v_and_b32 v7, 0xffff0000, v39
    v_fmac_f32 v30, v9, v6
    v_fmac_f32 v31, v9, v7
    v_lshlrev_b32 v6, 16, v40
    v_and_b32 v7, 0xffff0000, v40
    v_fmac_f32 v24, v10, v6
    v_fmac_f32 v25, v10, v7
    v_lshlrev_b32 v6, 16, v41
    v_and_b32 v7, 0xffff0000, v41
    v_fmac_f32 v26, v10, v6
    v_fmac_f32 v27, v10, v7
    v_lshlrev_b32 v6, 16, v42
    v_and_b32 v7, 0xffff0000, v42
    v_fmac_f32 v28, v10, v6
    v_fmac_f32 v29, v10, v7
    v_lshlrev_b32 v6, 16, v43
    v_and_b32 v7, 0xffff0000, v43
    v_fmac_f32 v30, v10, v6
    v_fmac_f32 v31, v10, v7
    v_lshlrev_b32 v6, 16, v44
    v_and_b32 v7, 0xffff0000, v44
    v_fmac_f32 v24, v11, v6
    v_fmac_f32 v25, v11, v7
    v_lshlrev_b32 v6, 16, v45
    v_and_b32 v7, 0xffff0000, v45
    v_fmac_f32 v26, v11, v6
    v_fmac_f32 v27, v11, v7
    v_lshlrev_b32 v6, 16, v46
    v_and_b32 v7, 0xffff0000, v46
    v_fmac_f32 v28, v11, v6
    v_fmac_f32 v29, v11, v7
    v_lshlrev_b32 v6, 16, v47
    v_and_b32 v7, 0xffff0000, v47
    v_fmac_f32 v30, v11, v6
    v_fmac_f32 v31, v11, v7
    v_lshlrev_b32 v6, 16, v48
    v_and_b32 v7, 0xffff0000, v48
    v_fmac_f32 v24, v12, v6
    v_fmac_f32 v25, v12, v7
    v_lshlrev_b32 v6, 16, v49
    v_and_b32 v7, 0xffff0000, v49
    v_fmac_f32 v26, v12, v6
    v_fmac_f32 v27, v12, v7
    v_lshlrev_b32 v6, 16, v50
    v_and_b32 v7, 0xffff0000, v50
    v_fmac_f32 v28, v12, v6
    v_fmac_f32 v29, v12, v7
    v_lshlrev_b32 v6, 16, v51
    v_and_b32 v7, 0xffff0000, v51
    v_fmac_f32 v30, v12, v6
    v_fmac_f32 v31, v12, v7
    v_lshlrev_b32 v6, 16, v52
    v_and_b32 v7, 0xffff0000, v52
    v_fmac_f32 v24, v13, v6
    v_fmac_f32 v25, v13, v7
    v_lshlrev_b32 v6, 16, v53
    v_and_b32 v7, 0xffff0000, v53
    v_fmac_f32 v26, v13, v6
    v_fmac_f32 v27, v13, v7
    v_lshlrev_b32 v6, 16, v54
    v_and_b32 v7, 0xffff0000, v54
    v_fmac_f32 v28, v13, v6
    v_fmac_f32 v29, v13, v7
    v_lshlrev_b32 v6, 16, v55
    v_and_b32 v7, 0xffff0000, v55
    v_fmac_f32 v30, v13, v6
    v_fmac_f32 v31, v13, v7
    v_lshlrev_b32 v6, 16, v56
    v_and_b32 v7, 0xffff0000, v56
    v_fmac_f32 v24, v14, v6
    v_fmac_f32 v25, v14, v7
    v_lshlrev_b32 v6, 16, v57
    v_and_b32 v7, 0xffff0000, v57
    v_fmac_f32 v26, v14, v6
    v_fmac_f32 v27, v14, v7
    v_lshlrev_b32 v6, 16, v58
    v_and_b32 v7, 0xffff0000, v58
    v_fmac_f32 v28, v14, v6
    v_fmac_f32 v29, v14, v7
    v_lshlrev_b32 v6, 16, v59
    v_and_b32 v7, 0xffff0000, v59
    v_fmac_f32 v30, v14, v6
    v_fmac_f32 v31, v14, v7
    v_lshlrev_b32 v6, 16, v60
    v_and_b32 v7, 0xffff0000, v60
    v_fmac_f32 v24, v15, v6
    v_fmac_f32 v25, v15, v7
    v_lshlrev_b32 v6, 16, v61
    v_and_b32 v7, 0xffff0000, v61
    v_fmac_f32 v26, v15, v6
    v_fmac_f32 v27, v15, v7
    v_lshlrev_b32 v6, 16, v62
    v_and_b32 v7, 0xffff0000, v62
    v_fmac_f32 v28, v15, v6
    v_fmac_f32 v29, v15, v7
    v_lshlrev_b32 v6, 16, v63
    v_and_b32 v7, 0xffff0000, v63
    v_fmac_f32 v30, v15, v6
    v_fmac_f32 v31, v15, v7
    v_lshlrev_b32 v6, 16, v64
    v_and_b32 v7, 0xffff0000, v64
    v_fmac_f32 v24, v16, v6
    v_fmac_f32 v25, v16, v7
    v_lshlrev_b32 v6, 16, v65
    v_and_b32 v7, 0xffff0000, v65
    v_fmac_f32 v26, v16, v6
    v_fmac_f32 v27, v16, v7
    v_lshlrev_b32 v6, 16, v66
    v_and_b32 v7, 0xffff0000, v66
    v_fmac_f32 v28, v16, v6
    v_fmac_f32 v29, v16, v7
    v_lshlrev_b32 v6, 16, v67
    v_and_b32 v7, 0xffff0000, v67
    v_fmac_f32 v30, v16, v6
    v_fmac_f32 v31, v16, v7
    v_lshlrev_b32 v6, 16, v68
    v_and_b32 v7, 0xffff0000, v68
    v_fmac_f32 v24, v17, v6
    v_fmac_f32 v25, v17, v7
    v_lshlrev_b32 v6, 16, v69
    v_and_b32 v7, 0xffff0000, v69
    v_fmac_f32 v26, v17, v6
    v_fmac_f32 v27, v17, v7
    v_lshlrev_b32 v6, 16, v70
    v_and_b32 v7, 0xffff0000, v70
    v_fmac_f32 v28, v17, v6
    v_fmac_f32 v29, v17, v7
    v_lshlrev_b32 v6, 16, v71
    v_and_b32 v7, 0xffff0000, v71
    v_fmac_f32 v30, v17, v6
    v_fmac_f32 v31, v17, v7
    v_lshlrev_b32 v6, 16, v72
    v_and_b32 v7, 0xffff0000, v72
    v_fmac_f32 v24, v18, v6
    v_fmac_f32 v25, v18, v7
    v_lshlrev_b32 v6, 16, v73
    v_and_b32 v7, 0xffff0000, v73
    v_fmac_f32 v26, v18, v6
    v_fmac_f32 v27, v18, v7
    v_lshlrev_b32 v6, 16, v74
    v_and_b32 v7, 0xffff0000, v74
    v_fmac_f32 v28, v18, v6
    v_fmac_f32 v29, v18, v7
    v_lshlrev_b32 v6, 16, v75
    v_and_b32 v7, 0xffff0000, v75
    v_fmac_f32 v30, v18, v6
    v_fmac_f32 v31, v18, v7
    v_lshlrev_b32 v6, 16, v76
    v_and_b32 v7, 0xffff0000, v76
    v_fmac_f32 v24, v19, v6
    v_fmac_f32 v25, v19, v7
    v_lshlrev_b32 v6, 16, v77
    v_and_b32 v7, 0xffff0000, v77
    v_fmac_f32 v26, v19, v6
    v_fmac_f32 v27, v19, v7
    v_lshlrev_b32 v6, 16, v78
    v_and_b32 v7, 0xffff0000, v78
    v_fmac_f32 v28, v19, v6
    v_fmac_f32 v29, v19, v7
    v_lshlrev_b32 v6, 16, v79
    v_and_b32 v7, 0xffff0000, v79
    v_fmac_f32 v30, v19, v6
    v_fmac_f32 v31, v19, v7
    v_lshlrev_b32 v6, 16, v80
    v_and_b32 v7, 0xffff0000, v80
    v_fmac_f32 v24, v20, v6
    v_fmac_f32 v25, v20, v7
    v_lshlrev_b32 v6, 16, v81
    v_and_b32 v7, 0xffff0000, v81
    v_fmac_f32 v26, v20, v6
    v_fmac_f32 v27, v20, v7
    v_lshlrev_b32 v6, 16, v82
    v_and_b32 v7, 0xffff0000, v82
    v_fmac_f32 v28, v20, v6
    v_fmac_f32 v29, v20, v7
    v_lshlrev_b32 v6, 16, v83
    v_and_b32 v7, 0xffff0000, v83
    v_fmac_f32 v30, v20, v6
    v_fmac_f32 v31, v20, v7
    v_lshlrev_b32 v6, 16, v84
    v_and_b32 v7, 0xffff0000, v84
    v_fmac_f32 v24, v21, v6
    v_fmac_f32 v25, v21, v7
    v_lshlrev_b32 v6, 16, v85
    v_and_b32 v7, 0xffff0000, v85
    v_fmac_f32 v26, v21, v6
    v_fmac_f32 v27, v21, v7
    v_lshlrev_b32 v6, 16, v86
    v_and_b32 v7, 0xffff0000, v86
    v_fmac_f32 v28, v21, v6
    v_fmac_f32 v29, v21, v7
    v_lshlrev_b32 v6, 16, v87
    v_and_b32 v7, 0xffff0000, v87
    v_fmac_f32 v30, v21, v6
    v_fmac_f32 v31, v21, v7
    v_lshlrev_b32 v6, 8, v2
    v_lshl_add_u32 v6, v1, 5, v6
    ds_write_b128 v6, v[24:27]
    ds_write_b128 v6, v[28:31] offset:16
    s_waitcnt lgkmcnt(0)
    s_barrier
    v_cmp_gt_u32 vcc, 64, v0
    s_and_saveexec_b64 s[18:19], vcc
    s_cbranch_execz modskip_71
    v_lshlrev_b32 v6, 2, v0
    ds_read_b32 v32, v6 offset:0
    ds_read_b32 v33, v6 offset:256
    ds_read_b32 v34, v6 offset:512
    ds_read_b32 v35, v6 offset:768
    ds_read_b32 v36, v6 offset:1024
    ds_read_b32 v37, v6 offset:1280
    ds_read_b32 v38, v6 offset:1536
    ds_read_b32 v39, v6 offset:1792
    s_waitcnt lgkmcnt(0)
    ds_read_b32 v40, v6 offset:2048
    ds_read_b32 v41, v6 offset:2304
    ds_read_b32 v42, v6 offset:2560
    ds_read_b32 v43, v6 offset:2816
    ds_read_b32 v44, v6 offset:3072
    ds_read_b32 v45, v6 offset:3328
    ds_read_b32 v46, v6 offset:3584
    ds_read_b32 v47, v6 offset:3840
    s_waitcnt lgkmcnt(0)
    ds_read_b32 v48, v6 offset:4096
    ds_read_b32 v49, v6 offset:4352
    ds_read_b32 v50, v6 offset:4608
    ds_read_b32 v51, v6 offset:4864
    ds_read_b32 v52, v6 offset:5120
    ds_read_b32 v53, v6 offset:5376
    ds_read_b32 v54, v6 offset:5632
    ds_read_b32 v55, v6 offset:5888
    s_waitcnt lgkmcnt(0)
    ds_read_b32 v56, v6 offset:6144
    ds_read_b32 v57, v6 offset:6400
    ds_read_b32 v58, v6 offset:6656
    ds_read_b32 v59, v6 offset:6912
    ds_read_b32 v60, v6 offset:7168
    ds_read_b32 v61, v6 offset:7424
    ds_read_b32 v62, v6 offset:7680
    ds_read_b32 v63, v6 offset:7936
    s_waitcnt lgkmcnt(0)
    v_add_f32 v32, v32, v48
    v_add_f32 v33, v33, v49
    v_add_f32 v34, v34, v50
    v_add_f32 v35, v35, v51
    v_add_f32 v36, v36, v52
    v_add_f32 v37, v37, v53
    v_add_f32 v38, v38, v54
    v_add_f32 v39, v39, v55
    v_add_f32 v40, v40, v56
    v_add_f32 v41, v41, v57
    v_add_f32 v42, v42, v58
    v_add_f32 v43, v43, v59
    v_add_f32 v44, v44, v60
    v_add_f32 v45, v45, v61
    v_add_f32 v46, v46, v62
    v_add_f32 v47, v47, v63
    v_add_f32 v32, v32, v40
    v_add_f32 v33, v33, v41
    v_add_f32 v34, v34, v42
    v_add_f32 v35, v35, v43
    v_add_f32 v36, v36, v44
    v_add_f32 v37, v37, v45
    v_add_f32 v38, v38, v46
    v_add_f32 v39, v39, v47
    v_add_f32 v32, v32, v36
    v_add_f32 v33, v33, v37
    v_add_f32 v34, v34, v38
    v_add_f32 v35, v35, v39
    v_add_f32 v32, v32, v34
    v_add_f32 v33, v33, v35
    v_add_f32 v32, v32, v33
    v_cvt_pk_bf16_f32 v7, v32, v32
    v_lshlrev_b32 v32, 16, v7
    s_lshl_b32 s16, s3, 8
    s_add_u32 s16, s16, 87052288
    buffer_store_dword v32, v6, s[4:7], s16 offen sc1
modskip_71:
    s_mov_b64 exec, s[18:19]
    s_mov_b32 s93, 90977408
    s_waitcnt vmcnt(0)
    s_barrier
    s_cmp_lg_u32 s87, 0
    s_cbranch_scc1 sig_72
    v_mov_b32 v250, 0
    v_mov_b32 v251, 1
    s_mov_b64 exec, 1
    buffer_atomic_add v251, v250, s[4:7], s93 offen
    s_mov_b64 exec, -1
sig_72:
nomod2_70:
    s_lshl_b32 s91, s85, 3
    s_add_u32 s84, s81, 32
    s_sub_u32 s84, s84, s91
    s_and_b32 s84, s84, 31
L_job:
    s_mul_i32 s91, s85, 30
    s_cmp_ge_u32 s84, s91
    s_cbranch_scc1 L_jobs_done
    s_mul_i32 s91, s85, 14
    s_cmp_ge_u32 s84, s91
    s_cselect_b32 s92, s91, 0
    s_cselect_b32 s93, 0, 2
    s_sub_u32 s92, s84, s92
    s_lshr_b32 s25, s92, 1
    s_mul_i32 s16, s92, 43
    s_lshr_b32 s16, s16, 7
    s_cmp_eq_u32 s85, 3
    s_cselect_b32 s25, s16, s25
    s_mul_i32 s16, s25, s85
    s_sub_u32 s17, s92, s16
    s_add_u32 s25, s25, s93
    s_cmp_ge_u32 s80, s74
    s_cselect_b32 s18, 1, 0
    s_add_u32 s18, s18, s80
    s_lshl_b32 s19, s17, 3
    s_add_u32 s18, s18, s19
    s_lshl_b32 s19, s80, 3
    s_add_u32 s19, s19, s74
    s_cmp_eq_u32 s17, 2
    s_cselect_b32 s24, s19, s18
    s_lshl_b32 s93, s25, 6
    s_add_u32 s93, s93, 90975232
    s_cmp_lg_u32 s87, 0
    s_cbranch_scc1 wsk_75
    s_mov_b32 s90, 0
    v_mov_b32 v250, 0
wge_73:
    buffer_load_dword v251, v250, s[4:7], s93 offen sc1
    s_waitcnt vmcnt(0)
    v_readfirstlane_b32 s92, v251
    s_nop 3
    s_cmp_ge_u32 s92, 16
    s_cbranch_scc1 wok_74
    s_sleep 3
    s_add_u32 s90, s90, 1
    s_cmp_lt_u32 s90, 400000
    s_cbranch_scc1 wge_73
    s_branch L_abort
wok_74:
wsk_75:
    s_barrier
    s_mul_i32 s91, s85, 14
    s_cmp_ge_u32 s84, s91
    s_cbranch_scc1 L_sjob
    v_and_b32 v1, 63, v0
    v_lshrrev_b32 v8, 6, v0
    s_nop 0
    v_readfirstlane_b32 s26, v8
    v_lshrrev_b32 v8, 5, v1
    v_lshlrev_b32 v2, 8, v8
    v_bfe_u32 v9, v1, 2, 2
    v_lshl_add_u32 v2, v9, 6, v2
    v_bfe_u32 v10, v1, 4, 1
    v_lshl_add_u32 v2, v10, 5, v2
    v_and_b32 v11, 1, v1
    v_lshl_add_u32 v2, v11, 4, v2
    v_bfe_u32 v11, v1, 1, 1
    v_lshl_add_u32 v2, v11, 3, v2
    v_lshlrev_b32 v3, 10, v8
    v_lshl_add_u32 v3, v9, 6, v3
    v_lshl_add_u32 v3, v10, 5, v3
    v_and_b32 v11, 3, v1
    v_lshl_add_u32 v3, v11, 3, v3
    v_bfe_u32 v9, v1, 2, 3
    v_lshlrev_b32 v4, 13, v9
    v_lshl_add_u32 v4, v8, 6, v4
    v_lshl_add_u32 v4, v11, 4, v4
    v_mul_u32_u24 v5, 896, v9
    v_lshl_add_u32 v5, v8, 6, v5
    v_lshl_add_u32 v5, v11, 4, v5
    v_and_b32 v9, 31, v1
    v_lshlrev_b32 v6, 13, v9
    v_lshl_add_u32 v6, v8, 4, v6
    v_lshlrev_b32 v7, 10, v10
    v_lshl_add_u32 v7, v8, 8, v7
    v_and_b32 v9, 15, v1
    v_lshl_add_u32 v7, v9, 4, v7
    v_add_u32 v12, 57344, v2
    v_add_u32 v13, 57344, v3
    v_lshlrev_b32 v14, 4, v1
    v_add_u32 v15, 57344, v14
    s_lshl_b32 s27, s25, 2
    s_add_u32 s27, s27, s26
    s_load_dwordx2 s[8:9], s[0:1], 32
    s_waitcnt lgkmcnt(0)
    s_and_b32 s9, s9, 0xffff
    s_mov_b32 s10, 3670016
    s_mov_b32 s11, 0x20000
    s_load_dwordx2 s[12:13], s[0:1], 40
    s_waitcnt lgkmcnt(0)
    s_and_b32 s13, s13, 0xffff
    s_mov_b32 s14, 3670016
    s_mov_b32 s15, 0x20000
    s_mul_i32 s19, s26, 14336
    s_lshl_b32 s29, s26, 13
    s_lshl_b32 s16, s24, 9
    s_mul_i32 s31, s26, 917504
    s_add_u32 s31, s31, s16
    s_mul_i32 s32, s24, 229376
    s_mul_i32 s17, s26, 57344
    s_add_u32 s32, s32, s17
    s_lshl_b32 s33, s26, 7
    s_add_u32 s33, s33, s16
    s_barrier
    s_add_u32 s17, s19, 0
    s_mov_b32 m0, s17
    s_add_u32 s18, s31, 0
    buffer_load_dwordx4 v4, s[8:11], s18 offen lds
    s_add_u32 s17, s19, 1024
    s_mov_b32 m0, s17
    s_add_u32 s18, s31, 65536
    buffer_load_dwordx4 v4, s[8:11], s18 offen lds
    s_add_u32 s17, s19, 2048
    s_mov_b32 m0, s17
    s_add_u32 s18, s31, 131072
    buffer_load_dwordx4 v4, s[8:11], s18 offen lds
    s_add_u32 s17, s19, 3072
    s_mov_b32 m0, s17
    s_add_u32 s18, s31, 196608
    buffer_load_dwordx4 v4, s[8:11], s18 offen lds
    s_add_u32 s17, s19, 4096
    s_mov_b32 m0, s17
    s_add_u32 s18, s31, 262144
    buffer_load_dwordx4 v4, s[8:11], s18 offen lds
    s_add_u32 s17, s19, 5120
    s_mov_b32 m0, s17
    s_add_u32 s18, s31, 327680
    buffer_load_dwordx4 v4, s[8:11], s18 offen lds
    s_add_u32 s17, s19, 6144
    s_mov_b32 m0, s17
    s_add_u32 s18, s31, 393216
    buffer_load_dwordx4 v4, s[8:11], s18 offen lds
    s_add_u32 s17, s19, 7168
    s_mov_b32 m0, s17
    s_add_u32 s18, s31, 458752
    buffer_load_dwordx4 v4, s[8:11], s18 offen lds
    s_add_u32 s17, s19, 8192
    s_mov_b32 m0, s17
    s_add_u32 s18, s31, 524288
    buffer_load_dwordx4 v4, s[8:11], s18 offen lds
    s_add_u32 s17, s19, 9216
    s_mov_b32 m0, s17
    s_add_u32 s18, s31, 589824
    buffer_load_dwordx4 v4, s[8:11], s18 offen lds
    s_add_u32 s17, s19, 10240
    s_mov_b32 m0, s17
    s_add_u32 s18, s31, 655360
    buffer_load_dwordx4 v4, s[8:11], s18 offen lds
    s_add_u32 s17, s19, 11264
    s_mov_b32 m0, s17
    s_add_u32 s18, s31, 720896
    buffer_load_dwordx4 v4, s[8:11], s18 offen lds
    s_add_u32 s17, s19, 12288
    s_mov_b32 m0, s17
    s_add_u32 s18, s31, 786432
    buffer_load_dwordx4 v4, s[8:11], s18 offen lds
    s_add_u32 s17, s19, 13312
    s_mov_b32 m0, s17
    s_add_u32 s18, s31, 851968
    buffer_load_dwordx4 v4, s[8:11], s18 offen lds
    s_mul_i32 s16, s27, 28672
    s_add_u32 s16, s16, 12845056
    buffer_load_dwordx4 a[0:3], v14, s[4:7], s16 offen offset:0 sc1
    buffer_load_dwordx4 a[4:7], v14, s[4:7], s16 offen offset:1024 sc1
    buffer_load_dwordx4 a[8:11], v14, s[4:7], s16 offen offset:2048 sc1
    buffer_load_dwordx4 a[12:15], v14, s[4:7], s16 offen offset:3072 sc1
    s_add_u32 s16, s16, 4096
    buffer_load_dwordx4 a[16:19], v14, s[4:7], s16 offen offset:0 sc1
    buffer_load_dwordx4 a[20:23], v14, s[4:7], s16 offen offset:1024 sc1
    buffer_load_dwordx4 a[24:27], v14, s[4:7], s16 offen offset:2048 sc1
    buffer_load_dwordx4 a[28:31], v14, s[4:7], s16 offen offset:3072 sc1
    s_add_u32 s16, s16, 4096
    buffer_load_dwordx4 a[32:35], v14, s[4:7], s16 offen offset:0 sc1
    buffer_load_dwordx4 a[36:39], v14, s[4:7], s16 offen offset:1024 sc1
    buffer_load_dwordx4 a[40:43], v14, s[4:7], s16 offen offset:2048 sc1
    buffer_load_dwordx4 a[44:47], v14, s[4:7], s16 offen offset:3072 sc1
    s_add_u32 s16, s16, 4096
    buffer_load_dwordx4 a[48:51], v14, s[4:7], s16 offen offset:0 sc1
    buffer_load_dwordx4 a[52:55], v14, s[4:7], s16 offen offset:1024 sc1
    buffer_load_dwordx4 a[56:59], v14, s[4:7], s16 offen offset:2048 sc1
    buffer_load_dwordx4 a[60:63], v14, s[4:7], s16 offen offset:3072 sc1
    s_add_u32 s16, s16, 4096
    buffer_load_dwordx4 a[64:67], v14, s[4:7], s16 offen offset:0 sc1
    buffer_load_dwordx4 a[68:71], v14, s[4:7], s16 offen offset:1024 sc1
    buffer_load_dwordx4 a[72:75], v14, s[4:7], s16 offen offset:2048 sc1
    buffer_load_dwordx4 a[76:79], v14, s[4:7], s16 offen offset:3072 sc1
    s_add_u32 s16, s16, 4096
    buffer_load_dwordx4 a[80:83], v14, s[4:7], s16 offen offset:0 sc1
    buffer_load_dwordx4 a[84:87], v14, s[4:7], s16 offen offset:1024 sc1
    buffer_load_dwordx4 a[88:91], v14, s[4:7], s16 offen offset:2048 sc1
    buffer_load_dwordx4 a[92:95], v14, s[4:7], s16 offen offset:3072 sc1
    s_add_u32 s16, s16, 4096
    buffer_load_dwordx4 a[96:99], v14, s[4:7], s16 offen offset:0 sc1
    buffer_load_dwordx4 a[100:103], v14, s[4:7], s16 offen offset:1024 sc1
    buffer_load_dwordx4 a[104:107], v14, s[4:7], s16 offen offset:2048 sc1
    buffer_load_dwordx4 a[108:111], v14, s[4:7], s16 offen offset:3072 sc1
    s_add_u32 s16, s16, 4096
    s_waitcnt vmcnt(0)
    s_barrier
    ds_read_b64_tr_b16 v[48:49], v2 offset:0
    ds_read_b64_tr_b16 v[50:51], v2 offset:1024
    ds_read_b64_tr_b16 v[52:53], v2 offset:512
    ds_read_b64_tr_b16 v[54:55], v2 offset:1536
    ds_read_b64_tr_b16 v[56:57], v2 offset:2048
    ds_read_b64_tr_b16 v[58:59], v2 offset:3072
    ds_read_b64_tr_b16 v[60:61], v2 offset:2560
    ds_read_b64_tr_b16 v[62:63], v2 offset:3584
    ds_read_b64_tr_b16 v[64:65], v2 offset:4096
    ds_read_b64_tr_b16 v[66:67], v2 offset:5120
    ds_read_b64_tr_b16 v[68:69], v2 offset:4608
    ds_read_b64_tr_b16 v[70:71], v2 offset:5632
    s_waitcnt lgkmcnt(8)
    v_mfma_f32_32x32x16_bf16 v[16:31], v[48:51], a[0:3], 0
    v_mfma_f32_32x32x16_bf16 v[32:47], v[52:55], a[0:3], 0
    s_add_u32 s17, s19, 57344
    s_mov_b32 m0, s17
    s_add_u32 s18, s31, 128
    buffer_load_dwordx4 v4, s[8:11], s18 offen lds
    ds_read_b64_tr_b16 v[48:49], v2 offset:6144
    ds_read_b64_tr_b16 v[50:51], v2 offset:7168
    ds_read_b64_tr_b16 v[52:53], v2 offset:6656
    ds_read_b64_tr_b16 v[54:55], v2 offset:7680
    s_waitcnt lgkmcnt(8)
    v_mfma_f32_32x32x16_bf16 v[16:31], v[56:59], a[4:7], v[16:31]
    v_mfma_f32_32x32x16_bf16 v[32:47], v[60:63], a[4:7], v[32:47]
    ds_read_b64_tr_b16 v[56:57], v2 offset:8192
    ds_read_b64_tr_b16 v[58:59], v2 offset:9216
    ds_read_b64_tr_b16 v[60:61], v2 offset:8704
    ds_read_b64_tr_b16 v[62:63], v2 offset:9728
    s_waitcnt lgkmcnt(8)
    v_mfma_f32_32x32x16_bf16 v[16:31], v[64:67], a[8:11], v[16:31]
    v_mfma_f32_32x32x16_bf16 v[32:47], v[68:71], a[8:11], v[32:47]
    s_add_u32 s17, s19, 58368
    s_mov_b32 m0, s17
    s_add_u32 s18, s31, 65664
    buffer_load_dwordx4 v4, s[8:11], s18 offen lds
    ds_read_b64_tr_b16 v[64:65], v2 offset:10240
    ds_read_b64_tr_b16 v[66:67], v2 offset:11264
    ds_read_b64_tr_b16 v[68:69], v2 offset:10752
    ds_read_b64_tr_b16 v[70:71], v2 offset:11776
    s_waitcnt lgkmcnt(8)
    v_mfma_f32_32x32x16_bf16 v[16:31], v[48:51], a[12:15], v[16:31]
    v_mfma_f32_32x32x16_bf16 v[32:47], v[52:55], a[12:15], v[32:47]
    ds_read_b64_tr_b16 v[48:49], v2 offset:12288
    ds_read_b64_tr_b16 v[50:51], v2 offset:13312
    ds_read_b64_tr_b16 v[52:53], v2 offset:12800
    ds_read_b64_tr_b16 v[54:55], v2 offset:13824
    s_waitcnt lgkmcnt(8)
    v_mfma_f32_32x32x16_bf16 v[16:31], v[56:59], a[16:19], v[16:31]
    v_mfma_f32_32x32x16_bf16 v[32:47], v[60:63], a[16:19], v[32:47]
    s_add_u32 s17, s19, 59392
    s_mov_b32 m0, s17
    s_add_u32 s18, s31, 131200
    buffer_load_dwordx4 v4, s[8:11], s18 offen lds
    ds_read_b64_tr_b16 v[56:57], v2 offset:14336
    ds_read_b64_tr_b16 v[58:59], v2 offset:15360
    ds_read_b64_tr_b16 v[60:61], v2 offset:14848
    ds_read_b64_tr_b16 v[62:63], v2 offset:15872
    s_waitcnt lgkmcnt(8)
    v_mfma_f32_32x32x16_bf16 v[16:31], v[64:67], a[20:23], v[16:31]
    v_mfma_f32_32x32x16_bf16 v[32:47], v[68:71], a[20:23], v[32:47]
    ds_read_b64_tr_b16 v[64:65], v2 offset:16384
    ds_read_b64_tr_b16 v[66:67], v2 offset:17408
    ds_read_b64_tr_b16 v[68:69], v2 offset:16896
    ds_read_b64_tr_b16 v[70:71], v2 offset:17920
    s_waitcnt lgkmcnt(8)
    v_mfma_f32_32x32x16_bf16 v[16:31], v[48:51], a[24:27], v[16:31]
    v_mfma_f32_32x32x16_bf16 v[32:47], v[52:55], a[24:27], v[32:47]
    s_add_u32 s17, s19, 60416
    s_mov_b32 m0, s17
    s_add_u32 s18, s31, 196736
    buffer_load_dwordx4 v4, s[8:11], s18 offen lds
    ds_read_b64_tr_b16 v[48:49], v2 offset:18432
    ds_read_b64_tr_b16 v[50:51], v2 offset:19456
    ds_read_b64_tr_b16 v[52:53], v2 offset:18944
    ds_read_b64_tr_b16 v[54:55], v2 offset:19968
    s_waitcnt lgkmcnt(8)
    v_mfma_f32_32x32x16_bf16 v[16:31], v[56:59], a[28:31], v[16:31]
    v_mfma_f32_32x32x16_bf16 v[32:47], v[60:63], a[28:31], v[32:47]
    ds_read_b64_tr_b16 v[56:57], v2 offset:20480
    ds_read_b64_tr_b16 v[58:59], v2 offset:21504
    ds_read_b64_tr_b16 v[60:61], v2 offset:20992
    ds_read_b64_tr_b16 v[62:63], v2 offset:22016
    s_waitcnt lgkmcnt(8)
    v_mfma_f32_32x32x16_bf16 v[16:31], v[64:67], a[32:35], v[16:31]
    v_mfma_f32_32x32x16_bf16 v[32:47], v[68:71], a[32:35], v[32:47]
    s_add_u32 s17, s19, 61440
    s_mov_b32 m0, s17
    s_add_u32 s18, s31, 262272
    buffer_load_dwordx4 v4, s[8:11], s18 offen lds
    ds_read_b64_tr_b16 v[64:65], v2 offset:22528
    ds_read_b64_tr_b16 v[66:67], v2 offset:23552
    ds_read_b64_tr_b16 v[68:69], v2 offset:23040
    ds_read_b64_tr_b16 v[70:71], v2 offset:24064
    s_waitcnt lgkmcnt(8)
    v_mfma_f32_32x32x16_bf16 v[16:31], v[48:51], a[36:39], v[16:31]
    v_mfma_f32_32x32x16_bf16 v[32:47], v[52:55], a[36:39], v[32:47]
    ds_read_b64_tr_b16 v[48:49], v2 offset:24576
    ds_read_b64_tr_b16 v[50:51], v2 offset:25600
    ds_read_b64_tr_b16 v[52:53], v2 offset:25088
    ds_read_b64_tr_b16 v[54:55], v2 offset:26112
    s_waitcnt lgkmcnt(8)
    v_mfma_f32_32x32x16_bf16 v[16:31], v[56:59], a[40:43], v[16:31]
    v_mfma_f32_32x32x16_bf16 v[32:47], v[60:63], a[40:43], v[32:47]
    s_add_u32 s17, s19, 62464
    s_mov_b32 m0, s17
    s_add_u32 s18, s31, 327808
    buffer_load_dwordx4 v4, s[8:11], s18 offen lds
    ds_read_b64_tr_b16 v[56:57], v2 offset:26624
    ds_read_b64_tr_b16 v[58:59], v2 offset:27648
    ds_read_b64_tr_b16 v[60:61], v2 offset:27136
    ds_read_b64_tr_b16 v[62:63], v2 offset:28160
    s_waitcnt lgkmcnt(8)
    v_mfma_f32_32x32x16_bf16 v[16:31], v[64:67], a[44:47], v[16:31]
    v_mfma_f32_32x32x16_bf16 v[32:47], v[68:71], a[44:47], v[32:47]
    ds_read_b64_tr_b16 v[64:65], v2 offset:28672
    ds_read_b64_tr_b16 v[66:67], v2 offset:29696
    ds_read_b64_tr_b16 v[68:69], v2 offset:29184
    ds_read_b64_tr_b16 v[70:71], v2 offset:30208
    s_waitcnt lgkmcnt(8)
    v_mfma_f32_32x32x16_bf16 v[16:31], v[48:51], a[48:51], v[16:31]
    v_mfma_f32_32x32x16_bf16 v[32:47], v[52:55], a[48:51], v[32:47]
    s_add_u32 s17, s19, 63488
    s_mov_b32 m0, s17
    s_add_u32 s18, s31, 393344
    buffer_load_dwordx4 v4, s[8:11], s18 offen lds
    ds_read_b64_tr_b16 v[48:49], v2 offset:30720
    ds_read_b64_tr_b16 v[50:51], v2 offset:31744
    ds_read_b64_tr_b16 v[52:53], v2 offset:31232
    ds_read_b64_tr_b16 v[54:55], v2 offset:32256
    s_waitcnt lgkmcnt(8)
    v_mfma_f32_32x32x16_bf16 v[16:31], v[56:59], a[52:55], v[16:31]
    v_mfma_f32_32x32x16_bf16 v[32:47], v[60:63], a[52:55], v[32:47]
    ds_read_b64_tr_b16 v[56:57], v2 offset:32768
    ds_read_b64_tr_b16 v[58:59], v2 offset:33792
    ds_read_b64_tr_b16 v[60:61], v2 offset:33280
    ds_read_b64_tr_b16 v[62:63], v2 offset:34304
    s_waitcnt lgkmcnt(8)
    v_mfma_f32_32x32x16_bf16 v[16:31], v[64:67], a[56:59], v[16:31]
    v_mfma_f32_32x32x16_bf16 v[32:47], v[68:71], a[56:59], v[32:47]
    s_add_u32 s17, s19, 64512
    s_mov_b32 m0, s17
    s_add_u32 s18, s31, 458880
    buffer_load_dwordx4 v4, s[8:11], s18 offen lds
    ds_read_b64_tr_b16 v[64:65], v2 offset:34816
    ds_read_b64_tr_b16 v[66:67], v2 offset:35840
    ds_read_b64_tr_b16 v[68:69], v2 offset:35328
    ds_read_b64_tr_b16 v[70:71], v2 offset:36352
    s_waitcnt lgkmcnt(8)
    v_mfma_f32_32x32x16_bf16 v[16:31], v[48:51], a[60:63], v[16:31]
    v_mfma_f32_32x32x16_bf16 v[32:47], v[52:55], a[60:63], v[32:47]
    ds_read_b64_tr_b16 v[48:49], v2 offset:36864
    ds_read_b64_tr_b16 v[50:51], v2 offset:37888
    ds_read_b64_tr_b16 v[52:53], v2 offset:37376
    ds_read_b64_tr_b16 v[54:55], v2 offset:38400
    s_waitcnt lgkmcnt(8)
    v_mfma_f32_32x32x16_bf16 v[16:31], v[56:59], a[64:67], v[16:31]
    v_mfma_f32_32x32x16_bf16 v[32:47], v[60:63], a[64:67], v[32:47]
    s_add_u32 s17, s19, 65536
    s_mov_b32 m0, s17
    s_add_u32 s18, s31, 524416
    buffer_load_dwordx4 v4, s[8:11], s18 offen lds
    ds_read_b64_tr_b16 v[56:57], v2 offset:38912
    ds_read_b64_tr_b16 v[58:59], v2 offset:39936
    ds_read_b64_tr_b16 v[60:61], v2 offset:39424
    ds_read_b64_tr_b16 v[62:63], v2 offset:40448
    s_waitcnt lgkmcnt(8)
    v_mfma_f32_32x32x16_bf16 v[16:31], v[64:67], a[68:71], v[16:31]
    v_mfma_f32_32x32x16_bf16 v[32:47], v[68:71], a[68:71], v[32:47]
    ds_read_b64_tr_b16 v[64:65], v2 offset:40960
    ds_read_b64_tr_b16 v[66:67], v2 offset:41984
    ds_read_b64_tr_b16 v[68:69], v2 offset:41472
    ds_read_b64_tr_b16 v[70:71], v2 offset:42496
    s_waitcnt lgkmcnt(8)
    v_mfma_f32_32x32x16_bf16 v[16:31], v[48:51], a[72:75], v[16:31]
    v_mfma_f32_32x32x16_bf16 v[32:47], v[52:55], a[72:75], v[32:47]
    s_add_u32 s17, s19, 66560
    s_mov_b32 m0, s17
    s_add_u32 s18, s31, 589952
    buffer_load_dwordx4 v4, s[8:11], s18 offen lds
    ds_read_b64_tr_b16 v[48:49], v2 offset:43008
    ds_read_b64_tr_b16 v[50:51], v2 offset:44032
    ds_read_b64_tr_b16 v[52:53], v2 offset:43520
    ds_read_b64_tr_b16 v[54:55], v2 offset:44544
    s_waitcnt lgkmcnt(8)
    v_mfma_f32_32x32x16_bf16 v[16:31], v[56:59], a[76:79], v[16:31]
    v_mfma_f32_32x32x16_bf16 v[32:47], v[60:63], a[76:79], v[32:47]
    ds_read_b64_tr_b16 v[56:57], v2 offset:45056
    ds_read_b64_tr_b16 v[58:59], v2 offset:46080
    ds_read_b64_tr_b16 v[60:61], v2 offset:45568
    ds_read_b64_tr_b16 v[62:63], v2 offset:46592
    s_waitcnt lgkmcnt(8)
    v_mfma_f32_32x32x16_bf16 v[16:31], v[64:67], a[80:83], v[16:31]
    v_mfma_f32_32x32x16_bf16 v[32:47], v[68:71], a[80:83], v[32:47]
    s_add_u32 s17, s19, 67584
    s_mov_b32 m0, s17
    s_add_u32 s18, s31, 655488
    buffer_load_dwordx4 v4, s[8:11], s18 offen lds
    ds_read_b64_tr_b16 v[64:65], v2 offset:47104
    ds_read_b64_tr_b16 v[66:67], v2 offset:48128
    ds_read_b64_tr_b16 v[68:69], v2 offset:47616
    ds_read_b64_tr_b16 v[70:71], v2 offset:48640
    s_waitcnt lgkmcnt(8)
    v_mfma_f32_32x32x16_bf16 v[16:31], v[48:51], a[84:87], v[16:31]
    v_mfma_f32_32x32x16_bf16 v[32:47], v[52:55], a[84:87], v[32:47]
    ds_read_b64_tr_b16 v[48:49], v2 offset:49152
    ds_read_b64_tr_b16 v[50:51], v2 offset:50176
    ds_read_b64_tr_b16 v[52:53], v2 offset:49664
    ds_read_b64_tr_b16 v[54:55], v2 offset:50688
    s_waitcnt lgkmcnt(8)
    v_mfma_f32_32x32x16_bf16 v[16:31], v[56:59], a[88:91], v[16:31]
    v_mfma_f32_32x32x16_bf16 v[32:47], v[60:63], a[88:91], v[32:47]
    s_add_u32 s17, s19, 68608
    s_mov_b32 m0, s17
    s_add_u32 s18, s31, 721024
    buffer_load_dwordx4 v4, s[8:11], s18 offen lds
    ds_read_b64_tr_b16 v[56:57], v2 offset:51200
    ds_read_b64_tr_b16 v[58:59], v2 offset:52224
    ds_read_b64_tr_b16 v[60:61], v2 offset:51712
    ds_read_b64_tr_b16 v[62:63], v2 offset:52736
    s_waitcnt lgkmcnt(8)
    v_mfma_f32_32x32x16_bf16 v[16:31], v[64:67], a[92:95], v[16:31]
    v_mfma_f32_32x32x16_bf16 v[32:47], v[68:71], a[92:95], v[32:47]
    ds_read_b64_tr_b16 v[64:65], v2 offset:53248
    ds_read_b64_tr_b16 v[66:67], v2 offset:54272
    ds_read_b64_tr_b16 v[68:69], v2 offset:53760
    ds_read_b64_tr_b16 v[70:71], v2 offset:54784
    s_waitcnt lgkmcnt(8)
    v_mfma_f32_32x32x16_bf16 v[16:31], v[48:51], a[96:99], v[16:31]
    v_mfma_f32_32x32x16_bf16 v[32:47], v[52:55], a[96:99], v[32:47]
    s_add_u32 s17, s19, 69632
    s_mov_b32 m0, s17
    s_add_u32 s18, s31, 786560
    buffer_load_dwordx4 v4, s[8:11], s18 offen lds
    ds_read_b64_tr_b16 v[48:49], v2 offset:55296
    ds_read_b64_tr_b16 v[50:51], v2 offset:56320
    ds_read_b64_tr_b16 v[52:53], v2 offset:55808
    ds_read_b64_tr_b16 v[54:55], v2 offset:56832
    s_waitcnt lgkmcnt(8)
    v_mfma_f32_32x32x16_bf16 v[16:31], v[56:59], a[100:103], v[16:31]
    v_mfma_f32_32x32x16_bf16 v[32:47], v[60:63], a[100:103], v[32:47]
    s_waitcnt lgkmcnt(4)
    v_mfma_f32_32x32x16_bf16 v[16:31], v[64:67], a[104:107], v[16:31]
    v_mfma_f32_32x32x16_bf16 v[32:47], v[68:71], a[104:107], v[32:47]
    s_add_u32 s17, s19, 70656
    s_mov_b32 m0, s17
    s_add_u32 s18, s31, 852096
    buffer_load_dwordx4 v4, s[8:11], s18 offen lds
    s_waitcnt lgkmcnt(0)
    v_mfma_f32_32x32x16_bf16 v[16:31], v[48:51], a[108:111], v[16:31]
    v_mfma_f32_32x32x16_bf16 v[32:47], v[52:55], a[108:111], v[32:47]
    s_nop 11
    v_cvt_pk_bf16_f32 v96, v16, v17
    v_cvt_pk_bf16_f32 v97, v18, v19
    v_cvt_pk_bf16_f32 v98, v20, v21
    v_cvt_pk_bf16_f32 v99, v22, v23
    v_cvt_pk_bf16_f32 v100, v24, v25
    v_cvt_pk_bf16_f32 v101, v26, v27
    v_cvt_pk_bf16_f32 v102, v28, v29
    v_cvt_pk_bf16_f32 v103, v30, v31
    v_cvt_pk_bf16_f32 v104, v32, v33
    v_cvt_pk_bf16_f32 v105, v34, v35
    v_cvt_pk_bf16_f32 v106, v36, v37
    v_cvt_pk_bf16_f32 v107, v38, v39
    v_cvt_pk_bf16_f32 v108, v40, v41
    v_cvt_pk_bf16_f32 v109, v42, v43
    v_cvt_pk_bf16_f32 v110, v44, v45
    v_cvt_pk_bf16_f32 v111, v46, v47
    s_waitcnt vmcnt(0)
    s_barrier
    ds_read_b64_tr_b16 v[48:49], v12 offset:0
    ds_read_b64_tr_b16 v[50:51], v12 offset:1024
    ds_read_b64_tr_b16 v[52:53], v12 offset:512
    ds_read_b64_tr_b16 v[54:55], v12 offset:1536
    ds_read_b64_tr_b16 v[56:57], v12 offset:2048
    ds_read_b64_tr_b16 v[58:59], v12 offset:3072
    ds_read_b64_tr_b16 v[60:61], v12 offset:2560
    ds_read_b64_tr_b16 v[62:63], v12 offset:3584
    ds_read_b64_tr_b16 v[64:65], v12 offset:4096
    ds_read_b64_tr_b16 v[66:67], v12 offset:5120
    ds_read_b64_tr_b16 v[68:69], v12 offset:4608
    ds_read_b64_tr_b16 v[70:71], v12 offset:5632
    s_waitcnt lgkmcnt(8)
    v_mfma_f32_32x32x16_bf16 v[16:31], v[48:51], a[0:3], 0
    v_mfma_f32_32x32x16_bf16 v[32:47], v[52:55], a[0:3], 0
    s_add_u32 s17, s19, 0
    s_mov_b32 m0, s17
    s_add_u32 s18, s31, 256
    buffer_load_dwordx4 v4, s[8:11], s18 offen lds
    ds_read_b64_tr_b16 v[48:49], v12 offset:6144
    ds_read_b64_tr_b16 v[50:51], v12 offset:7168
    ds_read_b64_tr_b16 v[52:53], v12 offset:6656
    ds_read_b64_tr_b16 v[54:55], v12 offset:7680
    s_waitcnt lgkmcnt(8)
    v_mfma_f32_32x32x16_bf16 v[16:31], v[56:59], a[4:7], v[16:31]
    v_mfma_f32_32x32x16_bf16 v[32:47], v[60:63], a[4:7], v[32:47]
    ds_read_b64_tr_b16 v[56:57], v12 offset:8192
    ds_read_b64_tr_b16 v[58:59], v12 offset:9216
    ds_read_b64_tr_b16 v[60:61], v12 offset:8704
    ds_read_b64_tr_b16 v[62:63], v12 offset:9728
    s_waitcnt lgkmcnt(8)
    v_mfma_f32_32x32x16_bf16 v[16:31], v[64:67], a[8:11], v[16:31]
    v_mfma_f32_32x32x16_bf16 v[32:47], v[68:71], a[8:11], v[32:47]
    s_add_u32 s17, s19, 1024
    s_mov_b32 m0, s17
    s_add_u32 s18, s31, 65792
    buffer_load_dwordx4 v4, s[8:11], s18 offen lds
    ds_read_b64_tr_b16 v[64:65], v12 offset:10240
    ds_read_b64_tr_b16 v[66:67], v12 offset:11264
    ds_read_b64_tr_b16 v[68:69], v12 offset:10752
    ds_read_b64_tr_b16 v[70:71], v12 offset:11776
    s_waitcnt lgkmcnt(8)
    v_mfma_f32_32x32x16_bf16 v[16:31], v[48:51], a[12:15], v[16:31]
    v_mfma_f32_32x32x16_bf16 v[32:47], v[52:55], a[12:15], v[32:47]
    ds_read_b64_tr_b16 v[48:49], v12 offset:12288
    ds_read_b64_tr_b16 v[50:51], v12 offset:13312
    ds_read_b64_tr_b16 v[52:53], v12 offset:12800
    ds_read_b64_tr_b16 v[54:55], v12 offset:13824
    s_waitcnt lgkmcnt(8)
    v_mfma_f32_32x32x16_bf16 v[16:31], v[56:59], a[16:19], v[16:31]
    v_mfma_f32_32x32x16_bf16 v[32:47], v[60:63], a[16:19], v[32:47]
    s_add_u32 s17, s19, 2048
    s_mov_b32 m0, s17
    s_add_u32 s18, s31, 131328
    buffer_load_dwordx4 v4, s[8:11], s18 offen lds
    ds_read_b64_tr_b16 v[56:57], v12 offset:14336
    ds_read_b64_tr_b16 v[58:59], v12 offset:15360
    ds_read_b64_tr_b16 v[60:61], v12 offset:14848
    ds_read_b64_tr_b16 v[62:63], v12 offset:15872
    s_waitcnt lgkmcnt(8)
    v_mfma_f32_32x32x16_bf16 v[16:31], v[64:67], a[20:23], v[16:31]
    v_mfma_f32_32x32x16_bf16 v[32:47], v[68:71], a[20:23], v[32:47]
    ds_read_b64_tr_b16 v[64:65], v12 offset:16384
    ds_read_b64_tr_b16 v[66:67], v12 offset:17408
    ds_read_b64_tr_b16 v[68:69], v12 offset:16896
    ds_read_b64_tr_b16 v[70:71], v12 offset:17920
    s_waitcnt lgkmcnt(8)
    v_mfma_f32_32x32x16_bf16 v[16:31], v[48:51], a[24:27], v[16:31]
    v_mfma_f32_32x32x16_bf16 v[32:47], v[52:55], a[24:27], v[32:47]
    s_add_u32 s17, s19, 3072
    s_mov_b32 m0, s17
    s_add_u32 s18, s31, 196864
    buffer_load_dwordx4 v4, s[8:11], s18 offen lds
    ds_read_b64_tr_b16 v[48:49], v12 offset:18432
    ds_read_b64_tr_b16 v[50:51], v12 offset:19456
    ds_read_b64_tr_b16 v[52:53], v12 offset:18944
    ds_read_b64_tr_b16 v[54:55], v12 offset:19968
    s_waitcnt lgkmcnt(8)
    v_mfma_f32_32x32x16_bf16 v[16:31], v[56:59], a[28:31], v[16:31]
    v_mfma_f32_32x32x16_bf16 v[32:47], v[60:63], a[28:31], v[32:47]
    ds_read_b64_tr_b16 v[56:57], v12 offset:20480
    ds_read_b64_tr_b16 v[58:59], v12 offset:21504
    ds_read_b64_tr_b16 v[60:61], v12 offset:20992
    ds_read_b64_tr_b16 v[62:63], v12 offset:22016
    s_waitcnt lgkmcnt(8)
    v_mfma_f32_32x32x16_bf16 v[16:31], v[64:67], a[32:35], v[16:31]
    v_mfma_f32_32x32x16_bf16 v[32:47], v[68:71], a[32:35], v[32:47]
    s_add_u32 s17, s19, 4096
    s_mov_b32 m0, s17
    s_add_u32 s18, s31, 262400
    buffer_load_dwordx4 v4, s[8:11], s18 offen lds
    ds_read_b64_tr_b16 v[64:65], v12 offset:22528
    ds_read_b64_tr_b16 v[66:67], v12 offset:23552
    ds_read_b64_tr_b16 v[68:69], v12 offset:23040
    ds_read_b64_tr_b16 v[70:71], v12 offset:24064
    s_waitcnt lgkmcnt(8)
    v_mfma_f32_32x32x16_bf16 v[16:31], v[48:51], a[36:39], v[16:31]
    v_mfma_f32_32x32x16_bf16 v[32:47], v[52:55], a[36:39], v[32:47]
    ds_read_b64_tr_b16 v[48:49], v12 offset:24576
    ds_read_b64_tr_b16 v[50:51], v12 offset:25600
    ds_read_b64_tr_b16 v[52:53], v12 offset:25088
    ds_read_b64_tr_b16 v[54:55], v12 offset:26112
    s_waitcnt lgkmcnt(8)
    v_mfma_f32_32x32x16_bf16 v[16:31], v[56:59], a[40:43], v[16:31]
    v_mfma_f32_32x32x16_bf16 v[32:47], v[60:63], a[40:43], v[32:47]
    s_add_u32 s17, s19, 5120
    s_mov_b32 m0, s17
    s_add_u32 s18, s31, 327936
    buffer_load_dwordx4 v4, s[8:11], s18 offen lds
    ds_read_b64_tr_b16 v[56:57], v12 offset:26624
    ds_read_b64_tr_b16 v[58:59], v12 offset:27648
    ds_read_b64_tr_b16 v[60:61], v12 offset:27136
    ds_read_b64_tr_b16 v[62:63], v12 offset:28160
    s_waitcnt lgkmcnt(8)
    v_mfma_f32_32x32x16_bf16 v[16:31], v[64:67], a[44:47], v[16:31]
    v_mfma_f32_32x32x16_bf16 v[32:47], v[68:71], a[44:47], v[32:47]
    ds_read_b64_tr_b16 v[64:65], v12 offset:28672
    ds_read_b64_tr_b16 v[66:67], v12 offset:29696
    ds_read_b64_tr_b16 v[68:69], v12 offset:29184
    ds_read_b64_tr_b16 v[70:71], v12 offset:30208
    s_waitcnt lgkmcnt(8)
    v_mfma_f32_32x32x16_bf16 v[16:31], v[48:51], a[48:51], v[16:31]
    v_mfma_f32_32x32x16_bf16 v[32:47], v[52:55], a[48:51], v[32:47]
    s_add_u32 s17, s19, 6144
    s_mov_b32 m0, s17
    s_add_u32 s18, s31, 393472
    buffer_load_dwordx4 v4, s[8:11], s18 offen lds
    ds_read_b64_tr_b16 v[48:49], v12 offset:30720
    ds_read_b64_tr_b16 v[50:51], v12 offset:31744
    ds_read_b64_tr_b16 v[52:53], v12 offset:31232
    ds_read_b64_tr_b16 v[54:55], v12 offset:32256
    s_waitcnt lgkmcnt(8)
    v_mfma_f32_32x32x16_bf16 v[16:31], v[56:59], a[52:55], v[16:31]
    v_mfma_f32_32x32x16_bf16 v[32:47], v[60:63], a[52:55], v[32:47]
    ds_read_b64_tr_b16 v[56:57], v12 offset:32768
    ds_read_b64_tr_b16 v[58:59], v12 offset:33792
    ds_read_b64_tr_b16 v[60:61], v12 offset:33280
    ds_read_b64_tr_b16 v[62:63], v12 offset:34304
    s_waitcnt lgkmcnt(8)
    v_mfma_f32_32x32x16_bf16 v[16:31], v[64:67], a[56:59], v[16:31]
    v_mfma_f32_32x32x16_bf16 v[32:47], v[68:71], a[56:59], v[32:47]
    s_add_u32 s17, s19, 7168
    s_mov_b32 m0, s17
    s_add_u32 s18, s31, 459008
    buffer_load_dwordx4 v4, s[8:11], s18 offen lds
    ds_read_b64_tr_b16 v[64:65], v12 offset:34816
    ds_read_b64_tr_b16 v[66:67], v12 offset:35840
    ds_read_b64_tr_b16 v[68:69], v12 offset:35328
    ds_read_b64_tr_b16 v[70:71], v12 offset:36352
    s_waitcnt lgkmcnt(8)
    v_mfma_f32_32x32x16_bf16 v[16:31], v[48:51], a[60:63], v[16:31]
    v_mfma_f32_32x32x16_bf16 v[32:47], v[52:55], a[60:63], v[32:47]
    ds_read_b64_tr_b16 v[48:49], v12 offset:36864
    ds_read_b64_tr_b16 v[50:51], v12 offset:37888
    ds_read_b64_tr_b16 v[52:53], v12 offset:37376
    ds_read_b64_tr_b16 v[54:55], v12 offset:38400
    s_waitcnt lgkmcnt(8)
    v_mfma_f32_32x32x16_bf16 v[16:31], v[56:59], a[64:67], v[16:31]
    v_mfma_f32_32x32x16_bf16 v[32:47], v[60:63], a[64:67], v[32:47]
    s_add_u32 s17, s19, 8192
    s_mov_b32 m0, s17
    s_add_u32 s18, s31, 524544
    buffer_load_dwordx4 v4, s[8:11], s18 offen lds
    ds_read_b64_tr_b16 v[56:57], v12 offset:38912
    ds_read_b64_tr_b16 v[58:59], v12 offset:39936
    ds_read_b64_tr_b16 v[60:61], v12 offset:39424
    ds_read_b64_tr_b16 v[62:63], v12 offset:40448
    s_waitcnt lgkmcnt(8)
    v_mfma_f32_32x32x16_bf16 v[16:31], v[64:67], a[68:71], v[16:31]
    v_mfma_f32_32x32x16_bf16 v[32:47], v[68:71], a[68:71], v[32:47]
    ds_read_b64_tr_b16 v[64:65], v12 offset:40960
    ds_read_b64_tr_b16 v[66:67], v12 offset:41984
    ds_read_b64_tr_b16 v[68:69], v12 offset:41472
    ds_read_b64_tr_b16 v[70:71], v12 offset:42496
    s_waitcnt lgkmcnt(8)
    v_mfma_f32_32x32x16_bf16 v[16:31], v[48:51], a[72:75], v[16:31]
    v_mfma_f32_32x32x16_bf16 v[32:47], v[52:55], a[72:75], v[32:47]
    s_add_u32 s17, s19, 9216
    s_mov_b32 m0, s17
    s_add_u32 s18, s31, 590080
    buffer_load_dwordx4 v4, s[8:11], s18 offen lds
    ds_read_b64_tr_b16 v[48:49], v12 offset:43008
    ds_read_b64_tr_b16 v[50:51], v12 offset:44032
    ds_read_b64_tr_b16 v[52:53], v12 offset:43520
    ds_read_b64_tr_b16 v[54:55], v12 offset:44544
    s_waitcnt lgkmcnt(8)
    v_mfma_f32_32x32x16_bf16 v[16:31], v[56:59], a[76:79], v[16:31]
    v_mfma_f32_32x32x16_bf16 v[32:47], v[60:63], a[76:79], v[32:47]
    ds_read_b64_tr_b16 v[56:57], v12 offset:45056
    ds_read_b64_tr_b16 v[58:59], v12 offset:46080
    ds_read_b64_tr_b16 v[60:61], v12 offset:45568
    ds_read_b64_tr_b16 v[62:63], v12 offset:46592
    s_waitcnt lgkmcnt(8)
    v_mfma_f32_32x32x16_bf16 v[16:31], v[64:67], a[80:83], v[16:31]
    v_mfma_f32_32x32x16_bf16 v[32:47], v[68:71], a[80:83], v[32:47]
    s_add_u32 s17, s19, 10240
    s_mov_b32 m0, s17
    s_add_u32 s18, s31, 655616
    buffer_load_dwordx4 v4, s[8:11], s18 offen lds
    ds_read_b64_tr_b16 v[64:65], v12 offset:47104
    ds_read_b64_tr_b16 v[66:67], v12 offset:48128
    ds_read_b64_tr_b16 v[68:69], v12 offset:47616
    ds_read_b64_tr_b16 v[70:71], v12 offset:48640
    s_waitcnt lgkmcnt(8)
    v_mfma_f32_32x32x16_bf16 v[16:31], v[48:51], a[84:87], v[16:31]
    v_mfma_f32_32x32x16_bf16 v[32:47], v[52:55], a[84:87], v[32:47]
    ds_read_b64_tr_b16 v[48:49], v12 offset:49152
    ds_read_b64_tr_b16 v[50:51], v12 offset:50176
    ds_read_b64_tr_b16 v[52:53], v12 offset:49664
    ds_read_b64_tr_b16 v[54:55], v12 offset:50688
    s_waitcnt lgkmcnt(8)
    v_mfma_f32_32x32x16_bf16 v[16:31], v[56:59], a[88:91], v[16:31]
    v_mfma_f32_32x32x16_bf16 v[32:47], v[60:63], a[88:91], v[32:47]
    s_add_u32 s17, s19, 11264
    s_mov_b32 m0, s17
    s_add_u32 s18, s31, 721152
    buffer_load_dwordx4 v4, s[8:11], s18 offen lds
    ds_read_b64_tr_b16 v[56:57], v12 offset:51200
    ds_read_b64_tr_b16 v[58:59], v12 offset:52224
    ds_read_b64_tr_b16 v[60:61], v12 offset:51712
    ds_read_b64_tr_b16 v[62:63], v12 offset:52736
    s_waitcnt lgkmcnt(8)
    v_mfma_f32_32x32x16_bf16 v[16:31], v[64:67], a[92:95], v[16:31]
    v_mfma_f32_32x32x16_bf16 v[32:47], v[68:71], a[92:95], v[32:47]
    ds_read_b64_tr_b16 v[64:65], v12 offset:53248
    ds_read_b64_tr_b16 v[66:67], v12 offset:54272
    ds_read_b64_tr_b16 v[68:69], v12 offset:53760
    ds_read_b64_tr_b16 v[70:71], v12 offset:54784
    s_waitcnt lgkmcnt(8)
    v_mfma_f32_32x32x16_bf16 v[16:31], v[48:51], a[96:99], v[16:31]
    v_mfma_f32_32x32x16_bf16 v[32:47], v[52:55], a[96:99], v[32:47]
    s_add_u32 s17, s19, 12288
    s_mov_b32 m0, s17
    s_add_u32 s18, s31, 786688
    buffer_load_dwordx4 v4, s[8:11], s18 offen lds
    ds_read_b64_tr_b16 v[48:49], v12 offset:55296
    ds_read_b64_tr_b16 v[50:51], v12 offset:56320
    ds_read_b64_tr_b16 v[52:53], v12 offset:55808
    ds_read_b64_tr_b16 v[54:55], v12 offset:56832
    s_waitcnt lgkmcnt(8)
    v_mfma_f32_32x32x16_bf16 v[16:31], v[56:59], a[100:103], v[16:31]
    v_mfma_f32_32x32x16_bf16 v[32:47], v[60:63], a[100:103], v[32:47]
    s_waitcnt lgkmcnt(4)
    v_mfma_f32_32x32x16_bf16 v[16:31], v[64:67], a[104:107], v[16:31]
    v_mfma_f32_32x32x16_bf16 v[32:47], v[68:71], a[104:107], v[32:47]
    s_add_u32 s17, s19, 13312
    s_mov_b32 m0, s17
    s_add_u32 s18, s31, 852224
    buffer_load_dwordx4 v4, s[8:11], s18 offen lds
    s_waitcnt lgkmcnt(0)
    v_mfma_f32_32x32x16_bf16 v[16:31], v[48:51], a[108:111], v[16:31]
    v_mfma_f32_32x32x16_bf16 v[32:47], v[52:55], a[108:111], v[32:47]
    s_nop 11
    v_cvt_pk_bf16_f32 v112, v16, v17
    v_cvt_pk_bf16_f32 v113, v18, v19
    v_cvt_pk_bf16_f32 v114, v20, v21
    v_cvt_pk_bf16_f32 v115, v22, v23
    v_cvt_pk_bf16_f32 v116, v24, v25
    v_cvt_pk_bf16_f32 v117, v26, v27
    v_cvt_pk_bf16_f32 v118, v28, v29
    v_cvt_pk_bf16_f32 v119, v30, v31
    v_cvt_pk_bf16_f32 v120, v32, v33
    v_cvt_pk_bf16_f32 v121, v34, v35
    v_cvt_pk_bf16_f32 v122, v36, v37
    v_cvt_pk_bf16_f32 v123, v38, v39
    v_cvt_pk_bf16_f32 v124, v40, v41
    v_cvt_pk_bf16_f32 v125, v42, v43
    v_cvt_pk_bf16_f32 v126, v44, v45
    v_cvt_pk_bf16_f32 v127, v46, v47
    s_waitcnt vmcnt(0)
    s_barrier
    ds_read_b64_tr_b16 v[48:49], v2 offset:0
    ds_read_b64_tr_b16 v[50:51], v2 offset:1024
    ds_read_b64_tr_b16 v[52:53], v2 offset:512
    ds_read_b64_tr_b16 v[54:55], v2 offset:1536
    ds_read_b64_tr_b16 v[56:57], v2 offset:2048
    ds_read_b64_tr_b16 v[58:59], v2 offset:3072
    ds_read_b64_tr_b16 v[60:61], v2 offset:2560
    ds_read_b64_tr_b16 v[62:63], v2 offset:3584
    ds_read_b64_tr_b16 v[64:65], v2 offset:4096
    ds_read_b64_tr_b16 v[66:67], v2 offset:5120
    ds_read_b64_tr_b16 v[68:69], v2 offset:4608
    ds_read_b64_tr_b16 v[70:71], v2 offset:5632
    s_waitcnt lgkmcnt(8)
    v_mfma_f32_32x32x16_bf16 v[16:31], v[48:51], a[0:3], 0
    v_mfma_f32_32x32x16_bf16 v[32:47], v[52:55], a[0:3], 0
    s_add_u32 s17, s19, 57344
    s_mov_b32 m0, s17
    s_add_u32 s18, s31, 384
    buffer_load_dwordx4 v4, s[8:11], s18 offen lds
    ds_read_b64_tr_b16 v[48:49], v2 offset:6144
    ds_read_b64_tr_b16 v[50:51], v2 offset:7168
    ds_read_b64_tr_b16 v[52:53], v2 offset:6656
    ds_read_b64_tr_b16 v[54:55], v2 offset:7680
    s_waitcnt lgkmcnt(8)
    v_mfma_f32_32x32x16_bf16 v[16:31], v[56:59], a[4:7], v[16:31]
    v_mfma_f32_32x32x16_bf16 v[32:47], v[60:63], a[4:7], v[32:47]
    ds_read_b64_tr_b16 v[56:57], v2 offset:8192
    ds_read_b64_tr_b16 v[58:59], v2 offset:9216
    ds_read_b64_tr_b16 v[60:61], v2 offset:8704
    ds_read_b64_tr_b16 v[62:63], v2 offset:9728
    s_waitcnt lgkmcnt(8)
    v_mfma_f32_32x32x16_bf16 v[16:31], v[64:67], a[8:11], v[16:31]
    v_mfma_f32_32x32x16_bf16 v[32:47], v[68:71], a[8:11], v[32:47]
    s_add_u32 s17, s19, 58368
    s_mov_b32 m0, s17
    s_add_u32 s18, s31, 65920
    buffer_load_dwordx4 v4, s[8:11], s18 offen lds
    ds_read_b64_tr_b16 v[64:65], v2 offset:10240
    ds_read_b64_tr_b16 v[66:67], v2 offset:11264
    ds_read_b64_tr_b16 v[68:69], v2 offset:10752
    ds_read_b64_tr_b16 v[70:71], v2 offset:11776
    s_waitcnt lgkmcnt(8)
    v_mfma_f32_32x32x16_bf16 v[16:31], v[48:51], a[12:15], v[16:31]
    v_mfma_f32_32x32x16_bf16 v[32:47], v[52:55], a[12:15], v[32:47]
    ds_read_b64_tr_b16 v[48:49], v2 offset:12288
    ds_read_b64_tr_b16 v[50:51], v2 offset:13312
    ds_read_b64_tr_b16 v[52:53], v2 offset:12800
    ds_read_b64_tr_b16 v[54:55], v2 offset:13824
    s_waitcnt lgkmcnt(8)
    v_mfma_f32_32x32x16_bf16 v[16:31], v[56:59], a[16:19], v[16:31]
    v_mfma_f32_32x32x16_bf16 v[32:47], v[60:63], a[16:19], v[32:47]
    s_add_u32 s17, s19, 59392
    s_mov_b32 m0, s17
    s_add_u32 s18, s31, 131456
    buffer_load_dwordx4 v4, s[8:11], s18 offen lds
    ds_read_b64_tr_b16 v[56:57], v2 offset:14336
    ds_read_b64_tr_b16 v[58:59], v2 offset:15360
    ds_read_b64_tr_b16 v[60:61], v2 offset:14848
    ds_read_b64_tr_b16 v[62:63], v2 offset:15872
    s_waitcnt lgkmcnt(8)
    v_mfma_f32_32x32x16_bf16 v[16:31], v[64:67], a[20:23], v[16:31]
    v_mfma_f32_32x32x16_bf16 v[32:47], v[68:71], a[20:23], v[32:47]
    ds_read_b64_tr_b16 v[64:65], v2 offset:16384
    ds_read_b64_tr_b16 v[66:67], v2 offset:17408
    ds_read_b64_tr_b16 v[68:69], v2 offset:16896
    ds_read_b64_tr_b16 v[70:71], v2 offset:17920
    s_waitcnt lgkmcnt(8)
    v_mfma_f32_32x32x16_bf16 v[16:31], v[48:51], a[24:27], v[16:31]
    v_mfma_f32_32x32x16_bf16 v[32:47], v[52:55], a[24:27], v[32:47]
    s_add_u32 s17, s19, 60416
    s_mov_b32 m0, s17
    s_add_u32 s18, s31, 196992
    buffer_load_dwordx4 v4, s[8:11], s18 offen lds
    ds_read_b64_tr_b16 v[48:49], v2 offset:18432
    ds_read_b64_tr_b16 v[50:51], v2 offset:19456
    ds_read_b64_tr_b16 v[52:53], v2 offset:18944
    ds_read_b64_tr_b16 v[54:55], v2 offset:19968
    s_waitcnt lgkmcnt(8)
    v_mfma_f32_32x32x16_bf16 v[16:31], v[56:59], a[28:31], v[16:31]
    v_mfma_f32_32x32x16_bf16 v[32:47], v[60:63], a[28:31], v[32:47]
    ds_read_b64_tr_b16 v[56:57], v2 offset:20480
    ds_read_b64_tr_b16 v[58:59], v2 offset:21504
    ds_read_b64_tr_b16 v[60:61], v2 offset:20992
    ds_read_b64_tr_b16 v[62:63], v2 offset:22016
    s_waitcnt lgkmcnt(8)
    v_mfma_f32_32x32x16_bf16 v[16:31], v[64:67], a[32:35], v[16:31]
    v_mfma_f32_32x32x16_bf16 v[32:47], v[68:71], a[32:35], v[32:47]
    s_add_u32 s17, s19, 61440
    s_mov_b32 m0, s17
    s_add_u32 s18, s31, 262528
    buffer_load_dwordx4 v4, s[8:11], s18 offen lds
    ds_read_b64_tr_b16 v[64:65], v2 offset:22528
    ds_read_b64_tr_b16 v[66:67], v2 offset:23552
    ds_read_b64_tr_b16 v[68:69], v2 offset:23040
    ds_read_b64_tr_b16 v[70:71], v2 offset:24064
    s_waitcnt lgkmcnt(8)
    v_mfma_f32_32x32x16_bf16 v[16:31], v[48:51], a[36:39], v[16:31]
    v_mfma_f32_32x32x16_bf16 v[32:47], v[52:55], a[36:39], v[32:47]
    ds_read_b64_tr_b16 v[48:49], v2 offset:24576
    ds_read_b64_tr_b16 v[50:51], v2 offset:25600
    ds_read_b64_tr_b16 v[52:53], v2 offset:25088
    ds_read_b64_tr_b16 v[54:55], v2 offset:26112
    s_waitcnt lgkmcnt(8)
    v_mfma_f32_32x32x16_bf16 v[16:31], v[56:59], a[40:43], v[16:31]
    v_mfma_f32_32x32x16_bf16 v[32:47], v[60:63], a[40:43], v[32:47]
    s_add_u32 s17, s19, 62464
    s_mov_b32 m0, s17
    s_add_u32 s18, s31, 328064
    buffer_load_dwordx4 v4, s[8:11], s18 offen lds
    ds_read_b64_tr_b16 v[56:57], v2 offset:26624
    ds_read_b64_tr_b16 v[58:59], v2 offset:27648
    ds_read_b64_tr_b16 v[60:61], v2 offset:27136
    ds_read_b64_tr_b16 v[62:63], v2 offset:28160
    s_waitcnt lgkmcnt(8)
    v_mfma_f32_32x32x16_bf16 v[16:31], v[64:67], a[44:47], v[16:31]
    v_mfma_f32_32x32x16_bf16 v[32:47], v[68:71], a[44:47], v[32:47]
    ds_read_b64_tr_b16 v[64:65], v2 offset:28672
    ds_read_b64_tr_b16 v[66:67], v2 offset:29696
    ds_read_b64_tr_b16 v[68:69], v2 offset:29184
    ds_read_b64_tr_b16 v[70:71], v2 offset:30208
    s_waitcnt lgkmcnt(8)
    v_mfma_f32_32x32x16_bf16 v[16:31], v[48:51], a[48:51], v[16:31]
    v_mfma_f32_32x32x16_bf16 v[32:47], v[52:55], a[48:51], v[32:47]
    s_add_u32 s17, s19, 63488
    s_mov_b32 m0, s17
    s_add_u32 s18, s31, 393600
    buffer_load_dwordx4 v4, s[8:11], s18 offen lds
    ds_read_b64_tr_b16 v[48:49], v2 offset:30720
    ds_read_b64_tr_b16 v[50:51], v2 offset:31744
    ds_read_b64_tr_b16 v[52:53], v2 offset:31232
    ds_read_b64_tr_b16 v[54:55], v2 offset:32256
    s_waitcnt lgkmcnt(8)
    v_mfma_f32_32x32x16_bf16 v[16:31], v[56:59], a[52:55], v[16:31]
    v_mfma_f32_32x32x16_bf16 v[32:47], v[60:63], a[52:55], v[32:47]
    ds_read_b64_tr_b16 v[56:57], v2 offset:32768
    ds_read_b64_tr_b16 v[58:59], v2 offset:33792
    ds_read_b64_tr_b16 v[60:61], v2 offset:33280
    ds_read_b64_tr_b16 v[62:63], v2 offset:34304
    s_waitcnt lgkmcnt(8)
    v_mfma_f32_32x32x16_bf16 v[16:31], v[64:67], a[56:59], v[16:31]
    v_mfma_f32_32x32x16_bf16 v[32:47], v[68:71], a[56:59], v[32:47]
    s_add_u32 s17, s19, 64512
    s_mov_b32 m0, s17
    s_add_u32 s18, s31, 459136
    buffer_load_dwordx4 v4, s[8:11], s18 offen lds
    ds_read_b64_tr_b16 v[64:65], v2 offset:34816
    ds_read_b64_tr_b16 v[66:67], v2 offset:35840
    ds_read_b64_tr_b16 v[68:69], v2 offset:35328
    ds_read_b64_tr_b16 v[70:71], v2 offset:36352
    s_waitcnt lgkmcnt(8)
    v_mfma_f32_32x32x16_bf16 v[16:31], v[48:51], a[60:63], v[16:31]
    v_mfma_f32_32x32x16_bf16 v[32:47], v[52:55], a[60:63], v[32:47]
    ds_read_b64_tr_b16 v[48:49], v2 offset:36864
    ds_read_b64_tr_b16 v[50:51], v2 offset:37888
    ds_read_b64_tr_b16 v[52:53], v2 offset:37376
    ds_read_b64_tr_b16 v[54:55], v2 offset:38400
    s_waitcnt lgkmcnt(8)
    v_mfma_f32_32x32x16_bf16 v[16:31], v[56:59], a[64:67], v[16:31]
    v_mfma_f32_32x32x16_bf16 v[32:47], v[60:63], a[64:67], v[32:47]
    s_add_u32 s17, s19, 65536
    s_mov_b32 m0, s17
    s_add_u32 s18, s31, 524672
    buffer_load_dwordx4 v4, s[8:11], s18 offen lds
    ds_read_b64_tr_b16 v[56:57], v2 offset:38912
    ds_read_b64_tr_b16 v[58:59], v2 offset:39936
    ds_read_b64_tr_b16 v[60:61], v2 offset:39424
    ds_read_b64_tr_b16 v[62:63], v2 offset:40448
    s_waitcnt lgkmcnt(8)
    v_mfma_f32_32x32x16_bf16 v[16:31], v[64:67], a[68:71], v[16:31]
    v_mfma_f32_32x32x16_bf16 v[32:47], v[68:71], a[68:71], v[32:47]
    ds_read_b64_tr_b16 v[64:65], v2 offset:40960
    ds_read_b64_tr_b16 v[66:67], v2 offset:41984
    ds_read_b64_tr_b16 v[68:69], v2 offset:41472
    ds_read_b64_tr_b16 v[70:71], v2 offset:42496
    s_waitcnt lgkmcnt(8)
    v_mfma_f32_32x32x16_bf16 v[16:31], v[48:51], a[72:75], v[16:31]
    v_mfma_f32_32x32x16_bf16 v[32:47], v[52:55], a[72:75], v[32:47]
    s_add_u32 s17, s19, 66560
    s_mov_b32 m0, s17
    s_add_u32 s18, s31, 590208
    buffer_load_dwordx4 v4, s[8:11], s18 offen lds
    ds_read_b64_tr_b16 v[48:49], v2 offset:43008
    ds_read_b64_tr_b16 v[50:51], v2 offset:44032
    ds_read_b64_tr_b16 v[52:53], v2 offset:43520
    ds_read_b64_tr_b16 v[54:55], v2 offset:44544
    s_waitcnt lgkmcnt(8)
    v_mfma_f32_32x32x16_bf16 v[16:31], v[56:59], a[76:79], v[16:31]
    v_mfma_f32_32x32x16_bf16 v[32:47], v[60:63], a[76:79], v[32:47]
    ds_read_b64_tr_b16 v[56:57], v2 offset:45056
    ds_read_b64_tr_b16 v[58:59], v2 offset:46080
    ds_read_b64_tr_b16 v[60:61], v2 offset:45568
    ds_read_b64_tr_b16 v[62:63], v2 offset:46592
    s_waitcnt lgkmcnt(8)
    v_mfma_f32_32x32x16_bf16 v[16:31], v[64:67], a[80:83], v[16:31]
    v_mfma_f32_32x32x16_bf16 v[32:47], v[68:71], a[80:83], v[32:47]
    s_add_u32 s17, s19, 67584
    s_mov_b32 m0, s17
    s_add_u32 s18, s31, 655744
    buffer_load_dwordx4 v4, s[8:11], s18 offen lds
    ds_read_b64_tr_b16 v[64:65], v2 offset:47104
    ds_read_b64_tr_b16 v[66:67], v2 offset:48128
    ds_read_b64_tr_b16 v[68:69], v2 offset:47616
    ds_read_b64_tr_b16 v[70:71], v2 offset:48640
    s_waitcnt lgkmcnt(8)
    v_mfma_f32_32x32x16_bf16 v[16:31], v[48:51], a[84:87], v[16:31]
    v_mfma_f32_32x32x16_bf16 v[32:47], v[52:55], a[84:87], v[32:47]
    ds_read_b64_tr_b16 v[48:49], v2 offset:49152
    ds_read_b64_tr_b16 v[50:51], v2 offset:50176
    ds_read_b64_tr_b16 v[52:53], v2 offset:49664
    ds_read_b64_tr_b16 v[54:55], v2 offset:50688
    s_waitcnt lgkmcnt(8)
    v_mfma_f32_32x32x16_bf16 v[16:31], v[56:59], a[88:91], v[16:31]
    v_mfma_f32_32x32x16_bf16 v[32:47], v[60:63], a[88:91], v[32:47]
    s_add_u32 s17, s19, 68608
    s_mov_b32 m0, s17
    s_add_u32 s18, s31, 721280
    buffer_load_dwordx4 v4, s[8:11], s18 offen lds
    ds_read_b64_tr_b16 v[56:57], v2 offset:51200
    ds_read_b64_tr_b16 v[58:59], v2 offset:52224
    ds_read_b64_tr_b16 v[60:61], v2 offset:51712
    ds_read_b64_tr_b16 v[62:63], v2 offset:52736
    s_waitcnt lgkmcnt(8)
    v_mfma_f32_32x32x16_bf16 v[16:31], v[64:67], a[92:95], v[16:31]
    v_mfma_f32_32x32x16_bf16 v[32:47], v[68:71], a[92:95], v[32:47]
    ds_read_b64_tr_b16 v[64:65], v2 offset:53248
    ds_read_b64_tr_b16 v[66:67], v2 offset:54272
    ds_read_b64_tr_b16 v[68:69], v2 offset:53760
    ds_read_b64_tr_b16 v[70:71], v2 offset:54784
    s_waitcnt lgkmcnt(8)
    v_mfma_f32_32x32x16_bf16 v[16:31], v[48:51], a[96:99], v[16:31]
    v_mfma_f32_32x32x16_bf16 v[32:47], v[52:55], a[96:99], v[32:47]
    s_add_u32 s17, s19, 69632
    s_mov_b32 m0, s17
    s_add_u32 s18, s31, 786816
    buffer_load_dwordx4 v4, s[8:11], s18 offen lds
    ds_read_b64_tr_b16 v[48:49], v2 offset:55296
    ds_read_b64_tr_b16 v[50:51], v2 offset:56320
    ds_read_b64_tr_b16 v[52:53], v2 offset:55808
    ds_read_b64_tr_b16 v[54:55], v2 offset:56832
    s_waitcnt lgkmcnt(8)
    v_mfma_f32_32x32x16_bf16 v[16:31], v[56:59], a[100:103], v[16:31]
    v_mfma_f32_32x32x16_bf16 v[32:47], v[60:63], a[100:103], v[32:47]
    s_waitcnt lgkmcnt(4)
    v_mfma_f32_32x32x16_bf16 v[16:31], v[64:67], a[104:107], v[16:31]
    v_mfma_f32_32x32x16_bf16 v[32:47], v[68:71], a[104:107], v[32:47]
    s_add_u32 s17, s19, 70656
    s_mov_b32 m0, s17
    s_add_u32 s18, s31, 852352
    buffer_load_dwordx4 v4, s[8:11], s18 offen lds
    s_waitcnt lgkmcnt(0)
    v_mfma_f32_32x32x16_bf16 v[16:31], v[48:51], a[108:111], v[16:31]
    v_mfma_f32_32x32x16_bf16 v[32:47], v[52:55], a[108:111], v[32:47]
    s_nop 11
    v_cvt_pk_bf16_f32 v128, v16, v17
    v_cvt_pk_bf16_f32 v129, v18, v19
    v_cvt_pk_bf16_f32 v130, v20, v21
    v_cvt_pk_bf16_f32 v131, v22, v23
    v_cvt_pk_bf16_f32 v132, v24, v25
    v_cvt_pk_bf16_f32 v133, v26, v27
    v_cvt_pk_bf16_f32 v134, v28, v29
    v_cvt_pk_bf16_f32 v135, v30, v31
    v_cvt_pk_bf16_f32 v136, v32, v33
    v_cvt_pk_bf16_f32 v137, v34, v35
    v_cvt_pk_bf16_f32 v138, v36, v37
    v_cvt_pk_bf16_f32 v139, v38, v39
    v_cvt_pk_bf16_f32 v140, v40, v41
    v_cvt_pk_bf16_f32 v141, v42, v43
    v_cvt_pk_bf16_f32 v142, v44, v45
    v_cvt_pk_bf16_f32 v143, v46, v47
    s_waitcnt vmcnt(0)
    s_barrier
    ds_read_b64_tr_b16 v[48:49], v12 offset:0
    ds_read_b64_tr_b16 v[50:51], v12 offset:1024
    ds_read_b64_tr_b16 v[52:53], v12 offset:512
    ds_read_b64_tr_b16 v[54:55], v12 offset:1536
    ds_read_b64_tr_b16 v[56:57], v12 offset:2048
    ds_read_b64_tr_b16 v[58:59], v12 offset:3072
    ds_read_b64_tr_b16 v[60:61], v12 offset:2560
    ds_read_b64_tr_b16 v[62:63], v12 offset:3584
    ds_read_b64_tr_b16 v[64:65], v12 offset:4096
    ds_read_b64_tr_b16 v[66:67], v12 offset:5120
    ds_read_b64_tr_b16 v[68:69], v12 offset:4608
    ds_read_b64_tr_b16 v[70:71], v12 offset:5632
    s_waitcnt lgkmcnt(8)
    v_mfma_f32_32x32x16_bf16 v[16:31], v[48:51], a[0:3], 0
    v_mfma_f32_32x32x16_bf16 v[32:47], v[52:55], a[0:3], 0
    s_add_u32 s17, s29, 0
    s_mov_b32 m0, s17
    s_add_u32 s18, s32, 0
    buffer_load_dwordx4 v5, s[12:15], s18 offen lds
    ds_read_b64_tr_b16 v[48:49], v12 offset:6144
    ds_read_b64_tr_b16 v[50:51], v12 offset:7168
    ds_read_b64_tr_b16 v[52:53], v12 offset:6656
    ds_read_b64_tr_b16 v[54:55], v12 offset:7680
    s_waitcnt lgkmcnt(8)
    v_mfma_f32_32x32x16_bf16 v[16:31], v[56:59], a[4:7], v[16:31]
    v_mfma_f32_32x32x16_bf16 v[32:47], v[60:63], a[4:7], v[32:47]
    ds_read_b64_tr_b16 v[56:57], v12 offset:8192
    ds_read_b64_tr_b16 v[58:59], v12 offset:9216
    ds_read_b64_tr_b16 v[60:61], v12 offset:8704
    ds_read_b64_tr_b16 v[62:63], v12 offset:9728
    s_waitcnt lgkmcnt(8)
    v_mfma_f32_32x32x16_bf16 v[16:31], v[64:67], a[8:11], v[16:31]
    v_mfma_f32_32x32x16_bf16 v[32:47], v[68:71], a[8:11], v[32:47]
    ds_read_b64_tr_b16 v[64:65], v12 offset:10240
    ds_read_b64_tr_b16 v[66:67], v12 offset:11264
    ds_read_b64_tr_b16 v[68:69], v12 offset:10752
    ds_read_b64_tr_b16 v[70:71], v12 offset:11776
    s_waitcnt lgkmcnt(8)
    v_mfma_f32_32x32x16_bf16 v[16:31], v[48:51], a[12:15], v[16:31]
    v_mfma_f32_32x32x16_bf16 v[32:47], v[52:55], a[12:15], v[32:47]
    s_add_u32 s17, s29, 1024
    s_mov_b32 m0, s17
    s_add_u32 s18, s32, 7168
    buffer_load_dwordx4 v5, s[12:15], s18 offen lds
    ds_read_b64_tr_b16 v[48:49], v12 offset:12288
    ds_read_b64_tr_b16 v[50:51], v12 offset:13312
    ds_read_b64_tr_b16 v[52:53], v12 offset:12800
    ds_read_b64_tr_b16 v[54:55], v12 offset:13824
    s_waitcnt lgkmcnt(8)
    v_mfma_f32_32x32x16_bf16 v[16:31], v[56:59], a[16:19], v[16:31]
    v_mfma_f32_32x32x16_bf16 v[32:47], v[60:63], a[16:19], v[32:47]
    ds_read_b64_tr_b16 v[56:57], v12 offset:14336
    ds_read_b64_tr_b16 v[58:59], v12 offset:15360
    ds_read_b64_tr_b16 v[60:61], v12 offset:14848
    ds_read_b64_tr_b16 v[62:63], v12 offset:15872
    s_waitcnt lgkmcnt(8)
    v_mfma_f32_32x32x16_bf16 v[16:31], v[64:67], a[20:23], v[16:31]
    v_mfma_f32_32x32x16_bf16 v[32:47], v[68:71], a[20:23], v[32:47]
    ds_read_b64_tr_b16 v[64:65], v12 offset:16384
    ds_read_b64_tr_b16 v[66:67], v12 offset:17408
    ds_read_b64_tr_b16 v[68:69], v12 offset:16896
    ds_read_b64_tr_b16 v[70:71], v12 offset:17920
    s_waitcnt lgkmcnt(8)
    v_mfma_f32_32x32x16_bf16 v[16:31], v[48:51], a[24:27], v[16:31]
    v_mfma_f32_32x32x16_bf16 v[32:47], v[52:55], a[24:27], v[32:47]
    s_add_u32 s17, s29, 2048
    s_mov_b32 m0, s17
    s_add_u32 s18, s32, 14336
    buffer_load_dwordx4 v5, s[12:15], s18 offen lds
    ds_read_b64_tr_b16 v[48:49], v12 offset:18432
    ds_read_b64_tr_b16 v[50:51], v12 offset:19456
    ds_read_b64_tr_b16 v[52:53], v12 offset:18944
    ds_read_b64_tr_b16 v[54:55], v12 offset:19968
    s_waitcnt lgkmcnt(8)
    v_mfma_f32_32x32x16_bf16 v[16:31], v[56:59], a[28:31], v[16:31]
    v_mfma_f32_32x32x16_bf16 v[32:47], v[60:63], a[28:31], v[32:47]
    ds_read_b64_tr_b16 v[56:57], v12 offset:20480
    ds_read_b64_tr_b16 v[58:59], v12 offset:21504
    ds_read_b64_tr_b16 v[60:61], v12 offset:20992
    ds_read_b64_tr_b16 v[62:63], v12 offset:22016
    s_waitcnt lgkmcnt(8)
    v_mfma_f32_32x32x16_bf16 v[16:31], v[64:67], a[32:35], v[16:31]
    v_mfma_f32_32x32x16_bf16 v[32:47], v[68:71], a[32:35], v[32:47]
    ds_read_b64_tr_b16 v[64:65], v12 offset:22528
    ds_read_b64_tr_b16 v[66:67], v12 offset:23552
    ds_read_b64_tr_b16 v[68:69], v12 offset:23040
    ds_read_b64_tr_b16 v[70:71], v12 offset:24064
    s_waitcnt lgkmcnt(8)
    v_mfma_f32_32x32x16_bf16 v[16:31], v[48:51], a[36:39], v[16:31]
    v_mfma_f32_32x32x16_bf16 v[32:47], v[52:55], a[36:39], v[32:47]
    s_add_u32 s17, s29, 3072
    s_mov_b32 m0, s17
    s_add_u32 s18, s32, 21504
    buffer_load_dwordx4 v5, s[12:15], s18 offen lds
    ds_read_b64_tr_b16 v[48:49], v12 offset:24576
    ds_read_b64_tr_b16 v[50:51], v12 offset:25600
    ds_read_b64_tr_b16 v[52:53], v12 offset:25088
    ds_read_b64_tr_b16 v[54:55], v12 offset:26112
    s_waitcnt lgkmcnt(8)
    v_mfma_f32_32x32x16_bf16 v[16:31], v[56:59], a[40:43], v[16:31]
    v_mfma_f32_32x32x16_bf16 v[32:47], v[60:63], a[40:43], v[32:47]
    ds_read_b64_tr_b16 v[56:57], v12 offset:26624
    ds_read_b64_tr_b16 v[58:59], v12 offset:27648
    ds_read_b64_tr_b16 v[60:61], v12 offset:27136
    ds_read_b64_tr_b16 v[62:63], v12 offset:28160
    s_waitcnt lgkmcnt(8)
    v_mfma_f32_32x32x16_bf16 v[16:31], v[64:67], a[44:47], v[16:31]
    v_mfma_f32_32x32x16_bf16 v[32:47], v[68:71], a[44:47], v[32:47]
    ds_read_b64_tr_b16 v[64:65], v12 offset:28672
    ds_read_b64_tr_b16 v[66:67], v12 offset:29696
    ds_read_b64_tr_b16 v[68:69], v12 offset:29184
    ds_read_b64_tr_b16 v[70:71], v12 offset:30208
    s_waitcnt lgkmcnt(8)
    v_mfma_f32_32x32x16_bf16 v[16:31], v[48:51], a[48:51], v[16:31]
    v_mfma_f32_32x32x16_bf16 v[32:47], v[52:55], a[48:51], v[32:47]
    s_add_u32 s17, s29, 4096
    s_mov_b32 m0, s17
    s_add_u32 s18, s32, 28672
    buffer_load_dwordx4 v5, s[12:15], s18 offen lds
    ds_read_b64_tr_b16 v[48:49], v12 offset:30720
    ds_read_b64_tr_b16 v[50:51], v12 offset:31744
    ds_read_b64_tr_b16 v[52:53], v12 offset:31232
    ds_read_b64_tr_b16 v[54:55], v12 offset:32256
    s_waitcnt lgkmcnt(8)
    v_mfma_f32_32x32x16_bf16 v[16:31], v[56:59], a[52:55], v[16:31]
    v_mfma_f32_32x32x16_bf16 v[32:47], v[60:63], a[52:55], v[32:47]
    ds_read_b64_tr_b16 v[56:57], v12 offset:32768
    ds_read_b64_tr_b16 v[58:59], v12 offset:33792
    ds_read_b64_tr_b16 v[60:61], v12 offset:33280
    ds_read_b64_tr_b16 v[62:63], v12 offset:34304
    s_waitcnt lgkmcnt(8)
    v_mfma_f32_32x32x16_bf16 v[16:31], v[64:67], a[56:59], v[16:31]
    v_mfma_f32_32x32x16_bf16 v[32:47], v[68:71], a[56:59], v[32:47]
    ds_read_b64_tr_b16 v[64:65], v12 offset:34816
    ds_read_b64_tr_b16 v[66:67], v12 offset:35840
    ds_read_b64_tr_b16 v[68:69], v12 offset:35328
    ds_read_b64_tr_b16 v[70:71], v12 offset:36352
    s_waitcnt lgkmcnt(8)
    v_mfma_f32_32x32x16_bf16 v[16:31], v[48:51], a[60:63], v[16:31]
    v_mfma_f32_32x32x16_bf16 v[32:47], v[52:55], a[60:63], v[32:47]
    s_add_u32 s17, s29, 5120
    s_mov_b32 m0, s17
    s_add_u32 s18, s32, 35840
    buffer_load_dwordx4 v5, s[12:15], s18 offen lds
    ds_read_b64_tr_b16 v[48:49], v12 offset:36864
    ds_read_b64_tr_b16 v[50:51], v12 offset:37888
    ds_read_b64_tr_b16 v[52:53], v12 offset:37376
    ds_read_b64_tr_b16 v[54:55], v12 offset:38400
    s_waitcnt lgkmcnt(8)
    v_mfma_f32_32x32x16_bf16 v[16:31], v[56:59], a[64:67], v[16:31]
    v_mfma_f32_32x32x16_bf16 v[32:47], v[60:63], a[64:67], v[32:47]
    ds_read_b64_tr_b16 v[56:57], v12 offset:38912
    ds_read_b64_tr_b16 v[58:59], v12 offset:39936
    ds_read_b64_tr_b16 v[60:61], v12 offset:39424
    ds_read_b64_tr_b16 v[62:63], v12 offset:40448
    s_waitcnt lgkmcnt(8)
    v_mfma_f32_32x32x16_bf16 v[16:31], v[64:67], a[68:71], v[16:31]
    v_mfma_f32_32x32x16_bf16 v[32:47], v[68:71], a[68:71], v[32:47]
    ds_read_b64_tr_b16 v[64:65], v12 offset:40960
    ds_read_b64_tr_b16 v[66:67], v12 offset:41984
    ds_read_b64_tr_b16 v[68:69], v12 offset:41472
    ds_read_b64_tr_b16 v[70:71], v12 offset:42496
    s_waitcnt lgkmcnt(8)
    v_mfma_f32_32x32x16_bf16 v[16:31], v[48:51], a[72:75], v[16:31]
    v_mfma_f32_32x32x16_bf16 v[32:47], v[52:55], a[72:75], v[32:47]
    s_add_u32 s17, s29, 6144
    s_mov_b32 m0, s17
    s_add_u32 s18, s32, 43008
    buffer_load_dwordx4 v5, s[12:15], s18 offen lds
    ds_read_b64_tr_b16 v[48:49], v12 offset:43008
    ds_read_b64_tr_b16 v[50:51], v12 offset:44032
    ds_read_b64_tr_b16 v[52:53], v12 offset:43520
    ds_read_b64_tr_b16 v[54:55], v12 offset:44544
    s_waitcnt lgkmcnt(8)
    v_mfma_f32_32x32x16_bf16 v[16:31], v[56:59], a[76:79], v[16:31]
    v_mfma_f32_32x32x16_bf16 v[32:47], v[60:63], a[76:79], v[32:47]
    ds_read_b64_tr_b16 v[56:57], v12 offset:45056
    ds_read_b64_tr_b16 v[58:59], v12 offset:46080
    ds_read_b64_tr_b16 v[60:61], v12 offset:45568
    ds_read_b64_tr_b16 v[62:63], v12 offset:46592
    s_waitcnt lgkmcnt(8)
    v_mfma_f32_32x32x16_bf16 v[16:31], v[64:67], a[80:83], v[16:31]
    v_mfma_f32_32x32x16_bf16 v[32:47], v[68:71], a[80:83], v[32:47]
    ds_read_b64_tr_b16 v[64:65], v12 offset:47104
    ds_read_b64_tr_b16 v[66:67], v12 offset:48128
    ds_read_b64_tr_b16 v[68:69], v12 offset:47616
    ds_read_b64_tr_b16 v[70:71], v12 offset:48640
    s_waitcnt lgkmcnt(8)
    v_mfma_f32_32x32x16_bf16 v[16:31], v[48:51], a[84:87], v[16:31]
    v_mfma_f32_32x32x16_bf16 v[32:47], v[52:55], a[84:87], v[32:47]
    s_add_u32 s17, s29, 7168
    s_mov_b32 m0, s17
    s_add_u32 s18, s32, 50176
    buffer_load_dwordx4 v5, s[12:15], s18 offen lds
    ds_read_b64_tr_b16 v[48:49], v12 offset:49152
    ds_read_b64_tr_b16 v[50:51], v12 offset:50176
    ds_read_b64_tr_b16 v[52:53], v12 offset:49664
    ds_read_b64_tr_b16 v[54:55], v12 offset:50688
    s_waitcnt lgkmcnt(8)
    v_mfma_f32_32x32x16_bf16 v[16:31], v[56:59], a[88:91], v[16:31]
    v_mfma_f32_32x32x16_bf16 v[32:47], v[60:63], a[88:91], v[32:47]
    ds_read_b64_tr_b16 v[56:57], v12 offset:51200
    ds_read_b64_tr_b16 v[58:59], v12 offset:52224
    ds_read_b64_tr_b16 v[60:61], v12 offset:51712
    ds_read_b64_tr_b16 v[62:63], v12 offset:52736
    s_waitcnt lgkmcnt(8)
    v_mfma_f32_32x32x16_bf16 v[16:31], v[64:67], a[92:95], v[16:31]
    v_mfma_f32_32x32x16_bf16 v[32:47], v[68:71], a[92:95], v[32:47]
    ds_read_b64_tr_b16 v[64:65], v12 offset:53248
    ds_read_b64_tr_b16 v[66:67], v12 offset:54272
    ds_read_b64_tr_b16 v[68:69], v12 offset:53760
    ds_read_b64_tr_b16 v[70:71], v12 offset:54784
    s_waitcnt lgkmcnt(8)
    v_mfma_f32_32x32x16_bf16 v[16:31], v[48:51], a[96:99], v[16:31]
    v_mfma_f32_32x32x16_bf16 v[32:47], v[52:55], a[96:99], v[32:47]
    ds_read_b64_tr_b16 v[48:49], v12 offset:55296
    ds_read_b64_tr_b16 v[50:51], v12 offset:56320
    ds_read_b64_tr_b16 v[52:53], v12 offset:55808
    ds_read_b64_tr_b16 v[54:55], v12 offset:56832
    s_waitcnt lgkmcnt(8)
    v_mfma_f32_32x32x16_bf16 v[16:31], v[56:59], a[100:103], v[16:31]
    v_mfma_f32_32x32x16_bf16 v[32:47], v[60:63], a[100:103], v[32:47]
    s_waitcnt lgkmcnt(4)
    v_mfma_f32_32x32x16_bf16 v[16:31], v[64:67], a[104:107], v[16:31]
    v_mfma_f32_32x32x16_bf16 v[32:47], v[68:71], a[104:107], v[32:47]
    s_waitcnt lgkmcnt(0)
    v_mfma_f32_32x32x16_bf16 v[16:31], v[48:51], a[108:111], v[16:31]
    v_mfma_f32_32x32x16_bf16 v[32:47], v[52:55], a[108:111], v[32:47]
    s_nop 11
    v_cvt_pk_bf16_f32 v144, v16, v17
    v_cvt_pk_bf16_f32 v145, v18, v19
    v_cvt_pk_bf16_f32 v146, v20, v21
    v_cvt_pk_bf16_f32 v147, v22, v23
    v_cvt_pk_bf16_f32 v148, v24, v25
    v_cvt_pk_bf16_f32 v149, v26, v27
    v_cvt_pk_bf16_f32 v150, v28, v29
    v_cvt_pk_bf16_f32 v151, v30, v31
    v_cvt_pk_bf16_f32 v152, v32, v33
    v_cvt_pk_bf16_f32 v153, v34, v35
    v_cvt_pk_bf16_f32 v154, v36, v37
    v_cvt_pk_bf16_f32 v155, v38, v39
    v_cvt_pk_bf16_f32 v156, v40, v41
    v_cvt_pk_bf16_f32 v157, v42, v43
    v_cvt_pk_bf16_f32 v158, v44, v45
    v_cvt_pk_bf16_f32 v159, v46, v47
    s_lshl_b32 s30, s27, 4
    s_add_u32 s30, s30, s24
    s_mul_i32 s30, s30, 28672
    s_add_u32 s30, s30, 14684160
    s_waitcnt vmcnt(0)
    s_barrier
    ds_read_b64_tr_b16 v[48:49], v3 offset:0
    ds_read_b64_tr_b16 v[50:51], v3 offset:256
    ds_read_b64_tr_b16 v[52:53], v3 offset:512
    ds_read_b64_tr_b16 v[54:55], v3 offset:768
    ds_read_b64_tr_b16 v[56:57], v3 offset:2048
    ds_read_b64_tr_b16 v[58:59], v3 offset:2304
    ds_read_b64_tr_b16 v[60:61], v3 offset:2560
    ds_read_b64_tr_b16 v[62:63], v3 offset:2816
    ds_read_b64_tr_b16 v[64:65], v3 offset:4096
    ds_read_b64_tr_b16 v[66:67], v3 offset:4352
    ds_read_b64_tr_b16 v[68:69], v3 offset:4608
    ds_read_b64_tr_b16 v[70:71], v3 offset:4864
    s_waitcnt lgkmcnt(8)
    v_mfma_f32_32x32x16_bf16 v[16:31], v[96:99], v[48:51], 0
    v_mfma_f32_32x32x16_bf16 v[32:47], v[96:99], v[52:55], 0
    s_add_u32 s17, s29, 57344
    s_mov_b32 m0, s17
    s_add_u32 s18, s32, 128
    buffer_load_dwordx4 v5, s[12:15], s18 offen lds
    ds_read_b64_tr_b16 v[48:49], v3 offset:6144
    ds_read_b64_tr_b16 v[50:51], v3 offset:6400
    ds_read_b64_tr_b16 v[52:53], v3 offset:6656
    ds_read_b64_tr_b16 v[54:55], v3 offset:6912
    s_waitcnt lgkmcnt(8)
    v_mfma_f32_32x32x16_bf16 v[16:31], v[100:103], v[56:59], v[16:31]
    v_mfma_f32_32x32x16_bf16 v[32:47], v[100:103], v[60:63], v[32:47]
    ds_read_b64_tr_b16 v[56:57], v3 offset:8192
    ds_read_b64_tr_b16 v[58:59], v3 offset:8448
    ds_read_b64_tr_b16 v[60:61], v3 offset:8704
    ds_read_b64_tr_b16 v[62:63], v3 offset:8960
    s_waitcnt lgkmcnt(8)
    v_mfma_f32_32x32x16_bf16 v[16:31], v[104:107], v[64:67], v[16:31]
    v_mfma_f32_32x32x16_bf16 v[32:47], v[104:107], v[68:71], v[32:47]
    s_add_u32 s17, s29, 58368
    s_mov_b32 m0, s17
    s_add_u32 s18, s32, 7296
    buffer_load_dwordx4 v5, s[12:15], s18 offen lds
    ds_read_b64_tr_b16 v[64:65], v3 offset:10240
    ds_read_b64_tr_b16 v[66:67], v3 offset:10496
    ds_read_b64_tr_b16 v[68:69], v3 offset:10752
    ds_read_b64_tr_b16 v[70:71], v3 offset:11008
    s_waitcnt lgkmcnt(8)
    v_mfma_f32_32x32x16_bf16 v[16:31], v[108:111], v[48:51], v[16:31]
    v_mfma_f32_32x32x16_bf16 v[32:47], v[108:111], v[52:55], v[32:47]
    ds_read_b64_tr_b16 v[48:49], v3 offset:12288
    ds_read_b64_tr_b16 v[50:51], v3 offset:12544
    ds_read_b64_tr_b16 v[52:53], v3 offset:12800
    ds_read_b64_tr_b16 v[54:55], v3 offset:13056
    s_waitcnt lgkmcnt(8)
    v_mfma_f32_32x32x16_bf16 v[16:31], v[112:115], v[56:59], v[16:31]
    v_mfma_f32_32x32x16_bf16 v[32:47], v[112:115], v[60:63], v[32:47]
    s_add_u32 s17, s29, 59392
    s_mov_b32 m0, s17
    s_add_u32 s18, s32, 14464
    buffer_load_dwordx4 v5, s[12:15], s18 offen lds
    ds_read_b64_tr_b16 v[56:57], v3 offset:14336
    ds_read_b64_tr_b16 v[58:59], v3 offset:14592
    ds_read_b64_tr_b16 v[60:61], v3 offset:14848
    ds_read_b64_tr_b16 v[62:63], v3 offset:15104
    s_waitcnt lgkmcnt(8)
    v_mfma_f32_32x32x16_bf16 v[16:31], v[116:119], v[64:67], v[16:31]
    v_mfma_f32_32x32x16_bf16 v[32:47], v[116:119], v[68:71], v[32:47]
    ds_read_b64_tr_b16 v[64:65], v3 offset:16384
    ds_read_b64_tr_b16 v[66:67], v3 offset:16640
    ds_read_b64_tr_b16 v[68:69], v3 offset:16896
    ds_read_b64_tr_b16 v[70:71], v3 offset:17152
    s_waitcnt lgkmcnt(8)
    v_mfma_f32_32x32x16_bf16 v[16:31], v[120:123], v[48:51], v[16:31]
    v_mfma_f32_32x32x16_bf16 v[32:47], v[120:123], v[52:55], v[32:47]
    s_add_u32 s17, s29, 60416
    s_mov_b32 m0, s17
    s_add_u32 s18, s32, 21632
    buffer_load_dwordx4 v5, s[12:15], s18 offen lds
    ds_read_b64_tr_b16 v[48:49], v3 offset:18432
    ds_read_b64_tr_b16 v[50:51], v3 offset:18688
    ds_read_b64_tr_b16 v[52:53], v3 offset:18944
    ds_read_b64_tr_b16 v[54:55], v3 offset:19200
    s_waitcnt lgkmcnt(8)
    v_mfma_f32_32x32x16_bf16 v[16:31], v[124:127], v[56:59], v[16:31]
    v_mfma_f32_32x32x16_bf16 v[32:47], v[124:127], v[60:63], v[32:47]
    ds_read_b64_tr_b16 v[56:57], v3 offset:20480
    ds_read_b64_tr_b16 v[58:59], v3 offset:20736
    ds_read_b64_tr_b16 v[60:61], v3 offset:20992
    ds_read_b64_tr_b16 v[62:63], v3 offset:21248
    s_waitcnt lgkmcnt(8)
    v_mfma_f32_32x32x16_bf16 v[16:31], v[128:131], v[64:67], v[16:31]
    v_mfma_f32_32x32x16_bf16 v[32:47], v[128:131], v[68:71], v[32:47]
    s_add_u32 s17, s29, 61440
    s_mov_b32 m0, s17
    s_add_u32 s18, s32, 28800
    buffer_load_dwordx4 v5, s[12:15], s18 offen lds
    ds_read_b64_tr_b16 v[64:65], v3 offset:22528
    ds_read_b64_tr_b16 v[66:67], v3 offset:22784
    ds_read_b64_tr_b16 v[68:69], v3 offset:23040
    ds_read_b64_tr_b16 v[70:71], v3 offset:23296
    s_waitcnt lgkmcnt(8)
    v_mfma_f32_32x32x16_bf16 v[16:31], v[132:135], v[48:51], v[16:31]
    v_mfma_f32_32x32x16_bf16 v[32:47], v[132:135], v[52:55], v[32:47]
    ds_read_b64_tr_b16 v[48:49], v3 offset:24576
    ds_read_b64_tr_b16 v[50:51], v3 offset:24832
    ds_read_b64_tr_b16 v[52:53], v3 offset:25088
    ds_read_b64_tr_b16 v[54:55], v3 offset:25344
    s_waitcnt lgkmcnt(8)
    v_mfma_f32_32x32x16_bf16 v[16:31], v[136:139], v[56:59], v[16:31]
    v_mfma_f32_32x32x16_bf16 v[32:47], v[136:139], v[60:63], v[32:47]
    s_add_u32 s17, s29, 62464
    s_mov_b32 m0, s17
    s_add_u32 s18, s32, 35968
    buffer_load_dwordx4 v5, s[12:15], s18 offen lds
    ds_read_b64_tr_b16 v[56:57], v3 offset:26624
    ds_read_b64_tr_b16 v[58:59], v3 offset:26880
    ds_read_b64_tr_b16 v[60:61], v3 offset:27136
    ds_read_b64_tr_b16 v[62:63], v3 offset:27392
    s_waitcnt lgkmcnt(8)
    v_mfma_f32_32x32x16_bf16 v[16:31], v[140:143], v[64:67], v[16:31]
    v_mfma_f32_32x32x16_bf16 v[32:47], v[140:143], v[68:71], v[32:47]
    ds_read_b64_tr_b16 v[64:65], v3 offset:28672
    ds_read_b64_tr_b16 v[66:67], v3 offset:28928
    ds_read_b64_tr_b16 v[68:69], v3 offset:29184
    ds_read_b64_tr_b16 v[70:71], v3 offset:29440
    s_waitcnt lgkmcnt(8)
    v_mfma_f32_32x32x16_bf16 v[16:31], v[144:147], v[48:51], v[16:31]
    v_mfma_f32_32x32x16_bf16 v[32:47], v[144:147], v[52:55], v[32:47]
    s_add_u32 s17, s29, 63488
    s_mov_b32 m0, s17
    s_add_u32 s18, s32, 43136
    buffer_load_dwordx4 v5, s[12:15], s18 offen lds
    ds_read_b64_tr_b16 v[48:49], v3 offset:30720
    ds_read_b64_tr_b16 v[50:51], v3 offset:30976
    ds_read_b64_tr_b16 v[52:53], v3 offset:31232
    ds_read_b64_tr_b16 v[54:55], v3 offset:31488
    s_waitcnt lgkmcnt(8)
    v_mfma_f32_32x32x16_bf16 v[16:31], v[148:151], v[56:59], v[16:31]
    v_mfma_f32_32x32x16_bf16 v[32:47], v[148:151], v[60:63], v[32:47]
    s_waitcnt lgkmcnt(4)
    v_mfma_f32_32x32x16_bf16 v[16:31], v[152:155], v[64:67], v[16:31]
    v_mfma_f32_32x32x16_bf16 v[32:47], v[152:155], v[68:71], v[32:47]
    s_add_u32 s17, s29, 64512
    s_mov_b32 m0, s17
    s_add_u32 s18, s32, 50304
    buffer_load_dwordx4 v5, s[12:15], s18 offen lds
    s_waitcnt lgkmcnt(0)
    v_mfma_f32_32x32x16_bf16 v[16:31], v[156:159], v[48:51], v[16:31]
    v_mfma_f32_32x32x16_bf16 v[32:47], v[156:159], v[52:55], v[32:47]
    s_nop 11
    v_cvt_pk_bf16_f32 v72, v16, v17
    v_cvt_pk_bf16_f32 v73, v18, v19
    v_cvt_pk_bf16_f32 v74, v20, v21
    v_cvt_pk_bf16_f32 v75, v22, v23
    v_cvt_pk_bf16_f32 v76, v24, v25
    v_cvt_pk_bf16_f32 v77, v26, v27
    v_cvt_pk_bf16_f32 v78, v28, v29
    v_cvt_pk_bf16_f32 v79, v30, v31
    v_cvt_pk_bf16_f32 v80, v32, v33
    v_cvt_pk_bf16_f32 v81, v34, v35
    v_cvt_pk_bf16_f32 v82, v36, v37
    v_cvt_pk_bf16_f32 v83, v38, v39
    v_cvt_pk_bf16_f32 v84, v40, v41
    v_cvt_pk_bf16_f32 v85, v42, v43
    v_cvt_pk_bf16_f32 v86, v44, v45
    v_cvt_pk_bf16_f32 v87, v46, v47
    buffer_store_dwordx4 v[72:75], v7, s[4:7], s30 offen offset:0 sc1
    buffer_store_dwordx4 v[76:79], v7, s[4:7], s30 offen offset:512 sc1
    buffer_store_dwordx4 v[80:83], v7, s[4:7], s30 offen offset:2048 sc1
    buffer_store_dwordx4 v[84:87], v7, s[4:7], s30 offen offset:2560 sc1
    s_add_u32 s30, s30, 4096
    s_waitcnt vmcnt(4)
    s_barrier
    ds_read_b64_tr_b16 v[48:49], v13 offset:0
    ds_read_b64_tr_b16 v[50:51], v13 offset:256
    ds_read_b64_tr_b16 v[52:53], v13 offset:512
    ds_read_b64_tr_b16 v[54:55], v13 offset:768
    ds_read_b64_tr_b16 v[56:57], v13 offset:2048
    ds_read_b64_tr_b16 v[58:59], v13 offset:2304
    ds_read_b64_tr_b16 v[60:61], v13 offset:2560
    ds_read_b64_tr_b16 v[62:63], v13 offset:2816
    ds_read_b64_tr_b16 v[64:65], v13 offset:4096
    ds_read_b64_tr_b16 v[66:67], v13 offset:4352
    ds_read_b64_tr_b16 v[68:69], v13 offset:4608
    ds_read_b64_tr_b16 v[70:71], v13 offset:4864
    s_waitcnt lgkmcnt(8)
    v_mfma_f32_32x32x16_bf16 v[16:31], v[96:99], v[48:51], 0
    v_mfma_f32_32x32x16_bf16 v[32:47], v[96:99], v[52:55], 0
    s_add_u32 s17, s29, 0
    s_mov_b32 m0, s17
    s_add_u32 s18, s32, 256
    buffer_load_dwordx4 v5, s[12:15], s18 offen lds
    ds_read_b64_tr_b16 v[48:49], v13 offset:6144
    ds_read_b64_tr_b16 v[50:51], v13 offset:6400
    ds_read_b64_tr_b16 v[52:53], v13 offset:6656
    ds_read_b64_tr_b16 v[54:55], v13 offset:6912
    s_waitcnt lgkmcnt(8)
    v_mfma_f32_32x32x16_bf16 v[16:31], v[100:103], v[56:59], v[16:31]
    v_mfma_f32_32x32x16_bf16 v[32:47], v[100:103], v[60:63], v[32:47]
    ds_read_b64_tr_b16 v[56:57], v13 offset:8192
    ds_read_b64_tr_b16 v[58:59], v13 offset:8448
    ds_read_b64_tr_b16 v[60:61], v13 offset:8704
    ds_read_b64_tr_b16 v[62:63], v13 offset:8960
    s_waitcnt lgkmcnt(8)
    v_mfma_f32_32x32x16_bf16 v[16:31], v[104:107], v[64:67], v[16:31]
    v_mfma_f32_32x32x16_bf16 v[32:47], v[104:107], v[68:71], v[32:47]
    s_add_u32 s17, s29, 1024
    s_mov_b32 m0, s17
    s_add_u32 s18, s32, 7424
    buffer_load_dwordx4 v5, s[12:15], s18 offen lds
    ds_read_b64_tr_b16 v[64:65], v13 offset:10240
    ds_read_b64_tr_b16 v[66:67], v13 offset:10496
    ds_read_b64_tr_b16 v[68:69], v13 offset:10752
    ds_read_b64_tr_b16 v[70:71], v13 offset:11008
    s_waitcnt lgkmcnt(8)
    v_mfma_f32_32x32x16_bf16 v[16:31], v[108:111], v[48:51], v[16:31]
    v_mfma_f32_32x32x16_bf16 v[32:47], v[108:111], v[52:55], v[32:47]
    ds_read_b64_tr_b16 v[48:49], v13 offset:12288
    ds_read_b64_tr_b16 v[50:51], v13 offset:12544
    ds_read_b64_tr_b16 v[52:53], v13 offset:12800
    ds_read_b64_tr_b16 v[54:55], v13 offset:13056
    s_waitcnt lgkmcnt(8)
    v_mfma_f32_32x32x16_bf16 v[16:31], v[112:115], v[56:59], v[16:31]
    v_mfma_f32_32x32x16_bf16 v[32:47], v[112:115], v[60:63], v[32:47]
    s_add_u32 s17, s29, 2048
    s_mov_b32 m0, s17
    s_add_u32 s18, s32, 14592
    buffer_load_dwordx4 v5, s[12:15], s18 offen lds
    ds_read_b64_tr_b16 v[56:57], v13 offset:14336
    ds_read_b64_tr_b16 v[58:59], v13 offset:14592
    ds_read_b64_tr_b16 v[60:61], v13 offset:14848
    ds_read_b64_tr_b16 v[62:63], v13 offset:15104
    s_waitcnt lgkmcnt(8)
    v_mfma_f32_32x32x16_bf16 v[16:31], v[116:119], v[64:67], v[16:31]
    v_mfma_f32_32x32x16_bf16 v[32:47], v[116:119], v[68:71], v[32:47]
    ds_read_b64_tr_b16 v[64:65], v13 offset:16384
    ds_read_b64_tr_b16 v[66:67], v13 offset:16640
    ds_read_b64_tr_b16 v[68:69], v13 offset:16896
    ds_read_b64_tr_b16 v[70:71], v13 offset:17152
    s_waitcnt lgkmcnt(8)
    v_mfma_f32_32x32x16_bf16 v[16:31], v[120:123], v[48:51], v[16:31]
    v_mfma_f32_32x32x16_bf16 v[32:47], v[120:123], v[52:55], v[32:47]
    s_add_u32 s17, s29, 3072
    s_mov_b32 m0, s17
    s_add_u32 s18, s32, 21760
    buffer_load_dwordx4 v5, s[12:15], s18 offen lds
    ds_read_b64_tr_b16 v[48:49], v13 offset:18432
    ds_read_b64_tr_b16 v[50:51], v13 offset:18688
    ds_read_b64_tr_b16 v[52:53], v13 offset:18944
    ds_read_b64_tr_b16 v[54:55], v13 offset:19200
    s_waitcnt lgkmcnt(8)
    v_mfma_f32_32x32x16_bf16 v[16:31], v[124:127], v[56:59], v[16:31]
    v_mfma_f32_32x32x16_bf16 v[32:47], v[124:127], v[60:63], v[32:47]
    ds_read_b64_tr_b16 v[56:57], v13 offset:20480
    ds_read_b64_tr_b16 v[58:59], v13 offset:20736
    ds_read_b64_tr_b16 v[60:61], v13 offset:20992
    ds_read_b64_tr_b16 v[62:63], v13 offset:21248
    s_waitcnt lgkmcnt(8)
    v_mfma_f32_32x32x16_bf16 v[16:31], v[128:131], v[64:67], v[16:31]
    v_mfma_f32_32x32x16_bf16 v[32:47], v[128:131], v[68:71], v[32:47]
    s_add_u32 s17, s29, 4096
    s_mov_b32 m0, s17
    s_add_u32 s18, s32, 28928
    buffer_load_dwordx4 v5, s[12:15], s18 offen lds
    ds_read_b64_tr_b16 v[64:65], v13 offset:22528
    ds_read_b64_tr_b16 v[66:67], v13 offset:22784
    ds_read_b64_tr_b16 v[68:69], v13 offset:23040
    ds_read_b64_tr_b16 v[70:71], v13 offset:23296
    s_waitcnt lgkmcnt(8)
    v_mfma_f32_32x32x16_bf16 v[16:31], v[132:135], v[48:51], v[16:31]
    v_mfma_f32_32x32x16_bf16 v[32:47], v[132:135], v[52:55], v[32:47]
    ds_read_b64_tr_b16 v[48:49], v13 offset:24576
    ds_read_b64_tr_b16 v[50:51], v13 offset:24832
    ds_read_b64_tr_b16 v[52:53], v13 offset:25088
    ds_read_b64_tr_b16 v[54:55], v13 offset:25344
    s_waitcnt lgkmcnt(8)
    v_mfma_f32_32x32x16_bf16 v[16:31], v[136:139], v[56:59], v[16:31]
    v_mfma_f32_32x32x16_bf16 v[32:47], v[136:139], v[60:63], v[32:47]
    s_add_u32 s17, s29, 5120
    s_mov_b32 m0, s17
    s_add_u32 s18, s32, 36096
    buffer_load_dwordx4 v5, s[12:15], s18 offen lds
    ds_read_b64_tr_b16 v[56:57], v13 offset:26624
    ds_read_b64_tr_b16 v[58:59], v13 offset:26880
    ds_read_b64_tr_b16 v[60:61], v13 offset:27136
    ds_read_b64_tr_b16 v[62:63], v13 offset:27392
    s_waitcnt lgkmcnt(8)
    v_mfma_f32_32x32x16_bf16 v[16:31], v[140:143], v[64:67], v[16:31]
    v_mfma_f32_32x32x16_bf16 v[32:47], v[140:143], v[68:71], v[32:47]
    ds_read_b64_tr_b16 v[64:65], v13 offset:28672
    ds_read_b64_tr_b16 v[66:67], v13 offset:28928
    ds_read_b64_tr_b16 v[68:69], v13 offset:29184
    ds_read_b64_tr_b16 v[70:71], v13 offset:29440
    s_waitcnt lgkmcnt(8)
    v_mfma_f32_32x32x16_bf16 v[16:31], v[144:147], v[48:51], v[16:31]
    v_mfma_f32_32x32x16_bf16 v[32:47], v[144:147], v[52:55], v[32:47]
    s_add_u32 s17, s29, 6144
    s_mov_b32 m0, s17
    s_add_u32 s18, s32, 43264
    buffer_load_dwordx4 v5, s[12:15], s18 offen lds
    ds_read_b64_tr_b16 v[48:49], v13 offset:30720
    ds_read_b64_tr_b16 v[50:51], v13 offset:30976
    ds_read_b64_tr_b16 v[52:53], v13 offset:31232
    ds_read_b64_tr_b16 v[54:55], v13 offset:31488
    s_waitcnt lgkmcnt(8)
    v_mfma_f32_32x32x16_bf16 v[16:31], v[148:151], v[56:59], v[16:31]
    v_mfma_f32_32x32x16_bf16 v[32:47], v[148:151], v[60:63], v[32:47]
    s_waitcnt lgkmcnt(4)
    v_mfma_f32_32x32x16_bf16 v[16:31], v[152:155], v[64:67], v[16:31]
    v_mfma_f32_32x32x16_bf16 v[32:47], v[152:155], v[68:71], v[32:47]
    s_add_u32 s17, s29, 7168
    s_mov_b32 m0, s17
    s_add_u32 s18, s32, 50432
    buffer_load_dwordx4 v5, s[12:15], s18 offen lds
    s_waitcnt lgkmcnt(0)
    v_mfma_f32_32x32x16_bf16 v[16:31], v[156:159], v[48:51], v[16:31]
    v_mfma_f32_32x32x16_bf16 v[32:47], v[156:159], v[52:55], v[32:47]
    s_nop 11
    v_cvt_pk_bf16_f32 v72, v16, v17
    v_cvt_pk_bf16_f32 v73, v18, v19
    v_cvt_pk_bf16_f32 v74, v20, v21
    v_cvt_pk_bf16_f32 v75, v22, v23
    v_cvt_pk_bf16_f32 v76, v24, v25
    v_cvt_pk_bf16_f32 v77, v26, v27
    v_cvt_pk_bf16_f32 v78, v28, v29
    v_cvt_pk_bf16_f32 v79, v30, v31
    v_cvt_pk_bf16_f32 v80, v32, v33
    v_cvt_pk_bf16_f32 v81, v34, v35
    v_cvt_pk_bf16_f32 v82, v36, v37
    v_cvt_pk_bf16_f32 v83, v38, v39
    v_cvt_pk_bf16_f32 v84, v40, v41
    v_cvt_pk_bf16_f32 v85, v42, v43
    v_cvt_pk_bf16_f32 v86, v44, v45
    v_cvt_pk_bf16_f32 v87, v46, v47
    buffer_store_dwordx4 v[72:75], v7, s[4:7], s30 offen offset:0 sc1
    buffer_store_dwordx4 v[76:79], v7, s[4:7], s30 offen offset:512 sc1
    buffer_store_dwordx4 v[80:83], v7, s[4:7], s30 offen offset:2048 sc1
    buffer_store_dwordx4 v[84:87], v7, s[4:7], s30 offen offset:2560 sc1
    s_add_u32 s30, s30, 4096
    s_waitcnt vmcnt(4)
    s_barrier
    ds_read_b64_tr_b16 v[48:49], v3 offset:0
    ds_read_b64_tr_b16 v[50:51], v3 offset:256
    ds_read_b64_tr_b16 v[52:53], v3 offset:512
    ds_read_b64_tr_b16 v[54:55], v3 offset:768
    ds_read_b64_tr_b16 v[56:57], v3 offset:2048
    ds_read_b64_tr_b16 v[58:59], v3 offset:2304
    ds_read_b64_tr_b16 v[60:61], v3 offset:2560
    ds_read_b64_tr_b16 v[62:63], v3 offset:2816
    ds_read_b64_tr_b16 v[64:65], v3 offset:4096
    ds_read_b64_tr_b16 v[66:67], v3 offset:4352
    ds_read_b64_tr_b16 v[68:69], v3 offset:4608
    ds_read_b64_tr_b16 v[70:71], v3 offset:4864
    s_waitcnt lgkmcnt(8)
    v_mfma_f32_32x32x16_bf16 v[16:31], v[96:99], v[48:51], 0
    v_mfma_f32_32x32x16_bf16 v[32:47], v[96:99], v[52:55], 0
    s_add_u32 s17, s29, 57344
    s_mov_b32 m0, s17
    s_add_u32 s18, s32, 384
    buffer_load_dwordx4 v5, s[12:15], s18 offen lds
    ds_read_b64_tr_b16 v[48:49], v3 offset:6144
    ds_read_b64_tr_b16 v[50:51], v3 offset:6400
    ds_read_b64_tr_b16 v[52:53], v3 offset:6656
    ds_read_b64_tr_b16 v[54:55], v3 offset:6912
    s_waitcnt lgkmcnt(8)
    v_mfma_f32_32x32x16_bf16 v[16:31], v[100:103], v[56:59], v[16:31]
    v_mfma_f32_32x32x16_bf16 v[32:47], v[100:103], v[60:63], v[32:47]
    ds_read_b64_tr_b16 v[56:57], v3 offset:8192
    ds_read_b64_tr_b16 v[58:59], v3 offset:8448
    ds_read_b64_tr_b16 v[60:61], v3 offset:8704
    ds_read_b64_tr_b16 v[62:63], v3 offset:8960
    s_waitcnt lgkmcnt(8)
    v_mfma_f32_32x32x16_bf16 v[16:31], v[104:107], v[64:67], v[16:31]
    v_mfma_f32_32x32x16_bf16 v[32:47], v[104:107], v[68:71], v[32:47]
    s_add_u32 s17, s29, 58368
    s_mov_b32 m0, s17
    s_add_u32 s18, s32, 7552
    buffer_load_dwordx4 v5, s[12:15], s18 offen lds
    ds_read_b64_tr_b16 v[64:65], v3 offset:10240
    ds_read_b64_tr_b16 v[66:67], v3 offset:10496
    ds_read_b64_tr_b16 v[68:69], v3 offset:10752
    ds_read_b64_tr_b16 v[70:71], v3 offset:11008
    s_waitcnt lgkmcnt(8)
    v_mfma_f32_32x32x16_bf16 v[16:31], v[108:111], v[48:51], v[16:31]
    v_mfma_f32_32x32x16_bf16 v[32:47], v[108:111], v[52:55], v[32:47]
    ds_read_b64_tr_b16 v[48:49], v3 offset:12288
    ds_read_b64_tr_b16 v[50:51], v3 offset:12544
    ds_read_b64_tr_b16 v[52:53], v3 offset:12800
    ds_read_b64_tr_b16 v[54:55], v3 offset:13056
    s_waitcnt lgkmcnt(8)
    v_mfma_f32_32x32x16_bf16 v[16:31], v[112:115], v[56:59], v[16:31]
    v_mfma_f32_32x32x16_bf16 v[32:47], v[112:115], v[60:63], v[32:47]
    s_add_u32 s17, s29, 59392
    s_mov_b32 m0, s17
    s_add_u32 s18, s32, 14720
    buffer_load_dwordx4 v5, s[12:15], s18 offen lds
    ds_read_b64_tr_b16 v[56:57], v3 offset:14336
    ds_read_b64_tr_b16 v[58:59], v3 offset:14592
    ds_read_b64_tr_b16 v[60:61], v3 offset:14848
    ds_read_b64_tr_b16 v[62:63], v3 offset:15104
    s_waitcnt lgkmcnt(8)
    v_mfma_f32_32x32x16_bf16 v[16:31], v[116:119], v[64:67], v[16:31]
    v_mfma_f32_32x32x16_bf16 v[32:47], v[116:119], v[68:71], v[32:47]
    ds_read_b64_tr_b16 v[64:65], v3 offset:16384
    ds_read_b64_tr_b16 v[66:67], v3 offset:16640
    ds_read_b64_tr_b16 v[68:69], v3 offset:16896
    ds_read_b64_tr_b16 v[70:71], v3 offset:17152
    s_waitcnt lgkmcnt(8)
    v_mfma_f32_32x32x16_bf16 v[16:31], v[120:123], v[48:51], v[16:31]
    v_mfma_f32_32x32x16_bf16 v[32:47], v[120:123], v[52:55], v[32:47]
    s_add_u32 s17, s29, 60416
    s_mov_b32 m0, s17
    s_add_u32 s18, s32, 21888
    buffer_load_dwordx4 v5, s[12:15], s18 offen lds
    ds_read_b64_tr_b16 v[48:49], v3 offset:18432
    ds_read_b64_tr_b16 v[50:51], v3 offset:18688
    ds_read_b64_tr_b16 v[52:53], v3 offset:18944
    ds_read_b64_tr_b16 v[54:55], v3 offset:19200
    s_waitcnt lgkmcnt(8)
    v_mfma_f32_32x32x16_bf16 v[16:31], v[124:127], v[56:59], v[16:31]
    v_mfma_f32_32x32x16_bf16 v[32:47], v[124:127], v[60:63], v[32:47]
    ds_read_b64_tr_b16 v[56:57], v3 offset:20480
    ds_read_b64_tr_b16 v[58:59], v3 offset:20736
    ds_read_b64_tr_b16 v[60:61], v3 offset:20992
    ds_read_b64_tr_b16 v[62:63], v3 offset:21248
    s_waitcnt lgkmcnt(8)
    v_mfma_f32_32x32x16_bf16 v[16:31], v[128:131], v[64:67], v[16:31]
    v_mfma_f32_32x32x16_bf16 v[32:47], v[128:131], v[68:71], v[32:47]
    s_add_u32 s17, s29, 61440
    s_mov_b32 m0, s17
    s_add_u32 s18, s32, 29056
    buffer_load_dwordx4 v5, s[12:15], s18 offen lds
    ds_read_b64_tr_b16 v[64:65], v3 offset:22528
    ds_read_b64_tr_b16 v[66:67], v3 offset:22784
    ds_read_b64_tr_b16 v[68:69], v3 offset:23040
    ds_read_b64_tr_b16 v[70:71], v3 offset:23296
    s_waitcnt lgkmcnt(8)
    v_mfma_f32_32x32x16_bf16 v[16:31], v[132:135], v[48:51], v[16:31]
    v_mfma_f32_32x32x16_bf16 v[32:47], v[132:135], v[52:55], v[32:47]
    ds_read_b64_tr_b16 v[48:49], v3 offset:24576
    ds_read_b64_tr_b16 v[50:51], v3 offset:24832
    ds_read_b64_tr_b16 v[52:53], v3 offset:25088
    ds_read_b64_tr_b16 v[54:55], v3 offset:25344
    s_waitcnt lgkmcnt(8)
    v_mfma_f32_32x32x16_bf16 v[16:31], v[136:139], v[56:59], v[16:31]
    v_mfma_f32_32x32x16_bf16 v[32:47], v[136:139], v[60:63], v[32:47]
    s_add_u32 s17, s29, 62464
    s_mov_b32 m0, s17
    s_add_u32 s18, s32, 36224
    buffer_load_dwordx4 v5, s[12:15], s18 offen lds
    ds_read_b64_tr_b16 v[56:57], v3 offset:26624
    ds_read_b64_tr_b16 v[58:59], v3 offset:26880
    ds_read_b64_tr_b16 v[60:61], v3 offset:27136
    ds_read_b64_tr_b16 v[62:63], v3 offset:27392
    s_waitcnt lgkmcnt(8)
    v_mfma_f32_32x32x16_bf16 v[16:31], v[140:143], v[64:67], v[16:31]
    v_mfma_f32_32x32x16_bf16 v[32:47], v[140:143], v[68:71], v[32:47]
    ds_read_b64_tr_b16 v[64:65], v3 offset:28672
    ds_read_b64_tr_b16 v[66:67], v3 offset:28928
    ds_read_b64_tr_b16 v[68:69], v3 offset:29184
    ds_read_b64_tr_b16 v[70:71], v3 offset:29440
    s_waitcnt lgkmcnt(8)
    v_mfma_f32_32x32x16_bf16 v[16:31], v[144:147], v[48:51], v[16:31]
    v_mfma_f32_32x32x16_bf16 v[32:47], v[144:147], v[52:55], v[32:47]
    s_add_u32 s17, s29, 63488
    s_mov_b32 m0, s17
    s_add_u32 s18, s32, 43392
    buffer_load_dwordx4 v5, s[12:15], s18 offen lds
    ds_read_b64_tr_b16 v[48:49], v3 offset:30720
    ds_read_b64_tr_b16 v[50:51], v3 offset:30976
    ds_read_b64_tr_b16 v[52:53], v3 offset:31232
    ds_read_b64_tr_b16 v[54:55], v3 offset:31488
    s_waitcnt lgkmcnt(8)
    v_mfma_f32_32x32x16_bf16 v[16:31], v[148:151], v[56:59], v[16:31]
    v_mfma_f32_32x32x16_bf16 v[32:47], v[148:151], v[60:63], v[32:47]
    s_waitcnt lgkmcnt(4)
    v_mfma_f32_32x32x16_bf16 v[16:31], v[152:155], v[64:67], v[16:31]
    v_mfma_f32_32x32x16_bf16 v[32:47], v[152:155], v[68:71], v[32:47]
    s_add_u32 s17, s29, 64512
    s_mov_b32 m0, s17
    s_add_u32 s18, s32, 50560
    buffer_load_dwordx4 v5, s[12:15], s18 offen lds
    s_waitcnt lgkmcnt(0)
    v_mfma_f32_32x32x16_bf16 v[16:31], v[156:159], v[48:51], v[16:31]
    v_mfma_f32_32x32x16_bf16 v[32:47], v[156:159], v[52:55], v[32:47]
    s_nop 11
    v_cvt_pk_bf16_f32 v72, v16, v17
    v_cvt_pk_bf16_f32 v73, v18, v19
    v_cvt_pk_bf16_f32 v74, v20, v21
    v_cvt_pk_bf16_f32 v75, v22, v23
    v_cvt_pk_bf16_f32 v76, v24, v25
    v_cvt_pk_bf16_f32 v77, v26, v27
    v_cvt_pk_bf16_f32 v78, v28, v29
    v_cvt_pk_bf16_f32 v79, v30, v31
    v_cvt_pk_bf16_f32 v80, v32, v33
    v_cvt_pk_bf16_f32 v81, v34, v35
    v_cvt_pk_bf16_f32 v82, v36, v37
    v_cvt_pk_bf16_f32 v83, v38, v39
    v_cvt_pk_bf16_f32 v84, v40, v41
    v_cvt_pk_bf16_f32 v85, v42, v43
    v_cvt_pk_bf16_f32 v86, v44, v45
    v_cvt_pk_bf16_f32 v87, v46, v47
    buffer_store_dwordx4 v[72:75], v7, s[4:7], s30 offen offset:0 sc1
    buffer_store_dwordx4 v[76:79], v7, s[4:7], s30 offen offset:512 sc1
    buffer_store_dwordx4 v[80:83], v7, s[4:7], s30 offen offset:2048 sc1
    buffer_store_dwordx4 v[84:87], v7, s[4:7], s30 offen offset:2560 sc1
    s_add_u32 s30, s30, 4096
    s_waitcnt vmcnt(4)
    s_barrier
    ds_read_b64_tr_b16 v[48:49], v13 offset:0
    ds_read_b64_tr_b16 v[50:51], v13 offset:256
    ds_read_b64_tr_b16 v[52:53], v13 offset:512
    ds_read_b64_tr_b16 v[54:55], v13 offset:768
    ds_read_b64_tr_b16 v[56:57], v13 offset:2048
    ds_read_b64_tr_b16 v[58:59], v13 offset:2304
    ds_read_b64_tr_b16 v[60:61], v13 offset:2560
    ds_read_b64_tr_b16 v[62:63], v13 offset:2816
    ds_read_b64_tr_b16 v[64:65], v13 offset:4096
    ds_read_b64_tr_b16 v[66:67], v13 offset:4352
    ds_read_b64_tr_b16 v[68:69], v13 offset:4608
    ds_read_b64_tr_b16 v[70:71], v13 offset:4864
    s_waitcnt lgkmcnt(8)
    v_mfma_f32_32x32x16_bf16 v[16:31], v[96:99], v[48:51], 0
    v_mfma_f32_32x32x16_bf16 v[32:47], v[96:99], v[52:55], 0
    s_add_u32 s17, s29, 0
    s_mov_b32 m0, s17
    s_add_u32 s18, s32, 512
    buffer_load_dwordx4 v5, s[12:15], s18 offen lds
    ds_read_b64_tr_b16 v[48:49], v13 offset:6144
    ds_read_b64_tr_b16 v[50:51], v13 offset:6400
    ds_read_b64_tr_b16 v[52:53], v13 offset:6656
    ds_read_b64_tr_b16 v[54:55], v13 offset:6912
    s_waitcnt lgkmcnt(8)
    v_mfma_f32_32x32x16_bf16 v[16:31], v[100:103], v[56:59], v[16:31]
    v_mfma_f32_32x32x16_bf16 v[32:47], v[100:103], v[60:63], v[32:47]
    ds_read_b64_tr_b16 v[56:57], v13 offset:8192
    ds_read_b64_tr_b16 v[58:59], v13 offset:8448
    ds_read_b64_tr_b16 v[60:61], v13 offset:8704
    ds_read_b64_tr_b16 v[62:63], v13 offset:8960
    s_waitcnt lgkmcnt(8)
    v_mfma_f32_32x32x16_bf16 v[16:31], v[104:107], v[64:67], v[16:31]
    v_mfma_f32_32x32x16_bf16 v[32:47], v[104:107], v[68:71], v[32:47]
    s_add_u32 s17, s29, 1024
    s_mov_b32 m0, s17
    s_add_u32 s18, s32, 7680
    buffer_load_dwordx4 v5, s[12:15], s18 offen lds
    ds_read_b64_tr_b16 v[64:65], v13 offset:10240
    ds_read_b64_tr_b16 v[66:67], v13 offset:10496
    ds_read_b64_tr_b16 v[68:69], v13 offset:10752
    ds_read_b64_tr_b16 v[70:71], v13 offset:11008
    s_waitcnt lgkmcnt(8)
    v_mfma_f32_32x32x16_bf16 v[16:31], v[108:111], v[48:51], v[16:31]
    v_mfma_f32_32x32x16_bf16 v[32:47], v[108:111], v[52:55], v[32:47]
    ds_read_b64_tr_b16 v[48:49], v13 offset:12288
    ds_read_b64_tr_b16 v[50:51], v13 offset:12544
    ds_read_b64_tr_b16 v[52:53], v13 offset:12800
    ds_read_b64_tr_b16 v[54:55], v13 offset:13056
    s_waitcnt lgkmcnt(8)
    v_mfma_f32_32x32x16_bf16 v[16:31], v[112:115], v[56:59], v[16:31]
    v_mfma_f32_32x32x16_bf16 v[32:47], v[112:115], v[60:63], v[32:47]
    s_add_u32 s17, s29, 2048
    s_mov_b32 m0, s17
    s_add_u32 s18, s32, 14848
    buffer_load_dwordx4 v5, s[12:15], s18 offen lds
    ds_read_b64_tr_b16 v[56:57], v13 offset:14336
    ds_read_b64_tr_b16 v[58:59], v13 offset:14592
    ds_read_b64_tr_b16 v[60:61], v13 offset:14848
    ds_read_b64_tr_b16 v[62:63], v13 offset:15104
    s_waitcnt lgkmcnt(8)
    v_mfma_f32_32x32x16_bf16 v[16:31], v[116:119], v[64:67], v[16:31]
    v_mfma_f32_32x32x16_bf16 v[32:47], v[116:119], v[68:71], v[32:47]
    ds_read_b64_tr_b16 v[64:65], v13 offset:16384
    ds_read_b64_tr_b16 v[66:67], v13 offset:16640
    ds_read_b64_tr_b16 v[68:69], v13 offset:16896
    ds_read_b64_tr_b16 v[70:71], v13 offset:17152
    s_waitcnt lgkmcnt(8)
    v_mfma_f32_32x32x16_bf16 v[16:31], v[120:123], v[48:51], v[16:31]
    v_mfma_f32_32x32x16_bf16 v[32:47], v[120:123], v[52:55], v[32:47]
    s_add_u32 s17, s29, 3072
    s_mov_b32 m0, s17
    s_add_u32 s18, s32, 22016
    buffer_load_dwordx4 v5, s[12:15], s18 offen lds
    ds_read_b64_tr_b16 v[48:49], v13 offset:18432
    ds_read_b64_tr_b16 v[50:51], v13 offset:18688
    ds_read_b64_tr_b16 v[52:53], v13 offset:18944
    ds_read_b64_tr_b16 v[54:55], v13 offset:19200
    s_waitcnt lgkmcnt(8)
    v_mfma_f32_32x32x16_bf16 v[16:31], v[124:127], v[56:59], v[16:31]
    v_mfma_f32_32x32x16_bf16 v[32:47], v[124:127], v[60:63], v[32:47]
    ds_read_b64_tr_b16 v[56:57], v13 offset:20480
    ds_read_b64_tr_b16 v[58:59], v13 offset:20736
    ds_read_b64_tr_b16 v[60:61], v13 offset:20992
    ds_read_b64_tr_b16 v[62:63], v13 offset:21248
    s_waitcnt lgkmcnt(8)
    v_mfma_f32_32x32x16_bf16 v[16:31], v[128:131], v[64:67], v[16:31]
    v_mfma_f32_32x32x16_bf16 v[32:47], v[128:131], v[68:71], v[32:47]
    s_add_u32 s17, s29, 4096
    s_mov_b32 m0, s17
    s_add_u32 s18, s32, 29184
    buffer_load_dwordx4 v5, s[12:15], s18 offen lds
    ds_read_b64_tr_b16 v[64:65], v13 offset:22528
    ds_read_b64_tr_b16 v[66:67], v13 offset:22784
    ds_read_b64_tr_b16 v[68:69], v13 offset:23040
    ds_read_b64_tr_b16 v[70:71], v13 offset:23296
    s_waitcnt lgkmcnt(8)
    v_mfma_f32_32x32x16_bf16 v[16:31], v[132:135], v[48:51], v[16:31]
    v_mfma_f32_32x32x16_bf16 v[32:47], v[132:135], v[52:55], v[32:47]
    ds_read_b64_tr_b16 v[48:49], v13 offset:24576
    ds_read_b64_tr_b16 v[50:51], v13 offset:24832
    ds_read_b64_tr_b16 v[52:53], v13 offset:25088
    ds_read_b64_tr_b16 v[54:55], v13 offset:25344
    s_waitcnt lgkmcnt(8)
    v_mfma_f32_32x32x16_bf16 v[16:31], v[136:139], v[56:59], v[16:31]
    v_mfma_f32_32x32x16_bf16 v[32:47], v[136:139], v[60:63], v[32:47]
    s_add_u32 s17, s29, 5120
    s_mov_b32 m0, s17
    s_add_u32 s18, s32, 36352
    buffer_load_dwordx4 v5, s[12:15], s18 offen lds
    ds_read_b64_tr_b16 v[56:57], v13 offset:26624
    ds_read_b64_tr_b16 v[58:59], v13 offset:26880
    ds_read_b64_tr_b16 v[60:61], v13 offset:27136
    ds_read_b64_tr_b16 v[62:63], v13 offset:27392
    s_waitcnt lgkmcnt(8)
    v_mfma_f32_32x32x16_bf16 v[16:31], v[140:143], v[64:67], v[16:31]
    v_mfma_f32_32x32x16_bf16 v[32:47], v[140:143], v[68:71], v[32:47]
    ds_read_b64_tr_b16 v[64:65], v13 offset:28672
    ds_read_b64_tr_b16 v[66:67], v13 offset:28928
    ds_read_b64_tr_b16 v[68:69], v13 offset:29184
    ds_read_b64_tr_b16 v[70:71], v13 offset:29440
    s_waitcnt lgkmcnt(8)
    v_mfma_f32_32x32x16_bf16 v[16:31], v[144:147], v[48:51], v[16:31]
    v_mfma_f32_32x32x16_bf16 v[32:47], v[144:147], v[52:55], v[32:47]
    s_add_u32 s17, s29, 6144
    s_mov_b32 m0, s17
    s_add_u32 s18, s32, 43520
    buffer_load_dwordx4 v5, s[12:15], s18 offen lds
    ds_read_b64_tr_b16 v[48:49], v13 offset:30720
    ds_read_b64_tr_b16 v[50:51], v13 offset:30976
    ds_read_b64_tr_b16 v[52:53], v13 offset:31232
    ds_read_b64_tr_b16 v[54:55], v13 offset:31488
    s_waitcnt lgkmcnt(8)
    v_mfma_f32_32x32x16_bf16 v[16:31], v[148:151], v[56:59], v[16:31]
    v_mfma_f32_32x32x16_bf16 v[32:47], v[148:151], v[60:63], v[32:47]
    s_waitcnt lgkmcnt(4)
    v_mfma_f32_32x32x16_bf16 v[16:31], v[152:155], v[64:67], v[16:31]
    v_mfma_f32_32x32x16_bf16 v[32:47], v[152:155], v[68:71], v[32:47]
    s_add_u32 s17, s29, 7168
    s_mov_b32 m0, s17
    s_add_u32 s18, s32, 50688
    buffer_load_dwordx4 v5, s[12:15], s18 offen lds
    s_waitcnt lgkmcnt(0)
    v_mfma_f32_32x32x16_bf16 v[16:31], v[156:159], v[48:51], v[16:31]
    v_mfma_f32_32x32x16_bf16 v[32:47], v[156:159], v[52:55], v[32:47]
    s_nop 11
    v_cvt_pk_bf16_f32 v72, v16, v17
    v_cvt_pk_bf16_f32 v73, v18, v19
    v_cvt_pk_bf16_f32 v74, v20, v21
    v_cvt_pk_bf16_f32 v75, v22, v23
    v_cvt_pk_bf16_f32 v76, v24, v25
    v_cvt_pk_bf16_f32 v77, v26, v27
    v_cvt_pk_bf16_f32 v78, v28, v29
    v_cvt_pk_bf16_f32 v79, v30, v31
    v_cvt_pk_bf16_f32 v80, v32, v33
    v_cvt_pk_bf16_f32 v81, v34, v35
    v_cvt_pk_bf16_f32 v82, v36, v37
    v_cvt_pk_bf16_f32 v83, v38, v39
    v_cvt_pk_bf16_f32 v84, v40, v41
    v_cvt_pk_bf16_f32 v85, v42, v43
    v_cvt_pk_bf16_f32 v86, v44, v45
    v_cvt_pk_bf16_f32 v87, v46, v47
    buffer_store_dwordx4 v[72:75], v7, s[4:7], s30 offen offset:0 sc1
    buffer_store_dwordx4 v[76:79], v7, s[4:7], s30 offen offset:512 sc1
    buffer_store_dwordx4 v[80:83], v7, s[4:7], s30 offen offset:2048 sc1
    buffer_store_dwordx4 v[84:87], v7, s[4:7], s30 offen offset:2560 sc1
    s_add_u32 s30, s30, 4096
    s_waitcnt vmcnt(4)
    s_barrier
    ds_read_b64_tr_b16 v[48:49], v3 offset:0
    ds_read_b64_tr_b16 v[50:51], v3 offset:256
    ds_read_b64_tr_b16 v[52:53], v3 offset:512
    ds_read_b64_tr_b16 v[54:55], v3 offset:768
    ds_read_b64_tr_b16 v[56:57], v3 offset:2048
    ds_read_b64_tr_b16 v[58:59], v3 offset:2304
    ds_read_b64_tr_b16 v[60:61], v3 offset:2560
    ds_read_b64_tr_b16 v[62:63], v3 offset:2816
    ds_read_b64_tr_b16 v[64:65], v3 offset:4096
    ds_read_b64_tr_b16 v[66:67], v3 offset:4352
    ds_read_b64_tr_b16 v[68:69], v3 offset:4608
    ds_read_b64_tr_b16 v[70:71], v3 offset:4864
    s_waitcnt lgkmcnt(8)
    v_mfma_f32_32x32x16_bf16 v[16:31], v[96:99], v[48:51], 0
    v_mfma_f32_32x32x16_bf16 v[32:47], v[96:99], v[52:55], 0
    s_add_u32 s17, s29, 57344
    s_mov_b32 m0, s17
    s_add_u32 s18, s32, 640
    buffer_load_dwordx4 v5, s[12:15], s18 offen lds
    ds_read_b64_tr_b16 v[48:49], v3 offset:6144
    ds_read_b64_tr_b16 v[50:51], v3 offset:6400
    ds_read_b64_tr_b16 v[52:53], v3 offset:6656
    ds_read_b64_tr_b16 v[54:55], v3 offset:6912
    s_waitcnt lgkmcnt(8)
    v_mfma_f32_32x32x16_bf16 v[16:31], v[100:103], v[56:59], v[16:31]
    v_mfma_f32_32x32x16_bf16 v[32:47], v[100:103], v[60:63], v[32:47]
    ds_read_b64_tr_b16 v[56:57], v3 offset:8192
    ds_read_b64_tr_b16 v[58:59], v3 offset:8448
    ds_read_b64_tr_b16 v[60:61], v3 offset:8704
    ds_read_b64_tr_b16 v[62:63], v3 offset:8960
    s_waitcnt lgkmcnt(8)
    v_mfma_f32_32x32x16_bf16 v[16:31], v[104:107], v[64:67], v[16:31]
    v_mfma_f32_32x32x16_bf16 v[32:47], v[104:107], v[68:71], v[32:47]
    s_add_u32 s17, s29, 58368
    s_mov_b32 m0, s17
    s_add_u32 s18, s32, 7808
    buffer_load_dwordx4 v5, s[12:15], s18 offen lds
    ds_read_b64_tr_b16 v[64:65], v3 offset:10240
    ds_read_b64_tr_b16 v[66:67], v3 offset:10496
    ds_read_b64_tr_b16 v[68:69], v3 offset:10752
    ds_read_b64_tr_b16 v[70:71], v3 offset:11008
    s_waitcnt lgkmcnt(8)
    v_mfma_f32_32x32x16_bf16 v[16:31], v[108:111], v[48:51], v[16:31]
    v_mfma_f32_32x32x16_bf16 v[32:47], v[108:111], v[52:55], v[32:47]
    ds_read_b64_tr_b16 v[48:49], v3 offset:12288
    ds_read_b64_tr_b16 v[50:51], v3 offset:12544
    ds_read_b64_tr_b16 v[52:53], v3 offset:12800
    ds_read_b64_tr_b16 v[54:55], v3 offset:13056
    s_waitcnt lgkmcnt(8)
    v_mfma_f32_32x32x16_bf16 v[16:31], v[112:115], v[56:59], v[16:31]
    v_mfma_f32_32x32x16_bf16 v[32:47], v[112:115], v[60:63], v[32:47]
    s_add_u32 s17, s29, 59392
    s_mov_b32 m0, s17
    s_add_u32 s18, s32, 14976
    buffer_load_dwordx4 v5, s[12:15], s18 offen lds
    ds_read_b64_tr_b16 v[56:57], v3 offset:14336
    ds_read_b64_tr_b16 v[58:59], v3 offset:14592
    ds_read_b64_tr_b16 v[60:61], v3 offset:14848
    ds_read_b64_tr_b16 v[62:63], v3 offset:15104
    s_waitcnt lgkmcnt(8)
    v_mfma_f32_32x32x16_bf16 v[16:31], v[116:119], v[64:67], v[16:31]
    v_mfma_f32_32x32x16_bf16 v[32:47], v[116:119], v[68:71], v[32:47]
    ds_read_b64_tr_b16 v[64:65], v3 offset:16384
    ds_read_b64_tr_b16 v[66:67], v3 offset:16640
    ds_read_b64_tr_b16 v[68:69], v3 offset:16896
    ds_read_b64_tr_b16 v[70:71], v3 offset:17152
    s_waitcnt lgkmcnt(8)
    v_mfma_f32_32x32x16_bf16 v[16:31], v[120:123], v[48:51], v[16:31]
    v_mfma_f32_32x32x16_bf16 v[32:47], v[120:123], v[52:55], v[32:47]
    s_add_u32 s17, s29, 60416
    s_mov_b32 m0, s17
    s_add_u32 s18, s32, 22144
    buffer_load_dwordx4 v5, s[12:15], s18 offen lds
    ds_read_b64_tr_b16 v[48:49], v3 offset:18432
    ds_read_b64_tr_b16 v[50:51], v3 offset:18688
    ds_read_b64_tr_b16 v[52:53], v3 offset:18944
    ds_read_b64_tr_b16 v[54:55], v3 offset:19200
    s_waitcnt lgkmcnt(8)
    v_mfma_f32_32x32x16_bf16 v[16:31], v[124:127], v[56:59], v[16:31]
    v_mfma_f32_32x32x16_bf16 v[32:47], v[124:127], v[60:63], v[32:47]
    ds_read_b64_tr_b16 v[56:57], v3 offset:20480
    ds_read_b64_tr_b16 v[58:59], v3 offset:20736
    ds_read_b64_tr_b16 v[60:61], v3 offset:20992
    ds_read_b64_tr_b16 v[62:63], v3 offset:21248
    s_waitcnt lgkmcnt(8)
    v_mfma_f32_32x32x16_bf16 v[16:31], v[128:131], v[64:67], v[16:31]
    v_mfma_f32_32x32x16_bf16 v[32:47], v[128:131], v[68:71], v[32:47]
    s_add_u32 s17, s29, 61440
    s_mov_b32 m0, s17
    s_add_u32 s18, s32, 29312
    buffer_load_dwordx4 v5, s[12:15], s18 offen lds
    ds_read_b64_tr_b16 v[64:65], v3 offset:22528
    ds_read_b64_tr_b16 v[66:67], v3 offset:22784
    ds_read_b64_tr_b16 v[68:69], v3 offset:23040
    ds_read_b64_tr_b16 v[70:71], v3 offset:23296
    s_waitcnt lgkmcnt(8)
    v_mfma_f32_32x32x16_bf16 v[16:31], v[132:135], v[48:51], v[16:31]
    v_mfma_f32_32x32x16_bf16 v[32:47], v[132:135], v[52:55], v[32:47]
    ds_read_b64_tr_b16 v[48:49], v3 offset:24576
    ds_read_b64_tr_b16 v[50:51], v3 offset:24832
    ds_read_b64_tr_b16 v[52:53], v3 offset:25088
    ds_read_b64_tr_b16 v[54:55], v3 offset:25344
    s_waitcnt lgkmcnt(8)
    v_mfma_f32_32x32x16_bf16 v[16:31], v[136:139], v[56:59], v[16:31]
    v_mfma_f32_32x32x16_bf16 v[32:47], v[136:139], v[60:63], v[32:47]
    s_add_u32 s17, s29, 62464
    s_mov_b32 m0, s17
    s_add_u32 s18, s32, 36480
    buffer_load_dwordx4 v5, s[12:15], s18 offen lds
    ds_read_b64_tr_b16 v[56:57], v3 offset:26624
    ds_read_b64_tr_b16 v[58:59], v3 offset:26880
    ds_read_b64_tr_b16 v[60:61], v3 offset:27136
    ds_read_b64_tr_b16 v[62:63], v3 offset:27392
    s_waitcnt lgkmcnt(8)
    v_mfma_f32_32x32x16_bf16 v[16:31], v[140:143], v[64:67], v[16:31]
    v_mfma_f32_32x32x16_bf16 v[32:47], v[140:143], v[68:71], v[32:47]
    ds_read_b64_tr_b16 v[64:65], v3 offset:28672
    ds_read_b64_tr_b16 v[66:67], v3 offset:28928
    ds_read_b64_tr_b16 v[68:69], v3 offset:29184
    ds_read_b64_tr_b16 v[70:71], v3 offset:29440
    s_waitcnt lgkmcnt(8)
    v_mfma_f32_32x32x16_bf16 v[16:31], v[144:147], v[48:51], v[16:31]
    v_mfma_f32_32x32x16_bf16 v[32:47], v[144:147], v[52:55], v[32:47]
    s_add_u32 s17, s29, 63488
    s_mov_b32 m0, s17
    s_add_u32 s18, s32, 43648
    buffer_load_dwordx4 v5, s[12:15], s18 offen lds
    ds_read_b64_tr_b16 v[48:49], v3 offset:30720
    ds_read_b64_tr_b16 v[50:51], v3 offset:30976
    ds_read_b64_tr_b16 v[52:53], v3 offset:31232
    ds_read_b64_tr_b16 v[54:55], v3 offset:31488
    s_waitcnt lgkmcnt(8)
    v_mfma_f32_32x32x16_bf16 v[16:31], v[148:151], v[56:59], v[16:31]
    v_mfma_f32_32x32x16_bf16 v[32:47], v[148:151], v[60:63], v[32:47]
    s_waitcnt lgkmcnt(4)
    v_mfma_f32_32x32x16_bf16 v[16:31], v[152:155], v[64:67], v[16:31]
    v_mfma_f32_32x32x16_bf16 v[32:47], v[152:155], v[68:71], v[32:47]
    s_add_u32 s17, s29, 64512
    s_mov_b32 m0, s17
    s_add_u32 s18, s32, 50816
    buffer_load_dwordx4 v5, s[12:15], s18 offen lds
    s_waitcnt lgkmcnt(0)
    v_mfma_f32_32x32x16_bf16 v[16:31], v[156:159], v[48:51], v[16:31]
    v_mfma_f32_32x32x16_bf16 v[32:47], v[156:159], v[52:55], v[32:47]
    s_nop 11
    v_cvt_pk_bf16_f32 v72, v16, v17
    v_cvt_pk_bf16_f32 v73, v18, v19
    v_cvt_pk_bf16_f32 v74, v20, v21
    v_cvt_pk_bf16_f32 v75, v22, v23
    v_cvt_pk_bf16_f32 v76, v24, v25
    v_cvt_pk_bf16_f32 v77, v26, v27
    v_cvt_pk_bf16_f32 v78, v28, v29
    v_cvt_pk_bf16_f32 v79, v30, v31
    v_cvt_pk_bf16_f32 v80, v32, v33
    v_cvt_pk_bf16_f32 v81, v34, v35
    v_cvt_pk_bf16_f32 v82, v36, v37
    v_cvt_pk_bf16_f32 v83, v38, v39
    v_cvt_pk_bf16_f32 v84, v40, v41
    v_cvt_pk_bf16_f32 v85, v42, v43
    v_cvt_pk_bf16_f32 v86, v44, v45
    v_cvt_pk_bf16_f32 v87, v46, v47
    buffer_store_dwordx4 v[72:75], v7, s[4:7], s30 offen offset:0 sc1
    buffer_store_dwordx4 v[76:79], v7, s[4:7], s30 offen offset:512 sc1
    buffer_store_dwordx4 v[80:83], v7, s[4:7], s30 offen offset:2048 sc1
    buffer_store_dwordx4 v[84:87], v7, s[4:7], s30 offen offset:2560 sc1
    s_add_u32 s30, s30, 4096
    s_waitcnt vmcnt(4)
    s_barrier
    ds_read_b64_tr_b16 v[48:49], v13 offset:0
    ds_read_b64_tr_b16 v[50:51], v13 offset:256
    ds_read_b64_tr_b16 v[52:53], v13 offset:512
    ds_read_b64_tr_b16 v[54:55], v13 offset:768
    ds_read_b64_tr_b16 v[56:57], v13 offset:2048
    ds_read_b64_tr_b16 v[58:59], v13 offset:2304
    ds_read_b64_tr_b16 v[60:61], v13 offset:2560
    ds_read_b64_tr_b16 v[62:63], v13 offset:2816
    ds_read_b64_tr_b16 v[64:65], v13 offset:4096
    ds_read_b64_tr_b16 v[66:67], v13 offset:4352
    ds_read_b64_tr_b16 v[68:69], v13 offset:4608
    ds_read_b64_tr_b16 v[70:71], v13 offset:4864
    s_waitcnt lgkmcnt(8)
    v_mfma_f32_32x32x16_bf16 v[16:31], v[96:99], v[48:51], 0
    v_mfma_f32_32x32x16_bf16 v[32:47], v[96:99], v[52:55], 0
    s_add_u32 s17, s29, 0
    s_mov_b32 m0, s17
    s_add_u32 s18, s32, 768
    buffer_load_dwordx4 v5, s[12:15], s18 offen lds
    ds_read_b64_tr_b16 v[48:49], v13 offset:6144
    ds_read_b64_tr_b16 v[50:51], v13 offset:6400
    ds_read_b64_tr_b16 v[52:53], v13 offset:6656
    ds_read_b64_tr_b16 v[54:55], v13 offset:6912
    s_waitcnt lgkmcnt(8)
    v_mfma_f32_32x32x16_bf16 v[16:31], v[100:103], v[56:59], v[16:31]
    v_mfma_f32_32x32x16_bf16 v[32:47], v[100:103], v[60:63], v[32:47]
    ds_read_b64_tr_b16 v[56:57], v13 offset:8192
    ds_read_b64_tr_b16 v[58:59], v13 offset:8448
    ds_read_b64_tr_b16 v[60:61], v13 offset:8704
    ds_read_b64_tr_b16 v[62:63], v13 offset:8960
    s_waitcnt lgkmcnt(8)
    v_mfma_f32_32x32x16_bf16 v[16:31], v[104:107], v[64:67], v[16:31]
    v_mfma_f32_32x32x16_bf16 v[32:47], v[104:107], v[68:71], v[32:47]
    s_add_u32 s17, s29, 1024
    s_mov_b32 m0, s17
    s_add_u32 s18, s32, 7936
    buffer_load_dwordx4 v5, s[12:15], s18 offen lds
    ds_read_b64_tr_b16 v[64:65], v13 offset:10240
    ds_read_b64_tr_b16 v[66:67], v13 offset:10496
    ds_read_b64_tr_b16 v[68:69], v13 offset:10752
    ds_read_b64_tr_b16 v[70:71], v13 offset:11008
    s_waitcnt lgkmcnt(8)
    v_mfma_f32_32x32x16_bf16 v[16:31], v[108:111], v[48:51], v[16:31]
    v_mfma_f32_32x32x16_bf16 v[32:47], v[108:111], v[52:55], v[32:47]
    ds_read_b64_tr_b16 v[48:49], v13 offset:12288
    ds_read_b64_tr_b16 v[50:51], v13 offset:12544
    ds_read_b64_tr_b16 v[52:53], v13 offset:12800
    ds_read_b64_tr_b16 v[54:55], v13 offset:13056
    s_waitcnt lgkmcnt(8)
    v_mfma_f32_32x32x16_bf16 v[16:31], v[112:115], v[56:59], v[16:31]
    v_mfma_f32_32x32x16_bf16 v[32:47], v[112:115], v[60:63], v[32:47]
    s_add_u32 s17, s29, 2048
    s_mov_b32 m0, s17
    s_add_u32 s18, s32, 15104
    buffer_load_dwordx4 v5, s[12:15], s18 offen lds
    ds_read_b64_tr_b16 v[56:57], v13 offset:14336
    ds_read_b64_tr_b16 v[58:59], v13 offset:14592
    ds_read_b64_tr_b16 v[60:61], v13 offset:14848
    ds_read_b64_tr_b16 v[62:63], v13 offset:15104
    s_waitcnt lgkmcnt(8)
    v_mfma_f32_32x32x16_bf16 v[16:31], v[116:119], v[64:67], v[16:31]
    v_mfma_f32_32x32x16_bf16 v[32:47], v[116:119], v[68:71], v[32:47]
    ds_read_b64_tr_b16 v[64:65], v13 offset:16384
    ds_read_b64_tr_b16 v[66:67], v13 offset:16640
    ds_read_b64_tr_b16 v[68:69], v13 offset:16896
    ds_read_b64_tr_b16 v[70:71], v13 offset:17152
    s_waitcnt lgkmcnt(8)
    v_mfma_f32_32x32x16_bf16 v[16:31], v[120:123], v[48:51], v[16:31]
    v_mfma_f32_32x32x16_bf16 v[32:47], v[120:123], v[52:55], v[32:47]
    s_add_u32 s17, s29, 3072
    s_mov_b32 m0, s17
    s_add_u32 s18, s32, 22272
    buffer_load_dwordx4 v5, s[12:15], s18 offen lds
    ds_read_b64_tr_b16 v[48:49], v13 offset:18432
    ds_read_b64_tr_b16 v[50:51], v13 offset:18688
    ds_read_b64_tr_b16 v[52:53], v13 offset:18944
    ds_read_b64_tr_b16 v[54:55], v13 offset:19200
    s_waitcnt lgkmcnt(8)
    v_mfma_f32_32x32x16_bf16 v[16:31], v[124:127], v[56:59], v[16:31]
    v_mfma_f32_32x32x16_bf16 v[32:47], v[124:127], v[60:63], v[32:47]
    ds_read_b64_tr_b16 v[56:57], v13 offset:20480
    ds_read_b64_tr_b16 v[58:59], v13 offset:20736
    ds_read_b64_tr_b16 v[60:61], v13 offset:20992
    ds_read_b64_tr_b16 v[62:63], v13 offset:21248
    s_waitcnt lgkmcnt(8)
    v_mfma_f32_32x32x16_bf16 v[16:31], v[128:131], v[64:67], v[16:31]
    v_mfma_f32_32x32x16_bf16 v[32:47], v[128:131], v[68:71], v[32:47]
    s_add_u32 s17, s29, 4096
    s_mov_b32 m0, s17
    s_add_u32 s18, s32, 29440
    buffer_load_dwordx4 v5, s[12:15], s18 offen lds
    ds_read_b64_tr_b16 v[64:65], v13 offset:22528
    ds_read_b64_tr_b16 v[66:67], v13 offset:22784
    ds_read_b64_tr_b16 v[68:69], v13 offset:23040
    ds_read_b64_tr_b16 v[70:71], v13 offset:23296
    s_waitcnt lgkmcnt(8)
    v_mfma_f32_32x32x16_bf16 v[16:31], v[132:135], v[48:51], v[16:31]
    v_mfma_f32_32x32x16_bf16 v[32:47], v[132:135], v[52:55], v[32:47]
    ds_read_b64_tr_b16 v[48:49], v13 offset:24576
    ds_read_b64_tr_b16 v[50:51], v13 offset:24832
    ds_read_b64_tr_b16 v[52:53], v13 offset:25088
    ds_read_b64_tr_b16 v[54:55], v13 offset:25344
    s_waitcnt lgkmcnt(8)
    v_mfma_f32_32x32x16_bf16 v[16:31], v[136:139], v[56:59], v[16:31]
    v_mfma_f32_32x32x16_bf16 v[32:47], v[136:139], v[60:63], v[32:47]
    s_add_u32 s17, s29, 5120
    s_mov_b32 m0, s17
    s_add_u32 s18, s32, 36608
    buffer_load_dwordx4 v5, s[12:15], s18 offen lds
    ds_read_b64_tr_b16 v[56:57], v13 offset:26624
    ds_read_b64_tr_b16 v[58:59], v13 offset:26880
    ds_read_b64_tr_b16 v[60:61], v13 offset:27136
    ds_read_b64_tr_b16 v[62:63], v13 offset:27392
    s_waitcnt lgkmcnt(8)
    v_mfma_f32_32x32x16_bf16 v[16:31], v[140:143], v[64:67], v[16:31]
    v_mfma_f32_32x32x16_bf16 v[32:47], v[140:143], v[68:71], v[32:47]
    ds_read_b64_tr_b16 v[64:65], v13 offset:28672
    ds_read_b64_tr_b16 v[66:67], v13 offset:28928
    ds_read_b64_tr_b16 v[68:69], v13 offset:29184
    ds_read_b64_tr_b16 v[70:71], v13 offset:29440
    s_waitcnt lgkmcnt(8)
    v_mfma_f32_32x32x16_bf16 v[16:31], v[144:147], v[48:51], v[16:31]
    v_mfma_f32_32x32x16_bf16 v[32:47], v[144:147], v[52:55], v[32:47]
    s_add_u32 s17, s29, 6144
    s_mov_b32 m0, s17
    s_add_u32 s18, s32, 43776
    buffer_load_dwordx4 v5, s[12:15], s18 offen lds
    ds_read_b64_tr_b16 v[48:49], v13 offset:30720
    ds_read_b64_tr_b16 v[50:51], v13 offset:30976
    ds_read_b64_tr_b16 v[52:53], v13 offset:31232
    ds_read_b64_tr_b16 v[54:55], v13 offset:31488
    s_waitcnt lgkmcnt(8)
    v_mfma_f32_32x32x16_bf16 v[16:31], v[148:151], v[56:59], v[16:31]
    v_mfma_f32_32x32x16_bf16 v[32:47], v[148:151], v[60:63], v[32:47]
    s_waitcnt lgkmcnt(4)
    v_mfma_f32_32x32x16_bf16 v[16:31], v[152:155], v[64:67], v[16:31]
    v_mfma_f32_32x32x16_bf16 v[32:47], v[152:155], v[68:71], v[32:47]
    s_add_u32 s17, s29, 7168
    s_mov_b32 m0, s17
    s_add_u32 s18, s32, 50944
    buffer_load_dwordx4 v5, s[12:15], s18 offen lds
    s_waitcnt lgkmcnt(0)
    v_mfma_f32_32x32x16_bf16 v[16:31], v[156:159], v[48:51], v[16:31]
    v_mfma_f32_32x32x16_bf16 v[32:47], v[156:159], v[52:55], v[32:47]
    s_nop 11
    v_cvt_pk_bf16_f32 v72, v16, v17
    v_cvt_pk_bf16_f32 v73, v18, v19
    v_cvt_pk_bf16_f32 v74, v20, v21
    v_cvt_pk_bf16_f32 v75, v22, v23
    v_cvt_pk_bf16_f32 v76, v24, v25
    v_cvt_pk_bf16_f32 v77, v26, v27
    v_cvt_pk_bf16_f32 v78, v28, v29
    v_cvt_pk_bf16_f32 v79, v30, v31
    v_cvt_pk_bf16_f32 v80, v32, v33
    v_cvt_pk_bf16_f32 v81, v34, v35
    v_cvt_pk_bf16_f32 v82, v36, v37
    v_cvt_pk_bf16_f32 v83, v38, v39
    v_cvt_pk_bf16_f32 v84, v40, v41
    v_cvt_pk_bf16_f32 v85, v42, v43
    v_cvt_pk_bf16_f32 v86, v44, v45
    v_cvt_pk_bf16_f32 v87, v46, v47
    buffer_store_dwordx4 v[72:75], v7, s[4:7], s30 offen offset:0 sc1
    buffer_store_dwordx4 v[76:79], v7, s[4:7], s30 offen offset:512 sc1
    buffer_store_dwordx4 v[80:83], v7, s[4:7], s30 offen offset:2048 sc1
    buffer_store_dwordx4 v[84:87], v7, s[4:7], s30 offen offset:2560 sc1
    s_add_u32 s30, s30, 4096
    s_waitcnt vmcnt(4)
    s_barrier
    ds_read_b64_tr_b16 v[48:49], v3 offset:0
    ds_read_b64_tr_b16 v[50:51], v3 offset:256
    ds_read_b64_tr_b16 v[52:53], v3 offset:512
    ds_read_b64_tr_b16 v[54:55], v3 offset:768
    ds_read_b64_tr_b16 v[56:57], v3 offset:2048
    ds_read_b64_tr_b16 v[58:59], v3 offset:2304
    ds_read_b64_tr_b16 v[60:61], v3 offset:2560
    ds_read_b64_tr_b16 v[62:63], v3 offset:2816
    ds_read_b64_tr_b16 v[64:65], v3 offset:4096
    ds_read_b64_tr_b16 v[66:67], v3 offset:4352
    ds_read_b64_tr_b16 v[68:69], v3 offset:4608
    ds_read_b64_tr_b16 v[70:71], v3 offset:4864
    s_waitcnt lgkmcnt(8)
    v_mfma_f32_32x32x16_bf16 v[16:31], v[96:99], v[48:51], 0
    v_mfma_f32_32x32x16_bf16 v[32:47], v[96:99], v[52:55], 0
    ds_read_b64_tr_b16 v[48:49], v3 offset:6144
    ds_read_b64_tr_b16 v[50:51], v3 offset:6400
    ds_read_b64_tr_b16 v[52:53], v3 offset:6656
    ds_read_b64_tr_b16 v[54:55], v3 offset:6912
    s_waitcnt lgkmcnt(8)
    v_mfma_f32_32x32x16_bf16 v[16:31], v[100:103], v[56:59], v[16:31]
    v_mfma_f32_32x32x16_bf16 v[32:47], v[100:103], v[60:63], v[32:47]
    ds_read_b64_tr_b16 v[56:57], v3 offset:8192
    ds_read_b64_tr_b16 v[58:59], v3 offset:8448
    ds_read_b64_tr_b16 v[60:61], v3 offset:8704
    ds_read_b64_tr_b16 v[62:63], v3 offset:8960
    s_waitcnt lgkmcnt(8)
    v_mfma_f32_32x32x16_bf16 v[16:31], v[104:107], v[64:67], v[16:31]
    v_mfma_f32_32x32x16_bf16 v[32:47], v[104:107], v[68:71], v[32:47]
    ds_read_b64_tr_b16 v[64:65], v3 offset:10240
    ds_read_b64_tr_b16 v[66:67], v3 offset:10496
    ds_read_b64_tr_b16 v[68:69], v3 offset:10752
    ds_read_b64_tr_b16 v[70:71], v3 offset:11008
    s_waitcnt lgkmcnt(8)
    v_mfma_f32_32x32x16_bf16 v[16:31], v[108:111], v[48:51], v[16:31]
    v_mfma_f32_32x32x16_bf16 v[32:47], v[108:111], v[52:55], v[32:47]
    ds_read_b64_tr_b16 v[48:49], v3 offset:12288
    ds_read_b64_tr_b16 v[50:51], v3 offset:12544
    ds_read_b64_tr_b16 v[52:53], v3 offset:12800
    ds_read_b64_tr_b16 v[54:55], v3 offset:13056
    s_waitcnt lgkmcnt(8)
    v_mfma_f32_32x32x16_bf16 v[16:31], v[112:115], v[56:59], v[16:31]
    v_mfma_f32_32x32x16_bf16 v[32:47], v[112:115], v[60:63], v[32:47]
    ds_read_b64_tr_b16 v[56:57], v3 offset:14336
    ds_read_b64_tr_b16 v[58:59], v3 offset:14592
    ds_read_b64_tr_b16 v[60:61], v3 offset:14848
    ds_read_b64_tr_b16 v[62:63], v3 offset:15104
    s_waitcnt lgkmcnt(8)
    v_mfma_f32_32x32x16_bf16 v[16:31], v[116:119], v[64:67], v[16:31]
    v_mfma_f32_32x32x16_bf16 v[32:47], v[116:119], v[68:71], v[32:47]
    ds_read_b64_tr_b16 v[64:65], v3 offset:16384
    ds_read_b64_tr_b16 v[66:67], v3 offset:16640
    ds_read_b64_tr_b16 v[68:69], v3 offset:16896
    ds_read_b64_tr_b16 v[70:71], v3 offset:17152
    s_waitcnt lgkmcnt(8)
    v_mfma_f32_32x32x16_bf16 v[16:31], v[120:123], v[48:51], v[16:31]
    v_mfma_f32_32x32x16_bf16 v[32:47], v[120:123], v[52:55], v[32:47]
    ds_read_b64_tr_b16 v[48:49], v3 offset:18432
    ds_read_b64_tr_b16 v[50:51], v3 offset:18688
    ds_read_b64_tr_b16 v[52:53], v3 offset:18944
    ds_read_b64_tr_b16 v[54:55], v3 offset:19200
    s_waitcnt lgkmcnt(8)
    v_mfma_f32_32x32x16_bf16 v[16:31], v[124:127], v[56:59], v[16:31]
    v_mfma_f32_32x32x16_bf16 v[32:47], v[124:127], v[60:63], v[32:47]
    ds_read_b64_tr_b16 v[56:57], v3 offset:20480
    ds_read_b64_tr_b16 v[58:59], v3 offset:20736
    ds_read_b64_tr_b16 v[60:61], v3 offset:20992
    ds_read_b64_tr_b16 v[62:63], v3 offset:21248
    s_waitcnt lgkmcnt(8)
    v_mfma_f32_32x32x16_bf16 v[16:31], v[128:131], v[64:67], v[16:31]
    v_mfma_f32_32x32x16_bf16 v[32:47], v[128:131], v[68:71], v[32:47]
    ds_read_b64_tr_b16 v[64:65], v3 offset:22528
    ds_read_b64_tr_b16 v[66:67], v3 offset:22784
    ds_read_b64_tr_b16 v[68:69], v3 offset:23040
    ds_read_b64_tr_b16 v[70:71], v3 offset:23296
    s_waitcnt lgkmcnt(8)
    v_mfma_f32_32x32x16_bf16 v[16:31], v[132:135], v[48:51], v[16:31]
    v_mfma_f32_32x32x16_bf16 v[32:47], v[132:135], v[52:55], v[32:47]
    ds_read_b64_tr_b16 v[48:49], v3 offset:24576
    ds_read_b64_tr_b16 v[50:51], v3 offset:24832
    ds_read_b64_tr_b16 v[52:53], v3 offset:25088
    ds_read_b64_tr_b16 v[54:55], v3 offset:25344
    s_waitcnt lgkmcnt(8)
    v_mfma_f32_32x32x16_bf16 v[16:31], v[136:139], v[56:59], v[16:31]
    v_mfma_f32_32x32x16_bf16 v[32:47], v[136:139], v[60:63], v[32:47]
    ds_read_b64_tr_b16 v[56:57], v3 offset:26624
    ds_read_b64_tr_b16 v[58:59], v3 offset:26880
    ds_read_b64_tr_b16 v[60:61], v3 offset:27136
    ds_read_b64_tr_b16 v[62:63], v3 offset:27392
    s_waitcnt lgkmcnt(8)
    v_mfma_f32_32x32x16_bf16 v[16:31], v[140:143], v[64:67], v[16:31]
    v_mfma_f32_32x32x16_bf16 v[32:47], v[140:143], v[68:71], v[32:47]
    ds_read_b64_tr_b16 v[64:65], v3 offset:28672
    ds_read_b64_tr_b16 v[66:67], v3 offset:28928
    ds_read_b64_tr_b16 v[68:69], v3 offset:29184
    ds_read_b64_tr_b16 v[70:71], v3 offset:29440
    s_waitcnt lgkmcnt(8)
    v_mfma_f32_32x32x16_bf16 v[16:31], v[144:147], v[48:51], v[16:31]
    v_mfma_f32_32x32x16_bf16 v[32:47], v[144:147], v[52:55], v[32:47]
    ds_read_b64_tr_b16 v[48:49], v3 offset:30720
    ds_read_b64_tr_b16 v[50:51], v3 offset:30976
    ds_read_b64_tr_b16 v[52:53], v3 offset:31232
    ds_read_b64_tr_b16 v[54:55], v3 offset:31488
    s_waitcnt lgkmcnt(8)
    v_mfma_f32_32x32x16_bf16 v[16:31], v[148:151], v[56:59], v[16:31]
    v_mfma_f32_32x32x16_bf16 v[32:47], v[148:151], v[60:63], v[32:47]
    s_waitcnt lgkmcnt(4)
    v_mfma_f32_32x32x16_bf16 v[16:31], v[152:155], v[64:67], v[16:31]
    v_mfma_f32_32x32x16_bf16 v[32:47], v[152:155], v[68:71], v[32:47]
    s_waitcnt lgkmcnt(0)
    v_mfma_f32_32x32x16_bf16 v[16:31], v[156:159], v[48:51], v[16:31]
    v_mfma_f32_32x32x16_bf16 v[32:47], v[156:159], v[52:55], v[32:47]
    s_nop 11
    v_cvt_pk_bf16_f32 v72, v16, v17
    v_cvt_pk_bf16_f32 v73, v18, v19
    v_cvt_pk_bf16_f32 v74, v20, v21
    v_cvt_pk_bf16_f32 v75, v22, v23
    v_cvt_pk_bf16_f32 v76, v24, v25
    v_cvt_pk_bf16_f32 v77, v26, v27
    v_cvt_pk_bf16_f32 v78, v28, v29
    v_cvt_pk_bf16_f32 v79, v30, v31
    v_cvt_pk_bf16_f32 v80, v32, v33
    v_cvt_pk_bf16_f32 v81, v34, v35
    v_cvt_pk_bf16_f32 v82, v36, v37
    v_cvt_pk_bf16_f32 v83, v38, v39
    v_cvt_pk_bf16_f32 v84, v40, v41
    v_cvt_pk_bf16_f32 v85, v42, v43
    v_cvt_pk_bf16_f32 v86, v44, v45
    v_cvt_pk_bf16_f32 v87, v46, v47
    buffer_store_dwordx4 v[72:75], v7, s[4:7], s30 offen offset:0 sc1
    buffer_store_dwordx4 v[76:79], v7, s[4:7], s30 offen offset:512 sc1
    buffer_store_dwordx4 v[80:83], v7, s[4:7], s30 offen offset:2048 sc1
    buffer_store_dwordx4 v[84:87], v7, s[4:7], s30 offen offset:2560 sc1
    s_add_u32 s30, s30, 4096
    s_lshl_b32 s93, s25, 6
    s_add_u32 s93, s93, 90972160
    s_waitcnt vmcnt(0)
    s_barrier
    s_cmp_lg_u32 s87, 0
    s_cbranch_scc1 sig_76
    v_mov_b32 v250, 0
    v_mov_b32 v251, 4
    s_mov_b64 exec, 1
    buffer_atomic_add v251, v250, s[4:7], s93 offen
    s_mov_b64 exec, -1
sig_76:
    s_branch L_job_next
L_sjob:
    v_and_b32 v1, 63, v0
    v_lshrrev_b32 v8, 6, v0
    s_nop 0
    v_readfirstlane_b32 s26, v8
    v_lshrrev_b32 v8, 5, v1
    v_lshlrev_b32 v2, 8, v8
    v_bfe_u32 v9, v1, 2, 2
    v_lshl_add_u32 v2, v9, 6, v2
    v_bfe_u32 v10, v1, 4, 1
    v_lshl_add_u32 v2, v10, 5, v2
    v_and_b32 v11, 1, v1
    v_lshl_add_u32 v2, v11, 4, v2
    v_bfe_u32 v11, v1, 1, 1
    v_lshl_add_u32 v2, v11, 3, v2
    v_lshlrev_b32 v3, 10, v8
    v_lshl_add_u32 v3, v9, 6, v3
    v_lshl_add_u32 v3, v10, 5, v3
    v_and_b32 v11, 3, v1
    v_lshl_add_u32 v3, v11, 3, v3
    v_bfe_u32 v9, v1, 2, 3
    v_lshlrev_b32 v4, 13, v9
    v_lshl_add_u32 v4, v8, 6, v4
    v_lshl_add_u32 v4, v11, 4, v4
    v_mul_u32_u24 v5, 896, v9
    v_lshl_add_u32 v5, v8, 6, v5
    v_lshl_add_u32 v5, v11, 4, v5
    v_and_b32 v9, 31, v1
    v_lshlrev_b32 v6, 13, v9
    v_lshl_add_u32 v6, v8, 4, v6
    v_lshlrev_b32 v7, 10, v10
    v_lshl_add_u32 v7, v8, 8, v7
    v_and_b32 v9, 15, v1
    v_lshl_add_u32 v7, v9, 4, v7
    v_add_u32 v12, 57344, v2
    v_add_u32 v13, 57344, v3
    v_lshlrev_b32 v14, 4, v1
    v_add_u32 v15, 57344, v14
    s_lshl_b32 s27, s25, 2
    s_add_u32 s27, s27, s26
    s_load_dwordx2 s[8:9], s[0:1], 16
    s_waitcnt lgkmcnt(0)
    s_and_b32 s9, s9, 0xffff
    s_mov_b32 s10, 3670016
    s_mov_b32 s11, 0x20000
    s_load_dwordx2 s[12:13], s[0:1], 24
    s_waitcnt lgkmcnt(0)
    s_and_b32 s13, s13, 0xffff
    s_mov_b32 s14, 3670016
    s_mov_b32 s15, 0x20000
    s_mul_i32 s19, s26, 14336
    s_lshl_b32 s29, s26, 13
    s_lshl_b32 s16, s24, 9
    s_mul_i32 s31, s26, 917504
    s_add_u32 s31, s31, s16
    s_mul_i32 s32, s24, 229376
    s_mul_i32 s17, s26, 57344
    s_add_u32 s32, s32, s17
    s_lshl_b32 s33, s26, 7
    s_add_u32 s33, s33, s16
    s_barrier
    s_add_u32 s17, s19, 0
    s_mov_b32 m0, s17
    s_add_u32 s18, s31, 0
    buffer_load_dwordx4 v4, s[8:11], s18 offen lds
    s_add_u32 s17, s19, 1024
    s_mov_b32 m0, s17
    s_add_u32 s18, s31, 65536
    buffer_load_dwordx4 v4, s[8:11], s18 offen lds
    s_add_u32 s17, s19, 2048
    s_mov_b32 m0, s17
    s_add_u32 s18, s31, 131072
    buffer_load_dwordx4 v4, s[8:11], s18 offen lds
    s_add_u32 s17, s19, 3072
    s_mov_b32 m0, s17
    s_add_u32 s18, s31, 196608
    buffer_load_dwordx4 v4, s[8:11], s18 offen lds
    s_add_u32 s17, s19, 4096
    s_mov_b32 m0, s17
    s_add_u32 s18, s31, 262144
    buffer_load_dwordx4 v4, s[8:11], s18 offen lds
    s_add_u32 s17, s19, 5120
    s_mov_b32 m0, s17
    s_add_u32 s18, s31, 327680
    buffer_load_dwordx4 v4, s[8:11], s18 offen lds
    s_add_u32 s17, s19, 6144
    s_mov_b32 m0, s17
    s_add_u32 s18, s31, 393216
    buffer_load_dwordx4 v4, s[8:11], s18 offen lds
    s_add_u32 s17, s19, 7168
    s_mov_b32 m0, s17
    s_add_u32 s18, s31, 458752
    buffer_load_dwordx4 v4, s[8:11], s18 offen lds
    s_add_u32 s17, s19, 8192
    s_mov_b32 m0, s17
    s_add_u32 s18, s31, 524288
    buffer_load_dwordx4 v4, s[8:11], s18 offen lds
    s_add_u32 s17, s19, 9216
    s_mov_b32 m0, s17
    s_add_u32 s18, s31, 589824
    buffer_load_dwordx4 v4, s[8:11], s18 offen lds
    s_add_u32 s17, s19, 10240
    s_mov_b32 m0, s17
    s_add_u32 s18, s31, 655360
    buffer_load_dwordx4 v4, s[8:11], s18 offen lds
    s_add_u32 s17, s19, 11264
    s_mov_b32 m0, s17
    s_add_u32 s18, s31, 720896
    buffer_load_dwordx4 v4, s[8:11], s18 offen lds
    s_add_u32 s17, s19, 12288
    s_mov_b32 m0, s17
    s_add_u32 s18, s31, 786432
    buffer_load_dwordx4 v4, s[8:11], s18 offen lds
    s_add_u32 s17, s19, 13312
    s_mov_b32 m0, s17
    s_add_u32 s18, s31, 851968
    buffer_load_dwordx4 v4, s[8:11], s18 offen lds
    s_mul_i32 s16, s27, 28672
    s_add_u32 s16, s16, 12845056
    buffer_load_dwordx4 a[0:3], v14, s[4:7], s16 offen offset:0 sc1
    buffer_load_dwordx4 a[4:7], v14, s[4:7], s16 offen offset:1024 sc1
    buffer_load_dwordx4 a[8:11], v14, s[4:7], s16 offen offset:2048 sc1
    buffer_load_dwordx4 a[12:15], v14, s[4:7], s16 offen offset:3072 sc1
    s_add_u32 s16, s16, 4096
    buffer_load_dwordx4 a[16:19], v14, s[4:7], s16 offen offset:0 sc1
    buffer_load_dwordx4 a[20:23], v14, s[4:7], s16 offen offset:1024 sc1
    buffer_load_dwordx4 a[24:27], v14, s[4:7], s16 offen offset:2048 sc1
    buffer_load_dwordx4 a[28:31], v14, s[4:7], s16 offen offset:3072 sc1
    s_add_u32 s16, s16, 4096
    buffer_load_dwordx4 a[32:35], v14, s[4:7], s16 offen offset:0 sc1
    buffer_load_dwordx4 a[36:39], v14, s[4:7], s16 offen offset:1024 sc1
    buffer_load_dwordx4 a[40:43], v14, s[4:7], s16 offen offset:2048 sc1
    buffer_load_dwordx4 a[44:47], v14, s[4:7], s16 offen offset:3072 sc1
    s_add_u32 s16, s16, 4096
    buffer_load_dwordx4 a[48:51], v14, s[4:7], s16 offen offset:0 sc1
    buffer_load_dwordx4 a[52:55], v14, s[4:7], s16 offen offset:1024 sc1
    buffer_load_dwordx4 a[56:59], v14, s[4:7], s16 offen offset:2048 sc1
    buffer_load_dwordx4 a[60:63], v14, s[4:7], s16 offen offset:3072 sc1
    s_add_u32 s16, s16, 4096
    buffer_load_dwordx4 a[64:67], v14, s[4:7], s16 offen offset:0 sc1
    buffer_load_dwordx4 a[68:71], v14, s[4:7], s16 offen offset:1024 sc1
    buffer_load_dwordx4 a[72:75], v14, s[4:7], s16 offen offset:2048 sc1
    buffer_load_dwordx4 a[76:79], v14, s[4:7], s16 offen offset:3072 sc1
    s_add_u32 s16, s16, 4096
    buffer_load_dwordx4 a[80:83], v14, s[4:7], s16 offen offset:0 sc1
    buffer_load_dwordx4 a[84:87], v14, s[4:7], s16 offen offset:1024 sc1
    buffer_load_dwordx4 a[88:91], v14, s[4:7], s16 offen offset:2048 sc1
    buffer_load_dwordx4 a[92:95], v14, s[4:7], s16 offen offset:3072 sc1
    s_add_u32 s16, s16, 4096
    buffer_load_dwordx4 a[96:99], v14, s[4:7], s16 offen offset:0 sc1
    buffer_load_dwordx4 a[100:103], v14, s[4:7], s16 offen offset:1024 sc1
    buffer_load_dwordx4 a[104:107], v14, s[4:7], s16 offen offset:2048 sc1
    buffer_load_dwordx4 a[108:111], v14, s[4:7], s16 offen offset:3072 sc1
    s_add_u32 s16, s16, 4096
    s_waitcnt vmcnt(0)
    s_barrier
    ds_read_b64_tr_b16 v[48:49], v2 offset:0
    ds_read_b64_tr_b16 v[50:51], v2 offset:1024
    ds_read_b64_tr_b16 v[52:53], v2 offset:512
    ds_read_b64_tr_b16 v[54:55], v2 offset:1536
    ds_read_b64_tr_b16 v[56:57], v2 offset:2048
    ds_read_b64_tr_b16 v[58:59], v2 offset:3072
    ds_read_b64_tr_b16 v[60:61], v2 offset:2560
    ds_read_b64_tr_b16 v[62:63], v2 offset:3584
    ds_read_b64_tr_b16 v[64:65], v2 offset:4096
    ds_read_b64_tr_b16 v[66:67], v2 offset:5120
    ds_read_b64_tr_b16 v[68:69], v2 offset:4608
    ds_read_b64_tr_b16 v[70:71], v2 offset:5632
    s_waitcnt lgkmcnt(8)
    v_mfma_f32_32x32x16_bf16 v[16:31], v[48:51], a[0:3], 0
    v_mfma_f32_32x32x16_bf16 v[32:47], v[52:55], a[0:3], 0
    s_add_u32 s17, s19, 57344
    s_mov_b32 m0, s17
    s_add_u32 s18, s31, 128
    buffer_load_dwordx4 v4, s[8:11], s18 offen lds
    ds_read_b64_tr_b16 v[48:49], v2 offset:6144
    ds_read_b64_tr_b16 v[50:51], v2 offset:7168
    ds_read_b64_tr_b16 v[52:53], v2 offset:6656
    ds_read_b64_tr_b16 v[54:55], v2 offset:7680
    s_waitcnt lgkmcnt(8)
    v_mfma_f32_32x32x16_bf16 v[16:31], v[56:59], a[4:7], v[16:31]
    v_mfma_f32_32x32x16_bf16 v[32:47], v[60:63], a[4:7], v[32:47]
    ds_read_b64_tr_b16 v[56:57], v2 offset:8192
    ds_read_b64_tr_b16 v[58:59], v2 offset:9216
    ds_read_b64_tr_b16 v[60:61], v2 offset:8704
    ds_read_b64_tr_b16 v[62:63], v2 offset:9728
    s_waitcnt lgkmcnt(8)
    v_mfma_f32_32x32x16_bf16 v[16:31], v[64:67], a[8:11], v[16:31]
    v_mfma_f32_32x32x16_bf16 v[32:47], v[68:71], a[8:11], v[32:47]
    s_add_u32 s17, s19, 58368
    s_mov_b32 m0, s17
    s_add_u32 s18, s31, 65664
    buffer_load_dwordx4 v4, s[8:11], s18 offen lds
    ds_read_b64_tr_b16 v[64:65], v2 offset:10240
    ds_read_b64_tr_b16 v[66:67], v2 offset:11264
    ds_read_b64_tr_b16 v[68:69], v2 offset:10752
    ds_read_b64_tr_b16 v[70:71], v2 offset:11776
    s_waitcnt lgkmcnt(8)
    v_mfma_f32_32x32x16_bf16 v[16:31], v[48:51], a[12:15], v[16:31]
    v_mfma_f32_32x32x16_bf16 v[32:47], v[52:55], a[12:15], v[32:47]
    ds_read_b64_tr_b16 v[48:49], v2 offset:12288
    ds_read_b64_tr_b16 v[50:51], v2 offset:13312
    ds_read_b64_tr_b16 v[52:53], v2 offset:12800
    ds_read_b64_tr_b16 v[54:55], v2 offset:13824
    s_waitcnt lgkmcnt(8)
    v_mfma_f32_32x32x16_bf16 v[16:31], v[56:59], a[16:19], v[16:31]
    v_mfma_f32_32x32x16_bf16 v[32:47], v[60:63], a[16:19], v[32:47]
    s_add_u32 s17, s19, 59392
    s_mov_b32 m0, s17
    s_add_u32 s18, s31, 131200
    buffer_load_dwordx4 v4, s[8:11], s18 offen lds
    ds_read_b64_tr_b16 v[56:57], v2 offset:14336
    ds_read_b64_tr_b16 v[58:59], v2 offset:15360
    ds_read_b64_tr_b16 v[60:61], v2 offset:14848
    ds_read_b64_tr_b16 v[62:63], v2 offset:15872
    s_waitcnt lgkmcnt(8)
    v_mfma_f32_32x32x16_bf16 v[16:31], v[64:67], a[20:23], v[16:31]
    v_mfma_f32_32x32x16_bf16 v[32:47], v[68:71], a[20:23], v[32:47]
    ds_read_b64_tr_b16 v[64:65], v2 offset:16384
    ds_read_b64_tr_b16 v[66:67], v2 offset:17408
    ds_read_b64_tr_b16 v[68:69], v2 offset:16896
    ds_read_b64_tr_b16 v[70:71], v2 offset:17920
    s_waitcnt lgkmcnt(8)
    v_mfma_f32_32x32x16_bf16 v[16:31], v[48:51], a[24:27], v[16:31]
    v_mfma_f32_32x32x16_bf16 v[32:47], v[52:55], a[24:27], v[32:47]
    s_add_u32 s17, s19, 60416
    s_mov_b32 m0, s17
    s_add_u32 s18, s31, 196736
    buffer_load_dwordx4 v4, s[8:11], s18 offen lds
    ds_read_b64_tr_b16 v[48:49], v2 offset:18432
    ds_read_b64_tr_b16 v[50:51], v2 offset:19456
    ds_read_b64_tr_b16 v[52:53], v2 offset:18944
    ds_read_b64_tr_b16 v[54:55], v2 offset:19968
    s_waitcnt lgkmcnt(8)
    v_mfma_f32_32x32x16_bf16 v[16:31], v[56:59], a[28:31], v[16:31]
    v_mfma_f32_32x32x16_bf16 v[32:47], v[60:63], a[28:31], v[32:47]
    ds_read_b64_tr_b16 v[56:57], v2 offset:20480
    ds_read_b64_tr_b16 v[58:59], v2 offset:21504
    ds_read_b64_tr_b16 v[60:61], v2 offset:20992
    ds_read_b64_tr_b16 v[62:63], v2 offset:22016
    s_waitcnt lgkmcnt(8)
    v_mfma_f32_32x32x16_bf16 v[16:31], v[64:67], a[32:35], v[16:31]
    v_mfma_f32_32x32x16_bf16 v[32:47], v[68:71], a[32:35], v[32:47]
    s_add_u32 s17, s19, 61440
    s_mov_b32 m0, s17
    s_add_u32 s18, s31, 262272
    buffer_load_dwordx4 v4, s[8:11], s18 offen lds
    ds_read_b64_tr_b16 v[64:65], v2 offset:22528
    ds_read_b64_tr_b16 v[66:67], v2 offset:23552
    ds_read_b64_tr_b16 v[68:69], v2 offset:23040
    ds_read_b64_tr_b16 v[70:71], v2 offset:24064
    s_waitcnt lgkmcnt(8)
    v_mfma_f32_32x32x16_bf16 v[16:31], v[48:51], a[36:39], v[16:31]
    v_mfma_f32_32x32x16_bf16 v[32:47], v[52:55], a[36:39], v[32:47]
    ds_read_b64_tr_b16 v[48:49], v2 offset:24576
    ds_read_b64_tr_b16 v[50:51], v2 offset:25600
    ds_read_b64_tr_b16 v[52:53], v2 offset:25088
    ds_read_b64_tr_b16 v[54:55], v2 offset:26112
    s_waitcnt lgkmcnt(8)
    v_mfma_f32_32x32x16_bf16 v[16:31], v[56:59], a[40:43], v[16:31]
    v_mfma_f32_32x32x16_bf16 v[32:47], v[60:63], a[40:43], v[32:47]
    s_add_u32 s17, s19, 62464
    s_mov_b32 m0, s17
    s_add_u32 s18, s31, 327808
    buffer_load_dwordx4 v4, s[8:11], s18 offen lds
    ds_read_b64_tr_b16 v[56:57], v2 offset:26624
    ds_read_b64_tr_b16 v[58:59], v2 offset:27648
    ds_read_b64_tr_b16 v[60:61], v2 offset:27136
    ds_read_b64_tr_b16 v[62:63], v2 offset:28160
    s_waitcnt lgkmcnt(8)
    v_mfma_f32_32x32x16_bf16 v[16:31], v[64:67], a[44:47], v[16:31]
    v_mfma_f32_32x32x16_bf16 v[32:47], v[68:71], a[44:47], v[32:47]
    ds_read_b64_tr_b16 v[64:65], v2 offset:28672
    ds_read_b64_tr_b16 v[66:67], v2 offset:29696
    ds_read_b64_tr_b16 v[68:69], v2 offset:29184
    ds_read_b64_tr_b16 v[70:71], v2 offset:30208
    s_waitcnt lgkmcnt(8)
    v_mfma_f32_32x32x16_bf16 v[16:31], v[48:51], a[48:51], v[16:31]
    v_mfma_f32_32x32x16_bf16 v[32:47], v[52:55], a[48:51], v[32:47]
    s_add_u32 s17, s19, 63488
    s_mov_b32 m0, s17
    s_add_u32 s18, s31, 393344
    buffer_load_dwordx4 v4, s[8:11], s18 offen lds
    ds_read_b64_tr_b16 v[48:49], v2 offset:30720
    ds_read_b64_tr_b16 v[50:51], v2 offset:31744
    ds_read_b64_tr_b16 v[52:53], v2 offset:31232
    ds_read_b64_tr_b16 v[54:55], v2 offset:32256
    s_waitcnt lgkmcnt(8)
    v_mfma_f32_32x32x16_bf16 v[16:31], v[56:59], a[52:55], v[16:31]
    v_mfma_f32_32x32x16_bf16 v[32:47], v[60:63], a[52:55], v[32:47]
    ds_read_b64_tr_b16 v[56:57], v2 offset:32768
    ds_read_b64_tr_b16 v[58:59], v2 offset:33792
    ds_read_b64_tr_b16 v[60:61], v2 offset:33280
    ds_read_b64_tr_b16 v[62:63], v2 offset:34304
    s_waitcnt lgkmcnt(8)
    v_mfma_f32_32x32x16_bf16 v[16:31], v[64:67], a[56:59], v[16:31]
    v_mfma_f32_32x32x16_bf16 v[32:47], v[68:71], a[56:59], v[32:47]
    s_add_u32 s17, s19, 64512
    s_mov_b32 m0, s17
    s_add_u32 s18, s31, 458880
    buffer_load_dwordx4 v4, s[8:11], s18 offen lds
    ds_read_b64_tr_b16 v[64:65], v2 offset:34816
    ds_read_b64_tr_b16 v[66:67], v2 offset:35840
    ds_read_b64_tr_b16 v[68:69], v2 offset:35328
    ds_read_b64_tr_b16 v[70:71], v2 offset:36352
    s_waitcnt lgkmcnt(8)
    v_mfma_f32_32x32x16_bf16 v[16:31], v[48:51], a[60:63], v[16:31]
    v_mfma_f32_32x32x16_bf16 v[32:47], v[52:55], a[60:63], v[32:47]
    ds_read_b64_tr_b16 v[48:49], v2 offset:36864
    ds_read_b64_tr_b16 v[50:51], v2 offset:37888
    ds_read_b64_tr_b16 v[52:53], v2 offset:37376
    ds_read_b64_tr_b16 v[54:55], v2 offset:38400
    s_waitcnt lgkmcnt(8)
    v_mfma_f32_32x32x16_bf16 v[16:31], v[56:59], a[64:67], v[16:31]
    v_mfma_f32_32x32x16_bf16 v[32:47], v[60:63], a[64:67], v[32:47]
    s_add_u32 s17, s19, 65536
    s_mov_b32 m0, s17
    s_add_u32 s18, s31, 524416
    buffer_load_dwordx4 v4, s[8:11], s18 offen lds
    ds_read_b64_tr_b16 v[56:57], v2 offset:38912
    ds_read_b64_tr_b16 v[58:59], v2 offset:39936
    ds_read_b64_tr_b16 v[60:61], v2 offset:39424
    ds_read_b64_tr_b16 v[62:63], v2 offset:40448
    s_waitcnt lgkmcnt(8)
    v_mfma_f32_32x32x16_bf16 v[16:31], v[64:67], a[68:71], v[16:31]
    v_mfma_f32_32x32x16_bf16 v[32:47], v[68:71], a[68:71], v[32:47]
    ds_read_b64_tr_b16 v[64:65], v2 offset:40960
    ds_read_b64_tr_b16 v[66:67], v2 offset:41984
    ds_read_b64_tr_b16 v[68:69], v2 offset:41472
    ds_read_b64_tr_b16 v[70:71], v2 offset:42496
    s_waitcnt lgkmcnt(8)
    v_mfma_f32_32x32x16_bf16 v[16:31], v[48:51], a[72:75], v[16:31]
    v_mfma_f32_32x32x16_bf16 v[32:47], v[52:55], a[72:75], v[32:47]
    s_add_u32 s17, s19, 66560
    s_mov_b32 m0, s17
    s_add_u32 s18, s31, 589952
    buffer_load_dwordx4 v4, s[8:11], s18 offen lds
    ds_read_b64_tr_b16 v[48:49], v2 offset:43008
    ds_read_b64_tr_b16 v[50:51], v2 offset:44032
    ds_read_b64_tr_b16 v[52:53], v2 offset:43520
    ds_read_b64_tr_b16 v[54:55], v2 offset:44544
    s_waitcnt lgkmcnt(8)
    v_mfma_f32_32x32x16_bf16 v[16:31], v[56:59], a[76:79], v[16:31]
    v_mfma_f32_32x32x16_bf16 v[32:47], v[60:63], a[76:79], v[32:47]
    ds_read_b64_tr_b16 v[56:57], v2 offset:45056
    ds_read_b64_tr_b16 v[58:59], v2 offset:46080
    ds_read_b64_tr_b16 v[60:61], v2 offset:45568
    ds_read_b64_tr_b16 v[62:63], v2 offset:46592
    s_waitcnt lgkmcnt(8)
    v_mfma_f32_32x32x16_bf16 v[16:31], v[64:67], a[80:83], v[16:31]
    v_mfma_f32_32x32x16_bf16 v[32:47], v[68:71], a[80:83], v[32:47]
    s_add_u32 s17, s19, 67584
    s_mov_b32 m0, s17
    s_add_u32 s18, s31, 655488
    buffer_load_dwordx4 v4, s[8:11], s18 offen lds
    ds_read_b64_tr_b16 v[64:65], v2 offset:47104
    ds_read_b64_tr_b16 v[66:67], v2 offset:48128
    ds_read_b64_tr_b16 v[68:69], v2 offset:47616
    ds_read_b64_tr_b16 v[70:71], v2 offset:48640
    s_waitcnt lgkmcnt(8)
    v_mfma_f32_32x32x16_bf16 v[16:31], v[48:51], a[84:87], v[16:31]
    v_mfma_f32_32x32x16_bf16 v[32:47], v[52:55], a[84:87], v[32:47]
    ds_read_b64_tr_b16 v[48:49], v2 offset:49152
    ds_read_b64_tr_b16 v[50:51], v2 offset:50176
    ds_read_b64_tr_b16 v[52:53], v2 offset:49664
    ds_read_b64_tr_b16 v[54:55], v2 offset:50688
    s_waitcnt lgkmcnt(8)
    v_mfma_f32_32x32x16_bf16 v[16:31], v[56:59], a[88:91], v[16:31]
    v_mfma_f32_32x32x16_bf16 v[32:47], v[60:63], a[88:91], v[32:47]
    s_add_u32 s17, s19, 68608
    s_mov_b32 m0, s17
    s_add_u32 s18, s31, 721024
    buffer_load_dwordx4 v4, s[8:11], s18 offen lds
    ds_read_b64_tr_b16 v[56:57], v2 offset:51200
    ds_read_b64_tr_b16 v[58:59], v2 offset:52224
    ds_read_b64_tr_b16 v[60:61], v2 offset:51712
    ds_read_b64_tr_b16 v[62:63], v2 offset:52736
    s_waitcnt lgkmcnt(8)
    v_mfma_f32_32x32x16_bf16 v[16:31], v[64:67], a[92:95], v[16:31]
    v_mfma_f32_32x32x16_bf16 v[32:47], v[68:71], a[92:95], v[32:47]
    ds_read_b64_tr_b16 v[64:65], v2 offset:53248
    ds_read_b64_tr_b16 v[66:67], v2 offset:54272
    ds_read_b64_tr_b16 v[68:69], v2 offset:53760
    ds_read_b64_tr_b16 v[70:71], v2 offset:54784
    s_waitcnt lgkmcnt(8)
    v_mfma_f32_32x32x16_bf16 v[16:31], v[48:51], a[96:99], v[16:31]
    v_mfma_f32_32x32x16_bf16 v[32:47], v[52:55], a[96:99], v[32:47]
    s_add_u32 s17, s19, 69632
    s_mov_b32 m0, s17
    s_add_u32 s18, s31, 786560
    buffer_load_dwordx4 v4, s[8:11], s18 offen lds
    ds_read_b64_tr_b16 v[48:49], v2 offset:55296
    ds_read_b64_tr_b16 v[50:51], v2 offset:56320
    ds_read_b64_tr_b16 v[52:53], v2 offset:55808
    ds_read_b64_tr_b16 v[54:55], v2 offset:56832
    s_waitcnt lgkmcnt(8)
    v_mfma_f32_32x32x16_bf16 v[16:31], v[56:59], a[100:103], v[16:31]
    v_mfma_f32_32x32x16_bf16 v[32:47], v[60:63], a[100:103], v[32:47]
    s_waitcnt lgkmcnt(4)
    v_mfma_f32_32x32x16_bf16 v[16:31], v[64:67], a[104:107], v[16:31]
    v_mfma_f32_32x32x16_bf16 v[32:47], v[68:71], a[104:107], v[32:47]
    s_add_u32 s17, s19, 70656
    s_mov_b32 m0, s17
    s_add_u32 s18, s31, 852096
    buffer_load_dwordx4 v4, s[8:11], s18 offen lds
    s_waitcnt lgkmcnt(0)
    v_mfma_f32_32x32x16_bf16 v[16:31], v[48:51], a[108:111], v[16:31]
    v_mfma_f32_32x32x16_bf16 v[32:47], v[52:55], a[108:111], v[32:47]
    s_nop 11
    v_cvt_pk_bf16_f32 v96, v16, v17
    v_cvt_pk_bf16_f32 v97, v18, v19
    v_cvt_pk_bf16_f32 v98, v20, v21
    v_cvt_pk_bf16_f32 v99, v22, v23
    v_cvt_pk_bf16_f32 v100, v24, v25
    v_cvt_pk_bf16_f32 v101, v26, v27
    v_cvt_pk_bf16_f32 v102, v28, v29
    v_cvt_pk_bf16_f32 v103, v30, v31
    v_cvt_pk_bf16_f32 v104, v32, v33
    v_cvt_pk_bf16_f32 v105, v34, v35
    v_cvt_pk_bf16_f32 v106, v36, v37
    v_cvt_pk_bf16_f32 v107, v38, v39
    v_cvt_pk_bf16_f32 v108, v40, v41
    v_cvt_pk_bf16_f32 v109, v42, v43
    v_cvt_pk_bf16_f32 v110, v44, v45
    v_cvt_pk_bf16_f32 v111, v46, v47
    s_waitcnt vmcnt(0)
    s_barrier
    ds_read_b64_tr_b16 v[48:49], v12 offset:0
    ds_read_b64_tr_b16 v[50:51], v12 offset:1024
    ds_read_b64_tr_b16 v[52:53], v12 offset:512
    ds_read_b64_tr_b16 v[54:55], v12 offset:1536
    ds_read_b64_tr_b16 v[56:57], v12 offset:2048
    ds_read_b64_tr_b16 v[58:59], v12 offset:3072
    ds_read_b64_tr_b16 v[60:61], v12 offset:2560
    ds_read_b64_tr_b16 v[62:63], v12 offset:3584
    ds_read_b64_tr_b16 v[64:65], v12 offset:4096
    ds_read_b64_tr_b16 v[66:67], v12 offset:5120
    ds_read_b64_tr_b16 v[68:69], v12 offset:4608
    ds_read_b64_tr_b16 v[70:71], v12 offset:5632
    s_waitcnt lgkmcnt(8)
    v_mfma_f32_32x32x16_bf16 v[16:31], v[48:51], a[0:3], 0
    v_mfma_f32_32x32x16_bf16 v[32:47], v[52:55], a[0:3], 0
    s_add_u32 s17, s19, 0
    s_mov_b32 m0, s17
    s_add_u32 s18, s31, 256
    buffer_load_dwordx4 v4, s[8:11], s18 offen lds
    ds_read_b64_tr_b16 v[48:49], v12 offset:6144
    ds_read_b64_tr_b16 v[50:51], v12 offset:7168
    ds_read_b64_tr_b16 v[52:53], v12 offset:6656
    ds_read_b64_tr_b16 v[54:55], v12 offset:7680
    s_waitcnt lgkmcnt(8)
    v_mfma_f32_32x32x16_bf16 v[16:31], v[56:59], a[4:7], v[16:31]
    v_mfma_f32_32x32x16_bf16 v[32:47], v[60:63], a[4:7], v[32:47]
    ds_read_b64_tr_b16 v[56:57], v12 offset:8192
    ds_read_b64_tr_b16 v[58:59], v12 offset:9216
    ds_read_b64_tr_b16 v[60:61], v12 offset:8704
    ds_read_b64_tr_b16 v[62:63], v12 offset:9728
    s_waitcnt lgkmcnt(8)
    v_mfma_f32_32x32x16_bf16 v[16:31], v[64:67], a[8:11], v[16:31]
    v_mfma_f32_32x32x16_bf16 v[32:47], v[68:71], a[8:11], v[32:47]
    s_add_u32 s17, s19, 1024
    s_mov_b32 m0, s17
    s_add_u32 s18, s31, 65792
    buffer_load_dwordx4 v4, s[8:11], s18 offen lds
    ds_read_b64_tr_b16 v[64:65], v12 offset:10240
    ds_read_b64_tr_b16 v[66:67], v12 offset:11264
    ds_read_b64_tr_b16 v[68:69], v12 offset:10752
    ds_read_b64_tr_b16 v[70:71], v12 offset:11776
    s_waitcnt lgkmcnt(8)
    v_mfma_f32_32x32x16_bf16 v[16:31], v[48:51], a[12:15], v[16:31]
    v_mfma_f32_32x32x16_bf16 v[32:47], v[52:55], a[12:15], v[32:47]
    ds_read_b64_tr_b16 v[48:49], v12 offset:12288
    ds_read_b64_tr_b16 v[50:51], v12 offset:13312
    ds_read_b64_tr_b16 v[52:53], v12 offset:12800
    ds_read_b64_tr_b16 v[54:55], v12 offset:13824
    s_waitcnt lgkmcnt(8)
    v_mfma_f32_32x32x16_bf16 v[16:31], v[56:59], a[16:19], v[16:31]
    v_mfma_f32_32x32x16_bf16 v[32:47], v[60:63], a[16:19], v[32:47]
    s_add_u32 s17, s19, 2048
    s_mov_b32 m0, s17
    s_add_u32 s18, s31, 131328
    buffer_load_dwordx4 v4, s[8:11], s18 offen lds
    ds_read_b64_tr_b16 v[56:57], v12 offset:14336
    ds_read_b64_tr_b16 v[58:59], v12 offset:15360
    ds_read_b64_tr_b16 v[60:61], v12 offset:14848
    ds_read_b64_tr_b16 v[62:63], v12 offset:15872
    s_waitcnt lgkmcnt(8)
    v_mfma_f32_32x32x16_bf16 v[16:31], v[64:67], a[20:23], v[16:31]
    v_mfma_f32_32x32x16_bf16 v[32:47], v[68:71], a[20:23], v[32:47]
    ds_read_b64_tr_b16 v[64:65], v12 offset:16384
    ds_read_b64_tr_b16 v[66:67], v12 offset:17408
    ds_read_b64_tr_b16 v[68:69], v12 offset:16896
    ds_read_b64_tr_b16 v[70:71], v12 offset:17920
    s_waitcnt lgkmcnt(8)
    v_mfma_f32_32x32x16_bf16 v[16:31], v[48:51], a[24:27], v[16:31]
    v_mfma_f32_32x32x16_bf16 v[32:47], v[52:55], a[24:27], v[32:47]
    s_add_u32 s17, s19, 3072
    s_mov_b32 m0, s17
    s_add_u32 s18, s31, 196864
    buffer_load_dwordx4 v4, s[8:11], s18 offen lds
    ds_read_b64_tr_b16 v[48:49], v12 offset:18432
    ds_read_b64_tr_b16 v[50:51], v12 offset:19456
    ds_read_b64_tr_b16 v[52:53], v12 offset:18944
    ds_read_b64_tr_b16 v[54:55], v12 offset:19968
    s_waitcnt lgkmcnt(8)
    v_mfma_f32_32x32x16_bf16 v[16:31], v[56:59], a[28:31], v[16:31]
    v_mfma_f32_32x32x16_bf16 v[32:47], v[60:63], a[28:31], v[32:47]
    ds_read_b64_tr_b16 v[56:57], v12 offset:20480
    ds_read_b64_tr_b16 v[58:59], v12 offset:21504
    ds_read_b64_tr_b16 v[60:61], v12 offset:20992
    ds_read_b64_tr_b16 v[62:63], v12 offset:22016
    s_waitcnt lgkmcnt(8)
    v_mfma_f32_32x32x16_bf16 v[16:31], v[64:67], a[32:35], v[16:31]
    v_mfma_f32_32x32x16_bf16 v[32:47], v[68:71], a[32:35], v[32:47]
    s_add_u32 s17, s19, 4096
    s_mov_b32 m0, s17
    s_add_u32 s18, s31, 262400
    buffer_load_dwordx4 v4, s[8:11], s18 offen lds
    ds_read_b64_tr_b16 v[64:65], v12 offset:22528
    ds_read_b64_tr_b16 v[66:67], v12 offset:23552
    ds_read_b64_tr_b16 v[68:69], v12 offset:23040
    ds_read_b64_tr_b16 v[70:71], v12 offset:24064
    s_waitcnt lgkmcnt(8)
    v_mfma_f32_32x32x16_bf16 v[16:31], v[48:51], a[36:39], v[16:31]
    v_mfma_f32_32x32x16_bf16 v[32:47], v[52:55], a[36:39], v[32:47]
    ds_read_b64_tr_b16 v[48:49], v12 offset:24576
    ds_read_b64_tr_b16 v[50:51], v12 offset:25600
    ds_read_b64_tr_b16 v[52:53], v12 offset:25088
    ds_read_b64_tr_b16 v[54:55], v12 offset:26112
    s_waitcnt lgkmcnt(8)
    v_mfma_f32_32x32x16_bf16 v[16:31], v[56:59], a[40:43], v[16:31]
    v_mfma_f32_32x32x16_bf16 v[32:47], v[60:63], a[40:43], v[32:47]
    s_add_u32 s17, s19, 5120
    s_mov_b32 m0, s17
    s_add_u32 s18, s31, 327936
    buffer_load_dwordx4 v4, s[8:11], s18 offen lds
    ds_read_b64_tr_b16 v[56:57], v12 offset:26624
    ds_read_b64_tr_b16 v[58:59], v12 offset:27648
    ds_read_b64_tr_b16 v[60:61], v12 offset:27136
    ds_read_b64_tr_b16 v[62:63], v12 offset:28160
    s_waitcnt lgkmcnt(8)
    v_mfma_f32_32x32x16_bf16 v[16:31], v[64:67], a[44:47], v[16:31]
    v_mfma_f32_32x32x16_bf16 v[32:47], v[68:71], a[44:47], v[32:47]
    ds_read_b64_tr_b16 v[64:65], v12 offset:28672
    ds_read_b64_tr_b16 v[66:67], v12 offset:29696
    ds_read_b64_tr_b16 v[68:69], v12 offset:29184
    ds_read_b64_tr_b16 v[70:71], v12 offset:30208
    s_waitcnt lgkmcnt(8)
    v_mfma_f32_32x32x16_bf16 v[16:31], v[48:51], a[48:51], v[16:31]
    v_mfma_f32_32x32x16_bf16 v[32:47], v[52:55], a[48:51], v[32:47]
    s_add_u32 s17, s19, 6144
    s_mov_b32 m0, s17
    s_add_u32 s18, s31, 393472
    buffer_load_dwordx4 v4, s[8:11], s18 offen lds
    ds_read_b64_tr_b16 v[48:49], v12 offset:30720
    ds_read_b64_tr_b16 v[50:51], v12 offset:31744
    ds_read_b64_tr_b16 v[52:53], v12 offset:31232
    ds_read_b64_tr_b16 v[54:55], v12 offset:32256
    s_waitcnt lgkmcnt(8)
    v_mfma_f32_32x32x16_bf16 v[16:31], v[56:59], a[52:55], v[16:31]
    v_mfma_f32_32x32x16_bf16 v[32:47], v[60:63], a[52:55], v[32:47]
    ds_read_b64_tr_b16 v[56:57], v12 offset:32768
    ds_read_b64_tr_b16 v[58:59], v12 offset:33792
    ds_read_b64_tr_b16 v[60:61], v12 offset:33280
    ds_read_b64_tr_b16 v[62:63], v12 offset:34304
    s_waitcnt lgkmcnt(8)
    v_mfma_f32_32x32x16_bf16 v[16:31], v[64:67], a[56:59], v[16:31]
    v_mfma_f32_32x32x16_bf16 v[32:47], v[68:71], a[56:59], v[32:47]
    s_add_u32 s17, s19, 7168
    s_mov_b32 m0, s17
    s_add_u32 s18, s31, 459008
    buffer_load_dwordx4 v4, s[8:11], s18 offen lds
    ds_read_b64_tr_b16 v[64:65], v12 offset:34816
    ds_read_b64_tr_b16 v[66:67], v12 offset:35840
    ds_read_b64_tr_b16 v[68:69], v12 offset:35328
    ds_read_b64_tr_b16 v[70:71], v12 offset:36352
    s_waitcnt lgkmcnt(8)
    v_mfma_f32_32x32x16_bf16 v[16:31], v[48:51], a[60:63], v[16:31]
    v_mfma_f32_32x32x16_bf16 v[32:47], v[52:55], a[60:63], v[32:47]
    ds_read_b64_tr_b16 v[48:49], v12 offset:36864
    ds_read_b64_tr_b16 v[50:51], v12 offset:37888
    ds_read_b64_tr_b16 v[52:53], v12 offset:37376
    ds_read_b64_tr_b16 v[54:55], v12 offset:38400
    s_waitcnt lgkmcnt(8)
    v_mfma_f32_32x32x16_bf16 v[16:31], v[56:59], a[64:67], v[16:31]
    v_mfma_f32_32x32x16_bf16 v[32:47], v[60:63], a[64:67], v[32:47]
    s_add_u32 s17, s19, 8192
    s_mov_b32 m0, s17
    s_add_u32 s18, s31, 524544
    buffer_load_dwordx4 v4, s[8:11], s18 offen lds
    ds_read_b64_tr_b16 v[56:57], v12 offset:38912
    ds_read_b64_tr_b16 v[58:59], v12 offset:39936
    ds_read_b64_tr_b16 v[60:61], v12 offset:39424
    ds_read_b64_tr_b16 v[62:63], v12 offset:40448
    s_waitcnt lgkmcnt(8)
    v_mfma_f32_32x32x16_bf16 v[16:31], v[64:67], a[68:71], v[16:31]
    v_mfma_f32_32x32x16_bf16 v[32:47], v[68:71], a[68:71], v[32:47]
    ds_read_b64_tr_b16 v[64:65], v12 offset:40960
    ds_read_b64_tr_b16 v[66:67], v12 offset:41984
    ds_read_b64_tr_b16 v[68:69], v12 offset:41472
    ds_read_b64_tr_b16 v[70:71], v12 offset:42496
    s_waitcnt lgkmcnt(8)
    v_mfma_f32_32x32x16_bf16 v[16:31], v[48:51], a[72:75], v[16:31]
    v_mfma_f32_32x32x16_bf16 v[32:47], v[52:55], a[72:75], v[32:47]
    s_add_u32 s17, s19, 9216
    s_mov_b32 m0, s17
    s_add_u32 s18, s31, 590080
    buffer_load_dwordx4 v4, s[8:11], s18 offen lds
    ds_read_b64_tr_b16 v[48:49], v12 offset:43008
    ds_read_b64_tr_b16 v[50:51], v12 offset:44032
    ds_read_b64_tr_b16 v[52:53], v12 offset:43520
    ds_read_b64_tr_b16 v[54:55], v12 offset:44544
    s_waitcnt lgkmcnt(8)
    v_mfma_f32_32x32x16_bf16 v[16:31], v[56:59], a[76:79], v[16:31]
    v_mfma_f32_32x32x16_bf16 v[32:47], v[60:63], a[76:79], v[32:47]
    ds_read_b64_tr_b16 v[56:57], v12 offset:45056
    ds_read_b64_tr_b16 v[58:59], v12 offset:46080
    ds_read_b64_tr_b16 v[60:61], v12 offset:45568
    ds_read_b64_tr_b16 v[62:63], v12 offset:46592
    s_waitcnt lgkmcnt(8)
    v_mfma_f32_32x32x16_bf16 v[16:31], v[64:67], a[80:83], v[16:31]
    v_mfma_f32_32x32x16_bf16 v[32:47], v[68:71], a[80:83], v[32:47]
    s_add_u32 s17, s19, 10240
    s_mov_b32 m0, s17
    s_add_u32 s18, s31, 655616
    buffer_load_dwordx4 v4, s[8:11], s18 offen lds
    ds_read_b64_tr_b16 v[64:65], v12 offset:47104
    ds_read_b64_tr_b16 v[66:67], v12 offset:48128
    ds_read_b64_tr_b16 v[68:69], v12 offset:47616
    ds_read_b64_tr_b16 v[70:71], v12 offset:48640
    s_waitcnt lgkmcnt(8)
    v_mfma_f32_32x32x16_bf16 v[16:31], v[48:51], a[84:87], v[16:31]
    v_mfma_f32_32x32x16_bf16 v[32:47], v[52:55], a[84:87], v[32:47]
    ds_read_b64_tr_b16 v[48:49], v12 offset:49152
    ds_read_b64_tr_b16 v[50:51], v12 offset:50176
    ds_read_b64_tr_b16 v[52:53], v12 offset:49664
    ds_read_b64_tr_b16 v[54:55], v12 offset:50688
    s_waitcnt lgkmcnt(8)
    v_mfma_f32_32x32x16_bf16 v[16:31], v[56:59], a[88:91], v[16:31]
    v_mfma_f32_32x32x16_bf16 v[32:47], v[60:63], a[88:91], v[32:47]
    s_add_u32 s17, s19, 11264
    s_mov_b32 m0, s17
    s_add_u32 s18, s31, 721152
    buffer_load_dwordx4 v4, s[8:11], s18 offen lds
    ds_read_b64_tr_b16 v[56:57], v12 offset:51200
    ds_read_b64_tr_b16 v[58:59], v12 offset:52224
    ds_read_b64_tr_b16 v[60:61], v12 offset:51712
    ds_read_b64_tr_b16 v[62:63], v12 offset:52736
    s_waitcnt lgkmcnt(8)
    v_mfma_f32_32x32x16_bf16 v[16:31], v[64:67], a[92:95], v[16:31]
    v_mfma_f32_32x32x16_bf16 v[32:47], v[68:71], a[92:95], v[32:47]
    ds_read_b64_tr_b16 v[64:65], v12 offset:53248
    ds_read_b64_tr_b16 v[66:67], v12 offset:54272
    ds_read_b64_tr_b16 v[68:69], v12 offset:53760
    ds_read_b64_tr_b16 v[70:71], v12 offset:54784
    s_waitcnt lgkmcnt(8)
    v_mfma_f32_32x32x16_bf16 v[16:31], v[48:51], a[96:99], v[16:31]
    v_mfma_f32_32x32x16_bf16 v[32:47], v[52:55], a[96:99], v[32:47]
    s_add_u32 s17, s19, 12288
    s_mov_b32 m0, s17
    s_add_u32 s18, s31, 786688
    buffer_load_dwordx4 v4, s[8:11], s18 offen lds
    ds_read_b64_tr_b16 v[48:49], v12 offset:55296
    ds_read_b64_tr_b16 v[50:51], v12 offset:56320
    ds_read_b64_tr_b16 v[52:53], v12 offset:55808
    ds_read_b64_tr_b16 v[54:55], v12 offset:56832
    s_waitcnt lgkmcnt(8)
    v_mfma_f32_32x32x16_bf16 v[16:31], v[56:59], a[100:103], v[16:31]
    v_mfma_f32_32x32x16_bf16 v[32:47], v[60:63], a[100:103], v[32:47]
    s_waitcnt lgkmcnt(4)
    v_mfma_f32_32x32x16_bf16 v[16:31], v[64:67], a[104:107], v[16:31]
    v_mfma_f32_32x32x16_bf16 v[32:47], v[68:71], a[104:107], v[32:47]
    s_add_u32 s17, s19, 13312
    s_mov_b32 m0, s17
    s_add_u32 s18, s31, 852224
    buffer_load_dwordx4 v4, s[8:11], s18 offen lds
    s_waitcnt lgkmcnt(0)
    v_mfma_f32_32x32x16_bf16 v[16:31], v[48:51], a[108:111], v[16:31]
    v_mfma_f32_32x32x16_bf16 v[32:47], v[52:55], a[108:111], v[32:47]
    s_nop 11
    v_cvt_pk_bf16_f32 v112, v16, v17
    v_cvt_pk_bf16_f32 v113, v18, v19
    v_cvt_pk_bf16_f32 v114, v20, v21
    v_cvt_pk_bf16_f32 v115, v22, v23
    v_cvt_pk_bf16_f32 v116, v24, v25
    v_cvt_pk_bf16_f32 v117, v26, v27
    v_cvt_pk_bf16_f32 v118, v28, v29
    v_cvt_pk_bf16_f32 v119, v30, v31
    v_cvt_pk_bf16_f32 v120, v32, v33
    v_cvt_pk_bf16_f32 v121, v34, v35
    v_cvt_pk_bf16_f32 v122, v36, v37
    v_cvt_pk_bf16_f32 v123, v38, v39
    v_cvt_pk_bf16_f32 v124, v40, v41
    v_cvt_pk_bf16_f32 v125, v42, v43
    v_cvt_pk_bf16_f32 v126, v44, v45
    v_cvt_pk_bf16_f32 v127, v46, v47
    s_waitcnt vmcnt(0)
    s_barrier
    ds_read_b64_tr_b16 v[48:49], v2 offset:0
    ds_read_b64_tr_b16 v[50:51], v2 offset:1024
    ds_read_b64_tr_b16 v[52:53], v2 offset:512
    ds_read_b64_tr_b16 v[54:55], v2 offset:1536
    ds_read_b64_tr_b16 v[56:57], v2 offset:2048
    ds_read_b64_tr_b16 v[58:59], v2 offset:3072
    ds_read_b64_tr_b16 v[60:61], v2 offset:2560
    ds_read_b64_tr_b16 v[62:63], v2 offset:3584
    ds_read_b64_tr_b16 v[64:65], v2 offset:4096
    ds_read_b64_tr_b16 v[66:67], v2 offset:5120
    ds_read_b64_tr_b16 v[68:69], v2 offset:4608
    ds_read_b64_tr_b16 v[70:71], v2 offset:5632
    s_waitcnt lgkmcnt(8)
    v_mfma_f32_32x32x16_bf16 v[16:31], v[48:51], a[0:3], 0
    v_mfma_f32_32x32x16_bf16 v[32:47], v[52:55], a[0:3], 0
    s_add_u32 s17, s19, 57344
    s_mov_b32 m0, s17
    s_add_u32 s18, s31, 384
    buffer_load_dwordx4 v4, s[8:11], s18 offen lds
    ds_read_b64_tr_b16 v[48:49], v2 offset:6144
    ds_read_b64_tr_b16 v[50:51], v2 offset:7168
    ds_read_b64_tr_b16 v[52:53], v2 offset:6656
    ds_read_b64_tr_b16 v[54:55], v2 offset:7680
    s_waitcnt lgkmcnt(8)
    v_mfma_f32_32x32x16_bf16 v[16:31], v[56:59], a[4:7], v[16:31]
    v_mfma_f32_32x32x16_bf16 v[32:47], v[60:63], a[4:7], v[32:47]
    ds_read_b64_tr_b16 v[56:57], v2 offset:8192
    ds_read_b64_tr_b16 v[58:59], v2 offset:9216
    ds_read_b64_tr_b16 v[60:61], v2 offset:8704
    ds_read_b64_tr_b16 v[62:63], v2 offset:9728
    s_waitcnt lgkmcnt(8)
    v_mfma_f32_32x32x16_bf16 v[16:31], v[64:67], a[8:11], v[16:31]
    v_mfma_f32_32x32x16_bf16 v[32:47], v[68:71], a[8:11], v[32:47]
    s_add_u32 s17, s19, 58368
    s_mov_b32 m0, s17
    s_add_u32 s18, s31, 65920
    buffer_load_dwordx4 v4, s[8:11], s18 offen lds
    ds_read_b64_tr_b16 v[64:65], v2 offset:10240
    ds_read_b64_tr_b16 v[66:67], v2 offset:11264
    ds_read_b64_tr_b16 v[68:69], v2 offset:10752
    ds_read_b64_tr_b16 v[70:71], v2 offset:11776
    s_waitcnt lgkmcnt(8)
    v_mfma_f32_32x32x16_bf16 v[16:31], v[48:51], a[12:15], v[16:31]
    v_mfma_f32_32x32x16_bf16 v[32:47], v[52:55], a[12:15], v[32:47]
    ds_read_b64_tr_b16 v[48:49], v2 offset:12288
    ds_read_b64_tr_b16 v[50:51], v2 offset:13312
    ds_read_b64_tr_b16 v[52:53], v2 offset:12800
    ds_read_b64_tr_b16 v[54:55], v2 offset:13824
    s_waitcnt lgkmcnt(8)
    v_mfma_f32_32x32x16_bf16 v[16:31], v[56:59], a[16:19], v[16:31]
    v_mfma_f32_32x32x16_bf16 v[32:47], v[60:63], a[16:19], v[32:47]
    s_add_u32 s17, s19, 59392
    s_mov_b32 m0, s17
    s_add_u32 s18, s31, 131456
    buffer_load_dwordx4 v4, s[8:11], s18 offen lds
    ds_read_b64_tr_b16 v[56:57], v2 offset:14336
    ds_read_b64_tr_b16 v[58:59], v2 offset:15360
    ds_read_b64_tr_b16 v[60:61], v2 offset:14848
    ds_read_b64_tr_b16 v[62:63], v2 offset:15872
    s_waitcnt lgkmcnt(8)
    v_mfma_f32_32x32x16_bf16 v[16:31], v[64:67], a[20:23], v[16:31]
    v_mfma_f32_32x32x16_bf16 v[32:47], v[68:71], a[20:23], v[32:47]
    ds_read_b64_tr_b16 v[64:65], v2 offset:16384
    ds_read_b64_tr_b16 v[66:67], v2 offset:17408
    ds_read_b64_tr_b16 v[68:69], v2 offset:16896
    ds_read_b64_tr_b16 v[70:71], v2 offset:17920
    s_waitcnt lgkmcnt(8)
    v_mfma_f32_32x32x16_bf16 v[16:31], v[48:51], a[24:27], v[16:31]
    v_mfma_f32_32x32x16_bf16 v[32:47], v[52:55], a[24:27], v[32:47]
    s_add_u32 s17, s19, 60416
    s_mov_b32 m0, s17
    s_add_u32 s18, s31, 196992
    buffer_load_dwordx4 v4, s[8:11], s18 offen lds
    ds_read_b64_tr_b16 v[48:49], v2 offset:18432
    ds_read_b64_tr_b16 v[50:51], v2 offset:19456
    ds_read_b64_tr_b16 v[52:53], v2 offset:18944
    ds_read_b64_tr_b16 v[54:55], v2 offset:19968
    s_waitcnt lgkmcnt(8)
    v_mfma_f32_32x32x16_bf16 v[16:31], v[56:59], a[28:31], v[16:31]
    v_mfma_f32_32x32x16_bf16 v[32:47], v[60:63], a[28:31], v[32:47]
    ds_read_b64_tr_b16 v[56:57], v2 offset:20480
    ds_read_b64_tr_b16 v[58:59], v2 offset:21504
    ds_read_b64_tr_b16 v[60:61], v2 offset:20992
    ds_read_b64_tr_b16 v[62:63], v2 offset:22016
    s_waitcnt lgkmcnt(8)
    v_mfma_f32_32x32x16_bf16 v[16:31], v[64:67], a[32:35], v[16:31]
    v_mfma_f32_32x32x16_bf16 v[32:47], v[68:71], a[32:35], v[32:47]
    s_add_u32 s17, s19, 61440
    s_mov_b32 m0, s17
    s_add_u32 s18, s31, 262528
    buffer_load_dwordx4 v4, s[8:11], s18 offen lds
    ds_read_b64_tr_b16 v[64:65], v2 offset:22528
    ds_read_b64_tr_b16 v[66:67], v2 offset:23552
    ds_read_b64_tr_b16 v[68:69], v2 offset:23040
    ds_read_b64_tr_b16 v[70:71], v2 offset:24064
    s_waitcnt lgkmcnt(8)
    v_mfma_f32_32x32x16_bf16 v[16:31], v[48:51], a[36:39], v[16:31]
    v_mfma_f32_32x32x16_bf16 v[32:47], v[52:55], a[36:39], v[32:47]
    ds_read_b64_tr_b16 v[48:49], v2 offset:24576
    ds_read_b64_tr_b16 v[50:51], v2 offset:25600
    ds_read_b64_tr_b16 v[52:53], v2 offset:25088
    ds_read_b64_tr_b16 v[54:55], v2 offset:26112
    s_waitcnt lgkmcnt(8)
    v_mfma_f32_32x32x16_bf16 v[16:31], v[56:59], a[40:43], v[16:31]
    v_mfma_f32_32x32x16_bf16 v[32:47], v[60:63], a[40:43], v[32:47]
    s_add_u32 s17, s19, 62464
    s_mov_b32 m0, s17
    s_add_u32 s18, s31, 328064
    buffer_load_dwordx4 v4, s[8:11], s18 offen lds
    ds_read_b64_tr_b16 v[56:57], v2 offset:26624
    ds_read_b64_tr_b16 v[58:59], v2 offset:27648
    ds_read_b64_tr_b16 v[60:61], v2 offset:27136
    ds_read_b64_tr_b16 v[62:63], v2 offset:28160
    s_waitcnt lgkmcnt(8)
    v_mfma_f32_32x32x16_bf16 v[16:31], v[64:67], a[44:47], v[16:31]
    v_mfma_f32_32x32x16_bf16 v[32:47], v[68:71], a[44:47], v[32:47]
    ds_read_b64_tr_b16 v[64:65], v2 offset:28672
    ds_read_b64_tr_b16 v[66:67], v2 offset:29696
    ds_read_b64_tr_b16 v[68:69], v2 offset:29184
    ds_read_b64_tr_b16 v[70:71], v2 offset:30208
    s_waitcnt lgkmcnt(8)
    v_mfma_f32_32x32x16_bf16 v[16:31], v[48:51], a[48:51], v[16:31]
    v_mfma_f32_32x32x16_bf16 v[32:47], v[52:55], a[48:51], v[32:47]
    s_add_u32 s17, s19, 63488
    s_mov_b32 m0, s17
    s_add_u32 s18, s31, 393600
    buffer_load_dwordx4 v4, s[8:11], s18 offen lds
    ds_read_b64_tr_b16 v[48:49], v2 offset:30720
    ds_read_b64_tr_b16 v[50:51], v2 offset:31744
    ds_read_b64_tr_b16 v[52:53], v2 offset:31232
    ds_read_b64_tr_b16 v[54:55], v2 offset:32256
    s_waitcnt lgkmcnt(8)
    v_mfma_f32_32x32x16_bf16 v[16:31], v[56:59], a[52:55], v[16:31]
    v_mfma_f32_32x32x16_bf16 v[32:47], v[60:63], a[52:55], v[32:47]
    ds_read_b64_tr_b16 v[56:57], v2 offset:32768
    ds_read_b64_tr_b16 v[58:59], v2 offset:33792
    ds_read_b64_tr_b16 v[60:61], v2 offset:33280
    ds_read_b64_tr_b16 v[62:63], v2 offset:34304
    s_waitcnt lgkmcnt(8)
    v_mfma_f32_32x32x16_bf16 v[16:31], v[64:67], a[56:59], v[16:31]
    v_mfma_f32_32x32x16_bf16 v[32:47], v[68:71], a[56:59], v[32:47]
    s_add_u32 s17, s19, 64512
    s_mov_b32 m0, s17
    s_add_u32 s18, s31, 459136
    buffer_load_dwordx4 v4, s[8:11], s18 offen lds
    ds_read_b64_tr_b16 v[64:65], v2 offset:34816
    ds_read_b64_tr_b16 v[66:67], v2 offset:35840
    ds_read_b64_tr_b16 v[68:69], v2 offset:35328
    ds_read_b64_tr_b16 v[70:71], v2 offset:36352
    s_waitcnt lgkmcnt(8)
    v_mfma_f32_32x32x16_bf16 v[16:31], v[48:51], a[60:63], v[16:31]
    v_mfma_f32_32x32x16_bf16 v[32:47], v[52:55], a[60:63], v[32:47]
    ds_read_b64_tr_b16 v[48:49], v2 offset:36864
    ds_read_b64_tr_b16 v[50:51], v2 offset:37888
    ds_read_b64_tr_b16 v[52:53], v2 offset:37376
    ds_read_b64_tr_b16 v[54:55], v2 offset:38400
    s_waitcnt lgkmcnt(8)
    v_mfma_f32_32x32x16_bf16 v[16:31], v[56:59], a[64:67], v[16:31]
    v_mfma_f32_32x32x16_bf16 v[32:47], v[60:63], a[64:67], v[32:47]
    s_add_u32 s17, s19, 65536
    s_mov_b32 m0, s17
    s_add_u32 s18, s31, 524672
    buffer_load_dwordx4 v4, s[8:11], s18 offen lds
    ds_read_b64_tr_b16 v[56:57], v2 offset:38912
    ds_read_b64_tr_b16 v[58:59], v2 offset:39936
    ds_read_b64_tr_b16 v[60:61], v2 offset:39424
    ds_read_b64_tr_b16 v[62:63], v2 offset:40448
    s_waitcnt lgkmcnt(8)
    v_mfma_f32_32x32x16_bf16 v[16:31], v[64:67], a[68:71], v[16:31]
    v_mfma_f32_32x32x16_bf16 v[32:47], v[68:71], a[68:71], v[32:47]
    ds_read_b64_tr_b16 v[64:65], v2 offset:40960
    ds_read_b64_tr_b16 v[66:67], v2 offset:41984
    ds_read_b64_tr_b16 v[68:69], v2 offset:41472
    ds_read_b64_tr_b16 v[70:71], v2 offset:42496
    s_waitcnt lgkmcnt(8)
    v_mfma_f32_32x32x16_bf16 v[16:31], v[48:51], a[72:75], v[16:31]
    v_mfma_f32_32x32x16_bf16 v[32:47], v[52:55], a[72:75], v[32:47]
    s_add_u32 s17, s19, 66560
    s_mov_b32 m0, s17
    s_add_u32 s18, s31, 590208
    buffer_load_dwordx4 v4, s[8:11], s18 offen lds
    ds_read_b64_tr_b16 v[48:49], v2 offset:43008
    ds_read_b64_tr_b16 v[50:51], v2 offset:44032
    ds_read_b64_tr_b16 v[52:53], v2 offset:43520
    ds_read_b64_tr_b16 v[54:55], v2 offset:44544
    s_waitcnt lgkmcnt(8)
    v_mfma_f32_32x32x16_bf16 v[16:31], v[56:59], a[76:79], v[16:31]
    v_mfma_f32_32x32x16_bf16 v[32:47], v[60:63], a[76:79], v[32:47]
    ds_read_b64_tr_b16 v[56:57], v2 offset:45056
    ds_read_b64_tr_b16 v[58:59], v2 offset:46080
    ds_read_b64_tr_b16 v[60:61], v2 offset:45568
    ds_read_b64_tr_b16 v[62:63], v2 offset:46592
    s_waitcnt lgkmcnt(8)
    v_mfma_f32_32x32x16_bf16 v[16:31], v[64:67], a[80:83], v[16:31]
    v_mfma_f32_32x32x16_bf16 v[32:47], v[68:71], a[80:83], v[32:47]
    s_add_u32 s17, s19, 67584
    s_mov_b32 m0, s17
    s_add_u32 s18, s31, 655744
    buffer_load_dwordx4 v4, s[8:11], s18 offen lds
    ds_read_b64_tr_b16 v[64:65], v2 offset:47104
    ds_read_b64_tr_b16 v[66:67], v2 offset:48128
    ds_read_b64_tr_b16 v[68:69], v2 offset:47616
    ds_read_b64_tr_b16 v[70:71], v2 offset:48640
    s_waitcnt lgkmcnt(8)
    v_mfma_f32_32x32x16_bf16 v[16:31], v[48:51], a[84:87], v[16:31]
    v_mfma_f32_32x32x16_bf16 v[32:47], v[52:55], a[84:87], v[32:47]
    ds_read_b64_tr_b16 v[48:49], v2 offset:49152
    ds_read_b64_tr_b16 v[50:51], v2 offset:50176
    ds_read_b64_tr_b16 v[52:53], v2 offset:49664
    ds_read_b64_tr_b16 v[54:55], v2 offset:50688
    s_waitcnt lgkmcnt(8)
    v_mfma_f32_32x32x16_bf16 v[16:31], v[56:59], a[88:91], v[16:31]
    v_mfma_f32_32x32x16_bf16 v[32:47], v[60:63], a[88:91], v[32:47]
    s_add_u32 s17, s19, 68608
    s_mov_b32 m0, s17
    s_add_u32 s18, s31, 721280
    buffer_load_dwordx4 v4, s[8:11], s18 offen lds
    ds_read_b64_tr_b16 v[56:57], v2 offset:51200
    ds_read_b64_tr_b16 v[58:59], v2 offset:52224
    ds_read_b64_tr_b16 v[60:61], v2 offset:51712
    ds_read_b64_tr_b16 v[62:63], v2 offset:52736
    s_waitcnt lgkmcnt(8)
    v_mfma_f32_32x32x16_bf16 v[16:31], v[64:67], a[92:95], v[16:31]
    v_mfma_f32_32x32x16_bf16 v[32:47], v[68:71], a[92:95], v[32:47]
    ds_read_b64_tr_b16 v[64:65], v2 offset:53248
    ds_read_b64_tr_b16 v[66:67], v2 offset:54272
    ds_read_b64_tr_b16 v[68:69], v2 offset:53760
    ds_read_b64_tr_b16 v[70:71], v2 offset:54784
    s_waitcnt lgkmcnt(8)
    v_mfma_f32_32x32x16_bf16 v[16:31], v[48:51], a[96:99], v[16:31]
    v_mfma_f32_32x32x16_bf16 v[32:47], v[52:55], a[96:99], v[32:47]
    s_add_u32 s17, s19, 69632
    s_mov_b32 m0, s17
    s_add_u32 s18, s31, 786816
    buffer_load_dwordx4 v4, s[8:11], s18 offen lds
    ds_read_b64_tr_b16 v[48:49], v2 offset:55296
    ds_read_b64_tr_b16 v[50:51], v2 offset:56320
    ds_read_b64_tr_b16 v[52:53], v2 offset:55808
    ds_read_b64_tr_b16 v[54:55], v2 offset:56832
    s_waitcnt lgkmcnt(8)
    v_mfma_f32_32x32x16_bf16 v[16:31], v[56:59], a[100:103], v[16:31]
    v_mfma_f32_32x32x16_bf16 v[32:47], v[60:63], a[100:103], v[32:47]
    s_waitcnt lgkmcnt(4)
    v_mfma_f32_32x32x16_bf16 v[16:31], v[64:67], a[104:107], v[16:31]
    v_mfma_f32_32x32x16_bf16 v[32:47], v[68:71], a[104:107], v[32:47]
    s_add_u32 s17, s19, 70656
    s_mov_b32 m0, s17
    s_add_u32 s18, s31, 852352
    buffer_load_dwordx4 v4, s[8:11], s18 offen lds
    s_waitcnt lgkmcnt(0)
    v_mfma_f32_32x32x16_bf16 v[16:31], v[48:51], a[108:111], v[16:31]
    v_mfma_f32_32x32x16_bf16 v[32:47], v[52:55], a[108:111], v[32:47]
    s_nop 11
    v_cvt_pk_bf16_f32 v128, v16, v17
    v_cvt_pk_bf16_f32 v129, v18, v19
    v_cvt_pk_bf16_f32 v130, v20, v21
    v_cvt_pk_bf16_f32 v131, v22, v23
    v_cvt_pk_bf16_f32 v132, v24, v25
    v_cvt_pk_bf16_f32 v133, v26, v27
    v_cvt_pk_bf16_f32 v134, v28, v29
    v_cvt_pk_bf16_f32 v135, v30, v31
    v_cvt_pk_bf16_f32 v136, v32, v33
    v_cvt_pk_bf16_f32 v137, v34, v35
    v_cvt_pk_bf16_f32 v138, v36, v37
    v_cvt_pk_bf16_f32 v139, v38, v39
    v_cvt_pk_bf16_f32 v140, v40, v41
    v_cvt_pk_bf16_f32 v141, v42, v43
    v_cvt_pk_bf16_f32 v142, v44, v45
    v_cvt_pk_bf16_f32 v143, v46, v47
    s_waitcnt vmcnt(0)
    s_barrier
    ds_read_b64_tr_b16 v[48:49], v12 offset:0
    ds_read_b64_tr_b16 v[50:51], v12 offset:1024
    ds_read_b64_tr_b16 v[52:53], v12 offset:512
    ds_read_b64_tr_b16 v[54:55], v12 offset:1536
    ds_read_b64_tr_b16 v[56:57], v12 offset:2048
    ds_read_b64_tr_b16 v[58:59], v12 offset:3072
    ds_read_b64_tr_b16 v[60:61], v12 offset:2560
    ds_read_b64_tr_b16 v[62:63], v12 offset:3584
    ds_read_b64_tr_b16 v[64:65], v12 offset:4096
    ds_read_b64_tr_b16 v[66:67], v12 offset:5120
    ds_read_b64_tr_b16 v[68:69], v12 offset:4608
    ds_read_b64_tr_b16 v[70:71], v12 offset:5632
    s_waitcnt lgkmcnt(8)
    v_mfma_f32_32x32x16_bf16 v[16:31], v[48:51], a[0:3], 0
    v_mfma_f32_32x32x16_bf16 v[32:47], v[52:55], a[0:3], 0
    s_add_u32 s17, s19, 0
    s_mov_b32 m0, s17
    s_add_u32 s18, s31, 0
    buffer_load_dwordx4 v4, s[12:15], s18 offen lds
    ds_read_b64_tr_b16 v[48:49], v12 offset:6144
    ds_read_b64_tr_b16 v[50:51], v12 offset:7168
    ds_read_b64_tr_b16 v[52:53], v12 offset:6656
    ds_read_b64_tr_b16 v[54:55], v12 offset:7680
    s_waitcnt lgkmcnt(8)
    v_mfma_f32_32x32x16_bf16 v[16:31], v[56:59], a[4:7], v[16:31]
    v_mfma_f32_32x32x16_bf16 v[32:47], v[60:63], a[4:7], v[32:47]
    ds_read_b64_tr_b16 v[56:57], v12 offset:8192
    ds_read_b64_tr_b16 v[58:59], v12 offset:9216
    ds_read_b64_tr_b16 v[60:61], v12 offset:8704
    ds_read_b64_tr_b16 v[62:63], v12 offset:9728
    s_waitcnt lgkmcnt(8)
    v_mfma_f32_32x32x16_bf16 v[16:31], v[64:67], a[8:11], v[16:31]
    v_mfma_f32_32x32x16_bf16 v[32:47], v[68:71], a[8:11], v[32:47]
    s_add_u32 s17, s19, 1024
    s_mov_b32 m0, s17
    s_add_u32 s18, s31, 65536
    buffer_load_dwordx4 v4, s[12:15], s18 offen lds
    ds_read_b64_tr_b16 v[64:65], v12 offset:10240
    ds_read_b64_tr_b16 v[66:67], v12 offset:11264
    ds_read_b64_tr_b16 v[68:69], v12 offset:10752
    ds_read_b64_tr_b16 v[70:71], v12 offset:11776
    s_waitcnt lgkmcnt(8)
    v_mfma_f32_32x32x16_bf16 v[16:31], v[48:51], a[12:15], v[16:31]
    v_mfma_f32_32x32x16_bf16 v[32:47], v[52:55], a[12:15], v[32:47]
    ds_read_b64_tr_b16 v[48:49], v12 offset:12288
    ds_read_b64_tr_b16 v[50:51], v12 offset:13312
    ds_read_b64_tr_b16 v[52:53], v12 offset:12800
    ds_read_b64_tr_b16 v[54:55], v12 offset:13824
    s_waitcnt lgkmcnt(8)
    v_mfma_f32_32x32x16_bf16 v[16:31], v[56:59], a[16:19], v[16:31]
    v_mfma_f32_32x32x16_bf16 v[32:47], v[60:63], a[16:19], v[32:47]
    s_add_u32 s17, s19, 2048
    s_mov_b32 m0, s17
    s_add_u32 s18, s31, 131072
    buffer_load_dwordx4 v4, s[12:15], s18 offen lds
    ds_read_b64_tr_b16 v[56:57], v12 offset:14336
    ds_read_b64_tr_b16 v[58:59], v12 offset:15360
    ds_read_b64_tr_b16 v[60:61], v12 offset:14848
    ds_read_b64_tr_b16 v[62:63], v12 offset:15872
    s_waitcnt lgkmcnt(8)
    v_mfma_f32_32x32x16_bf16 v[16:31], v[64:67], a[20:23], v[16:31]
    v_mfma_f32_32x32x16_bf16 v[32:47], v[68:71], a[20:23], v[32:47]
    ds_read_b64_tr_b16 v[64:65], v12 offset:16384
    ds_read_b64_tr_b16 v[66:67], v12 offset:17408
    ds_read_b64_tr_b16 v[68:69], v12 offset:16896
    ds_read_b64_tr_b16 v[70:71], v12 offset:17920
    s_waitcnt lgkmcnt(8)
    v_mfma_f32_32x32x16_bf16 v[16:31], v[48:51], a[24:27], v[16:31]
    v_mfma_f32_32x32x16_bf16 v[32:47], v[52:55], a[24:27], v[32:47]
    s_add_u32 s17, s19, 3072
    s_mov_b32 m0, s17
    s_add_u32 s18, s31, 196608
    buffer_load_dwordx4 v4, s[12:15], s18 offen lds
    ds_read_b64_tr_b16 v[48:49], v12 offset:18432
    ds_read_b64_tr_b16 v[50:51], v12 offset:19456
    ds_read_b64_tr_b16 v[52:53], v12 offset:18944
    ds_read_b64_tr_b16 v[54:55], v12 offset:19968
    s_waitcnt lgkmcnt(8)
    v_mfma_f32_32x32x16_bf16 v[16:31], v[56:59], a[28:31], v[16:31]
    v_mfma_f32_32x32x16_bf16 v[32:47], v[60:63], a[28:31], v[32:47]
    ds_read_b64_tr_b16 v[56:57], v12 offset:20480
    ds_read_b64_tr_b16 v[58:59], v12 offset:21504
    ds_read_b64_tr_b16 v[60:61], v12 offset:20992
    ds_read_b64_tr_b16 v[62:63], v12 offset:22016
    s_waitcnt lgkmcnt(8)
    v_mfma_f32_32x32x16_bf16 v[16:31], v[64:67], a[32:35], v[16:31]
    v_mfma_f32_32x32x16_bf16 v[32:47], v[68:71], a[32:35], v[32:47]
    s_add_u32 s17, s19, 4096
    s_mov_b32 m0, s17
    s_add_u32 s18, s31, 262144
    buffer_load_dwordx4 v4, s[12:15], s18 offen lds
    ds_read_b64_tr_b16 v[64:65], v12 offset:22528
    ds_read_b64_tr_b16 v[66:67], v12 offset:23552
    ds_read_b64_tr_b16 v[68:69], v12 offset:23040
    ds_read_b64_tr_b16 v[70:71], v12 offset:24064
    s_waitcnt lgkmcnt(8)
    v_mfma_f32_32x32x16_bf16 v[16:31], v[48:51], a[36:39], v[16:31]
    v_mfma_f32_32x32x16_bf16 v[32:47], v[52:55], a[36:39], v[32:47]
    ds_read_b64_tr_b16 v[48:49], v12 offset:24576
    ds_read_b64_tr_b16 v[50:51], v12 offset:25600
    ds_read_b64_tr_b16 v[52:53], v12 offset:25088
    ds_read_b64_tr_b16 v[54:55], v12 offset:26112
    s_waitcnt lgkmcnt(8)
    v_mfma_f32_32x32x16_bf16 v[16:31], v[56:59], a[40:43], v[16:31]
    v_mfma_f32_32x32x16_bf16 v[32:47], v[60:63], a[40:43], v[32:47]
    s_add_u32 s17, s19, 5120
    s_mov_b32 m0, s17
    s_add_u32 s18, s31, 327680
    buffer_load_dwordx4 v4, s[12:15], s18 offen lds
    ds_read_b64_tr_b16 v[56:57], v12 offset:26624
    ds_read_b64_tr_b16 v[58:59], v12 offset:27648
    ds_read_b64_tr_b16 v[60:61], v12 offset:27136
    ds_read_b64_tr_b16 v[62:63], v12 offset:28160
    s_waitcnt lgkmcnt(8)
    v_mfma_f32_32x32x16_bf16 v[16:31], v[64:67], a[44:47], v[16:31]
    v_mfma_f32_32x32x16_bf16 v[32:47], v[68:71], a[44:47], v[32:47]
    ds_read_b64_tr_b16 v[64:65], v12 offset:28672
    ds_read_b64_tr_b16 v[66:67], v12 offset:29696
    ds_read_b64_tr_b16 v[68:69], v12 offset:29184
    ds_read_b64_tr_b16 v[70:71], v12 offset:30208
    s_waitcnt lgkmcnt(8)
    v_mfma_f32_32x32x16_bf16 v[16:31], v[48:51], a[48:51], v[16:31]
    v_mfma_f32_32x32x16_bf16 v[32:47], v[52:55], a[48:51], v[32:47]
    s_add_u32 s17, s19, 6144
    s_mov_b32 m0, s17
    s_add_u32 s18, s31, 393216
    buffer_load_dwordx4 v4, s[12:15], s18 offen lds
    ds_read_b64_tr_b16 v[48:49], v12 offset:30720
    ds_read_b64_tr_b16 v[50:51], v12 offset:31744
    ds_read_b64_tr_b16 v[52:53], v12 offset:31232
    ds_read_b64_tr_b16 v[54:55], v12 offset:32256
    s_waitcnt lgkmcnt(8)
    v_mfma_f32_32x32x16_bf16 v[16:31], v[56:59], a[52:55], v[16:31]
    v_mfma_f32_32x32x16_bf16 v[32:47], v[60:63], a[52:55], v[32:47]
    ds_read_b64_tr_b16 v[56:57], v12 offset:32768
    ds_read_b64_tr_b16 v[58:59], v12 offset:33792
    ds_read_b64_tr_b16 v[60:61], v12 offset:33280
    ds_read_b64_tr_b16 v[62:63], v12 offset:34304
    s_waitcnt lgkmcnt(8)
    v_mfma_f32_32x32x16_bf16 v[16:31], v[64:67], a[56:59], v[16:31]
    v_mfma_f32_32x32x16_bf16 v[32:47], v[68:71], a[56:59], v[32:47]
    s_add_u32 s17, s19, 7168
    s_mov_b32 m0, s17
    s_add_u32 s18, s31, 458752
    buffer_load_dwordx4 v4, s[12:15], s18 offen lds
    ds_read_b64_tr_b16 v[64:65], v12 offset:34816
    ds_read_b64_tr_b16 v[66:67], v12 offset:35840
    ds_read_b64_tr_b16 v[68:69], v12 offset:35328
    ds_read_b64_tr_b16 v[70:71], v12 offset:36352
    s_waitcnt lgkmcnt(8)
    v_mfma_f32_32x32x16_bf16 v[16:31], v[48:51], a[60:63], v[16:31]
    v_mfma_f32_32x32x16_bf16 v[32:47], v[52:55], a[60:63], v[32:47]
    ds_read_b64_tr_b16 v[48:49], v12 offset:36864
    ds_read_b64_tr_b16 v[50:51], v12 offset:37888
    ds_read_b64_tr_b16 v[52:53], v12 offset:37376
    ds_read_b64_tr_b16 v[54:55], v12 offset:38400
    s_waitcnt lgkmcnt(8)
    v_mfma_f32_32x32x16_bf16 v[16:31], v[56:59], a[64:67], v[16:31]
    v_mfma_f32_32x32x16_bf16 v[32:47], v[60:63], a[64:67], v[32:47]
    s_add_u32 s17, s19, 8192
    s_mov_b32 m0, s17
    s_add_u32 s18, s31, 524288
    buffer_load_dwordx4 v4, s[12:15], s18 offen lds
    ds_read_b64_tr_b16 v[56:57], v12 offset:38912
    ds_read_b64_tr_b16 v[58:59], v12 offset:39936
    ds_read_b64_tr_b16 v[60:61], v12 offset:39424
    ds_read_b64_tr_b16 v[62:63], v12 offset:40448
    s_waitcnt lgkmcnt(8)
    v_mfma_f32_32x32x16_bf16 v[16:31], v[64:67], a[68:71], v[16:31]
    v_mfma_f32_32x32x16_bf16 v[32:47], v[68:71], a[68:71], v[32:47]
    ds_read_b64_tr_b16 v[64:65], v12 offset:40960
    ds_read_b64_tr_b16 v[66:67], v12 offset:41984
    ds_read_b64_tr_b16 v[68:69], v12 offset:41472
    ds_read_b64_tr_b16 v[70:71], v12 offset:42496
    s_waitcnt lgkmcnt(8)
    v_mfma_f32_32x32x16_bf16 v[16:31], v[48:51], a[72:75], v[16:31]
    v_mfma_f32_32x32x16_bf16 v[32:47], v[52:55], a[72:75], v[32:47]
    s_add_u32 s17, s19, 9216
    s_mov_b32 m0, s17
    s_add_u32 s18, s31, 589824
    buffer_load_dwordx4 v4, s[12:15], s18 offen lds
    ds_read_b64_tr_b16 v[48:49], v12 offset:43008
    ds_read_b64_tr_b16 v[50:51], v12 offset:44032
    ds_read_b64_tr_b16 v[52:53], v12 offset:43520
    ds_read_b64_tr_b16 v[54:55], v12 offset:44544
    s_waitcnt lgkmcnt(8)
    v_mfma_f32_32x32x16_bf16 v[16:31], v[56:59], a[76:79], v[16:31]
    v_mfma_f32_32x32x16_bf16 v[32:47], v[60:63], a[76:79], v[32:47]
    ds_read_b64_tr_b16 v[56:57], v12 offset:45056
    ds_read_b64_tr_b16 v[58:59], v12 offset:46080
    ds_read_b64_tr_b16 v[60:61], v12 offset:45568
    ds_read_b64_tr_b16 v[62:63], v12 offset:46592
    s_waitcnt lgkmcnt(8)
    v_mfma_f32_32x32x16_bf16 v[16:31], v[64:67], a[80:83], v[16:31]
    v_mfma_f32_32x32x16_bf16 v[32:47], v[68:71], a[80:83], v[32:47]
    s_add_u32 s17, s19, 10240
    s_mov_b32 m0, s17
    s_add_u32 s18, s31, 655360
    buffer_load_dwordx4 v4, s[12:15], s18 offen lds
    ds_read_b64_tr_b16 v[64:65], v12 offset:47104
    ds_read_b64_tr_b16 v[66:67], v12 offset:48128
    ds_read_b64_tr_b16 v[68:69], v12 offset:47616
    ds_read_b64_tr_b16 v[70:71], v12 offset:48640
    s_waitcnt lgkmcnt(8)
    v_mfma_f32_32x32x16_bf16 v[16:31], v[48:51], a[84:87], v[16:31]
    v_mfma_f32_32x32x16_bf16 v[32:47], v[52:55], a[84:87], v[32:47]
    ds_read_b64_tr_b16 v[48:49], v12 offset:49152
    ds_read_b64_tr_b16 v[50:51], v12 offset:50176
    ds_read_b64_tr_b16 v[52:53], v12 offset:49664
    ds_read_b64_tr_b16 v[54:55], v12 offset:50688
    s_waitcnt lgkmcnt(8)
    v_mfma_f32_32x32x16_bf16 v[16:31], v[56:59], a[88:91], v[16:31]
    v_mfma_f32_32x32x16_bf16 v[32:47], v[60:63], a[88:91], v[32:47]
    s_add_u32 s17, s19, 11264
    s_mov_b32 m0, s17
    s_add_u32 s18, s31, 720896
    buffer_load_dwordx4 v4, s[12:15], s18 offen lds
    ds_read_b64_tr_b16 v[56:57], v12 offset:51200
    ds_read_b64_tr_b16 v[58:59], v12 offset:52224
    ds_read_b64_tr_b16 v[60:61], v12 offset:51712
    ds_read_b64_tr_b16 v[62:63], v12 offset:52736
    s_waitcnt lgkmcnt(8)
    v_mfma_f32_32x32x16_bf16 v[16:31], v[64:67], a[92:95], v[16:31]
    v_mfma_f32_32x32x16_bf16 v[32:47], v[68:71], a[92:95], v[32:47]
    ds_read_b64_tr_b16 v[64:65], v12 offset:53248
    ds_read_b64_tr_b16 v[66:67], v12 offset:54272
    ds_read_b64_tr_b16 v[68:69], v12 offset:53760
    ds_read_b64_tr_b16 v[70:71], v12 offset:54784
    s_waitcnt lgkmcnt(8)
    v_mfma_f32_32x32x16_bf16 v[16:31], v[48:51], a[96:99], v[16:31]
    v_mfma_f32_32x32x16_bf16 v[32:47], v[52:55], a[96:99], v[32:47]
    s_add_u32 s17, s19, 12288
    s_mov_b32 m0, s17
    s_add_u32 s18, s31, 786432
    buffer_load_dwordx4 v4, s[12:15], s18 offen lds
    ds_read_b64_tr_b16 v[48:49], v12 offset:55296
    ds_read_b64_tr_b16 v[50:51], v12 offset:56320
    ds_read_b64_tr_b16 v[52:53], v12 offset:55808
    ds_read_b64_tr_b16 v[54:55], v12 offset:56832
    s_waitcnt lgkmcnt(8)
    v_mfma_f32_32x32x16_bf16 v[16:31], v[56:59], a[100:103], v[16:31]
    v_mfma_f32_32x32x16_bf16 v[32:47], v[60:63], a[100:103], v[32:47]
    s_waitcnt lgkmcnt(4)
    v_mfma_f32_32x32x16_bf16 v[16:31], v[64:67], a[104:107], v[16:31]
    v_mfma_f32_32x32x16_bf16 v[32:47], v[68:71], a[104:107], v[32:47]
    s_add_u32 s17, s19, 13312
    s_mov_b32 m0, s17
    s_add_u32 s18, s31, 851968
    buffer_load_dwordx4 v4, s[12:15], s18 offen lds
    s_waitcnt lgkmcnt(0)
    v_mfma_f32_32x32x16_bf16 v[16:31], v[48:51], a[108:111], v[16:31]
    v_mfma_f32_32x32x16_bf16 v[32:47], v[52:55], a[108:111], v[32:47]
    s_nop 11
    v_cvt_pk_bf16_f32 v144, v16, v17
    v_cvt_pk_bf16_f32 v145, v18, v19
    v_cvt_pk_bf16_f32 v146, v20, v21
    v_cvt_pk_bf16_f32 v147, v22, v23
    v_cvt_pk_bf16_f32 v148, v24, v25
    v_cvt_pk_bf16_f32 v149, v26, v27
    v_cvt_pk_bf16_f32 v150, v28, v29
    v_cvt_pk_bf16_f32 v151, v30, v31
    v_cvt_pk_bf16_f32 v152, v32, v33
    v_cvt_pk_bf16_f32 v153, v34, v35
    v_cvt_pk_bf16_f32 v154, v36, v37
    v_cvt_pk_bf16_f32 v155, v38, v39
    v_cvt_pk_bf16_f32 v156, v40, v41
    v_cvt_pk_bf16_f32 v157, v42, v43
    v_cvt_pk_bf16_f32 v158, v44, v45
    v_cvt_pk_bf16_f32 v159, v46, v47
    s_waitcnt vmcnt(0)
    s_barrier
    ds_read_b64_tr_b16 v[48:49], v2 offset:0
    ds_read_b64_tr_b16 v[50:51], v2 offset:1024
    ds_read_b64_tr_b16 v[52:53], v2 offset:512
    ds_read_b64_tr_b16 v[54:55], v2 offset:1536
    ds_read_b64_tr_b16 v[56:57], v2 offset:2048
    ds_read_b64_tr_b16 v[58:59], v2 offset:3072
    ds_read_b64_tr_b16 v[60:61], v2 offset:2560
    ds_read_b64_tr_b16 v[62:63], v2 offset:3584
    ds_read_b64_tr_b16 v[64:65], v2 offset:4096
    ds_read_b64_tr_b16 v[66:67], v2 offset:5120
    ds_read_b64_tr_b16 v[68:69], v2 offset:4608
    ds_read_b64_tr_b16 v[70:71], v2 offset:5632
    s_waitcnt lgkmcnt(8)
    v_mfma_f32_32x32x16_bf16 v[16:31], v[48:51], a[0:3], 0
    v_mfma_f32_32x32x16_bf16 v[32:47], v[52:55], a[0:3], 0
    s_add_u32 s17, s19, 57344
    s_mov_b32 m0, s17
    s_add_u32 s18, s31, 128
    buffer_load_dwordx4 v4, s[12:15], s18 offen lds
    ds_read_b64_tr_b16 v[48:49], v2 offset:6144
    ds_read_b64_tr_b16 v[50:51], v2 offset:7168
    ds_read_b64_tr_b16 v[52:53], v2 offset:6656
    ds_read_b64_tr_b16 v[54:55], v2 offset:7680
    s_waitcnt lgkmcnt(8)
    v_mfma_f32_32x32x16_bf16 v[16:31], v[56:59], a[4:7], v[16:31]
    v_mfma_f32_32x32x16_bf16 v[32:47], v[60:63], a[4:7], v[32:47]
    ds_read_b64_tr_b16 v[56:57], v2 offset:8192
    ds_read_b64_tr_b16 v[58:59], v2 offset:9216
    ds_read_b64_tr_b16 v[60:61], v2 offset:8704
    ds_read_b64_tr_b16 v[62:63], v2 offset:9728
    s_waitcnt lgkmcnt(8)
    v_mfma_f32_32x32x16_bf16 v[16:31], v[64:67], a[8:11], v[16:31]
    v_mfma_f32_32x32x16_bf16 v[32:47], v[68:71], a[8:11], v[32:47]
    s_add_u32 s17, s19, 58368
    s_mov_b32 m0, s17
    s_add_u32 s18, s31, 65664
    buffer_load_dwordx4 v4, s[12:15], s18 offen lds
    ds_read_b64_tr_b16 v[64:65], v2 offset:10240
    ds_read_b64_tr_b16 v[66:67], v2 offset:11264
    ds_read_b64_tr_b16 v[68:69], v2 offset:10752
    ds_read_b64_tr_b16 v[70:71], v2 offset:11776
    s_waitcnt lgkmcnt(8)
    v_mfma_f32_32x32x16_bf16 v[16:31], v[48:51], a[12:15], v[16:31]
    v_mfma_f32_32x32x16_bf16 v[32:47], v[52:55], a[12:15], v[32:47]
    ds_read_b64_tr_b16 v[48:49], v2 offset:12288
    ds_read_b64_tr_b16 v[50:51], v2 offset:13312
    ds_read_b64_tr_b16 v[52:53], v2 offset:12800
    ds_read_b64_tr_b16 v[54:55], v2 offset:13824
    s_waitcnt lgkmcnt(8)
    v_mfma_f32_32x32x16_bf16 v[16:31], v[56:59], a[16:19], v[16:31]
    v_mfma_f32_32x32x16_bf16 v[32:47], v[60:63], a[16:19], v[32:47]
    s_add_u32 s17, s19, 59392
    s_mov_b32 m0, s17
    s_add_u32 s18, s31, 131200
    buffer_load_dwordx4 v4, s[12:15], s18 offen lds
    ds_read_b64_tr_b16 v[56:57], v2 offset:14336
    ds_read_b64_tr_b16 v[58:59], v2 offset:15360
    ds_read_b64_tr_b16 v[60:61], v2 offset:14848
    ds_read_b64_tr_b16 v[62:63], v2 offset:15872
    s_waitcnt lgkmcnt(8)
    v_mfma_f32_32x32x16_bf16 v[16:31], v[64:67], a[20:23], v[16:31]
    v_mfma_f32_32x32x16_bf16 v[32:47], v[68:71], a[20:23], v[32:47]
    ds_read_b64_tr_b16 v[64:65], v2 offset:16384
    ds_read_b64_tr_b16 v[66:67], v2 offset:17408
    ds_read_b64_tr_b16 v[68:69], v2 offset:16896
    ds_read_b64_tr_b16 v[70:71], v2 offset:17920
    s_waitcnt lgkmcnt(8)
    v_mfma_f32_32x32x16_bf16 v[16:31], v[48:51], a[24:27], v[16:31]
    v_mfma_f32_32x32x16_bf16 v[32:47], v[52:55], a[24:27], v[32:47]
    s_add_u32 s17, s19, 60416
    s_mov_b32 m0, s17
    s_add_u32 s18, s31, 196736
    buffer_load_dwordx4 v4, s[12:15], s18 offen lds
    ds_read_b64_tr_b16 v[48:49], v2 offset:18432
    ds_read_b64_tr_b16 v[50:51], v2 offset:19456
    ds_read_b64_tr_b16 v[52:53], v2 offset:18944
    ds_read_b64_tr_b16 v[54:55], v2 offset:19968
    s_waitcnt lgkmcnt(8)
    v_mfma_f32_32x32x16_bf16 v[16:31], v[56:59], a[28:31], v[16:31]
    v_mfma_f32_32x32x16_bf16 v[32:47], v[60:63], a[28:31], v[32:47]
    ds_read_b64_tr_b16 v[56:57], v2 offset:20480
    ds_read_b64_tr_b16 v[58:59], v2 offset:21504
    ds_read_b64_tr_b16 v[60:61], v2 offset:20992
    ds_read_b64_tr_b16 v[62:63], v2 offset:22016
    s_waitcnt lgkmcnt(8)
    v_mfma_f32_32x32x16_bf16 v[16:31], v[64:67], a[32:35], v[16:31]
    v_mfma_f32_32x32x16_bf16 v[32:47], v[68:71], a[32:35], v[32:47]
    s_add_u32 s17, s19, 61440
    s_mov_b32 m0, s17
    s_add_u32 s18, s31, 262272
    buffer_load_dwordx4 v4, s[12:15], s18 offen lds
    ds_read_b64_tr_b16 v[64:65], v2 offset:22528
    ds_read_b64_tr_b16 v[66:67], v2 offset:23552
    ds_read_b64_tr_b16 v[68:69], v2 offset:23040
    ds_read_b64_tr_b16 v[70:71], v2 offset:24064
    s_waitcnt lgkmcnt(8)
    v_mfma_f32_32x32x16_bf16 v[16:31], v[48:51], a[36:39], v[16:31]
    v_mfma_f32_32x32x16_bf16 v[32:47], v[52:55], a[36:39], v[32:47]
    ds_read_b64_tr_b16 v[48:49], v2 offset:24576
    ds_read_b64_tr_b16 v[50:51], v2 offset:25600
    ds_read_b64_tr_b16 v[52:53], v2 offset:25088
    ds_read_b64_tr_b16 v[54:55], v2 offset:26112
    s_waitcnt lgkmcnt(8)
    v_mfma_f32_32x32x16_bf16 v[16:31], v[56:59], a[40:43], v[16:31]
    v_mfma_f32_32x32x16_bf16 v[32:47], v[60:63], a[40:43], v[32:47]
    s_add_u32 s17, s19, 62464
    s_mov_b32 m0, s17
    s_add_u32 s18, s31, 327808
    buffer_load_dwordx4 v4, s[12:15], s18 offen lds
    ds_read_b64_tr_b16 v[56:57], v2 offset:26624
    ds_read_b64_tr_b16 v[58:59], v2 offset:27648
    ds_read_b64_tr_b16 v[60:61], v2 offset:27136
    ds_read_b64_tr_b16 v[62:63], v2 offset:28160
    s_waitcnt lgkmcnt(8)
    v_mfma_f32_32x32x16_bf16 v[16:31], v[64:67], a[44:47], v[16:31]
    v_mfma_f32_32x32x16_bf16 v[32:47], v[68:71], a[44:47], v[32:47]
    ds_read_b64_tr_b16 v[64:65], v2 offset:28672
    ds_read_b64_tr_b16 v[66:67], v2 offset:29696
    ds_read_b64_tr_b16 v[68:69], v2 offset:29184
    ds_read_b64_tr_b16 v[70:71], v2 offset:30208
    s_waitcnt lgkmcnt(8)
    v_mfma_f32_32x32x16_bf16 v[16:31], v[48:51], a[48:51], v[16:31]
    v_mfma_f32_32x32x16_bf16 v[32:47], v[52:55], a[48:51], v[32:47]
    s_add_u32 s17, s19, 63488
    s_mov_b32 m0, s17
    s_add_u32 s18, s31, 393344
    buffer_load_dwordx4 v4, s[12:15], s18 offen lds
    ds_read_b64_tr_b16 v[48:49], v2 offset:30720
    ds_read_b64_tr_b16 v[50:51], v2 offset:31744
    ds_read_b64_tr_b16 v[52:53], v2 offset:31232
    ds_read_b64_tr_b16 v[54:55], v2 offset:32256
    s_waitcnt lgkmcnt(8)
    v_mfma_f32_32x32x16_bf16 v[16:31], v[56:59], a[52:55], v[16:31]
    v_mfma_f32_32x32x16_bf16 v[32:47], v[60:63], a[52:55], v[32:47]
    ds_read_b64_tr_b16 v[56:57], v2 offset:32768
    ds_read_b64_tr_b16 v[58:59], v2 offset:33792
    ds_read_b64_tr_b16 v[60:61], v2 offset:33280
    ds_read_b64_tr_b16 v[62:63], v2 offset:34304
    s_waitcnt lgkmcnt(8)
    v_mfma_f32_32x32x16_bf16 v[16:31], v[64:67], a[56:59], v[16:31]
    v_mfma_f32_32x32x16_bf16 v[32:47], v[68:71], a[56:59], v[32:47]
    s_add_u32 s17, s19, 64512
    s_mov_b32 m0, s17
    s_add_u32 s18, s31, 458880
    buffer_load_dwordx4 v4, s[12:15], s18 offen lds
    ds_read_b64_tr_b16 v[64:65], v2 offset:34816
    ds_read_b64_tr_b16 v[66:67], v2 offset:35840
    ds_read_b64_tr_b16 v[68:69], v2 offset:35328
    ds_read_b64_tr_b16 v[70:71], v2 offset:36352
    s_waitcnt lgkmcnt(8)
    v_mfma_f32_32x32x16_bf16 v[16:31], v[48:51], a[60:63], v[16:31]
    v_mfma_f32_32x32x16_bf16 v[32:47], v[52:55], a[60:63], v[32:47]
    ds_read_b64_tr_b16 v[48:49], v2 offset:36864
    ds_read_b64_tr_b16 v[50:51], v2 offset:37888
    ds_read_b64_tr_b16 v[52:53], v2 offset:37376
    ds_read_b64_tr_b16 v[54:55], v2 offset:38400
    s_waitcnt lgkmcnt(8)
    v_mfma_f32_32x32x16_bf16 v[16:31], v[56:59], a[64:67], v[16:31]
    v_mfma_f32_32x32x16_bf16 v[32:47], v[60:63], a[64:67], v[32:47]
    s_add_u32 s17, s19, 65536
    s_mov_b32 m0, s17
    s_add_u32 s18, s31, 524416
    buffer_load_dwordx4 v4, s[12:15], s18 offen lds
    ds_read_b64_tr_b16 v[56:57], v2 offset:38912
    ds_read_b64_tr_b16 v[58:59], v2 offset:39936
    ds_read_b64_tr_b16 v[60:61], v2 offset:39424
    ds_read_b64_tr_b16 v[62:63], v2 offset:40448
    s_waitcnt lgkmcnt(8)
    v_mfma_f32_32x32x16_bf16 v[16:31], v[64:67], a[68:71], v[16:31]
    v_mfma_f32_32x32x16_bf16 v[32:47], v[68:71], a[68:71], v[32:47]
    ds_read_b64_tr_b16 v[64:65], v2 offset:40960
    ds_read_b64_tr_b16 v[66:67], v2 offset:41984
    ds_read_b64_tr_b16 v[68:69], v2 offset:41472
    ds_read_b64_tr_b16 v[70:71], v2 offset:42496
    s_waitcnt lgkmcnt(8)
    v_mfma_f32_32x32x16_bf16 v[16:31], v[48:51], a[72:75], v[16:31]
    v_mfma_f32_32x32x16_bf16 v[32:47], v[52:55], a[72:75], v[32:47]
    s_add_u32 s17, s19, 66560
    s_mov_b32 m0, s17
    s_add_u32 s18, s31, 589952
    buffer_load_dwordx4 v4, s[12:15], s18 offen lds
    ds_read_b64_tr_b16 v[48:49], v2 offset:43008
    ds_read_b64_tr_b16 v[50:51], v2 offset:44032
    ds_read_b64_tr_b16 v[52:53], v2 offset:43520
    ds_read_b64_tr_b16 v[54:55], v2 offset:44544
    s_waitcnt lgkmcnt(8)
    v_mfma_f32_32x32x16_bf16 v[16:31], v[56:59], a[76:79], v[16:31]
    v_mfma_f32_32x32x16_bf16 v[32:47], v[60:63], a[76:79], v[32:47]
    ds_read_b64_tr_b16 v[56:57], v2 offset:45056
    ds_read_b64_tr_b16 v[58:59], v2 offset:46080
    ds_read_b64_tr_b16 v[60:61], v2 offset:45568
    ds_read_b64_tr_b16 v[62:63], v2 offset:46592
    s_waitcnt lgkmcnt(8)
    v_mfma_f32_32x32x16_bf16 v[16:31], v[64:67], a[80:83], v[16:31]
    v_mfma_f32_32x32x16_bf16 v[32:47], v[68:71], a[80:83], v[32:47]
    s_add_u32 s17, s19, 67584
    s_mov_b32 m0, s17
    s_add_u32 s18, s31, 655488
    buffer_load_dwordx4 v4, s[12:15], s18 offen lds
    ds_read_b64_tr_b16 v[64:65], v2 offset:47104
    ds_read_b64_tr_b16 v[66:67], v2 offset:48128
    ds_read_b64_tr_b16 v[68:69], v2 offset:47616
    ds_read_b64_tr_b16 v[70:71], v2 offset:48640
    s_waitcnt lgkmcnt(8)
    v_mfma_f32_32x32x16_bf16 v[16:31], v[48:51], a[84:87], v[16:31]
    v_mfma_f32_32x32x16_bf16 v[32:47], v[52:55], a[84:87], v[32:47]
    ds_read_b64_tr_b16 v[48:49], v2 offset:49152
    ds_read_b64_tr_b16 v[50:51], v2 offset:50176
    ds_read_b64_tr_b16 v[52:53], v2 offset:49664
    ds_read_b64_tr_b16 v[54:55], v2 offset:50688
    s_waitcnt lgkmcnt(8)
    v_mfma_f32_32x32x16_bf16 v[16:31], v[56:59], a[88:91], v[16:31]
    v_mfma_f32_32x32x16_bf16 v[32:47], v[60:63], a[88:91], v[32:47]
    s_add_u32 s17, s19, 68608
    s_mov_b32 m0, s17
    s_add_u32 s18, s31, 721024
    buffer_load_dwordx4 v4, s[12:15], s18 offen lds
    ds_read_b64_tr_b16 v[56:57], v2 offset:51200
    ds_read_b64_tr_b16 v[58:59], v2 offset:52224
    ds_read_b64_tr_b16 v[60:61], v2 offset:51712
    ds_read_b64_tr_b16 v[62:63], v2 offset:52736
    s_waitcnt lgkmcnt(8)
    v_mfma_f32_32x32x16_bf16 v[16:31], v[64:67], a[92:95], v[16:31]
    v_mfma_f32_32x32x16_bf16 v[32:47], v[68:71], a[92:95], v[32:47]
    ds_read_b64_tr_b16 v[64:65], v2 offset:53248
    ds_read_b64_tr_b16 v[66:67], v2 offset:54272
    ds_read_b64_tr_b16 v[68:69], v2 offset:53760
    ds_read_b64_tr_b16 v[70:71], v2 offset:54784
    s_waitcnt lgkmcnt(8)
    v_mfma_f32_32x32x16_bf16 v[16:31], v[48:51], a[96:99], v[16:31]
    v_mfma_f32_32x32x16_bf16 v[32:47], v[52:55], a[96:99], v[32:47]
    s_add_u32 s17, s19, 69632
    s_mov_b32 m0, s17
    s_add_u32 s18, s31, 786560
    buffer_load_dwordx4 v4, s[12:15], s18 offen lds
    ds_read_b64_tr_b16 v[48:49], v2 offset:55296
    ds_read_b64_tr_b16 v[50:51], v2 offset:56320
    ds_read_b64_tr_b16 v[52:53], v2 offset:55808
    ds_read_b64_tr_b16 v[54:55], v2 offset:56832
    s_waitcnt lgkmcnt(8)
    v_mfma_f32_32x32x16_bf16 v[16:31], v[56:59], a[100:103], v[16:31]
    v_mfma_f32_32x32x16_bf16 v[32:47], v[60:63], a[100:103], v[32:47]
    s_waitcnt lgkmcnt(4)
    v_mfma_f32_32x32x16_bf16 v[16:31], v[64:67], a[104:107], v[16:31]
    v_mfma_f32_32x32x16_bf16 v[32:47], v[68:71], a[104:107], v[32:47]
    s_add_u32 s17, s19, 70656
    s_mov_b32 m0, s17
    s_add_u32 s18, s31, 852096
    buffer_load_dwordx4 v4, s[12:15], s18 offen lds
    s_waitcnt lgkmcnt(0)
    v_mfma_f32_32x32x16_bf16 v[16:31], v[48:51], a[108:111], v[16:31]
    v_mfma_f32_32x32x16_bf16 v[32:47], v[52:55], a[108:111], v[32:47]
    s_nop 11
    v_cvt_pk_bf16_f32 v160, v16, v17
    v_cvt_pk_bf16_f32 v161, v18, v19
    v_cvt_pk_bf16_f32 v162, v20, v21
    v_cvt_pk_bf16_f32 v163, v22, v23
    v_cvt_pk_bf16_f32 v164, v24, v25
    v_cvt_pk_bf16_f32 v165, v26, v27
    v_cvt_pk_bf16_f32 v166, v28, v29
    v_cvt_pk_bf16_f32 v167, v30, v31
    v_cvt_pk_bf16_f32 v168, v32, v33
    v_cvt_pk_bf16_f32 v169, v34, v35
    v_cvt_pk_bf16_f32 v170, v36, v37
    v_cvt_pk_bf16_f32 v171, v38, v39
    v_cvt_pk_bf16_f32 v172, v40, v41
    v_cvt_pk_bf16_f32 v173, v42, v43
    v_cvt_pk_bf16_f32 v174, v44, v45
    v_cvt_pk_bf16_f32 v175, v46, v47
    s_waitcnt vmcnt(0)
    s_barrier
    ds_read_b64_tr_b16 v[48:49], v12 offset:0
    ds_read_b64_tr_b16 v[50:51], v12 offset:1024
    ds_read_b64_tr_b16 v[52:53], v12 offset:512
    ds_read_b64_tr_b16 v[54:55], v12 offset:1536
    ds_read_b64_tr_b16 v[56:57], v12 offset:2048
    ds_read_b64_tr_b16 v[58:59], v12 offset:3072
    ds_read_b64_tr_b16 v[60:61], v12 offset:2560
    ds_read_b64_tr_b16 v[62:63], v12 offset:3584
    ds_read_b64_tr_b16 v[64:65], v12 offset:4096
    ds_read_b64_tr_b16 v[66:67], v12 offset:5120
    ds_read_b64_tr_b16 v[68:69], v12 offset:4608
    ds_read_b64_tr_b16 v[70:71], v12 offset:5632
    s_waitcnt lgkmcnt(8)
    v_mfma_f32_32x32x16_bf16 v[16:31], v[48:51], a[0:3], 0
    v_mfma_f32_32x32x16_bf16 v[32:47], v[52:55], a[0:3], 0
    s_add_u32 s17, s19, 0
    s_mov_b32 m0, s17
    s_add_u32 s18, s31, 256
    buffer_load_dwordx4 v4, s[12:15], s18 offen lds
    ds_read_b64_tr_b16 v[48:49], v12 offset:6144
    ds_read_b64_tr_b16 v[50:51], v12 offset:7168
    ds_read_b64_tr_b16 v[52:53], v12 offset:6656
    ds_read_b64_tr_b16 v[54:55], v12 offset:7680
    s_waitcnt lgkmcnt(8)
    v_mfma_f32_32x32x16_bf16 v[16:31], v[56:59], a[4:7], v[16:31]
    v_mfma_f32_32x32x16_bf16 v[32:47], v[60:63], a[4:7], v[32:47]
    ds_read_b64_tr_b16 v[56:57], v12 offset:8192
    ds_read_b64_tr_b16 v[58:59], v12 offset:9216
    ds_read_b64_tr_b16 v[60:61], v12 offset:8704
    ds_read_b64_tr_b16 v[62:63], v12 offset:9728
    s_waitcnt lgkmcnt(8)
    v_mfma_f32_32x32x16_bf16 v[16:31], v[64:67], a[8:11], v[16:31]
    v_mfma_f32_32x32x16_bf16 v[32:47], v[68:71], a[8:11], v[32:47]
    s_add_u32 s17, s19, 1024
    s_mov_b32 m0, s17
    s_add_u32 s18, s31, 65792
    buffer_load_dwordx4 v4, s[12:15], s18 offen lds
    ds_read_b64_tr_b16 v[64:65], v12 offset:10240
    ds_read_b64_tr_b16 v[66:67], v12 offset:11264
    ds_read_b64_tr_b16 v[68:69], v12 offset:10752
    ds_read_b64_tr_b16 v[70:71], v12 offset:11776
    s_waitcnt lgkmcnt(8)
    v_mfma_f32_32x32x16_bf16 v[16:31], v[48:51], a[12:15], v[16:31]
    v_mfma_f32_32x32x16_bf16 v[32:47], v[52:55], a[12:15], v[32:47]
    ds_read_b64_tr_b16 v[48:49], v12 offset:12288
    ds_read_b64_tr_b16 v[50:51], v12 offset:13312
    ds_read_b64_tr_b16 v[52:53], v12 offset:12800
    ds_read_b64_tr_b16 v[54:55], v12 offset:13824
    s_waitcnt lgkmcnt(8)
    v_mfma_f32_32x32x16_bf16 v[16:31], v[56:59], a[16:19], v[16:31]
    v_mfma_f32_32x32x16_bf16 v[32:47], v[60:63], a[16:19], v[32:47]
    s_add_u32 s17, s19, 2048
    s_mov_b32 m0, s17
    s_add_u32 s18, s31, 131328
    buffer_load_dwordx4 v4, s[12:15], s18 offen lds
    ds_read_b64_tr_b16 v[56:57], v12 offset:14336
    ds_read_b64_tr_b16 v[58:59], v12 offset:15360
    ds_read_b64_tr_b16 v[60:61], v12 offset:14848
    ds_read_b64_tr_b16 v[62:63], v12 offset:15872
    s_waitcnt lgkmcnt(8)
    v_mfma_f32_32x32x16_bf16 v[16:31], v[64:67], a[20:23], v[16:31]
    v_mfma_f32_32x32x16_bf16 v[32:47], v[68:71], a[20:23], v[32:47]
    ds_read_b64_tr_b16 v[64:65], v12 offset:16384
    ds_read_b64_tr_b16 v[66:67], v12 offset:17408
    ds_read_b64_tr_b16 v[68:69], v12 offset:16896
    ds_read_b64_tr_b16 v[70:71], v12 offset:17920
    s_waitcnt lgkmcnt(8)
    v_mfma_f32_32x32x16_bf16 v[16:31], v[48:51], a[24:27], v[16:31]
    v_mfma_f32_32x32x16_bf16 v[32:47], v[52:55], a[24:27], v[32:47]
    s_add_u32 s17, s19, 3072
    s_mov_b32 m0, s17
    s_add_u32 s18, s31, 196864
    buffer_load_dwordx4 v4, s[12:15], s18 offen lds
    ds_read_b64_tr_b16 v[48:49], v12 offset:18432
    ds_read_b64_tr_b16 v[50:51], v12 offset:19456
    ds_read_b64_tr_b16 v[52:53], v12 offset:18944
    ds_read_b64_tr_b16 v[54:55], v12 offset:19968
    s_waitcnt lgkmcnt(8)
    v_mfma_f32_32x32x16_bf16 v[16:31], v[56:59], a[28:31], v[16:31]
    v_mfma_f32_32x32x16_bf16 v[32:47], v[60:63], a[28:31], v[32:47]
    ds_read_b64_tr_b16 v[56:57], v12 offset:20480
    ds_read_b64_tr_b16 v[58:59], v12 offset:21504
    ds_read_b64_tr_b16 v[60:61], v12 offset:20992
    ds_read_b64_tr_b16 v[62:63], v12 offset:22016
    s_waitcnt lgkmcnt(8)
    v_mfma_f32_32x32x16_bf16 v[16:31], v[64:67], a[32:35], v[16:31]
    v_mfma_f32_32x32x16_bf16 v[32:47], v[68:71], a[32:35], v[32:47]
    s_add_u32 s17, s19, 4096
    s_mov_b32 m0, s17
    s_add_u32 s18, s31, 262400
    buffer_load_dwordx4 v4, s[12:15], s18 offen lds
    ds_read_b64_tr_b16 v[64:65], v12 offset:22528
    ds_read_b64_tr_b16 v[66:67], v12 offset:23552
    ds_read_b64_tr_b16 v[68:69], v12 offset:23040
    ds_read_b64_tr_b16 v[70:71], v12 offset:24064
    s_waitcnt lgkmcnt(8)
    v_mfma_f32_32x32x16_bf16 v[16:31], v[48:51], a[36:39], v[16:31]
    v_mfma_f32_32x32x16_bf16 v[32:47], v[52:55], a[36:39], v[32:47]
    ds_read_b64_tr_b16 v[48:49], v12 offset:24576
    ds_read_b64_tr_b16 v[50:51], v12 offset:25600
    ds_read_b64_tr_b16 v[52:53], v12 offset:25088
    ds_read_b64_tr_b16 v[54:55], v12 offset:26112
    s_waitcnt lgkmcnt(8)
    v_mfma_f32_32x32x16_bf16 v[16:31], v[56:59], a[40:43], v[16:31]
    v_mfma_f32_32x32x16_bf16 v[32:47], v[60:63], a[40:43], v[32:47]
    s_add_u32 s17, s19, 5120
    s_mov_b32 m0, s17
    s_add_u32 s18, s31, 327936
    buffer_load_dwordx4 v4, s[12:15], s18 offen lds
    ds_read_b64_tr_b16 v[56:57], v12 offset:26624
    ds_read_b64_tr_b16 v[58:59], v12 offset:27648
    ds_read_b64_tr_b16 v[60:61], v12 offset:27136
    ds_read_b64_tr_b16 v[62:63], v12 offset:28160
    s_waitcnt lgkmcnt(8)
    v_mfma_f32_32x32x16_bf16 v[16:31], v[64:67], a[44:47], v[16:31]
    v_mfma_f32_32x32x16_bf16 v[32:47], v[68:71], a[44:47], v[32:47]
    ds_read_b64_tr_b16 v[64:65], v12 offset:28672
    ds_read_b64_tr_b16 v[66:67], v12 offset:29696
    ds_read_b64_tr_b16 v[68:69], v12 offset:29184
    ds_read_b64_tr_b16 v[70:71], v12 offset:30208
    s_waitcnt lgkmcnt(8)
    v_mfma_f32_32x32x16_bf16 v[16:31], v[48:51], a[48:51], v[16:31]
    v_mfma_f32_32x32x16_bf16 v[32:47], v[52:55], a[48:51], v[32:47]
    s_add_u32 s17, s19, 6144
    s_mov_b32 m0, s17
    s_add_u32 s18, s31, 393472
    buffer_load_dwordx4 v4, s[12:15], s18 offen lds
    ds_read_b64_tr_b16 v[48:49], v12 offset:30720
    ds_read_b64_tr_b16 v[50:51], v12 offset:31744
    ds_read_b64_tr_b16 v[52:53], v12 offset:31232
    ds_read_b64_tr_b16 v[54:55], v12 offset:32256
    s_waitcnt lgkmcnt(8)
    v_mfma_f32_32x32x16_bf16 v[16:31], v[56:59], a[52:55], v[16:31]
    v_mfma_f32_32x32x16_bf16 v[32:47], v[60:63], a[52:55], v[32:47]
    ds_read_b64_tr_b16 v[56:57], v12 offset:32768
    ds_read_b64_tr_b16 v[58:59], v12 offset:33792
    ds_read_b64_tr_b16 v[60:61], v12 offset:33280
    ds_read_b64_tr_b16 v[62:63], v12 offset:34304
    s_waitcnt lgkmcnt(8)
    v_mfma_f32_32x32x16_bf16 v[16:31], v[64:67], a[56:59], v[16:31]
    v_mfma_f32_32x32x16_bf16 v[32:47], v[68:71], a[56:59], v[32:47]
    s_add_u32 s17, s19, 7168
    s_mov_b32 m0, s17
    s_add_u32 s18, s31, 459008
    buffer_load_dwordx4 v4, s[12:15], s18 offen lds
    ds_read_b64_tr_b16 v[64:65], v12 offset:34816
    ds_read_b64_tr_b16 v[66:67], v12 offset:35840
    ds_read_b64_tr_b16 v[68:69], v12 offset:35328
    ds_read_b64_tr_b16 v[70:71], v12 offset:36352
    s_waitcnt lgkmcnt(8)
    v_mfma_f32_32x32x16_bf16 v[16:31], v[48:51], a[60:63], v[16:31]
    v_mfma_f32_32x32x16_bf16 v[32:47], v[52:55], a[60:63], v[32:47]
    ds_read_b64_tr_b16 v[48:49], v12 offset:36864
    ds_read_b64_tr_b16 v[50:51], v12 offset:37888
    ds_read_b64_tr_b16 v[52:53], v12 offset:37376
    ds_read_b64_tr_b16 v[54:55], v12 offset:38400
    s_waitcnt lgkmcnt(8)
    v_mfma_f32_32x32x16_bf16 v[16:31], v[56:59], a[64:67], v[16:31]
    v_mfma_f32_32x32x16_bf16 v[32:47], v[60:63], a[64:67], v[32:47]
    s_add_u32 s17, s19, 8192
    s_mov_b32 m0, s17
    s_add_u32 s18, s31, 524544
    buffer_load_dwordx4 v4, s[12:15], s18 offen lds
    ds_read_b64_tr_b16 v[56:57], v12 offset:38912
    ds_read_b64_tr_b16 v[58:59], v12 offset:39936
    ds_read_b64_tr_b16 v[60:61], v12 offset:39424
    ds_read_b64_tr_b16 v[62:63], v12 offset:40448
    s_waitcnt lgkmcnt(8)
    v_mfma_f32_32x32x16_bf16 v[16:31], v[64:67], a[68:71], v[16:31]
    v_mfma_f32_32x32x16_bf16 v[32:47], v[68:71], a[68:71], v[32:47]
    ds_read_b64_tr_b16 v[64:65], v12 offset:40960
    ds_read_b64_tr_b16 v[66:67], v12 offset:41984
    ds_read_b64_tr_b16 v[68:69], v12 offset:41472
    ds_read_b64_tr_b16 v[70:71], v12 offset:42496
    s_waitcnt lgkmcnt(8)
    v_mfma_f32_32x32x16_bf16 v[16:31], v[48:51], a[72:75], v[16:31]
    v_mfma_f32_32x32x16_bf16 v[32:47], v[52:55], a[72:75], v[32:47]
    s_add_u32 s17, s19, 9216
    s_mov_b32 m0, s17
    s_add_u32 s18, s31, 590080
    buffer_load_dwordx4 v4, s[12:15], s18 offen lds
    ds_read_b64_tr_b16 v[48:49], v12 offset:43008
    ds_read_b64_tr_b16 v[50:51], v12 offset:44032
    ds_read_b64_tr_b16 v[52:53], v12 offset:43520
    ds_read_b64_tr_b16 v[54:55], v12 offset:44544
    s_waitcnt lgkmcnt(8)
    v_mfma_f32_32x32x16_bf16 v[16:31], v[56:59], a[76:79], v[16:31]
    v_mfma_f32_32x32x16_bf16 v[32:47], v[60:63], a[76:79], v[32:47]
    ds_read_b64_tr_b16 v[56:57], v12 offset:45056
    ds_read_b64_tr_b16 v[58:59], v12 offset:46080
    ds_read_b64_tr_b16 v[60:61], v12 offset:45568
    ds_read_b64_tr_b16 v[62:63], v12 offset:46592
    s_waitcnt lgkmcnt(8)
    v_mfma_f32_32x32x16_bf16 v[16:31], v[64:67], a[80:83], v[16:31]
    v_mfma_f32_32x32x16_bf16 v[32:47], v[68:71], a[80:83], v[32:47]
    s_add_u32 s17, s19, 10240
    s_mov_b32 m0, s17
    s_add_u32 s18, s31, 655616
    buffer_load_dwordx4 v4, s[12:15], s18 offen lds
    ds_read_b64_tr_b16 v[64:65], v12 offset:47104
    ds_read_b64_tr_b16 v[66:67], v12 offset:48128
    ds_read_b64_tr_b16 v[68:69], v12 offset:47616
    ds_read_b64_tr_b16 v[70:71], v12 offset:48640
    s_waitcnt lgkmcnt(8)
    v_mfma_f32_32x32x16_bf16 v[16:31], v[48:51], a[84:87], v[16:31]
    v_mfma_f32_32x32x16_bf16 v[32:47], v[52:55], a[84:87], v[32:47]
    ds_read_b64_tr_b16 v[48:49], v12 offset:49152
    ds_read_b64_tr_b16 v[50:51], v12 offset:50176
    ds_read_b64_tr_b16 v[52:53], v12 offset:49664
    ds_read_b64_tr_b16 v[54:55], v12 offset:50688
    s_waitcnt lgkmcnt(8)
    v_mfma_f32_32x32x16_bf16 v[16:31], v[56:59], a[88:91], v[16:31]
    v_mfma_f32_32x32x16_bf16 v[32:47], v[60:63], a[88:91], v[32:47]
    s_add_u32 s17, s19, 11264
    s_mov_b32 m0, s17
    s_add_u32 s18, s31, 721152
    buffer_load_dwordx4 v4, s[12:15], s18 offen lds
    ds_read_b64_tr_b16 v[56:57], v12 offset:51200
    ds_read_b64_tr_b16 v[58:59], v12 offset:52224
    ds_read_b64_tr_b16 v[60:61], v12 offset:51712
    ds_read_b64_tr_b16 v[62:63], v12 offset:52736
    s_waitcnt lgkmcnt(8)
    v_mfma_f32_32x32x16_bf16 v[16:31], v[64:67], a[92:95], v[16:31]
    v_mfma_f32_32x32x16_bf16 v[32:47], v[68:71], a[92:95], v[32:47]
    ds_read_b64_tr_b16 v[64:65], v12 offset:53248
    ds_read_b64_tr_b16 v[66:67], v12 offset:54272
    ds_read_b64_tr_b16 v[68:69], v12 offset:53760
    ds_read_b64_tr_b16 v[70:71], v12 offset:54784
    s_waitcnt lgkmcnt(8)
    v_mfma_f32_32x32x16_bf16 v[16:31], v[48:51], a[96:99], v[16:31]
    v_mfma_f32_32x32x16_bf16 v[32:47], v[52:55], a[96:99], v[32:47]
    s_add_u32 s17, s19, 12288
    s_mov_b32 m0, s17
    s_add_u32 s18, s31, 786688
    buffer_load_dwordx4 v4, s[12:15], s18 offen lds
    ds_read_b64_tr_b16 v[48:49], v12 offset:55296
    ds_read_b64_tr_b16 v[50:51], v12 offset:56320
    ds_read_b64_tr_b16 v[52:53], v12 offset:55808
    ds_read_b64_tr_b16 v[54:55], v12 offset:56832
    s_waitcnt lgkmcnt(8)
    v_mfma_f32_32x32x16_bf16 v[16:31], v[56:59], a[100:103], v[16:31]
    v_mfma_f32_32x32x16_bf16 v[32:47], v[60:63], a[100:103], v[32:47]
    s_waitcnt lgkmcnt(4)
    v_mfma_f32_32x32x16_bf16 v[16:31], v[64:67], a[104:107], v[16:31]
    v_mfma_f32_32x32x16_bf16 v[32:47], v[68:71], a[104:107], v[32:47]
    s_add_u32 s17, s19, 13312
    s_mov_b32 m0, s17
    s_add_u32 s18, s31, 852224
    buffer_load_dwordx4 v4, s[12:15], s18 offen lds
    s_waitcnt lgkmcnt(0)
    v_mfma_f32_32x32x16_bf16 v[16:31], v[48:51], a[108:111], v[16:31]
    v_mfma_f32_32x32x16_bf16 v[32:47], v[52:55], a[108:111], v[32:47]
    s_nop 11
    v_cvt_pk_bf16_f32 v176, v16, v17
    v_cvt_pk_bf16_f32 v177, v18, v19
    v_cvt_pk_bf16_f32 v178, v20, v21
    v_cvt_pk_bf16_f32 v179, v22, v23
    v_cvt_pk_bf16_f32 v180, v24, v25
    v_cvt_pk_bf16_f32 v181, v26, v27
    v_cvt_pk_bf16_f32 v182, v28, v29
    v_cvt_pk_bf16_f32 v183, v30, v31
    v_cvt_pk_bf16_f32 v184, v32, v33
    v_cvt_pk_bf16_f32 v185, v34, v35
    v_cvt_pk_bf16_f32 v186, v36, v37
    v_cvt_pk_bf16_f32 v187, v38, v39
    v_cvt_pk_bf16_f32 v188, v40, v41
    v_cvt_pk_bf16_f32 v189, v42, v43
    v_cvt_pk_bf16_f32 v190, v44, v45
    v_cvt_pk_bf16_f32 v191, v46, v47
    s_waitcnt vmcnt(0)
    s_barrier
    ds_read_b64_tr_b16 v[48:49], v2 offset:0
    ds_read_b64_tr_b16 v[50:51], v2 offset:1024
    ds_read_b64_tr_b16 v[52:53], v2 offset:512
    ds_read_b64_tr_b16 v[54:55], v2 offset:1536
    ds_read_b64_tr_b16 v[56:57], v2 offset:2048
    ds_read_b64_tr_b16 v[58:59], v2 offset:3072
    ds_read_b64_tr_b16 v[60:61], v2 offset:2560
    ds_read_b64_tr_b16 v[62:63], v2 offset:3584
    ds_read_b64_tr_b16 v[64:65], v2 offset:4096
    ds_read_b64_tr_b16 v[66:67], v2 offset:5120
    ds_read_b64_tr_b16 v[68:69], v2 offset:4608
    ds_read_b64_tr_b16 v[70:71], v2 offset:5632
    s_waitcnt lgkmcnt(8)
    v_mfma_f32_32x32x16_bf16 v[16:31], v[48:51], a[0:3], 0
    v_mfma_f32_32x32x16_bf16 v[32:47], v[52:55], a[0:3], 0
    s_add_u32 s17, s19, 57344
    s_mov_b32 m0, s17
    s_add_u32 s18, s31, 384
    buffer_load_dwordx4 v4, s[12:15], s18 offen lds
    ds_read_b64_tr_b16 v[48:49], v2 offset:6144
    ds_read_b64_tr_b16 v[50:51], v2 offset:7168
    ds_read_b64_tr_b16 v[52:53], v2 offset:6656
    ds_read_b64_tr_b16 v[54:55], v2 offset:7680
    s_waitcnt lgkmcnt(8)
    v_mfma_f32_32x32x16_bf16 v[16:31], v[56:59], a[4:7], v[16:31]
    v_mfma_f32_32x32x16_bf16 v[32:47], v[60:63], a[4:7], v[32:47]
    ds_read_b64_tr_b16 v[56:57], v2 offset:8192
    ds_read_b64_tr_b16 v[58:59], v2 offset:9216
    ds_read_b64_tr_b16 v[60:61], v2 offset:8704
    ds_read_b64_tr_b16 v[62:63], v2 offset:9728
    s_waitcnt lgkmcnt(8)
    v_mfma_f32_32x32x16_bf16 v[16:31], v[64:67], a[8:11], v[16:31]
    v_mfma_f32_32x32x16_bf16 v[32:47], v[68:71], a[8:11], v[32:47]
    s_add_u32 s17, s19, 58368
    s_mov_b32 m0, s17
    s_add_u32 s18, s31, 65920
    buffer_load_dwordx4 v4, s[12:15], s18 offen lds
    ds_read_b64_tr_b16 v[64:65], v2 offset:10240
    ds_read_b64_tr_b16 v[66:67], v2 offset:11264
    ds_read_b64_tr_b16 v[68:69], v2 offset:10752
    ds_read_b64_tr_b16 v[70:71], v2 offset:11776
    s_waitcnt lgkmcnt(8)
    v_mfma_f32_32x32x16_bf16 v[16:31], v[48:51], a[12:15], v[16:31]
    v_mfma_f32_32x32x16_bf16 v[32:47], v[52:55], a[12:15], v[32:47]
    ds_read_b64_tr_b16 v[48:49], v2 offset:12288
    ds_read_b64_tr_b16 v[50:51], v2 offset:13312
    ds_read_b64_tr_b16 v[52:53], v2 offset:12800
    ds_read_b64_tr_b16 v[54:55], v2 offset:13824
    s_waitcnt lgkmcnt(8)
    v_mfma_f32_32x32x16_bf16 v[16:31], v[56:59], a[16:19], v[16:31]
    v_mfma_f32_32x32x16_bf16 v[32:47], v[60:63], a[16:19], v[32:47]
    s_add_u32 s17, s19, 59392
    s_mov_b32 m0, s17
    s_add_u32 s18, s31, 131456
    buffer_load_dwordx4 v4, s[12:15], s18 offen lds
    ds_read_b64_tr_b16 v[56:57], v2 offset:14336
    ds_read_b64_tr_b16 v[58:59], v2 offset:15360
    ds_read_b64_tr_b16 v[60:61], v2 offset:14848
    ds_read_b64_tr_b16 v[62:63], v2 offset:15872
    s_waitcnt lgkmcnt(8)
    v_mfma_f32_32x32x16_bf16 v[16:31], v[64:67], a[20:23], v[16:31]
    v_mfma_f32_32x32x16_bf16 v[32:47], v[68:71], a[20:23], v[32:47]
    ds_read_b64_tr_b16 v[64:65], v2 offset:16384
    ds_read_b64_tr_b16 v[66:67], v2 offset:17408
    ds_read_b64_tr_b16 v[68:69], v2 offset:16896
    ds_read_b64_tr_b16 v[70:71], v2 offset:17920
    s_waitcnt lgkmcnt(8)
    v_mfma_f32_32x32x16_bf16 v[16:31], v[48:51], a[24:27], v[16:31]
    v_mfma_f32_32x32x16_bf16 v[32:47], v[52:55], a[24:27], v[32:47]
    s_add_u32 s17, s19, 60416
    s_mov_b32 m0, s17
    s_add_u32 s18, s31, 196992
    buffer_load_dwordx4 v4, s[12:15], s18 offen lds
    ds_read_b64_tr_b16 v[48:49], v2 offset:18432
    ds_read_b64_tr_b16 v[50:51], v2 offset:19456
    ds_read_b64_tr_b16 v[52:53], v2 offset:18944
    ds_read_b64_tr_b16 v[54:55], v2 offset:19968
    s_waitcnt lgkmcnt(8)
    v_mfma_f32_32x32x16_bf16 v[16:31], v[56:59], a[28:31], v[16:31]
    v_mfma_f32_32x32x16_bf16 v[32:47], v[60:63], a[28:31], v[32:47]
    ds_read_b64_tr_b16 v[56:57], v2 offset:20480
    ds_read_b64_tr_b16 v[58:59], v2 offset:21504
    ds_read_b64_tr_b16 v[60:61], v2 offset:20992
    ds_read_b64_tr_b16 v[62:63], v2 offset:22016
    s_waitcnt lgkmcnt(8)
    v_mfma_f32_32x32x16_bf16 v[16:31], v[64:67], a[32:35], v[16:31]
    v_mfma_f32_32x32x16_bf16 v[32:47], v[68:71], a[32:35], v[32:47]
    s_add_u32 s17, s19, 61440
    s_mov_b32 m0, s17
    s_add_u32 s18, s31, 262528
    buffer_load_dwordx4 v4, s[12:15], s18 offen lds
    ds_read_b64_tr_b16 v[64:65], v2 offset:22528
    ds_read_b64_tr_b16 v[66:67], v2 offset:23552
    ds_read_b64_tr_b16 v[68:69], v2 offset:23040
    ds_read_b64_tr_b16 v[70:71], v2 offset:24064
    s_waitcnt lgkmcnt(8)
    v_mfma_f32_32x32x16_bf16 v[16:31], v[48:51], a[36:39], v[16:31]
    v_mfma_f32_32x32x16_bf16 v[32:47], v[52:55], a[36:39], v[32:47]
    ds_read_b64_tr_b16 v[48:49], v2 offset:24576
    ds_read_b64_tr_b16 v[50:51], v2 offset:25600
    ds_read_b64_tr_b16 v[52:53], v2 offset:25088
    ds_read_b64_tr_b16 v[54:55], v2 offset:26112
    s_waitcnt lgkmcnt(8)
    v_mfma_f32_32x32x16_bf16 v[16:31], v[56:59], a[40:43], v[16:31]
    v_mfma_f32_32x32x16_bf16 v[32:47], v[60:63], a[40:43], v[32:47]
    s_add_u32 s17, s19, 62464
    s_mov_b32 m0, s17
    s_add_u32 s18, s31, 328064
    buffer_load_dwordx4 v4, s[12:15], s18 offen lds
    ds_read_b64_tr_b16 v[56:57], v2 offset:26624
    ds_read_b64_tr_b16 v[58:59], v2 offset:27648
    ds_read_b64_tr_b16 v[60:61], v2 offset:27136
    ds_read_b64_tr_b16 v[62:63], v2 offset:28160
    s_waitcnt lgkmcnt(8)
    v_mfma_f32_32x32x16_bf16 v[16:31], v[64:67], a[44:47], v[16:31]
    v_mfma_f32_32x32x16_bf16 v[32:47], v[68:71], a[44:47], v[32:47]
    ds_read_b64_tr_b16 v[64:65], v2 offset:28672
    ds_read_b64_tr_b16 v[66:67], v2 offset:29696
    ds_read_b64_tr_b16 v[68:69], v2 offset:29184
    ds_read_b64_tr_b16 v[70:71], v2 offset:30208
    s_waitcnt lgkmcnt(8)
    v_mfma_f32_32x32x16_bf16 v[16:31], v[48:51], a[48:51], v[16:31]
    v_mfma_f32_32x32x16_bf16 v[32:47], v[52:55], a[48:51], v[32:47]
    s_add_u32 s17, s19, 63488
    s_mov_b32 m0, s17
    s_add_u32 s18, s31, 393600
    buffer_load_dwordx4 v4, s[12:15], s18 offen lds
    ds_read_b64_tr_b16 v[48:49], v2 offset:30720
    ds_read_b64_tr_b16 v[50:51], v2 offset:31744
    ds_read_b64_tr_b16 v[52:53], v2 offset:31232
    ds_read_b64_tr_b16 v[54:55], v2 offset:32256
    s_waitcnt lgkmcnt(8)
    v_mfma_f32_32x32x16_bf16 v[16:31], v[56:59], a[52:55], v[16:31]
    v_mfma_f32_32x32x16_bf16 v[32:47], v[60:63], a[52:55], v[32:47]
    ds_read_b64_tr_b16 v[56:57], v2 offset:32768
    ds_read_b64_tr_b16 v[58:59], v2 offset:33792
    ds_read_b64_tr_b16 v[60:61], v2 offset:33280
    ds_read_b64_tr_b16 v[62:63], v2 offset:34304
    s_waitcnt lgkmcnt(8)
    v_mfma_f32_32x32x16_bf16 v[16:31], v[64:67], a[56:59], v[16:31]
    v_mfma_f32_32x32x16_bf16 v[32:47], v[68:71], a[56:59], v[32:47]
    s_add_u32 s17, s19, 64512
    s_mov_b32 m0, s17
    s_add_u32 s18, s31, 459136
    buffer_load_dwordx4 v4, s[12:15], s18 offen lds
    ds_read_b64_tr_b16 v[64:65], v2 offset:34816
    ds_read_b64_tr_b16 v[66:67], v2 offset:35840
    ds_read_b64_tr_b16 v[68:69], v2 offset:35328
    ds_read_b64_tr_b16 v[70:71], v2 offset:36352
    s_waitcnt lgkmcnt(8)
    v_mfma_f32_32x32x16_bf16 v[16:31], v[48:51], a[60:63], v[16:31]
    v_mfma_f32_32x32x16_bf16 v[32:47], v[52:55], a[60:63], v[32:47]
    ds_read_b64_tr_b16 v[48:49], v2 offset:36864
    ds_read_b64_tr_b16 v[50:51], v2 offset:37888
    ds_read_b64_tr_b16 v[52:53], v2 offset:37376
    ds_read_b64_tr_b16 v[54:55], v2 offset:38400
    s_waitcnt lgkmcnt(8)
    v_mfma_f32_32x32x16_bf16 v[16:31], v[56:59], a[64:67], v[16:31]
    v_mfma_f32_32x32x16_bf16 v[32:47], v[60:63], a[64:67], v[32:47]
    s_add_u32 s17, s19, 65536
    s_mov_b32 m0, s17
    s_add_u32 s18, s31, 524672
    buffer_load_dwordx4 v4, s[12:15], s18 offen lds
    ds_read_b64_tr_b16 v[56:57], v2 offset:38912
    ds_read_b64_tr_b16 v[58:59], v2 offset:39936
    ds_read_b64_tr_b16 v[60:61], v2 offset:39424
    ds_read_b64_tr_b16 v[62:63], v2 offset:40448
    s_waitcnt lgkmcnt(8)
    v_mfma_f32_32x32x16_bf16 v[16:31], v[64:67], a[68:71], v[16:31]
    v_mfma_f32_32x32x16_bf16 v[32:47], v[68:71], a[68:71], v[32:47]
    ds_read_b64_tr_b16 v[64:65], v2 offset:40960
    ds_read_b64_tr_b16 v[66:67], v2 offset:41984
    ds_read_b64_tr_b16 v[68:69], v2 offset:41472
    ds_read_b64_tr_b16 v[70:71], v2 offset:42496
    s_waitcnt lgkmcnt(8)
    v_mfma_f32_32x32x16_bf16 v[16:31], v[48:51], a[72:75], v[16:31]
    v_mfma_f32_32x32x16_bf16 v[32:47], v[52:55], a[72:75], v[32:47]
    s_add_u32 s17, s19, 66560
    s_mov_b32 m0, s17
    s_add_u32 s18, s31, 590208
    buffer_load_dwordx4 v4, s[12:15], s18 offen lds
    ds_read_b64_tr_b16 v[48:49], v2 offset:43008
    ds_read_b64_tr_b16 v[50:51], v2 offset:44032
    ds_read_b64_tr_b16 v[52:53], v2 offset:43520
    ds_read_b64_tr_b16 v[54:55], v2 offset:44544
    s_waitcnt lgkmcnt(8)
    v_mfma_f32_32x32x16_bf16 v[16:31], v[56:59], a[76:79], v[16:31]
    v_mfma_f32_32x32x16_bf16 v[32:47], v[60:63], a[76:79], v[32:47]
    ds_read_b64_tr_b16 v[56:57], v2 offset:45056
    ds_read_b64_tr_b16 v[58:59], v2 offset:46080
    ds_read_b64_tr_b16 v[60:61], v2 offset:45568
    ds_read_b64_tr_b16 v[62:63], v2 offset:46592
    s_waitcnt lgkmcnt(8)
    v_mfma_f32_32x32x16_bf16 v[16:31], v[64:67], a[80:83], v[16:31]
    v_mfma_f32_32x32x16_bf16 v[32:47], v[68:71], a[80:83], v[32:47]
    s_add_u32 s17, s19, 67584
    s_mov_b32 m0, s17
    s_add_u32 s18, s31, 655744
    buffer_load_dwordx4 v4, s[12:15], s18 offen lds
    ds_read_b64_tr_b16 v[64:65], v2 offset:47104
    ds_read_b64_tr_b16 v[66:67], v2 offset:48128
    ds_read_b64_tr_b16 v[68:69], v2 offset:47616
    ds_read_b64_tr_b16 v[70:71], v2 offset:48640
    s_waitcnt lgkmcnt(8)
    v_mfma_f32_32x32x16_bf16 v[16:31], v[48:51], a[84:87], v[16:31]
    v_mfma_f32_32x32x16_bf16 v[32:47], v[52:55], a[84:87], v[32:47]
    ds_read_b64_tr_b16 v[48:49], v2 offset:49152
    ds_read_b64_tr_b16 v[50:51], v2 offset:50176
    ds_read_b64_tr_b16 v[52:53], v2 offset:49664
    ds_read_b64_tr_b16 v[54:55], v2 offset:50688
    s_waitcnt lgkmcnt(8)
    v_mfma_f32_32x32x16_bf16 v[16:31], v[56:59], a[88:91], v[16:31]
    v_mfma_f32_32x32x16_bf16 v[32:47], v[60:63], a[88:91], v[32:47]
    s_add_u32 s17, s19, 68608
    s_mov_b32 m0, s17
    s_add_u32 s18, s31, 721280
    buffer_load_dwordx4 v4, s[12:15], s18 offen lds
    ds_read_b64_tr_b16 v[56:57], v2 offset:51200
    ds_read_b64_tr_b16 v[58:59], v2 offset:52224
    ds_read_b64_tr_b16 v[60:61], v2 offset:51712
    ds_read_b64_tr_b16 v[62:63], v2 offset:52736
    s_waitcnt lgkmcnt(8)
    v_mfma_f32_32x32x16_bf16 v[16:31], v[64:67], a[92:95], v[16:31]
    v_mfma_f32_32x32x16_bf16 v[32:47], v[68:71], a[92:95], v[32:47]
    ds_read_b64_tr_b16 v[64:65], v2 offset:53248
    ds_read_b64_tr_b16 v[66:67], v2 offset:54272
    ds_read_b64_tr_b16 v[68:69], v2 offset:53760
    ds_read_b64_tr_b16 v[70:71], v2 offset:54784
    s_waitcnt lgkmcnt(8)
    v_mfma_f32_32x32x16_bf16 v[16:31], v[48:51], a[96:99], v[16:31]
    v_mfma_f32_32x32x16_bf16 v[32:47], v[52:55], a[96:99], v[32:47]
    s_add_u32 s17, s19, 69632
    s_mov_b32 m0, s17
    s_add_u32 s18, s31, 786816
    buffer_load_dwordx4 v4, s[12:15], s18 offen lds
    ds_read_b64_tr_b16 v[48:49], v2 offset:55296
    ds_read_b64_tr_b16 v[50:51], v2 offset:56320
    ds_read_b64_tr_b16 v[52:53], v2 offset:55808
    ds_read_b64_tr_b16 v[54:55], v2 offset:56832
    s_waitcnt lgkmcnt(8)
    v_mfma_f32_32x32x16_bf16 v[16:31], v[56:59], a[100:103], v[16:31]
    v_mfma_f32_32x32x16_bf16 v[32:47], v[60:63], a[100:103], v[32:47]
    s_waitcnt lgkmcnt(4)
    v_mfma_f32_32x32x16_bf16 v[16:31], v[64:67], a[104:107], v[16:31]
    v_mfma_f32_32x32x16_bf16 v[32:47], v[68:71], a[104:107], v[32:47]
    s_add_u32 s17, s19, 70656
    s_mov_b32 m0, s17
    s_add_u32 s18, s31, 852352
    buffer_load_dwordx4 v4, s[12:15], s18 offen lds
    s_waitcnt lgkmcnt(0)
    v_mfma_f32_32x32x16_bf16 v[16:31], v[48:51], a[108:111], v[16:31]
    v_mfma_f32_32x32x16_bf16 v[32:47], v[52:55], a[108:111], v[32:47]
    s_nop 11
    v_cvt_pk_bf16_f32 v192, v16, v17
    v_cvt_pk_bf16_f32 v193, v18, v19
    v_cvt_pk_bf16_f32 v194, v20, v21
    v_cvt_pk_bf16_f32 v195, v22, v23
    v_cvt_pk_bf16_f32 v196, v24, v25
    v_cvt_pk_bf16_f32 v197, v26, v27
    v_cvt_pk_bf16_f32 v198, v28, v29
    v_cvt_pk_bf16_f32 v199, v30, v31
    v_cvt_pk_bf16_f32 v200, v32, v33
    v_cvt_pk_bf16_f32 v201, v34, v35
    v_cvt_pk_bf16_f32 v202, v36, v37
    v_cvt_pk_bf16_f32 v203, v38, v39
    v_cvt_pk_bf16_f32 v204, v40, v41
    v_cvt_pk_bf16_f32 v205, v42, v43
    v_cvt_pk_bf16_f32 v206, v44, v45
    v_cvt_pk_bf16_f32 v207, v46, v47
    s_waitcnt vmcnt(0)
    s_barrier
    ds_read_b64_tr_b16 v[48:49], v12 offset:0
    ds_read_b64_tr_b16 v[50:51], v12 offset:1024
    ds_read_b64_tr_b16 v[52:53], v12 offset:512
    ds_read_b64_tr_b16 v[54:55], v12 offset:1536
    ds_read_b64_tr_b16 v[56:57], v12 offset:2048
    ds_read_b64_tr_b16 v[58:59], v12 offset:3072
    ds_read_b64_tr_b16 v[60:61], v12 offset:2560
    ds_read_b64_tr_b16 v[62:63], v12 offset:3584
    ds_read_b64_tr_b16 v[64:65], v12 offset:4096
    ds_read_b64_tr_b16 v[66:67], v12 offset:5120
    ds_read_b64_tr_b16 v[68:69], v12 offset:4608
    ds_read_b64_tr_b16 v[70:71], v12 offset:5632
    s_waitcnt lgkmcnt(8)
    v_mfma_f32_32x32x16_bf16 v[16:31], v[48:51], a[0:3], 0
    v_mfma_f32_32x32x16_bf16 v[32:47], v[52:55], a[0:3], 0
    s_add_u32 s17, s29, 0
    s_mov_b32 m0, s17
    s_add_u32 s18, s33, 0
    buffer_load_dwordx4 v6, s[12:15], s18 offen lds
    ds_read_b64_tr_b16 v[48:49], v12 offset:6144
    ds_read_b64_tr_b16 v[50:51], v12 offset:7168
    ds_read_b64_tr_b16 v[52:53], v12 offset:6656
    ds_read_b64_tr_b16 v[54:55], v12 offset:7680
    s_waitcnt lgkmcnt(8)
    v_mfma_f32_32x32x16_bf16 v[16:31], v[56:59], a[4:7], v[16:31]
    v_mfma_f32_32x32x16_bf16 v[32:47], v[60:63], a[4:7], v[32:47]
    ds_read_b64_tr_b16 v[56:57], v12 offset:8192
    ds_read_b64_tr_b16 v[58:59], v12 offset:9216
    ds_read_b64_tr_b16 v[60:61], v12 offset:8704
    ds_read_b64_tr_b16 v[62:63], v12 offset:9728
    s_waitcnt lgkmcnt(8)
    v_mfma_f32_32x32x16_bf16 v[16:31], v[64:67], a[8:11], v[16:31]
    v_mfma_f32_32x32x16_bf16 v[32:47], v[68:71], a[8:11], v[32:47]
    ds_read_b64_tr_b16 v[64:65], v12 offset:10240
    ds_read_b64_tr_b16 v[66:67], v12 offset:11264
    ds_read_b64_tr_b16 v[68:69], v12 offset:10752
    ds_read_b64_tr_b16 v[70:71], v12 offset:11776
    s_waitcnt lgkmcnt(8)
    v_mfma_f32_32x32x16_bf16 v[16:31], v[48:51], a[12:15], v[16:31]
    v_mfma_f32_32x32x16_bf16 v[32:47], v[52:55], a[12:15], v[32:47]
    s_add_u32 s17, s29, 1024
    s_mov_b32 m0, s17
    s_add_u32 s18, s33, 262144
    buffer_load_dwordx4 v6, s[12:15], s18 offen lds
    ds_read_b64_tr_b16 v[48:49], v12 offset:12288
    ds_read_b64_tr_b16 v[50:51], v12 offset:13312
    ds_read_b64_tr_b16 v[52:53], v12 offset:12800
    ds_read_b64_tr_b16 v[54:55], v12 offset:13824
    s_waitcnt lgkmcnt(8)
    v_mfma_f32_32x32x16_bf16 v[16:31], v[56:59], a[16:19], v[16:31]
    v_mfma_f32_32x32x16_bf16 v[32:47], v[60:63], a[16:19], v[32:47]
    ds_read_b64_tr_b16 v[56:57], v12 offset:14336
    ds_read_b64_tr_b16 v[58:59], v12 offset:15360
    ds_read_b64_tr_b16 v[60:61], v12 offset:14848
    ds_read_b64_tr_b16 v[62:63], v12 offset:15872
    s_waitcnt lgkmcnt(8)
    v_mfma_f32_32x32x16_bf16 v[16:31], v[64:67], a[20:23], v[16:31]
    v_mfma_f32_32x32x16_bf16 v[32:47], v[68:71], a[20:23], v[32:47]
    ds_read_b64_tr_b16 v[64:65], v12 offset:16384
    ds_read_b64_tr_b16 v[66:67], v12 offset:17408
    ds_read_b64_tr_b16 v[68:69], v12 offset:16896
    ds_read_b64_tr_b16 v[70:71], v12 offset:17920
    s_waitcnt lgkmcnt(8)
    v_mfma_f32_32x32x16_bf16 v[16:31], v[48:51], a[24:27], v[16:31]
    v_mfma_f32_32x32x16_bf16 v[32:47], v[52:55], a[24:27], v[32:47]
    s_add_u32 s17, s29, 2048
    s_mov_b32 m0, s17
    s_add_u32 s18, s33, 32
    buffer_load_dwordx4 v6, s[12:15], s18 offen lds
    ds_read_b64_tr_b16 v[48:49], v12 offset:18432
    ds_read_b64_tr_b16 v[50:51], v12 offset:19456
    ds_read_b64_tr_b16 v[52:53], v12 offset:18944
    ds_read_b64_tr_b16 v[54:55], v12 offset:19968
    s_waitcnt lgkmcnt(8)
    v_mfma_f32_32x32x16_bf16 v[16:31], v[56:59], a[28:31], v[16:31]
    v_mfma_f32_32x32x16_bf16 v[32:47], v[60:63], a[28:31], v[32:47]
    ds_read_b64_tr_b16 v[56:57], v12 offset:20480
    ds_read_b64_tr_b16 v[58:59], v12 offset:21504
    ds_read_b64_tr_b16 v[60:61], v12 offset:20992
    ds_read_b64_tr_b16 v[62:63], v12 offset:22016
    s_waitcnt lgkmcnt(8)
    v_mfma_f32_32x32x16_bf16 v[16:31], v[64:67], a[32:35], v[16:31]
    v_mfma_f32_32x32x16_bf16 v[32:47], v[68:71], a[32:35], v[32:47]
    ds_read_b64_tr_b16 v[64:65], v12 offset:22528
    ds_read_b64_tr_b16 v[66:67], v12 offset:23552
    ds_read_b64_tr_b16 v[68:69], v12 offset:23040
    ds_read_b64_tr_b16 v[70:71], v12 offset:24064
    s_waitcnt lgkmcnt(8)
    v_mfma_f32_32x32x16_bf16 v[16:31], v[48:51], a[36:39], v[16:31]
    v_mfma_f32_32x32x16_bf16 v[32:47], v[52:55], a[36:39], v[32:47]
    s_add_u32 s17, s29, 3072
    s_mov_b32 m0, s17
    s_add_u32 s18, s33, 262176
    buffer_load_dwordx4 v6, s[12:15], s18 offen lds
    ds_read_b64_tr_b16 v[48:49], v12 offset:24576
    ds_read_b64_tr_b16 v[50:51], v12 offset:25600
    ds_read_b64_tr_b16 v[52:53], v12 offset:25088
    ds_read_b64_tr_b16 v[54:55], v12 offset:26112
    s_waitcnt lgkmcnt(8)
    v_mfma_f32_32x32x16_bf16 v[16:31], v[56:59], a[40:43], v[16:31]
    v_mfma_f32_32x32x16_bf16 v[32:47], v[60:63], a[40:43], v[32:47]
    ds_read_b64_tr_b16 v[56:57], v12 offset:26624
    ds_read_b64_tr_b16 v[58:59], v12 offset:27648
    ds_read_b64_tr_b16 v[60:61], v12 offset:27136
    ds_read_b64_tr_b16 v[62:63], v12 offset:28160
    s_waitcnt lgkmcnt(8)
    v_mfma_f32_32x32x16_bf16 v[16:31], v[64:67], a[44:47], v[16:31]
    v_mfma_f32_32x32x16_bf16 v[32:47], v[68:71], a[44:47], v[32:47]
    ds_read_b64_tr_b16 v[64:65], v12 offset:28672
    ds_read_b64_tr_b16 v[66:67], v12 offset:29696
    ds_read_b64_tr_b16 v[68:69], v12 offset:29184
    ds_read_b64_tr_b16 v[70:71], v12 offset:30208
    s_waitcnt lgkmcnt(8)
    v_mfma_f32_32x32x16_bf16 v[16:31], v[48:51], a[48:51], v[16:31]
    v_mfma_f32_32x32x16_bf16 v[32:47], v[52:55], a[48:51], v[32:47]
    s_add_u32 s17, s29, 4096
    s_mov_b32 m0, s17
    s_add_u32 s18, s33, 64
    buffer_load_dwordx4 v6, s[12:15], s18 offen lds
    ds_read_b64_tr_b16 v[48:49], v12 offset:30720
    ds_read_b64_tr_b16 v[50:51], v12 offset:31744
    ds_read_b64_tr_b16 v[52:53], v12 offset:31232
    ds_read_b64_tr_b16 v[54:55], v12 offset:32256
    s_waitcnt lgkmcnt(8)
    v_mfma_f32_32x32x16_bf16 v[16:31], v[56:59], a[52:55], v[16:31]
    v_mfma_f32_32x32x16_bf16 v[32:47], v[60:63], a[52:55], v[32:47]
    ds_read_b64_tr_b16 v[56:57], v12 offset:32768
    ds_read_b64_tr_b16 v[58:59], v12 offset:33792
    ds_read_b64_tr_b16 v[60:61], v12 offset:33280
    ds_read_b64_tr_b16 v[62:63], v12 offset:34304
    s_waitcnt lgkmcnt(8)
    v_mfma_f32_32x32x16_bf16 v[16:31], v[64:67], a[56:59], v[16:31]
    v_mfma_f32_32x32x16_bf16 v[32:47], v[68:71], a[56:59], v[32:47]
    ds_read_b64_tr_b16 v[64:65], v12 offset:34816
    ds_read_b64_tr_b16 v[66:67], v12 offset:35840
    ds_read_b64_tr_b16 v[68:69], v12 offset:35328
    ds_read_b64_tr_b16 v[70:71], v12 offset:36352
    s_waitcnt lgkmcnt(8)
    v_mfma_f32_32x32x16_bf16 v[16:31], v[48:51], a[60:63], v[16:31]
    v_mfma_f32_32x32x16_bf16 v[32:47], v[52:55], a[60:63], v[32:47]
    s_add_u32 s17, s29, 5120
    s_mov_b32 m0, s17
    s_add_u32 s18, s33, 262208
    buffer_load_dwordx4 v6, s[12:15], s18 offen lds
    ds_read_b64_tr_b16 v[48:49], v12 offset:36864
    ds_read_b64_tr_b16 v[50:51], v12 offset:37888
    ds_read_b64_tr_b16 v[52:53], v12 offset:37376
    ds_read_b64_tr_b16 v[54:55], v12 offset:38400
    s_waitcnt lgkmcnt(8)
    v_mfma_f32_32x32x16_bf16 v[16:31], v[56:59], a[64:67], v[16:31]
    v_mfma_f32_32x32x16_bf16 v[32:47], v[60:63], a[64:67], v[32:47]
    ds_read_b64_tr_b16 v[56:57], v12 offset:38912
    ds_read_b64_tr_b16 v[58:59], v12 offset:39936
    ds_read_b64_tr_b16 v[60:61], v12 offset:39424
    ds_read_b64_tr_b16 v[62:63], v12 offset:40448
    s_waitcnt lgkmcnt(8)
    v_mfma_f32_32x32x16_bf16 v[16:31], v[64:67], a[68:71], v[16:31]
    v_mfma_f32_32x32x16_bf16 v[32:47], v[68:71], a[68:71], v[32:47]
    ds_read_b64_tr_b16 v[64:65], v12 offset:40960
    ds_read_b64_tr_b16 v[66:67], v12 offset:41984
    ds_read_b64_tr_b16 v[68:69], v12 offset:41472
    ds_read_b64_tr_b16 v[70:71], v12 offset:42496
    s_waitcnt lgkmcnt(8)
    v_mfma_f32_32x32x16_bf16 v[16:31], v[48:51], a[72:75], v[16:31]
    v_mfma_f32_32x32x16_bf16 v[32:47], v[52:55], a[72:75], v[32:47]
    s_add_u32 s17, s29, 6144
    s_mov_b32 m0, s17
    s_add_u32 s18, s33, 96
    buffer_load_dwordx4 v6, s[12:15], s18 offen lds
    ds_read_b64_tr_b16 v[48:49], v12 offset:43008
    ds_read_b64_tr_b16 v[50:51], v12 offset:44032
    ds_read_b64_tr_b16 v[52:53], v12 offset:43520
    ds_read_b64_tr_b16 v[54:55], v12 offset:44544
    s_waitcnt lgkmcnt(8)
    v_mfma_f32_32x32x16_bf16 v[16:31], v[56:59], a[76:79], v[16:31]
    v_mfma_f32_32x32x16_bf16 v[32:47], v[60:63], a[76:79], v[32:47]
    ds_read_b64_tr_b16 v[56:57], v12 offset:45056
    ds_read_b64_tr_b16 v[58:59], v12 offset:46080
    ds_read_b64_tr_b16 v[60:61], v12 offset:45568
    ds_read_b64_tr_b16 v[62:63], v12 offset:46592
    s_waitcnt lgkmcnt(8)
    v_mfma_f32_32x32x16_bf16 v[16:31], v[64:67], a[80:83], v[16:31]
    v_mfma_f32_32x32x16_bf16 v[32:47], v[68:71], a[80:83], v[32:47]
    ds_read_b64_tr_b16 v[64:65], v12 offset:47104
    ds_read_b64_tr_b16 v[66:67], v12 offset:48128
    ds_read_b64_tr_b16 v[68:69], v12 offset:47616
    ds_read_b64_tr_b16 v[70:71], v12 offset:48640
    s_waitcnt lgkmcnt(8)
    v_mfma_f32_32x32x16_bf16 v[16:31], v[48:51], a[84:87], v[16:31]
    v_mfma_f32_32x32x16_bf16 v[32:47], v[52:55], a[84:87], v[32:47]
    s_add_u32 s17, s29, 7168
    s_mov_b32 m0, s17
    s_add_u32 s18, s33, 262240
    buffer_load_dwordx4 v6, s[12:15], s18 offen lds
    ds_read_b64_tr_b16 v[48:49], v12 offset:49152
    ds_read_b64_tr_b16 v[50:51], v12 offset:50176
    ds_read_b64_tr_b16 v[52:53], v12 offset:49664
    ds_read_b64_tr_b16 v[54:55], v12 offset:50688
    s_waitcnt lgkmcnt(8)
    v_mfma_f32_32x32x16_bf16 v[16:31], v[56:59], a[88:91], v[16:31]
    v_mfma_f32_32x32x16_bf16 v[32:47], v[60:63], a[88:91], v[32:47]
    ds_read_b64_tr_b16 v[56:57], v12 offset:51200
    ds_read_b64_tr_b16 v[58:59], v12 offset:52224
    ds_read_b64_tr_b16 v[60:61], v12 offset:51712
    ds_read_b64_tr_b16 v[62:63], v12 offset:52736
    s_waitcnt lgkmcnt(8)
    v_mfma_f32_32x32x16_bf16 v[16:31], v[64:67], a[92:95], v[16:31]
    v_mfma_f32_32x32x16_bf16 v[32:47], v[68:71], a[92:95], v[32:47]
    ds_read_b64_tr_b16 v[64:65], v12 offset:53248
    ds_read_b64_tr_b16 v[66:67], v12 offset:54272
    ds_read_b64_tr_b16 v[68:69], v12 offset:53760
    ds_read_b64_tr_b16 v[70:71], v12 offset:54784
    s_waitcnt lgkmcnt(8)
    v_mfma_f32_32x32x16_bf16 v[16:31], v[48:51], a[96:99], v[16:31]
    v_mfma_f32_32x32x16_bf16 v[32:47], v[52:55], a[96:99], v[32:47]
    ds_read_b64_tr_b16 v[48:49], v12 offset:55296
    ds_read_b64_tr_b16 v[50:51], v12 offset:56320
    ds_read_b64_tr_b16 v[52:53], v12 offset:55808
    ds_read_b64_tr_b16 v[54:55], v12 offset:56832
    s_waitcnt lgkmcnt(8)
    v_mfma_f32_32x32x16_bf16 v[16:31], v[56:59], a[100:103], v[16:31]
    v_mfma_f32_32x32x16_bf16 v[32:47], v[60:63], a[100:103], v[32:47]
    s_waitcnt lgkmcnt(4)
    v_mfma_f32_32x32x16_bf16 v[16:31], v[64:67], a[104:107], v[16:31]
    v_mfma_f32_32x32x16_bf16 v[32:47], v[68:71], a[104:107], v[32:47]
    s_waitcnt lgkmcnt(0)
    v_mfma_f32_32x32x16_bf16 v[16:31], v[48:51], a[108:111], v[16:31]
    v_mfma_f32_32x32x16_bf16 v[32:47], v[52:55], a[108:111], v[32:47]
    s_nop 11
    v_cvt_pk_bf16_f32 v208, v16, v17
    v_cvt_pk_bf16_f32 v209, v18, v19
    v_cvt_pk_bf16_f32 v210, v20, v21
    v_cvt_pk_bf16_f32 v211, v22, v23
    v_cvt_pk_bf16_f32 v212, v24, v25
    v_cvt_pk_bf16_f32 v213, v26, v27
    v_cvt_pk_bf16_f32 v214, v28, v29
    v_cvt_pk_bf16_f32 v215, v30, v31
    v_cvt_pk_bf16_f32 v216, v32, v33
    v_cvt_pk_bf16_f32 v217, v34, v35
    v_cvt_pk_bf16_f32 v218, v36, v37
    v_cvt_pk_bf16_f32 v219, v38, v39
    v_cvt_pk_bf16_f32 v220, v40, v41
    v_cvt_pk_bf16_f32 v221, v42, v43
    v_cvt_pk_bf16_f32 v222, v44, v45
    v_cvt_pk_bf16_f32 v223, v46, v47
    v_mfma_f32_32x32x16_bf16 v[16:31], v[160:163], v[96:99], 0
    v_mfma_f32_32x32x16_bf16 v[16:31], v[164:167], v[100:103], v[16:31]
    v_mfma_f32_32x32x16_bf16 v[16:31], v[168:171], v[104:107], v[16:31]
    v_mfma_f32_32x32x16_bf16 v[16:31], v[172:175], v[108:111], v[16:31]
    v_mfma_f32_32x32x16_bf16 v[16:31], v[176:179], v[112:115], v[16:31]
    v_mfma_f32_32x32x16_bf16 v[16:31], v[180:183], v[116:119], v[16:31]
    v_mfma_f32_32x32x16_bf16 v[16:31], v[184:187], v[120:123], v[16:31]
    v_mfma_f32_32x32x16_bf16 v[16:31], v[188:191], v[124:127], v[16:31]
    v_mfma_f32_32x32x16_bf16 v[16:31], v[192:195], v[128:131], v[16:31]
    v_mfma_f32_32x32x16_bf16 v[16:31], v[196:199], v[132:135], v[16:31]
    v_mfma_f32_32x32x16_bf16 v[16:31], v[200:203], v[136:139], v[16:31]
    v_mfma_f32_32x32x16_bf16 v[16:31], v[204:207], v[140:143], v[16:31]
    v_mfma_f32_32x32x16_bf16 v[16:31], v[208:211], v[144:147], v[16:31]
    v_mfma_f32_32x32x16_bf16 v[16:31], v[212:215], v[148:151], v[16:31]
    v_mfma_f32_32x32x16_bf16 v[16:31], v[216:219], v[152:155], v[16:31]
    v_mfma_f32_32x32x16_bf16 v[16:31], v[220:223], v[156:159], v[16:31]
    s_nop 11
    v_cvt_pk_bf16_f32 v72, v16, v17
    v_cvt_pk_bf16_f32 v73, v18, v19
    v_cvt_pk_bf16_f32 v74, v20, v21
    v_cvt_pk_bf16_f32 v75, v22, v23
    v_cvt_pk_bf16_f32 v76, v24, v25
    v_cvt_pk_bf16_f32 v77, v26, v27
    v_cvt_pk_bf16_f32 v78, v28, v29
    v_cvt_pk_bf16_f32 v79, v30, v31
    s_lshl_b32 s30, s27, 4
    s_add_u32 s30, s30, s24
    s_lshl_b32 s16, s30, 11
    s_add_u32 s16, s16, 82333696
    buffer_store_dwordx4 v[72:75], v14, s[4:7], s16 offen offset:0 sc1
    buffer_store_dwordx4 v[76:79], v14, s[4:7], s16 offen offset:1024 sc1
    s_mul_i32 s30, s30, 28672
    s_add_u32 s30, s30, 52973568
    s_waitcnt vmcnt(2)
    s_barrier
    ds_read_b128 v[48:51], v14 offset:0
    ds_read_b128 v[52:55], v14 offset:1024
    ds_read_b128 v[56:59], v14 offset:2048
    ds_read_b128 v[60:63], v14 offset:3072
    ds_read_b128 v[64:67], v14 offset:4096
    ds_read_b128 v[68:71], v14 offset:5120
    s_waitcnt lgkmcnt(4)
    v_mfma_f32_32x32x16_bf16 v[16:31], v[48:51], v[96:99], 0
    v_mfma_f32_32x32x16_bf16 v[32:47], v[52:55], v[96:99], 0
    s_add_u32 s17, s29, 57344
    s_mov_b32 m0, s17
    s_add_u32 s18, s33, 524288
    buffer_load_dwordx4 v6, s[12:15], s18 offen lds
    ds_read_b128 v[48:51], v14 offset:6144
    ds_read_b128 v[52:55], v14 offset:7168
    s_waitcnt lgkmcnt(4)
    v_mfma_f32_32x32x16_bf16 v[16:31], v[56:59], v[100:103], v[16:31]
    v_mfma_f32_32x32x16_bf16 v[32:47], v[60:63], v[100:103], v[32:47]
    ds_read_b128 v[56:59], v14 offset:8192
    ds_read_b128 v[60:63], v14 offset:9216
    s_waitcnt lgkmcnt(4)
    v_mfma_f32_32x32x16_bf16 v[16:31], v[64:67], v[104:107], v[16:31]
    v_mfma_f32_32x32x16_bf16 v[32:47], v[68:71], v[104:107], v[32:47]
    s_add_u32 s17, s29, 58368
    s_mov_b32 m0, s17
    s_add_u32 s18, s33, 786432
    buffer_load_dwordx4 v6, s[12:15], s18 offen lds
    ds_read_b128 v[64:67], v14 offset:10240
    ds_read_b128 v[68:71], v14 offset:11264
    s_waitcnt lgkmcnt(4)
    v_mfma_f32_32x32x16_bf16 v[16:31], v[48:51], v[108:111], v[16:31]
    v_mfma_f32_32x32x16_bf16 v[32:47], v[52:55], v[108:111], v[32:47]
    ds_read_b128 v[48:51], v14 offset:12288
    ds_read_b128 v[52:55], v14 offset:13312
    s_waitcnt lgkmcnt(4)
    v_mfma_f32_32x32x16_bf16 v[16:31], v[56:59], v[112:115], v[16:31]
    v_mfma_f32_32x32x16_bf16 v[32:47], v[60:63], v[112:115], v[32:47]
    s_add_u32 s17, s29, 59392
    s_mov_b32 m0, s17
    s_add_u32 s18, s33, 524320
    buffer_load_dwordx4 v6, s[12:15], s18 offen lds
    ds_read_b128 v[56:59], v14 offset:14336
    ds_read_b128 v[60:63], v14 offset:15360
    s_waitcnt lgkmcnt(4)
    v_mfma_f32_32x32x16_bf16 v[16:31], v[64:67], v[116:119], v[16:31]
    v_mfma_f32_32x32x16_bf16 v[32:47], v[68:71], v[116:119], v[32:47]
    ds_read_b128 v[64:67], v14 offset:16384
    ds_read_b128 v[68:71], v14 offset:17408
    s_waitcnt lgkmcnt(4)
    v_mfma_f32_32x32x16_bf16 v[16:31], v[48:51], v[120:123], v[16:31]
    v_mfma_f32_32x32x16_bf16 v[32:47], v[52:55], v[120:123], v[32:47]
    s_add_u32 s17, s29, 60416
    s_mov_b32 m0, s17
    s_add_u32 s18, s33, 786464
    buffer_load_dwordx4 v6, s[12:15], s18 offen lds
    ds_read_b128 v[48:51], v14 offset:18432
    ds_read_b128 v[52:55], v14 offset:19456
    s_waitcnt lgkmcnt(4)
    v_mfma_f32_32x32x16_bf16 v[16:31], v[56:59], v[124:127], v[16:31]
    v_mfma_f32_32x32x16_bf16 v[32:47], v[60:63], v[124:127], v[32:47]
    ds_read_b128 v[56:59], v14 offset:20480
    ds_read_b128 v[60:63], v14 offset:21504
    s_waitcnt lgkmcnt(4)
    v_mfma_f32_32x32x16_bf16 v[16:31], v[64:67], v[128:131], v[16:31]
    v_mfma_f32_32x32x16_bf16 v[32:47], v[68:71], v[128:131], v[32:47]
    s_add_u32 s17, s29, 61440
    s_mov_b32 m0, s17
    s_add_u32 s18, s33, 524352
    buffer_load_dwordx4 v6, s[12:15], s18 offen lds
    ds_read_b128 v[64:67], v14 offset:22528
    ds_read_b128 v[68:71], v14 offset:23552
    s_waitcnt lgkmcnt(4)
    v_mfma_f32_32x32x16_bf16 v[16:31], v[48:51], v[132:135], v[16:31]
    v_mfma_f32_32x32x16_bf16 v[32:47], v[52:55], v[132:135], v[32:47]
    ds_read_b128 v[48:51], v14 offset:24576
    ds_read_b128 v[52:55], v14 offset:25600
    s_waitcnt lgkmcnt(4)
    v_mfma_f32_32x32x16_bf16 v[16:31], v[56:59], v[136:139], v[16:31]
    v_mfma_f32_32x32x16_bf16 v[32:47], v[60:63], v[136:139], v[32:47]
    s_add_u32 s17, s29, 62464
    s_mov_b32 m0, s17
    s_add_u32 s18, s33, 786496
    buffer_load_dwordx4 v6, s[12:15], s18 offen lds
    ds_read_b128 v[56:59], v14 offset:26624
    ds_read_b128 v[60:63], v14 offset:27648
    s_waitcnt lgkmcnt(4)
    v_mfma_f32_32x32x16_bf16 v[16:31], v[64:67], v[140:143], v[16:31]
    v_mfma_f32_32x32x16_bf16 v[32:47], v[68:71], v[140:143], v[32:47]
    ds_read_b128 v[64:67], v14 offset:28672
    ds_read_b128 v[68:71], v14 offset:29696
    s_waitcnt lgkmcnt(4)
    v_mfma_f32_32x32x16_bf16 v[16:31], v[48:51], v[144:147], v[16:31]
    v_mfma_f32_32x32x16_bf16 v[32:47], v[52:55], v[144:147], v[32:47]
    s_add_u32 s17, s29, 63488
    s_mov_b32 m0, s17
    s_add_u32 s18, s33, 524384
    buffer_load_dwordx4 v6, s[12:15], s18 offen lds
    ds_read_b128 v[48:51], v14 offset:30720
    ds_read_b128 v[52:55], v14 offset:31744
    s_waitcnt lgkmcnt(4)
    v_mfma_f32_32x32x16_bf16 v[16:31], v[56:59], v[148:151], v[16:31]
    v_mfma_f32_32x32x16_bf16 v[32:47], v[60:63], v[148:151], v[32:47]
    s_waitcnt lgkmcnt(2)
    v_mfma_f32_32x32x16_bf16 v[16:31], v[64:67], v[152:155], v[16:31]
    v_mfma_f32_32x32x16_bf16 v[32:47], v[68:71], v[152:155], v[32:47]
    s_add_u32 s17, s29, 64512
    s_mov_b32 m0, s17
    s_add_u32 s18, s33, 786528
    buffer_load_dwordx4 v6, s[12:15], s18 offen lds
    s_waitcnt lgkmcnt(0)
    v_mfma_f32_32x32x16_bf16 v[16:31], v[48:51], v[156:159], v[16:31]
    v_mfma_f32_32x32x16_bf16 v[32:47], v[52:55], v[156:159], v[32:47]
    s_nop 11
    v_cvt_pk_bf16_f32 v72, v16, v17
    v_cvt_pk_bf16_f32 v73, v18, v19
    v_cvt_pk_bf16_f32 v74, v20, v21
    v_cvt_pk_bf16_f32 v75, v22, v23
    v_cvt_pk_bf16_f32 v76, v24, v25
    v_cvt_pk_bf16_f32 v77, v26, v27
    v_cvt_pk_bf16_f32 v78, v28, v29
    v_cvt_pk_bf16_f32 v79, v30, v31
    v_cvt_pk_bf16_f32 v80, v32, v33
    v_cvt_pk_bf16_f32 v81, v34, v35
    v_cvt_pk_bf16_f32 v82, v36, v37
    v_cvt_pk_bf16_f32 v83, v38, v39
    v_cvt_pk_bf16_f32 v84, v40, v41
    v_cvt_pk_bf16_f32 v85, v42, v43
    v_cvt_pk_bf16_f32 v86, v44, v45
    v_cvt_pk_bf16_f32 v87, v46, v47
    buffer_store_dwordx4 v[72:75], v14, s[4:7], s30 offen offset:0 sc1
    buffer_store_dwordx4 v[76:79], v14, s[4:7], s30 offen offset:1024 sc1
    buffer_store_dwordx4 v[80:83], v14, s[4:7], s30 offen offset:2048 sc1
    buffer_store_dwordx4 v[84:87], v14, s[4:7], s30 offen offset:3072 sc1
    s_add_u32 s30, s30, 4096
    s_waitcnt vmcnt(4)
    s_barrier
    ds_read_b128 v[48:51], v15 offset:0
    ds_read_b128 v[52:55], v15 offset:1024
    ds_read_b128 v[56:59], v15 offset:2048
    ds_read_b128 v[60:63], v15 offset:3072
    ds_read_b128 v[64:67], v15 offset:4096
    ds_read_b128 v[68:71], v15 offset:5120
    s_waitcnt lgkmcnt(4)
    v_mfma_f32_32x32x16_bf16 v[16:31], v[48:51], v[96:99], 0
    v_mfma_f32_32x32x16_bf16 v[32:47], v[52:55], v[96:99], 0
    s_add_u32 s17, s29, 0
    s_mov_b32 m0, s17
    s_add_u32 s18, s33, 1048576
    buffer_load_dwordx4 v6, s[12:15], s18 offen lds
    ds_read_b128 v[48:51], v15 offset:6144
    ds_read_b128 v[52:55], v15 offset:7168
    s_waitcnt lgkmcnt(4)
    v_mfma_f32_32x32x16_bf16 v[16:31], v[56:59], v[100:103], v[16:31]
    v_mfma_f32_32x32x16_bf16 v[32:47], v[60:63], v[100:103], v[32:47]
    ds_read_b128 v[56:59], v15 offset:8192
    ds_read_b128 v[60:63], v15 offset:9216
    s_waitcnt lgkmcnt(4)
    v_mfma_f32_32x32x16_bf16 v[16:31], v[64:67], v[104:107], v[16:31]
    v_mfma_f32_32x32x16_bf16 v[32:47], v[68:71], v[104:107], v[32:47]
    s_add_u32 s17, s29, 1024
    s_mov_b32 m0, s17
    s_add_u32 s18, s33, 1310720
    buffer_load_dwordx4 v6, s[12:15], s18 offen lds
    ds_read_b128 v[64:67], v15 offset:10240
    ds_read_b128 v[68:71], v15 offset:11264
    s_waitcnt lgkmcnt(4)
    v_mfma_f32_32x32x16_bf16 v[16:31], v[48:51], v[108:111], v[16:31]
    v_mfma_f32_32x32x16_bf16 v[32:47], v[52:55], v[108:111], v[32:47]
    ds_read_b128 v[48:51], v15 offset:12288
    ds_read_b128 v[52:55], v15 offset:13312
    s_waitcnt lgkmcnt(4)
    v_mfma_f32_32x32x16_bf16 v[16:31], v[56:59], v[112:115], v[16:31]
    v_mfma_f32_32x32x16_bf16 v[32:47], v[60:63], v[112:115], v[32:47]
    s_add_u32 s17, s29, 2048
    s_mov_b32 m0, s17
    s_add_u32 s18, s33, 1048608
    buffer_load_dwordx4 v6, s[12:15], s18 offen lds
    ds_read_b128 v[56:59], v15 offset:14336
    ds_read_b128 v[60:63], v15 offset:15360
    s_waitcnt lgkmcnt(4)
    v_mfma_f32_32x32x16_bf16 v[16:31], v[64:67], v[116:119], v[16:31]
    v_mfma_f32_32x32x16_bf16 v[32:47], v[68:71], v[116:119], v[32:47]
    ds_read_b128 v[64:67], v15 offset:16384
    ds_read_b128 v[68:71], v15 offset:17408
    s_waitcnt lgkmcnt(4)
    v_mfma_f32_32x32x16_bf16 v[16:31], v[48:51], v[120:123], v[16:31]
    v_mfma_f32_32x32x16_bf16 v[32:47], v[52:55], v[120:123], v[32:47]
    s_add_u32 s17, s29, 3072
    s_mov_b32 m0, s17
    s_add_u32 s18, s33, 1310752
    buffer_load_dwordx4 v6, s[12:15], s18 offen lds
    ds_read_b128 v[48:51], v15 offset:18432
    ds_read_b128 v[52:55], v15 offset:19456
    s_waitcnt lgkmcnt(4)
    v_mfma_f32_32x32x16_bf16 v[16:31], v[56:59], v[124:127], v[16:31]
    v_mfma_f32_32x32x16_bf16 v[32:47], v[60:63], v[124:127], v[32:47]
    ds_read_b128 v[56:59], v15 offset:20480
    ds_read_b128 v[60:63], v15 offset:21504
    s_waitcnt lgkmcnt(4)
    v_mfma_f32_32x32x16_bf16 v[16:31], v[64:67], v[128:131], v[16:31]
    v_mfma_f32_32x32x16_bf16 v[32:47], v[68:71], v[128:131], v[32:47]
    s_add_u32 s17, s29, 4096
    s_mov_b32 m0, s17
    s_add_u32 s18, s33, 1048640
    buffer_load_dwordx4 v6, s[12:15], s18 offen lds
    ds_read_b128 v[64:67], v15 offset:22528
    ds_read_b128 v[68:71], v15 offset:23552
    s_waitcnt lgkmcnt(4)
    v_mfma_f32_32x32x16_bf16 v[16:31], v[48:51], v[132:135], v[16:31]
    v_mfma_f32_32x32x16_bf16 v[32:47], v[52:55], v[132:135], v[32:47]
    ds_read_b128 v[48:51], v15 offset:24576
    ds_read_b128 v[52:55], v15 offset:25600
    s_waitcnt lgkmcnt(4)
    v_mfma_f32_32x32x16_bf16 v[16:31], v[56:59], v[136:139], v[16:31]
    v_mfma_f32_32x32x16_bf16 v[32:47], v[60:63], v[136:139], v[32:47]
    s_add_u32 s17, s29, 5120
    s_mov_b32 m0, s17
    s_add_u32 s18, s33, 1310784
    buffer_load_dwordx4 v6, s[12:15], s18 offen lds
    ds_read_b128 v[56:59], v15 offset:26624
    ds_read_b128 v[60:63], v15 offset:27648
    s_waitcnt lgkmcnt(4)
    v_mfma_f32_32x32x16_bf16 v[16:31], v[64:67], v[140:143], v[16:31]
    v_mfma_f32_32x32x16_bf16 v[32:47], v[68:71], v[140:143], v[32:47]
    ds_read_b128 v[64:67], v15 offset:28672
    ds_read_b128 v[68:71], v15 offset:29696
    s_waitcnt lgkmcnt(4)
    v_mfma_f32_32x32x16_bf16 v[16:31], v[48:51], v[144:147], v[16:31]
    v_mfma_f32_32x32x16_bf16 v[32:47], v[52:55], v[144:147], v[32:47]
    s_add_u32 s17, s29, 6144
    s_mov_b32 m0, s17
    s_add_u32 s18, s33, 1048672
    buffer_load_dwordx4 v6, s[12:15], s18 offen lds
    ds_read_b128 v[48:51], v15 offset:30720
    ds_read_b128 v[52:55], v15 offset:31744
    s_waitcnt lgkmcnt(4)
    v_mfma_f32_32x32x16_bf16 v[16:31], v[56:59], v[148:151], v[16:31]
    v_mfma_f32_32x32x16_bf16 v[32:47], v[60:63], v[148:151], v[32:47]
    s_waitcnt lgkmcnt(2)
    v_mfma_f32_32x32x16_bf16 v[16:31], v[64:67], v[152:155], v[16:31]
    v_mfma_f32_32x32x16_bf16 v[32:47], v[68:71], v[152:155], v[32:47]
    s_add_u32 s17, s29, 7168
    s_mov_b32 m0, s17
    s_add_u32 s18, s33, 1310816
    buffer_load_dwordx4 v6, s[12:15], s18 offen lds
    s_waitcnt lgkmcnt(0)
    v_mfma_f32_32x32x16_bf16 v[16:31], v[48:51], v[156:159], v[16:31]
    v_mfma_f32_32x32x16_bf16 v[32:47], v[52:55], v[156:159], v[32:47]
    s_nop 11
    v_cvt_pk_bf16_f32 v72, v16, v17
    v_cvt_pk_bf16_f32 v73, v18, v19
    v_cvt_pk_bf16_f32 v74, v20, v21
    v_cvt_pk_bf16_f32 v75, v22, v23
    v_cvt_pk_bf16_f32 v76, v24, v25
    v_cvt_pk_bf16_f32 v77, v26, v27
    v_cvt_pk_bf16_f32 v78, v28, v29
    v_cvt_pk_bf16_f32 v79, v30, v31
    v_cvt_pk_bf16_f32 v80, v32, v33
    v_cvt_pk_bf16_f32 v81, v34, v35
    v_cvt_pk_bf16_f32 v82, v36, v37
    v_cvt_pk_bf16_f32 v83, v38, v39
    v_cvt_pk_bf16_f32 v84, v40, v41
    v_cvt_pk_bf16_f32 v85, v42, v43
    v_cvt_pk_bf16_f32 v86, v44, v45
    v_cvt_pk_bf16_f32 v87, v46, v47
    buffer_store_dwordx4 v[72:75], v14, s[4:7], s30 offen offset:0 sc1
    buffer_store_dwordx4 v[76:79], v14, s[4:7], s30 offen offset:1024 sc1
    buffer_store_dwordx4 v[80:83], v14, s[4:7], s30 offen offset:2048 sc1
    buffer_store_dwordx4 v[84:87], v14, s[4:7], s30 offen offset:3072 sc1
    s_add_u32 s30, s30, 4096
    s_waitcnt vmcnt(4)
    s_barrier
    ds_read_b128 v[48:51], v14 offset:0
    ds_read_b128 v[52:55], v14 offset:1024
    ds_read_b128 v[56:59], v14 offset:2048
    ds_read_b128 v[60:63], v14 offset:3072
    ds_read_b128 v[64:67], v14 offset:4096
    ds_read_b128 v[68:71], v14 offset:5120
    s_waitcnt lgkmcnt(4)
    v_mfma_f32_32x32x16_bf16 v[16:31], v[48:51], v[96:99], 0
    v_mfma_f32_32x32x16_bf16 v[32:47], v[52:55], v[96:99], 0
    s_add_u32 s17, s29, 57344
    s_mov_b32 m0, s17
    s_add_u32 s18, s33, 1572864
    buffer_load_dwordx4 v6, s[12:15], s18 offen lds
    ds_read_b128 v[48:51], v14 offset:6144
    ds_read_b128 v[52:55], v14 offset:7168
    s_waitcnt lgkmcnt(4)
    v_mfma_f32_32x32x16_bf16 v[16:31], v[56:59], v[100:103], v[16:31]
    v_mfma_f32_32x32x16_bf16 v[32:47], v[60:63], v[100:103], v[32:47]
    ds_read_b128 v[56:59], v14 offset:8192
    ds_read_b128 v[60:63], v14 offset:9216
    s_waitcnt lgkmcnt(4)
    v_mfma_f32_32x32x16_bf16 v[16:31], v[64:67], v[104:107], v[16:31]
    v_mfma_f32_32x32x16_bf16 v[32:47], v[68:71], v[104:107], v[32:47]
    s_add_u32 s17, s29, 58368
    s_mov_b32 m0, s17
    s_add_u32 s18, s33, 1835008
    buffer_load_dwordx4 v6, s[12:15], s18 offen lds
    ds_read_b128 v[64:67], v14 offset:10240
    ds_read_b128 v[68:71], v14 offset:11264
    s_waitcnt lgkmcnt(4)
    v_mfma_f32_32x32x16_bf16 v[16:31], v[48:51], v[108:111], v[16:31]
    v_mfma_f32_32x32x16_bf16 v[32:47], v[52:55], v[108:111], v[32:47]
    ds_read_b128 v[48:51], v14 offset:12288
    ds_read_b128 v[52:55], v14 offset:13312
    s_waitcnt lgkmcnt(4)
    v_mfma_f32_32x32x16_bf16 v[16:31], v[56:59], v[112:115], v[16:31]
    v_mfma_f32_32x32x16_bf16 v[32:47], v[60:63], v[112:115], v[32:47]
    s_add_u32 s17, s29, 59392
    s_mov_b32 m0, s17
    s_add_u32 s18, s33, 1572896
    buffer_load_dwordx4 v6, s[12:15], s18 offen lds
    ds_read_b128 v[56:59], v14 offset:14336
    ds_read_b128 v[60:63], v14 offset:15360
    s_waitcnt lgkmcnt(4)
    v_mfma_f32_32x32x16_bf16 v[16:31], v[64:67], v[116:119], v[16:31]
    v_mfma_f32_32x32x16_bf16 v[32:47], v[68:71], v[116:119], v[32:47]
    ds_read_b128 v[64:67], v14 offset:16384
    ds_read_b128 v[68:71], v14 offset:17408
    s_waitcnt lgkmcnt(4)
    v_mfma_f32_32x32x16_bf16 v[16:31], v[48:51], v[120:123], v[16:31]
    v_mfma_f32_32x32x16_bf16 v[32:47], v[52:55], v[120:123], v[32:47]
    s_add_u32 s17, s29, 60416
    s_mov_b32 m0, s17
    s_add_u32 s18, s33, 1835040
    buffer_load_dwordx4 v6, s[12:15], s18 offen lds
    ds_read_b128 v[48:51], v14 offset:18432
    ds_read_b128 v[52:55], v14 offset:19456
    s_waitcnt lgkmcnt(4)
    v_mfma_f32_32x32x16_bf16 v[16:31], v[56:59], v[124:127], v[16:31]
    v_mfma_f32_32x32x16_bf16 v[32:47], v[60:63], v[124:127], v[32:47]
    ds_read_b128 v[56:59], v14 offset:20480
    ds_read_b128 v[60:63], v14 offset:21504
    s_waitcnt lgkmcnt(4)
    v_mfma_f32_32x32x16_bf16 v[16:31], v[64:67], v[128:131], v[16:31]
    v_mfma_f32_32x32x16_bf16 v[32:47], v[68:71], v[128:131], v[32:47]
    s_add_u32 s17, s29, 61440
    s_mov_b32 m0, s17
    s_add_u32 s18, s33, 1572928
    buffer_load_dwordx4 v6, s[12:15], s18 offen lds
    ds_read_b128 v[64:67], v14 offset:22528
    ds_read_b128 v[68:71], v14 offset:23552
    s_waitcnt lgkmcnt(4)
    v_mfma_f32_32x32x16_bf16 v[16:31], v[48:51], v[132:135], v[16:31]
    v_mfma_f32_32x32x16_bf16 v[32:47], v[52:55], v[132:135], v[32:47]
    ds_read_b128 v[48:51], v14 offset:24576
    ds_read_b128 v[52:55], v14 offset:25600
    s_waitcnt lgkmcnt(4)
    v_mfma_f32_32x32x16_bf16 v[16:31], v[56:59], v[136:139], v[16:31]
    v_mfma_f32_32x32x16_bf16 v[32:47], v[60:63], v[136:139], v[32:47]
    s_add_u32 s17, s29, 62464
    s_mov_b32 m0, s17
    s_add_u32 s18, s33, 1835072
    buffer_load_dwordx4 v6, s[12:15], s18 offen lds
    ds_read_b128 v[56:59], v14 offset:26624
    ds_read_b128 v[60:63], v14 offset:27648
    s_waitcnt lgkmcnt(4)
    v_mfma_f32_32x32x16_bf16 v[16:31], v[64:67], v[140:143], v[16:31]
    v_mfma_f32_32x32x16_bf16 v[32:47], v[68:71], v[140:143], v[32:47]
    ds_read_b128 v[64:67], v14 offset:28672
    ds_read_b128 v[68:71], v14 offset:29696
    s_waitcnt lgkmcnt(4)
    v_mfma_f32_32x32x16_bf16 v[16:31], v[48:51], v[144:147], v[16:31]
    v_mfma_f32_32x32x16_bf16 v[32:47], v[52:55], v[144:147], v[32:47]
    s_add_u32 s17, s29, 63488
    s_mov_b32 m0, s17
    s_add_u32 s18, s33, 1572960
    buffer_load_dwordx4 v6, s[12:15], s18 offen lds
    ds_read_b128 v[48:51], v14 offset:30720
    ds_read_b128 v[52:55], v14 offset:31744
    s_waitcnt lgkmcnt(4)
    v_mfma_f32_32x32x16_bf16 v[16:31], v[56:59], v[148:151], v[16:31]
    v_mfma_f32_32x32x16_bf16 v[32:47], v[60:63], v[148:151], v[32:47]
    s_waitcnt lgkmcnt(2)
    v_mfma_f32_32x32x16_bf16 v[16:31], v[64:67], v[152:155], v[16:31]
    v_mfma_f32_32x32x16_bf16 v[32:47], v[68:71], v[152:155], v[32:47]
    s_add_u32 s17, s29, 64512
    s_mov_b32 m0, s17
    s_add_u32 s18, s33, 1835104
    buffer_load_dwordx4 v6, s[12:15], s18 offen lds
    s_waitcnt lgkmcnt(0)
    v_mfma_f32_32x32x16_bf16 v[16:31], v[48:51], v[156:159], v[16:31]
    v_mfma_f32_32x32x16_bf16 v[32:47], v[52:55], v[156:159], v[32:47]
    s_nop 11
    v_cvt_pk_bf16_f32 v72, v16, v17
    v_cvt_pk_bf16_f32 v73, v18, v19
    v_cvt_pk_bf16_f32 v74, v20, v21
    v_cvt_pk_bf16_f32 v75, v22, v23
    v_cvt_pk_bf16_f32 v76, v24, v25
    v_cvt_pk_bf16_f32 v77, v26, v27
    v_cvt_pk_bf16_f32 v78, v28, v29
    v_cvt_pk_bf16_f32 v79, v30, v31
    v_cvt_pk_bf16_f32 v80, v32, v33
    v_cvt_pk_bf16_f32 v81, v34, v35
    v_cvt_pk_bf16_f32 v82, v36, v37
    v_cvt_pk_bf16_f32 v83, v38, v39
    v_cvt_pk_bf16_f32 v84, v40, v41
    v_cvt_pk_bf16_f32 v85, v42, v43
    v_cvt_pk_bf16_f32 v86, v44, v45
    v_cvt_pk_bf16_f32 v87, v46, v47
    buffer_store_dwordx4 v[72:75], v14, s[4:7], s30 offen offset:0 sc1
    buffer_store_dwordx4 v[76:79], v14, s[4:7], s30 offen offset:1024 sc1
    buffer_store_dwordx4 v[80:83], v14, s[4:7], s30 offen offset:2048 sc1
    buffer_store_dwordx4 v[84:87], v14, s[4:7], s30 offen offset:3072 sc1
    s_add_u32 s30, s30, 4096
    s_waitcnt vmcnt(4)
    s_barrier
    ds_read_b128 v[48:51], v15 offset:0
    ds_read_b128 v[52:55], v15 offset:1024
    ds_read_b128 v[56:59], v15 offset:2048
    ds_read_b128 v[60:63], v15 offset:3072
    ds_read_b128 v[64:67], v15 offset:4096
    ds_read_b128 v[68:71], v15 offset:5120
    s_waitcnt lgkmcnt(4)
    v_mfma_f32_32x32x16_bf16 v[16:31], v[48:51], v[96:99], 0
    v_mfma_f32_32x32x16_bf16 v[32:47], v[52:55], v[96:99], 0
    s_add_u32 s17, s29, 0
    s_mov_b32 m0, s17
    s_add_u32 s18, s33, 2097152
    buffer_load_dwordx4 v6, s[12:15], s18 offen lds
    ds_read_b128 v[48:51], v15 offset:6144
    ds_read_b128 v[52:55], v15 offset:7168
    s_waitcnt lgkmcnt(4)
    v_mfma_f32_32x32x16_bf16 v[16:31], v[56:59], v[100:103], v[16:31]
    v_mfma_f32_32x32x16_bf16 v[32:47], v[60:63], v[100:103], v[32:47]
    ds_read_b128 v[56:59], v15 offset:8192
    ds_read_b128 v[60:63], v15 offset:9216
    s_waitcnt lgkmcnt(4)
    v_mfma_f32_32x32x16_bf16 v[16:31], v[64:67], v[104:107], v[16:31]
    v_mfma_f32_32x32x16_bf16 v[32:47], v[68:71], v[104:107], v[32:47]
    s_add_u32 s17, s29, 1024
    s_mov_b32 m0, s17
    s_add_u32 s18, s33, 2359296
    buffer_load_dwordx4 v6, s[12:15], s18 offen lds
    ds_read_b128 v[64:67], v15 offset:10240
    ds_read_b128 v[68:71], v15 offset:11264
    s_waitcnt lgkmcnt(4)
    v_mfma_f32_32x32x16_bf16 v[16:31], v[48:51], v[108:111], v[16:31]
    v_mfma_f32_32x32x16_bf16 v[32:47], v[52:55], v[108:111], v[32:47]
    ds_read_b128 v[48:51], v15 offset:12288
    ds_read_b128 v[52:55], v15 offset:13312
    s_waitcnt lgkmcnt(4)
    v_mfma_f32_32x32x16_bf16 v[16:31], v[56:59], v[112:115], v[16:31]
    v_mfma_f32_32x32x16_bf16 v[32:47], v[60:63], v[112:115], v[32:47]
    s_add_u32 s17, s29, 2048
    s_mov_b32 m0, s17
    s_add_u32 s18, s33, 2097184
    buffer_load_dwordx4 v6, s[12:15], s18 offen lds
    ds_read_b128 v[56:59], v15 offset:14336
    ds_read_b128 v[60:63], v15 offset:15360
    s_waitcnt lgkmcnt(4)
    v_mfma_f32_32x32x16_bf16 v[16:31], v[64:67], v[116:119], v[16:31]
    v_mfma_f32_32x32x16_bf16 v[32:47], v[68:71], v[116:119], v[32:47]
    ds_read_b128 v[64:67], v15 offset:16384
    ds_read_b128 v[68:71], v15 offset:17408
    s_waitcnt lgkmcnt(4)
    v_mfma_f32_32x32x16_bf16 v[16:31], v[48:51], v[120:123], v[16:31]
    v_mfma_f32_32x32x16_bf16 v[32:47], v[52:55], v[120:123], v[32:47]
    s_add_u32 s17, s29, 3072
    s_mov_b32 m0, s17
    s_add_u32 s18, s33, 2359328
    buffer_load_dwordx4 v6, s[12:15], s18 offen lds
    ds_read_b128 v[48:51], v15 offset:18432
    ds_read_b128 v[52:55], v15 offset:19456
    s_waitcnt lgkmcnt(4)
    v_mfma_f32_32x32x16_bf16 v[16:31], v[56:59], v[124:127], v[16:31]
    v_mfma_f32_32x32x16_bf16 v[32:47], v[60:63], v[124:127], v[32:47]
    ds_read_b128 v[56:59], v15 offset:20480
    ds_read_b128 v[60:63], v15 offset:21504
    s_waitcnt lgkmcnt(4)
    v_mfma_f32_32x32x16_bf16 v[16:31], v[64:67], v[128:131], v[16:31]
    v_mfma_f32_32x32x16_bf16 v[32:47], v[68:71], v[128:131], v[32:47]
    s_add_u32 s17, s29, 4096
    s_mov_b32 m0, s17
    s_add_u32 s18, s33, 2097216
    buffer_load_dwordx4 v6, s[12:15], s18 offen lds
    ds_read_b128 v[64:67], v15 offset:22528
    ds_read_b128 v[68:71], v15 offset:23552
    s_waitcnt lgkmcnt(4)
    v_mfma_f32_32x32x16_bf16 v[16:31], v[48:51], v[132:135], v[16:31]
    v_mfma_f32_32x32x16_bf16 v[32:47], v[52:55], v[132:135], v[32:47]
    ds_read_b128 v[48:51], v15 offset:24576
    ds_read_b128 v[52:55], v15 offset:25600
    s_waitcnt lgkmcnt(4)
    v_mfma_f32_32x32x16_bf16 v[16:31], v[56:59], v[136:139], v[16:31]
    v_mfma_f32_32x32x16_bf16 v[32:47], v[60:63], v[136:139], v[32:47]
    s_add_u32 s17, s29, 5120
    s_mov_b32 m0, s17
    s_add_u32 s18, s33, 2359360
    buffer_load_dwordx4 v6, s[12:15], s18 offen lds
    ds_read_b128 v[56:59], v15 offset:26624
    ds_read_b128 v[60:63], v15 offset:27648
    s_waitcnt lgkmcnt(4)
    v_mfma_f32_32x32x16_bf16 v[16:31], v[64:67], v[140:143], v[16:31]
    v_mfma_f32_32x32x16_bf16 v[32:47], v[68:71], v[140:143], v[32:47]
    ds_read_b128 v[64:67], v15 offset:28672
    ds_read_b128 v[68:71], v15 offset:29696
    s_waitcnt lgkmcnt(4)
    v_mfma_f32_32x32x16_bf16 v[16:31], v[48:51], v[144:147], v[16:31]
    v_mfma_f32_32x32x16_bf16 v[32:47], v[52:55], v[144:147], v[32:47]
    s_add_u32 s17, s29, 6144
    s_mov_b32 m0, s17
    s_add_u32 s18, s33, 2097248
    buffer_load_dwordx4 v6, s[12:15], s18 offen lds
    ds_read_b128 v[48:51], v15 offset:30720
    ds_read_b128 v[52:55], v15 offset:31744
    s_waitcnt lgkmcnt(4)
    v_mfma_f32_32x32x16_bf16 v[16:31], v[56:59], v[148:151], v[16:31]
    v_mfma_f32_32x32x16_bf16 v[32:47], v[60:63], v[148:151], v[32:47]
    s_waitcnt lgkmcnt(2)
    v_mfma_f32_32x32x16_bf16 v[16:31], v[64:67], v[152:155], v[16:31]
    v_mfma_f32_32x32x16_bf16 v[32:47], v[68:71], v[152:155], v[32:47]
    s_add_u32 s17, s29, 7168
    s_mov_b32 m0, s17
    s_add_u32 s18, s33, 2359392
    buffer_load_dwordx4 v6, s[12:15], s18 offen lds
    s_waitcnt lgkmcnt(0)
    v_mfma_f32_32x32x16_bf16 v[16:31], v[48:51], v[156:159], v[16:31]
    v_mfma_f32_32x32x16_bf16 v[32:47], v[52:55], v[156:159], v[32:47]
    s_nop 11
    v_cvt_pk_bf16_f32 v72, v16, v17
    v_cvt_pk_bf16_f32 v73, v18, v19
    v_cvt_pk_bf16_f32 v74, v20, v21
    v_cvt_pk_bf16_f32 v75, v22, v23
    v_cvt_pk_bf16_f32 v76, v24, v25
    v_cvt_pk_bf16_f32 v77, v26, v27
    v_cvt_pk_bf16_f32 v78, v28, v29
    v_cvt_pk_bf16_f32 v79, v30, v31
    v_cvt_pk_bf16_f32 v80, v32, v33
    v_cvt_pk_bf16_f32 v81, v34, v35
    v_cvt_pk_bf16_f32 v82, v36, v37
    v_cvt_pk_bf16_f32 v83, v38, v39
    v_cvt_pk_bf16_f32 v84, v40, v41
    v_cvt_pk_bf16_f32 v85, v42, v43
    v_cvt_pk_bf16_f32 v86, v44, v45
    v_cvt_pk_bf16_f32 v87, v46, v47
    buffer_store_dwordx4 v[72:75], v14, s[4:7], s30 offen offset:0 sc1
    buffer_store_dwordx4 v[76:79], v14, s[4:7], s30 offen offset:1024 sc1
    buffer_store_dwordx4 v[80:83], v14, s[4:7], s30 offen offset:2048 sc1
    buffer_store_dwordx4 v[84:87], v14, s[4:7], s30 offen offset:3072 sc1
    s_add_u32 s30, s30, 4096
    s_waitcnt vmcnt(4)
    s_barrier
    ds_read_b128 v[48:51], v14 offset:0
    ds_read_b128 v[52:55], v14 offset:1024
    ds_read_b128 v[56:59], v14 offset:2048
    ds_read_b128 v[60:63], v14 offset:3072
    ds_read_b128 v[64:67], v14 offset:4096
    ds_read_b128 v[68:71], v14 offset:5120
    s_waitcnt lgkmcnt(4)
    v_mfma_f32_32x32x16_bf16 v[16:31], v[48:51], v[96:99], 0
    v_mfma_f32_32x32x16_bf16 v[32:47], v[52:55], v[96:99], 0
    s_add_u32 s17, s29, 57344
    s_mov_b32 m0, s17
    s_add_u32 s18, s33, 2621440
    buffer_load_dwordx4 v6, s[12:15], s18 offen lds
    ds_read_b128 v[48:51], v14 offset:6144
    ds_read_b128 v[52:55], v14 offset:7168
    s_waitcnt lgkmcnt(4)
    v_mfma_f32_32x32x16_bf16 v[16:31], v[56:59], v[100:103], v[16:31]
    v_mfma_f32_32x32x16_bf16 v[32:47], v[60:63], v[100:103], v[32:47]
    ds_read_b128 v[56:59], v14 offset:8192
    ds_read_b128 v[60:63], v14 offset:9216
    s_waitcnt lgkmcnt(4)
    v_mfma_f32_32x32x16_bf16 v[16:31], v[64:67], v[104:107], v[16:31]
    v_mfma_f32_32x32x16_bf16 v[32:47], v[68:71], v[104:107], v[32:47]
    s_add_u32 s17, s29, 58368
    s_mov_b32 m0, s17
    s_add_u32 s18, s33, 2883584
    buffer_load_dwordx4 v6, s[12:15], s18 offen lds
    ds_read_b128 v[64:67], v14 offset:10240
    ds_read_b128 v[68:71], v14 offset:11264
    s_waitcnt lgkmcnt(4)
    v_mfma_f32_32x32x16_bf16 v[16:31], v[48:51], v[108:111], v[16:31]
    v_mfma_f32_32x32x16_bf16 v[32:47], v[52:55], v[108:111], v[32:47]
    ds_read_b128 v[48:51], v14 offset:12288
    ds_read_b128 v[52:55], v14 offset:13312
    s_waitcnt lgkmcnt(4)
    v_mfma_f32_32x32x16_bf16 v[16:31], v[56:59], v[112:115], v[16:31]
    v_mfma_f32_32x32x16_bf16 v[32:47], v[60:63], v[112:115], v[32:47]
    s_add_u32 s17, s29, 59392
    s_mov_b32 m0, s17
    s_add_u32 s18, s33, 2621472
    buffer_load_dwordx4 v6, s[12:15], s18 offen lds
    ds_read_b128 v[56:59], v14 offset:14336
    ds_read_b128 v[60:63], v14 offset:15360
    s_waitcnt lgkmcnt(4)
    v_mfma_f32_32x32x16_bf16 v[16:31], v[64:67], v[116:119], v[16:31]
    v_mfma_f32_32x32x16_bf16 v[32:47], v[68:71], v[116:119], v[32:47]
    ds_read_b128 v[64:67], v14 offset:16384
    ds_read_b128 v[68:71], v14 offset:17408
    s_waitcnt lgkmcnt(4)
    v_mfma_f32_32x32x16_bf16 v[16:31], v[48:51], v[120:123], v[16:31]
    v_mfma_f32_32x32x16_bf16 v[32:47], v[52:55], v[120:123], v[32:47]
    s_add_u32 s17, s29, 60416
    s_mov_b32 m0, s17
    s_add_u32 s18, s33, 2883616
    buffer_load_dwordx4 v6, s[12:15], s18 offen lds
    ds_read_b128 v[48:51], v14 offset:18432
    ds_read_b128 v[52:55], v14 offset:19456
    s_waitcnt lgkmcnt(4)
    v_mfma_f32_32x32x16_bf16 v[16:31], v[56:59], v[124:127], v[16:31]
    v_mfma_f32_32x32x16_bf16 v[32:47], v[60:63], v[124:127], v[32:47]
    ds_read_b128 v[56:59], v14 offset:20480
    ds_read_b128 v[60:63], v14 offset:21504
    s_waitcnt lgkmcnt(4)
    v_mfma_f32_32x32x16_bf16 v[16:31], v[64:67], v[128:131], v[16:31]
    v_mfma_f32_32x32x16_bf16 v[32:47], v[68:71], v[128:131], v[32:47]
    s_add_u32 s17, s29, 61440
    s_mov_b32 m0, s17
    s_add_u32 s18, s33, 2621504
    buffer_load_dwordx4 v6, s[12:15], s18 offen lds
    ds_read_b128 v[64:67], v14 offset:22528
    ds_read_b128 v[68:71], v14 offset:23552
    s_waitcnt lgkmcnt(4)
    v_mfma_f32_32x32x16_bf16 v[16:31], v[48:51], v[132:135], v[16:31]
    v_mfma_f32_32x32x16_bf16 v[32:47], v[52:55], v[132:135], v[32:47]
    ds_read_b128 v[48:51], v14 offset:24576
    ds_read_b128 v[52:55], v14 offset:25600
    s_waitcnt lgkmcnt(4)
    v_mfma_f32_32x32x16_bf16 v[16:31], v[56:59], v[136:139], v[16:31]
    v_mfma_f32_32x32x16_bf16 v[32:47], v[60:63], v[136:139], v[32:47]
    s_add_u32 s17, s29, 62464
    s_mov_b32 m0, s17
    s_add_u32 s18, s33, 2883648
    buffer_load_dwordx4 v6, s[12:15], s18 offen lds
    ds_read_b128 v[56:59], v14 offset:26624
    ds_read_b128 v[60:63], v14 offset:27648
    s_waitcnt lgkmcnt(4)
    v_mfma_f32_32x32x16_bf16 v[16:31], v[64:67], v[140:143], v[16:31]
    v_mfma_f32_32x32x16_bf16 v[32:47], v[68:71], v[140:143], v[32:47]
    ds_read_b128 v[64:67], v14 offset:28672
    ds_read_b128 v[68:71], v14 offset:29696
    s_waitcnt lgkmcnt(4)
    v_mfma_f32_32x32x16_bf16 v[16:31], v[48:51], v[144:147], v[16:31]
    v_mfma_f32_32x32x16_bf16 v[32:47], v[52:55], v[144:147], v[32:47]
    s_add_u32 s17, s29, 63488
    s_mov_b32 m0, s17
    s_add_u32 s18, s33, 2621536
    buffer_load_dwordx4 v6, s[12:15], s18 offen lds
    ds_read_b128 v[48:51], v14 offset:30720
    ds_read_b128 v[52:55], v14 offset:31744
    s_waitcnt lgkmcnt(4)
    v_mfma_f32_32x32x16_bf16 v[16:31], v[56:59], v[148:151], v[16:31]
    v_mfma_f32_32x32x16_bf16 v[32:47], v[60:63], v[148:151], v[32:47]
    s_waitcnt lgkmcnt(2)
    v_mfma_f32_32x32x16_bf16 v[16:31], v[64:67], v[152:155], v[16:31]
    v_mfma_f32_32x32x16_bf16 v[32:47], v[68:71], v[152:155], v[32:47]
    s_add_u32 s17, s29, 64512
    s_mov_b32 m0, s17
    s_add_u32 s18, s33, 2883680
    buffer_load_dwordx4 v6, s[12:15], s18 offen lds
    s_waitcnt lgkmcnt(0)
    v_mfma_f32_32x32x16_bf16 v[16:31], v[48:51], v[156:159], v[16:31]
    v_mfma_f32_32x32x16_bf16 v[32:47], v[52:55], v[156:159], v[32:47]
    s_nop 11
    v_cvt_pk_bf16_f32 v72, v16, v17
    v_cvt_pk_bf16_f32 v73, v18, v19
    v_cvt_pk_bf16_f32 v74, v20, v21
    v_cvt_pk_bf16_f32 v75, v22, v23
    v_cvt_pk_bf16_f32 v76, v24, v25
    v_cvt_pk_bf16_f32 v77, v26, v27
    v_cvt_pk_bf16_f32 v78, v28, v29
    v_cvt_pk_bf16_f32 v79, v30, v31
    v_cvt_pk_bf16_f32 v80, v32, v33
    v_cvt_pk_bf16_f32 v81, v34, v35
    v_cvt_pk_bf16_f32 v82, v36, v37
    v_cvt_pk_bf16_f32 v83, v38, v39
    v_cvt_pk_bf16_f32 v84, v40, v41
    v_cvt_pk_bf16_f32 v85, v42, v43
    v_cvt_pk_bf16_f32 v86, v44, v45
    v_cvt_pk_bf16_f32 v87, v46, v47
    buffer_store_dwordx4 v[72:75], v14, s[4:7], s30 offen offset:0 sc1
    buffer_store_dwordx4 v[76:79], v14, s[4:7], s30 offen offset:1024 sc1
    buffer_store_dwordx4 v[80:83], v14, s[4:7], s30 offen offset:2048 sc1
    buffer_store_dwordx4 v[84:87], v14, s[4:7], s30 offen offset:3072 sc1
    s_add_u32 s30, s30, 4096
    s_waitcnt vmcnt(4)
    s_barrier
    ds_read_b128 v[48:51], v15 offset:0
    ds_read_b128 v[52:55], v15 offset:1024
    ds_read_b128 v[56:59], v15 offset:2048
    ds_read_b128 v[60:63], v15 offset:3072
    ds_read_b128 v[64:67], v15 offset:4096
    ds_read_b128 v[68:71], v15 offset:5120
    s_waitcnt lgkmcnt(4)
    v_mfma_f32_32x32x16_bf16 v[16:31], v[48:51], v[96:99], 0
    v_mfma_f32_32x32x16_bf16 v[32:47], v[52:55], v[96:99], 0
    s_add_u32 s17, s29, 0
    s_mov_b32 m0, s17
    s_add_u32 s18, s33, 3145728
    buffer_load_dwordx4 v6, s[12:15], s18 offen lds
    ds_read_b128 v[48:51], v15 offset:6144
    ds_read_b128 v[52:55], v15 offset:7168
    s_waitcnt lgkmcnt(4)
    v_mfma_f32_32x32x16_bf16 v[16:31], v[56:59], v[100:103], v[16:31]
    v_mfma_f32_32x32x16_bf16 v[32:47], v[60:63], v[100:103], v[32:47]
    ds_read_b128 v[56:59], v15 offset:8192
    ds_read_b128 v[60:63], v15 offset:9216
    s_waitcnt lgkmcnt(4)
    v_mfma_f32_32x32x16_bf16 v[16:31], v[64:67], v[104:107], v[16:31]
    v_mfma_f32_32x32x16_bf16 v[32:47], v[68:71], v[104:107], v[32:47]
    s_add_u32 s17, s29, 1024
    s_mov_b32 m0, s17
    s_add_u32 s18, s33, 3407872
    buffer_load_dwordx4 v6, s[12:15], s18 offen lds
    ds_read_b128 v[64:67], v15 offset:10240
    ds_read_b128 v[68:71], v15 offset:11264
    s_waitcnt lgkmcnt(4)
    v_mfma_f32_32x32x16_bf16 v[16:31], v[48:51], v[108:111], v[16:31]
    v_mfma_f32_32x32x16_bf16 v[32:47], v[52:55], v[108:111], v[32:47]
    ds_read_b128 v[48:51], v15 offset:12288
    ds_read_b128 v[52:55], v15 offset:13312
    s_waitcnt lgkmcnt(4)
    v_mfma_f32_32x32x16_bf16 v[16:31], v[56:59], v[112:115], v[16:31]
    v_mfma_f32_32x32x16_bf16 v[32:47], v[60:63], v[112:115], v[32:47]
    s_add_u32 s17, s29, 2048
    s_mov_b32 m0, s17
    s_add_u32 s18, s33, 3145760
    buffer_load_dwordx4 v6, s[12:15], s18 offen lds
    ds_read_b128 v[56:59], v15 offset:14336
    ds_read_b128 v[60:63], v15 offset:15360
    s_waitcnt lgkmcnt(4)
    v_mfma_f32_32x32x16_bf16 v[16:31], v[64:67], v[116:119], v[16:31]
    v_mfma_f32_32x32x16_bf16 v[32:47], v[68:71], v[116:119], v[32:47]
    ds_read_b128 v[64:67], v15 offset:16384
    ds_read_b128 v[68:71], v15 offset:17408
    s_waitcnt lgkmcnt(4)
    v_mfma_f32_32x32x16_bf16 v[16:31], v[48:51], v[120:123], v[16:31]
    v_mfma_f32_32x32x16_bf16 v[32:47], v[52:55], v[120:123], v[32:47]
    s_add_u32 s17, s29, 3072
    s_mov_b32 m0, s17
    s_add_u32 s18, s33, 3407904
    buffer_load_dwordx4 v6, s[12:15], s18 offen lds
    ds_read_b128 v[48:51], v15 offset:18432
    ds_read_b128 v[52:55], v15 offset:19456
    s_waitcnt lgkmcnt(4)
    v_mfma_f32_32x32x16_bf16 v[16:31], v[56:59], v[124:127], v[16:31]
    v_mfma_f32_32x32x16_bf16 v[32:47], v[60:63], v[124:127], v[32:47]
    ds_read_b128 v[56:59], v15 offset:20480
    ds_read_b128 v[60:63], v15 offset:21504
    s_waitcnt lgkmcnt(4)
    v_mfma_f32_32x32x16_bf16 v[16:31], v[64:67], v[128:131], v[16:31]
    v_mfma_f32_32x32x16_bf16 v[32:47], v[68:71], v[128:131], v[32:47]
    s_add_u32 s17, s29, 4096
    s_mov_b32 m0, s17
    s_add_u32 s18, s33, 3145792
    buffer_load_dwordx4 v6, s[12:15], s18 offen lds
    ds_read_b128 v[64:67], v15 offset:22528
    ds_read_b128 v[68:71], v15 offset:23552
    s_waitcnt lgkmcnt(4)
    v_mfma_f32_32x32x16_bf16 v[16:31], v[48:51], v[132:135], v[16:31]
    v_mfma_f32_32x32x16_bf16 v[32:47], v[52:55], v[132:135], v[32:47]
    ds_read_b128 v[48:51], v15 offset:24576
    ds_read_b128 v[52:55], v15 offset:25600
    s_waitcnt lgkmcnt(4)
    v_mfma_f32_32x32x16_bf16 v[16:31], v[56:59], v[136:139], v[16:31]
    v_mfma_f32_32x32x16_bf16 v[32:47], v[60:63], v[136:139], v[32:47]
    s_add_u32 s17, s29, 5120
    s_mov_b32 m0, s17
    s_add_u32 s18, s33, 3407936
    buffer_load_dwordx4 v6, s[12:15], s18 offen lds
    ds_read_b128 v[56:59], v15 offset:26624
    ds_read_b128 v[60:63], v15 offset:27648
    s_waitcnt lgkmcnt(4)
    v_mfma_f32_32x32x16_bf16 v[16:31], v[64:67], v[140:143], v[16:31]
    v_mfma_f32_32x32x16_bf16 v[32:47], v[68:71], v[140:143], v[32:47]
    ds_read_b128 v[64:67], v15 offset:28672
    ds_read_b128 v[68:71], v15 offset:29696
    s_waitcnt lgkmcnt(4)
    v_mfma_f32_32x32x16_bf16 v[16:31], v[48:51], v[144:147], v[16:31]
    v_mfma_f32_32x32x16_bf16 v[32:47], v[52:55], v[144:147], v[32:47]
    s_add_u32 s17, s29, 6144
    s_mov_b32 m0, s17
    s_add_u32 s18, s33, 3145824
    buffer_load_dwordx4 v6, s[12:15], s18 offen lds
    ds_read_b128 v[48:51], v15 offset:30720
    ds_read_b128 v[52:55], v15 offset:31744
    s_waitcnt lgkmcnt(4)
    v_mfma_f32_32x32x16_bf16 v[16:31], v[56:59], v[148:151], v[16:31]
    v_mfma_f32_32x32x16_bf16 v[32:47], v[60:63], v[148:151], v[32:47]
    s_waitcnt lgkmcnt(2)
    v_mfma_f32_32x32x16_bf16 v[16:31], v[64:67], v[152:155], v[16:31]
    v_mfma_f32_32x32x16_bf16 v[32:47], v[68:71], v[152:155], v[32:47]
    s_add_u32 s17, s29, 7168
    s_mov_b32 m0, s17
    s_add_u32 s18, s33, 3407968
    buffer_load_dwordx4 v6, s[12:15], s18 offen lds
    s_waitcnt lgkmcnt(0)
    v_mfma_f32_32x32x16_bf16 v[16:31], v[48:51], v[156:159], v[16:31]
    v_mfma_f32_32x32x16_bf16 v[32:47], v[52:55], v[156:159], v[32:47]
    s_nop 11
    v_cvt_pk_bf16_f32 v72, v16, v17
    v_cvt_pk_bf16_f32 v73, v18, v19
    v_cvt_pk_bf16_f32 v74, v20, v21
    v_cvt_pk_bf16_f32 v75, v22, v23
    v_cvt_pk_bf16_f32 v76, v24, v25
    v_cvt_pk_bf16_f32 v77, v26, v27
    v_cvt_pk_bf16_f32 v78, v28, v29
    v_cvt_pk_bf16_f32 v79, v30, v31
    v_cvt_pk_bf16_f32 v80, v32, v33
    v_cvt_pk_bf16_f32 v81, v34, v35
    v_cvt_pk_bf16_f32 v82, v36, v37
    v_cvt_pk_bf16_f32 v83, v38, v39
    v_cvt_pk_bf16_f32 v84, v40, v41
    v_cvt_pk_bf16_f32 v85, v42, v43
    v_cvt_pk_bf16_f32 v86, v44, v45
    v_cvt_pk_bf16_f32 v87, v46, v47
    buffer_store_dwordx4 v[72:75], v14, s[4:7], s30 offen offset:0 sc1
    buffer_store_dwordx4 v[76:79], v14, s[4:7], s30 offen offset:1024 sc1
    buffer_store_dwordx4 v[80:83], v14, s[4:7], s30 offen offset:2048 sc1
    buffer_store_dwordx4 v[84:87], v14, s[4:7], s30 offen offset:3072 sc1
    s_add_u32 s30, s30, 4096
    s_waitcnt vmcnt(4)
    s_barrier
    ds_read_b128 v[48:51], v14 offset:0
    ds_read_b128 v[52:55], v14 offset:1024
    ds_read_b128 v[56:59], v14 offset:2048
    ds_read_b128 v[60:63], v14 offset:3072
    ds_read_b128 v[64:67], v14 offset:4096
    ds_read_b128 v[68:71], v14 offset:5120
    s_waitcnt lgkmcnt(4)
    v_mfma_f32_32x32x16_bf16 v[16:31], v[48:51], v[96:99], 0
    v_mfma_f32_32x32x16_bf16 v[32:47], v[52:55], v[96:99], 0
    ds_read_b128 v[48:51], v14 offset:6144
    ds_read_b128 v[52:55], v14 offset:7168
    s_waitcnt lgkmcnt(4)
    v_mfma_f32_32x32x16_bf16 v[16:31], v[56:59], v[100:103], v[16:31]
    v_mfma_f32_32x32x16_bf16 v[32:47], v[60:63], v[100:103], v[32:47]
    ds_read_b128 v[56:59], v14 offset:8192
    ds_read_b128 v[60:63], v14 offset:9216
    s_waitcnt lgkmcnt(4)
    v_mfma_f32_32x32x16_bf16 v[16:31], v[64:67], v[104:107], v[16:31]
    v_mfma_f32_32x32x16_bf16 v[32:47], v[68:71], v[104:107], v[32:47]
    ds_read_b128 v[64:67], v14 offset:10240
    ds_read_b128 v[68:71], v14 offset:11264
    s_waitcnt lgkmcnt(4)
    v_mfma_f32_32x32x16_bf16 v[16:31], v[48:51], v[108:111], v[16:31]
    v_mfma_f32_32x32x16_bf16 v[32:47], v[52:55], v[108:111], v[32:47]
    ds_read_b128 v[48:51], v14 offset:12288
    ds_read_b128 v[52:55], v14 offset:13312
    s_waitcnt lgkmcnt(4)
    v_mfma_f32_32x32x16_bf16 v[16:31], v[56:59], v[112:115], v[16:31]
    v_mfma_f32_32x32x16_bf16 v[32:47], v[60:63], v[112:115], v[32:47]
    ds_read_b128 v[56:59], v14 offset:14336
    ds_read_b128 v[60:63], v14 offset:15360
    s_waitcnt lgkmcnt(4)
    v_mfma_f32_32x32x16_bf16 v[16:31], v[64:67], v[116:119], v[16:31]
    v_mfma_f32_32x32x16_bf16 v[32:47], v[68:71], v[116:119], v[32:47]
    ds_read_b128 v[64:67], v14 offset:16384
    ds_read_b128 v[68:71], v14 offset:17408
    s_waitcnt lgkmcnt(4)
    v_mfma_f32_32x32x16_bf16 v[16:31], v[48:51], v[120:123], v[16:31]
    v_mfma_f32_32x32x16_bf16 v[32:47], v[52:55], v[120:123], v[32:47]
    ds_read_b128 v[48:51], v14 offset:18432
    ds_read_b128 v[52:55], v14 offset:19456
    s_waitcnt lgkmcnt(4)
    v_mfma_f32_32x32x16_bf16 v[16:31], v[56:59], v[124:127], v[16:31]
    v_mfma_f32_32x32x16_bf16 v[32:47], v[60:63], v[124:127], v[32:47]
    ds_read_b128 v[56:59], v14 offset:20480
    ds_read_b128 v[60:63], v14 offset:21504
    s_waitcnt lgkmcnt(4)
    v_mfma_f32_32x32x16_bf16 v[16:31], v[64:67], v[128:131], v[16:31]
    v_mfma_f32_32x32x16_bf16 v[32:47], v[68:71], v[128:131], v[32:47]
    ds_read_b128 v[64:67], v14 offset:22528
    ds_read_b128 v[68:71], v14 offset:23552
    s_waitcnt lgkmcnt(4)
    v_mfma_f32_32x32x16_bf16 v[16:31], v[48:51], v[132:135], v[16:31]
    v_mfma_f32_32x32x16_bf16 v[32:47], v[52:55], v[132:135], v[32:47]
    ds_read_b128 v[48:51], v14 offset:24576
    ds_read_b128 v[52:55], v14 offset:25600
    s_waitcnt lgkmcnt(4)
    v_mfma_f32_32x32x16_bf16 v[16:31], v[56:59], v[136:139], v[16:31]
    v_mfma_f32_32x32x16_bf16 v[32:47], v[60:63], v[136:139], v[32:47]
    ds_read_b128 v[56:59], v14 offset:26624
    ds_read_b128 v[60:63], v14 offset:27648
    s_waitcnt lgkmcnt(4)
    v_mfma_f32_32x32x16_bf16 v[16:31], v[64:67], v[140:143], v[16:31]
    v_mfma_f32_32x32x16_bf16 v[32:47], v[68:71], v[140:143], v[32:47]
    ds_read_b128 v[64:67], v14 offset:28672
    ds_read_b128 v[68:71], v14 offset:29696
    s_waitcnt lgkmcnt(4)
    v_mfma_f32_32x32x16_bf16 v[16:31], v[48:51], v[144:147], v[16:31]
    v_mfma_f32_32x32x16_bf16 v[32:47], v[52:55], v[144:147], v[32:47]
    ds_read_b128 v[48:51], v14 offset:30720
    ds_read_b128 v[52:55], v14 offset:31744
    s_waitcnt lgkmcnt(4)
    v_mfma_f32_32x32x16_bf16 v[16:31], v[56:59], v[148:151], v[16:31]
    v_mfma_f32_32x32x16_bf16 v[32:47], v[60:63], v[148:151], v[32:47]
    s_waitcnt lgkmcnt(2)
    v_mfma_f32_32x32x16_bf16 v[16:31], v[64:67], v[152:155], v[16:31]
    v_mfma_f32_32x32x16_bf16 v[32:47], v[68:71], v[152:155], v[32:47]
    s_waitcnt lgkmcnt(0)
    v_mfma_f32_32x32x16_bf16 v[16:31], v[48:51], v[156:159], v[16:31]
    v_mfma_f32_32x32x16_bf16 v[32:47], v[52:55], v[156:159], v[32:47]
    s_nop 11
    v_cvt_pk_bf16_f32 v72, v16, v17
    v_cvt_pk_bf16_f32 v73, v18, v19
    v_cvt_pk_bf16_f32 v74, v20, v21
    v_cvt_pk_bf16_f32 v75, v22, v23
    v_cvt_pk_bf16_f32 v76, v24, v25
    v_cvt_pk_bf16_f32 v77, v26, v27
    v_cvt_pk_bf16_f32 v78, v28, v29
    v_cvt_pk_bf16_f32 v79, v30, v31
    v_cvt_pk_bf16_f32 v80, v32, v33
    v_cvt_pk_bf16_f32 v81, v34, v35
    v_cvt_pk_bf16_f32 v82, v36, v37
    v_cvt_pk_bf16_f32 v83, v38, v39
    v_cvt_pk_bf16_f32 v84, v40, v41
    v_cvt_pk_bf16_f32 v85, v42, v43
    v_cvt_pk_bf16_f32 v86, v44, v45
    v_cvt_pk_bf16_f32 v87, v46, v47
    buffer_store_dwordx4 v[72:75], v14, s[4:7], s30 offen offset:0 sc1
    buffer_store_dwordx4 v[76:79], v14, s[4:7], s30 offen offset:1024 sc1
    buffer_store_dwordx4 v[80:83], v14, s[4:7], s30 offen offset:2048 sc1
    buffer_store_dwordx4 v[84:87], v14, s[4:7], s30 offen offset:3072 sc1
    s_add_u32 s30, s30, 4096
    s_lshl_b32 s93, s24, 4
    s_add_u32 s93, s93, s25
    s_lshl_b32 s93, s93, 2
    s_add_u32 s93, s93, 90973184
    s_waitcnt vmcnt(0)
    s_barrier
    s_cmp_lg_u32 s87, 0
    s_cbranch_scc1 sig_77
    v_mov_b32 v250, 0
    v_mov_b32 v251, 1
    s_mov_b64 exec, 1
    buffer_store_dword v251, v250, s[4:7], s93 offen sc1
    s_mov_b64 exec, -1
sig_77:
L_job_next:
    s_add_u32 s84, s84, 32
    s_branch L_job
L_jobs_done:
    s_add_u32 s84, s82, 160
    s_cmp_ge_u32 s84, 224
    s_cselect_b32 s91, 224, 0
    s_sub_u32 s84, s84, s91
    s_cmp_ge_u32 s84, 128
    s_cbranch_scc1 L_not_e
    s_and_b32 s25, s84, 15
    s_lshr_b32 s24, s84, 4
    s_lshl_b32 s24, s24, 2
    s_add_u32 s24, s24, s87
L_e_loop:
    s_lshr_b32 s16, s24, 2
    s_lshl_b32 s17, s25, 4
    s_add_u32 s16, s16, s17
    s_lshl_b32 s16, s16, 2
    s_add_u32 s93, s16, 90973184
    s_mov_b32 s90, 0
    v_mov_b32 v250, 0
wge_78:
    buffer_load_dword v251, v250, s[4:7], s93 offen sc1
    s_waitcnt vmcnt(0)
    v_readfirstlane_b32 s92, v251
    s_nop 3
    s_cmp_ge_u32 s92, 1
    s_cbranch_scc1 wok_79
    s_sleep 32
    s_add_u32 s90, s90, 1
    s_cmp_lt_u32 s90, 400000
    s_cbranch_scc1 wge_78
    s_branch L_abort
wok_79:
    v_and_b32 v1, 63, v0
    v_lshlrev_b32 v2, 4, v1
    s_lshl_b32 s16, s24, 4
    s_add_u32 s16, s16, s25
    s_mul_i32 s17, s16, 28672
    s_add_u32 s17, s17, 52973568
    buffer_load_dwordx4 a[0:3], v2, s[4:7], s17 offen offset:0 sc1
    buffer_load_dwordx4 a[4:7], v2, s[4:7], s17 offen offset:1024 sc1
    buffer_load_dwordx4 a[8:11], v2, s[4:7], s17 offen offset:2048 sc1
    buffer_load_dwordx4 a[12:15], v2, s[4:7], s17 offen offset:3072 sc1
    s_add_u32 s17, s17, 4096
    buffer_load_dwordx4 a[16:19], v2, s[4:7], s17 offen offset:0 sc1
    buffer_load_dwordx4 a[20:23], v2, s[4:7], s17 offen offset:1024 sc1
    buffer_load_dwordx4 a[24:27], v2, s[4:7], s17 offen offset:2048 sc1
    buffer_load_dwordx4 a[28:31], v2, s[4:7], s17 offen offset:3072 sc1
    s_add_u32 s17, s17, 4096
    buffer_load_dwordx4 a[32:35], v2, s[4:7], s17 offen offset:0 sc1
    buffer_load_dwordx4 a[36:39], v2, s[4:7], s17 offen offset:1024 sc1
    buffer_load_dwordx4 a[40:43], v2, s[4:7], s17 offen offset:2048 sc1
    buffer_load_dwordx4 a[44:47], v2, s[4:7], s17 offen offset:3072 sc1
    s_add_u32 s17, s17, 4096
    buffer_load_dwordx4 a[48:51], v2, s[4:7], s17 offen offset:0 sc1
    buffer_load_dwordx4 a[52:55], v2, s[4:7], s17 offen offset:1024 sc1
    buffer_load_dwordx4 a[56:59], v2, s[4:7], s17 offen offset:2048 sc1
    buffer_load_dwordx4 a[60:63], v2, s[4:7], s17 offen offset:3072 sc1
    s_add_u32 s17, s17, 4096
    buffer_load_dwordx4 a[64:67], v2, s[4:7], s17 offen offset:0 sc1
    buffer_load_dwordx4 a[68:71], v2, s[4:7], s17 offen offset:1024 sc1
    buffer_load_dwordx4 a[72:75], v2, s[4:7], s17 offen offset:2048 sc1
    buffer_load_dwordx4 a[76:79], v2, s[4:7], s17 offen offset:3072 sc1
    s_add_u32 s17, s17, 4096
    buffer_load_dwordx4 a[80:83], v2, s[4:7], s17 offen offset:0 sc1
    buffer_load_dwordx4 a[84:87], v2, s[4:7], s17 offen offset:1024 sc1
    buffer_load_dwordx4 a[88:91], v2, s[4:7], s17 offen offset:2048 sc1
    buffer_load_dwordx4 a[92:95], v2, s[4:7], s17 offen offset:3072 sc1
    s_add_u32 s17, s17, 4096
    buffer_load_dwordx4 a[96:99], v2, s[4:7], s17 offen offset:0 sc1
    buffer_load_dwordx4 a[100:103], v2, s[4:7], s17 offen offset:1024 sc1
    buffer_load_dwordx4 a[104:107], v2, s[4:7], s17 offen offset:2048 sc1
    buffer_load_dwordx4 a[108:111], v2, s[4:7], s17 offen offset:3072 sc1
    s_add_u32 s17, s17, 4096
    s_lshl_b32 s17, s16, 11
    s_add_u32 s17, s17, 82333696
    buffer_load_dwordx4 v[8:11], v2, s[4:7], s17 offen sc1
    buffer_load_dwordx4 v[12:15], v2, s[4:7], s17 offen offset:1024 sc1
    s_max_u32 s17, s24, 1
    s_sub_u32 s17, s17, 1
    s_mul_i32 s17, s17, 7168
    s_add_u32 s17, s17, 52506624
    v_mov_b32 v4, 0
    s_mov_b32 s90, 0
efar_81:
    buffer_load_dword v5, v4, s[4:7], s17 offen sc1
    s_waitcnt vmcnt(0)
    v_cmp_eq_u32 vcc, -1, v5
    s_cbranch_vccz efok_82
    s_cmp_ge_u32 s24, 54
    s_cbranch_scc1 efs_83
    s_sleep 40
efs_83:
    s_sleep 6
    s_add_u32 s90, s90, 1
    s_cmp_lt_u32 s90, 400000
    s_cbranch_scc1 efar_81
    s_branch L_abort
efok_82:
    v_and_b32 v1, 63, v0
    v_lshlrev_b32 v2, 4, v1
    s_mul_i32 s17, s24, 7168
    s_add_u32 s17, s17, 52506624
    s_add_u32 s18, s17, 4096
    s_mov_b32 s90, 0
emp_84:
    buffer_load_dwordx4 v[48:51], v2, s[4:7], s17 offen offset:0 sc1
    buffer_load_dwordx4 v[52:55], v2, s[4:7], s17 offen offset:1024 sc1
    buffer_load_dwordx4 v[56:59], v2, s[4:7], s17 offen offset:2048 sc1
    buffer_load_dwordx4 v[60:63], v2, s[4:7], s17 offen offset:3072 sc1
    buffer_load_dwordx4 v[64:67], v2, s[4:7], s18 offen offset:0 sc1
    buffer_load_dwordx4 v[68:71], v2, s[4:7], s18 offen offset:1024 sc1
    buffer_load_dwordx4 v[72:75], v2, s[4:7], s18 offen offset:2048 sc1
    s_waitcnt vmcnt(0)
    v_max3_u32 v4, v48, v49, v50
    v_max3_u32 v4, v4, v51, v52
    v_max3_u32 v4, v4, v53, v54
    v_max3_u32 v4, v4, v55, v56
    v_max3_u32 v4, v4, v57, v58
    v_max3_u32 v4, v4, v59, v60
    v_max3_u32 v4, v4, v61, v62
    v_max3_u32 v4, v4, v63, v64
    v_max3_u32 v4, v4, v65, v66
    v_max3_u32 v4, v4, v67, v68
    v_max3_u32 v4, v4, v69, v70
    v_max3_u32 v4, v4, v71, v72
    v_max3_u32 v4, v4, v73, v74
    v_max_u32 v4, v4, v75
    v_cmp_eq_u32 vcc, -1, v4
    s_cbranch_vccz emok_85
    s_sleep 1
    s_add_u32 s90, s90, 1
    s_cmp_lt_u32 s90, 400000
    s_cbranch_scc1 emp_84
    s_branch L_abort
emok_85:
    v_lshrrev_b32 v3, 5, v1
    v_lshlrev_b32 v4, 7, v3
    v_and_b32 v5, 7, v1
    v_lshl_add_u32 v4, v5, 4, v4
    s_mul_i32 s17, s87, 7168
    v_add_u32 v6, s17, v2
    ds_write_b128 v6, v[48:51] offset:0
    ds_write_b128 v6, v[52:55] offset:1024
    ds_write_b128 v6, v[56:59] offset:2048
    ds_write_b128 v6, v[60:63] offset:3072
    ds_write_b128 v6, v[64:67] offset:4096
    ds_write_b128 v6, v[68:71] offset:5120
    ds_write_b128 v6, v[72:75] offset:6144
    v_add_u32 v4, s17, v4
    s_waitcnt lgkmcnt(0)
    ds_read_b128 v[48:51], v4 offset:0
    ds_read_b128 v[52:55], v4 offset:256
    ds_read_b128 v[56:59], v4 offset:512
    ds_read_b128 v[60:63], v4 offset:768
    ds_read_b128 v[64:67], v4 offset:1024
    ds_read_b128 v[68:71], v4 offset:1280
    ds_read_b128 v[72:75], v4 offset:1536
    ds_read_b128 v[76:79], v4 offset:1792
    ds_read_b128 v[80:83], v4 offset:2048
    ds_read_b128 v[84:87], v4 offset:2304
    ds_read_b128 v[88:91], v4 offset:2560
    s_waitcnt lgkmcnt(10)
    v_mfma_f32_32x32x16_bf16 v[16:31], v[48:51], a[0:3], 0
    ds_read_b128 v[92:95], v4 offset:2816
    s_waitcnt lgkmcnt(10)
    v_mfma_f32_32x32x16_bf16 v[16:31], v[52:55], a[4:7], v[16:31]
    ds_read_b128 v[96:99], v4 offset:3072
    s_waitcnt lgkmcnt(10)
    v_mfma_f32_32x32x16_bf16 v[16:31], v[56:59], a[8:11], v[16:31]
    ds_read_b128 v[100:103], v4 offset:3328
    s_waitcnt lgkmcnt(10)
    v_mfma_f32_32x32x16_bf16 v[16:31], v[60:63], a[12:15], v[16:31]
    ds_read_b128 v[104:107], v4 offset:3584
    s_waitcnt lgkmcnt(10)
    v_mfma_f32_32x32x16_bf16 v[16:31], v[64:67], a[16:19], v[16:31]
    ds_read_b128 v[108:111], v4 offset:3840
    s_waitcnt lgkmcnt(10)
    v_mfma_f32_32x32x16_bf16 v[16:31], v[68:71], a[20:23], v[16:31]
    ds_read_b128 v[112:115], v4 offset:4096
    s_waitcnt lgkmcnt(10)
    v_mfma_f32_32x32x16_bf16 v[16:31], v[72:75], a[24:27], v[16:31]
    ds_read_b128 v[116:119], v4 offset:4352
    s_waitcnt lgkmcnt(10)
    v_mfma_f32_32x32x16_bf16 v[16:31], v[76:79], a[28:31], v[16:31]
    ds_read_b128 v[120:123], v4 offset:4608
    s_waitcnt lgkmcnt(10)
    v_mfma_f32_32x32x16_bf16 v[16:31], v[80:83], a[32:35], v[16:31]
    ds_read_b128 v[124:127], v4 offset:4864
    s_waitcnt lgkmcnt(10)
    v_mfma_f32_32x32x16_bf16 v[16:31], v[84:87], a[36:39], v[16:31]
    ds_read_b128 v[128:131], v4 offset:5120
    s_waitcnt lgkmcnt(10)
    v_mfma_f32_32x32x16_bf16 v[16:31], v[88:91], a[40:43], v[16:31]
    ds_read_b128 v[132:135], v4 offset:5376
    s_waitcnt lgkmcnt(10)
    v_mfma_f32_32x32x16_bf16 v[16:31], v[92:95], a[44:47], v[16:31]
    ds_read_b128 v[136:139], v4 offset:5632
    s_waitcnt lgkmcnt(10)
    v_mfma_f32_32x32x16_bf16 v[16:31], v[96:99], a[48:51], v[16:31]
    ds_read_b128 v[140:143], v4 offset:5888
    s_waitcnt lgkmcnt(10)
    v_mfma_f32_32x32x16_bf16 v[16:31], v[100:103], a[52:55], v[16:31]
    ds_read_b128 v[144:147], v4 offset:6144
    s_waitcnt lgkmcnt(10)
    v_mfma_f32_32x32x16_bf16 v[16:31], v[104:107], a[56:59], v[16:31]
    ds_read_b128 v[148:151], v4 offset:6400
    s_waitcnt lgkmcnt(10)
    v_mfma_f32_32x32x16_bf16 v[16:31], v[108:111], a[60:63], v[16:31]
    ds_read_b128 v[152:155], v4 offset:6656
    s_waitcnt lgkmcnt(10)
    v_mfma_f32_32x32x16_bf16 v[16:31], v[112:115], a[64:67], v[16:31]
    ds_read_b128 v[156:159], v4 offset:6912
    s_waitcnt lgkmcnt(10)
    v_mfma_f32_32x32x16_bf16 v[16:31], v[116:119], a[68:71], v[16:31]
    s_waitcnt lgkmcnt(9)
    v_mfma_f32_32x32x16_bf16 v[16:31], v[120:123], a[72:75], v[16:31]
    s_waitcnt lgkmcnt(8)
    v_mfma_f32_32x32x16_bf16 v[16:31], v[124:127], a[76:79], v[16:31]
    s_waitcnt lgkmcnt(7)
    v_mfma_f32_32x32x16_bf16 v[16:31], v[128:131], a[80:83], v[16:31]
    s_waitcnt lgkmcnt(6)
    v_mfma_f32_32x32x16_bf16 v[16:31], v[132:135], a[84:87], v[16:31]
    s_waitcnt lgkmcnt(5)
    v_mfma_f32_32x32x16_bf16 v[16:31], v[136:139], a[88:91], v[16:31]
    s_waitcnt lgkmcnt(4)
    v_mfma_f32_32x32x16_bf16 v[16:31], v[140:143], a[92:95], v[16:31]
    s_waitcnt lgkmcnt(3)
    v_mfma_f32_32x32x16_bf16 v[16:31], v[144:147], a[96:99], v[16:31]
    s_waitcnt lgkmcnt(2)
    v_mfma_f32_32x32x16_bf16 v[16:31], v[148:151], a[100:103], v[16:31]
    s_waitcnt lgkmcnt(1)
    v_mfma_f32_32x32x16_bf16 v[16:31], v[152:155], a[104:107], v[16:31]
    s_waitcnt lgkmcnt(0)
    v_mfma_f32_32x32x16_bf16 v[16:31], v[156:159], a[108:111], v[16:31]
    v_lshlrev_b32 v32, 16, v8
    v_and_b32 v33, 0xffff0000, v8
    v_lshlrev_b32 v34, 16, v9
    v_and_b32 v35, 0xffff0000, v9
    v_lshlrev_b32 v36, 16, v10
    v_and_b32 v37, 0xffff0000, v10
    v_lshlrev_b32 v38, 16, v11
    v_and_b32 v39, 0xffff0000, v11
    v_lshlrev_b32 v40, 16, v12
    v_and_b32 v41, 0xffff0000, v12
    v_lshlrev_b32 v42, 16, v13
    v_and_b32 v43, 0xffff0000, v13
    v_lshlrev_b32 v44, 16, v14
    v_and_b32 v45, 0xffff0000, v14
    v_lshlrev_b32 v46, 16, v15
    v_and_b32 v47, 0xffff0000, v15
    v_and_b32 v5, 31, v1
    v_lshlrev_b32 v6, 2, v3
    v_sub_u32 v5, v5, v6
    v_mov_b32 v6, 0xff800000
    v_cmp_le_i32 vcc, 0, v5
    s_nop 1
    v_cndmask_b32 v32, v6, v32, vcc
    v_cmp_le_i32 vcc, 1, v5
    s_nop 1
    v_cndmask_b32 v33, v6, v33, vcc
    v_cmp_le_i32 vcc, 2, v5
    s_nop 1
    v_cndmask_b32 v34, v6, v34, vcc
    v_cmp_le_i32 vcc, 3, v5
    s_nop 1
    v_cndmask_b32 v35, v6, v35, vcc
    v_cmp_le_i32 vcc, 8, v5
    s_nop 1
    v_cndmask_b32 v36, v6, v36, vcc
    v_cmp_le_i32 vcc, 9, v5
    s_nop 1
    v_cndmask_b32 v37, v6, v37, vcc
    v_cmp_le_i32 vcc, 10, v5
    s_nop 1
    v_cndmask_b32 v38, v6, v38, vcc
    v_cmp_le_i32 vcc, 11, v5
    s_nop 1
    v_cndmask_b32 v39, v6, v39, vcc
    v_cmp_le_i32 vcc, 16, v5
    s_nop 1
    v_cndmask_b32 v40, v6, v40, vcc
    v_cmp_le_i32 vcc, 17, v5
    s_nop 1
    v_cndmask_b32 v41, v6, v41, vcc
    v_cmp_le_i32 vcc, 18, v5
    s_nop 1
    v_cndmask_b32 v42, v6, v42, vcc
    v_cmp_le_i32 vcc, 19, v5
    s_nop 1
    v_cndmask_b32 v43, v6, v43, vcc
    v_cmp_le_i32 vcc, 24, v5
    s_nop 1
    v_cndmask_b32 v44, v6, v44, vcc
    v_cmp_le_i32 vcc, 25, v5
    s_nop 1
    v_cndmask_b32 v45, v6, v45, vcc
    v_cmp_le_i32 vcc, 26, v5
    s_nop 1
    v_cndmask_b32 v46, v6, v46, vcc
    v_cmp_le_i32 vcc, 27, v5
    s_nop 1
    v_cndmask_b32 v47, v6, v47, vcc
    s_nop 7
    v_cvt_pk_bf16_f32 v7, v16, v17
    v_lshlrev_b32 v16, 16, v7
    v_and_b32 v17, 0xffff0000, v7
    v_cvt_pk_bf16_f32 v7, v18, v19
    v_lshlrev_b32 v18, 16, v7
    v_and_b32 v19, 0xffff0000, v7
    v_max3_f32 v7, v16, v17, v18
    v_max3_f32 v7, v7, v19, v32
    v_max3_f32 v7, v7, v33, v34
    v_max3_f32 v7, v7, v35, v36
    v_max3_f32 v7, v7, v37, v38
    v_max3_f32 v7, v7, v39, v40
    v_max3_f32 v7, v7, v41, v42
    v_max3_f32 v7, v7, v43, v44
    v_max3_f32 v7, v7, v45, v46
    v_max_f32 v7, v7, v47
    v_mov_b32 v8, v7
    s_nop 1
    v_permlane32_swap_b32 v7, v8
    s_nop 0
    v_max_f32 v7, v7, v8
    s_mov_b32 s18, 0x3db8aa3b
    v_mul_f32 v7, s18, v7
    v_fma_f32 v16, v16, s18, -v7
    v_fma_f32 v17, v17, s18, -v7
    v_fma_f32 v18, v18, s18, -v7
    v_fma_f32 v19, v19, s18, -v7
    v_fma_f32 v32, v32, s18, -v7
    v_fma_f32 v33, v33, s18, -v7
    v_fma_f32 v34, v34, s18, -v7
    v_fma_f32 v35, v35, s18, -v7
    v_fma_f32 v36, v36, s18, -v7
    v_fma_f32 v37, v37, s18, -v7
    v_fma_f32 v38, v38, s18, -v7
    v_fma_f32 v39, v39, s18, -v7
    v_fma_f32 v40, v40, s18, -v7
    v_fma_f32 v41, v41, s18, -v7
    v_fma_f32 v42, v42, s18, -v7
    v_fma_f32 v43, v43, s18, -v7
    v_fma_f32 v44, v44, s18, -v7
    v_fma_f32 v45, v45, s18, -v7
    v_fma_f32 v46, v46, s18, -v7
    v_fma_f32 v47, v47, s18, -v7
    v_exp_f32 v16, v16
    v_exp_f32 v17, v17
    v_exp_f32 v18, v18
    v_exp_f32 v19, v19
    v_exp_f32 v32, v32
    v_exp_f32 v33, v33
    v_exp_f32 v34, v34
    v_exp_f32 v35, v35
    v_exp_f32 v36, v36
    v_exp_f32 v37, v37
    v_exp_f32 v38, v38
    v_exp_f32 v39, v39
    v_exp_f32 v40, v40
    v_exp_f32 v41, v41
    v_exp_f32 v42, v42
    v_exp_f32 v43, v43
    v_exp_f32 v44, v44
    v_exp_f32 v45, v45
    v_exp_f32 v46, v46
    v_exp_f32 v47, v47
    s_nop 0
    v_add_f32 v8, v16, v17
    v_add_f32 v8, v8, v18
    v_add_f32 v8, v8, v19
    v_add_f32 v8, v8, v32
    v_add_f32 v8, v8, v33
    v_add_f32 v8, v8, v34
    v_add_f32 v8, v8, v35
    v_add_f32 v8, v8, v36
    v_add_f32 v8, v8, v37
    v_add_f32 v8, v8, v38
    v_add_f32 v8, v8, v39
    v_add_f32 v8, v8, v40
    v_add_f32 v8, v8, v41
    v_add_f32 v8, v8, v42
    v_add_f32 v8, v8, v43
    v_add_f32 v8, v8, v44
    v_add_f32 v8, v8, v45
    v_add_f32 v8, v8, v46
    v_add_f32 v8, v8, v47
    v_mov_b32 v9, v8
    s_nop 1
    v_permlane32_swap_b32 v8, v9
    s_nop 0
    v_add_f32 v8, v8, v9
    v_rcp_f32 v8, v8
    s_nop 0
    v_mul_f32 v16, v16, v8
    v_mul_f32 v17, v17, v8
    v_mul_f32 v18, v18, v8
    v_mul_f32 v19, v19, v8
    v_mul_f32 v32, v32, v8
    v_mul_f32 v33, v33, v8
    v_mul_f32 v34, v34, v8
    v_mul_f32 v35, v35, v8
    v_mul_f32 v36, v36, v8
    v_mul_f32 v37, v37, v8
    v_mul_f32 v38, v38, v8
    v_mul_f32 v39, v39, v8
    v_mul_f32 v40, v40, v8
    v_mul_f32 v41, v41, v8
    v_mul_f32 v42, v42, v8
    v_mul_f32 v43, v43, v8
    v_mul_f32 v44, v44, v8
    v_mul_f32 v45, v45, v8
    v_mul_f32 v46, v46, v8
    v_mul_f32 v47, v47, v8
    v_cvt_pk_bf16_f32 v8, v32, v33
    v_cvt_pk_bf16_f32 v9, v34, v35
    v_cvt_pk_bf16_f32 v10, v36, v37
    v_cvt_pk_bf16_f32 v11, v38, v39
    v_cvt_pk_bf16_f32 v12, v40, v41
    v_cvt_pk_bf16_f32 v13, v42, v43
    v_cvt_pk_bf16_f32 v14, v44, v45
    v_cvt_pk_bf16_f32 v15, v46, v47
    v_cvt_pk_bf16_f32 v20, v16, v17
    v_cvt_pk_bf16_f32 v21, v18, v19
    s_mul_i32 s17, s24, 40960
    s_add_u32 s17, s17, 84430848
    s_lshl_b32 s18, s25, 11
    s_add_u32 s18, s18, s17
    buffer_store_dwordx4 v[8:11], v2, s[4:7], s18 offen sc1
    buffer_store_dwordx4 v[12:15], v2, s[4:7], s18 offen offset:1024 sc1
    s_lshr_b32 s18, s25, 1
    s_lshl_b32 s18, s18, 10
    s_and_b32 s19, s25, 1
    s_lshl_b32 s19, s19, 3
    s_add_u32 s18, s18, s19
    s_add_u32 s18, s18, s17
    s_add_u32 s18, s18, 32768
    buffer_store_dwordx2 v[20:21], v2, s[4:7], s18 offen sc1
    s_lshl_b32 s93, s24, 2
    s_add_u32 s93, s93, 90974208
    s_waitcnt vmcnt(0)
    v_mov_b32 v250, 0
    v_mov_b32 v251, 1
    s_mov_b64 exec, 1
    buffer_atomic_add v251, v250, s[4:7], s93 offen
    s_mov_b64 exec, -1
sig_86:
    s_add_u32 s24, s24, 32
    s_cmp_lt_u32 s24, 64
    s_cbranch_scc1 L_e_loop
    s_branch L_moe
L_not_e:
    s_cmp_ge_u32 s84, 216
    s_cbranch_scc1 L_moe
    s_sub_u32 s3, s84, 128
    s_lshl_b32 s76, s87, 3
    s_mov_b32 s77, 8
    s_cmp_lt_u32 s3, 56
    s_cbranch_scc1 ofull_87
    s_sub_u32 s77, s3, 56
    s_and_b32 s76, s77, 3
    s_lshl_b32 s76, s76, 3
    s_lshl_b32 s3, s87, 1
    s_add_u32 s76, s76, s3
    s_lshr_b32 s3, s77, 2
    s_add_u32 s3, s3, 56
    s_mov_b32 s77, 2
ofull_87:
    s_lshr_b32 s93, s3, 2
    s_lshl_b32 s93, s93, 6
    s_add_u32 s93, s93, 90972160
    s_cmp_lg_u32 s87, 0
    s_cbranch_scc1 wsk_90
    s_mov_b32 s90, 0
    v_mov_b32 v250, 0
wge_88:
    buffer_load_dword v251, v250, s[4:7], s93 offen sc1
    s_waitcnt vmcnt(0)
    v_readfirstlane_b32 s92, v251
    s_nop 3
    s_cmp_ge_u32 s92, 64
    s_cbranch_scc1 wok_89
    s_sleep 32
    s_add_u32 s90, s90, 1
    s_cmp_lt_u32 s90, 400000
    s_cbranch_scc1 wge_88
    s_branch L_abort
wok_89:
wsk_90:
    s_barrier
    s_mov_b32 s91, 90977408
    s_cmp_lg_u32 s87, 0
    s_cbranch_scc1 wsk_93
    s_mov_b32 s90, 0
    v_mov_b32 v250, 0
wge_91:
    buffer_load_dword v251, v250, s[4:7], s91 offen sc1
    s_waitcnt vmcnt(0)
    v_readfirstlane_b32 s92, v251
    s_nop 3
    s_cmp_ge_u32 s92, 28
    s_cbranch_scc1 wok_92
    s_sleep 32
    s_add_u32 s90, s90, 1
    s_cmp_lt_u32 s90, 400000
    s_cbranch_scc1 wge_91
    s_branch L_abort
wok_92:
wsk_93:
    s_barrier
    v_and_b32 v1, 63, v0
    v_lshrrev_b32 v2, 6, v0
    s_nop 0
    v_readfirstlane_b32 s26, v2
    v_lshlrev_b32 v2, 4, v1
    s_load_dwordx2 s[8:9], s[0:1], 0
    s_waitcnt lgkmcnt(0)
    s_and_b32 s9, s9, 0xffff
    s_mov_b32 s10, 1835008
    s_mov_b32 s11, 0x20000
    s_load_dwordx2 s[12:13], s[0:1], 112
    s_waitcnt lgkmcnt(0)
    s_and_b32 s13, s13, 0xffff
    s_mov_b32 s14, 1835008
    s_mov_b32 s15, 0x20000
    s_load_dwordx2 s[28:29], s[0:1], 64
    s_waitcnt lgkmcnt(0)
    s_and_b32 s29, s29, 0xffff
    s_mov_b32 s30, 896
    s_mov_b32 s31, 0x20000
    s_barrier
    s_mul_i32 s16, s3, 28672
    s_mul_i32 s17, s26, 7168
    s_add_u32 s16, s16, s17
    s_add_u32 m0, s17, 99328
    s_add_u32 s18, s16, 0
    buffer_load_dwordx4 v2, s[8:11], s18 offen lds
    s_add_u32 m0, s17, 100352
    s_add_u32 s18, s16, 1024
    buffer_load_dwordx4 v2, s[8:11], s18 offen lds
    s_add_u32 m0, s17, 101376
    s_add_u32 s18, s16, 2048
    buffer_load_dwordx4 v2, s[8:11], s18 offen lds
    s_add_u32 m0, s17, 102400
    s_add_u32 s18, s16, 3072
    buffer_load_dwordx4 v2, s[8:11], s18 offen lds
    s_add_u32 m0, s17, 103424
    s_add_u32 s18, s16, 4096
    buffer_load_dwordx4 v2, s[8:11], s18 offen lds
    s_add_u32 m0, s17, 104448
    s_add_u32 s18, s16, 5120
    buffer_load_dwordx4 v2, s[8:11], s18 offen lds
    s_add_u32 m0, s17, 105472
    s_add_u32 s18, s16, 6144
    buffer_load_dwordx4 v2, s[8:11], s18 offen lds
    s_lshl_b32 s17, s26, 11
    s_add_u32 m0, s17, 128000
    s_add_u32 s18, s17, 87055872
    buffer_load_dwordx4 v2, s[4:7], s18 offen sc1 lds
    s_add_u32 m0, s17, 129024
    s_cmp_eq_u32 s26, 3
    s_cbranch_scc1 opw_94
    s_add_u32 s18, s17, 87056896
    buffer_load_dwordx4 v2, s[4:7], s18 offen sc1 lds
    s_branch opx_95
opw_94:
    buffer_load_dwordx4 v2, s[28:31], 0 offen lds
opx_95:
    v_bfe_u32 v3, v1, 4, 1
    v_lshrrev_b32 v4, 5, v1
    v_and_b32 v5, 15, v1
    v_lshlrev_b32 v6, 10, v3
    v_lshl_add_u32 v6, v4, 8, v6
    v_lshl_add_u32 v6, v5, 4, v6
    s_mul_i32 s20, s3, 458752
    s_add_u32 s20, s20, 14684160
    s_mul_i32 s21, s3, 114688
    s_add_u32 s21, s21, 45166592
    s_add_u32 s25, s26, 0
    s_lshl_b32 s23, s25, 11
    s_add_u32 s23, s23, s20
    s_lshl_b32 s24, s25, 13
    s_add_u32 s24, s24, s21
    s_add_u32 s18, s23, 0
    buffer_load_dwordx4 a[0:3], v6, s[4:7], s18 offen offset:0 sc1
    s_add_u32 s18, s23, 0
    buffer_load_dwordx4 a[4:7], v6, s[4:7], s18 offen offset:512 sc1
    s_add_u32 s18, s23, 28672
    buffer_load_dwordx4 a[8:11], v6, s[4:7], s18 offen offset:0 sc1
    s_add_u32 s18, s23, 28672
    buffer_load_dwordx4 a[12:15], v6, s[4:7], s18 offen offset:512 sc1
    s_add_u32 s18, s23, 57344
    buffer_load_dwordx4 a[16:19], v6, s[4:7], s18 offen offset:0 sc1
    s_add_u32 s18, s23, 57344
    buffer_load_dwordx4 a[20:23], v6, s[4:7], s18 offen offset:512 sc1
    s_add_u32 s18, s23, 86016
    buffer_load_dwordx4 a[24:27], v6, s[4:7], s18 offen offset:0 sc1
    s_add_u32 s18, s23, 86016
    buffer_load_dwordx4 a[28:31], v6, s[4:7], s18 offen offset:512 sc1
    s_add_u32 s18, s23, 114688
    buffer_load_dwordx4 a[32:35], v6, s[4:7], s18 offen offset:0 sc1
    s_add_u32 s18, s23, 114688
    buffer_load_dwordx4 a[36:39], v6, s[4:7], s18 offen offset:512 sc1
    s_add_u32 s18, s23, 143360
    buffer_load_dwordx4 a[40:43], v6, s[4:7], s18 offen offset:0 sc1
    s_add_u32 s18, s23, 143360
    buffer_load_dwordx4 a[44:47], v6, s[4:7], s18 offen offset:512 sc1
    s_add_u32 s18, s23, 172032
    buffer_load_dwordx4 a[48:51], v6, s[4:7], s18 offen offset:0 sc1
    s_add_u32 s18, s23, 172032
    buffer_load_dwordx4 a[52:55], v6, s[4:7], s18 offen offset:512 sc1
    s_add_u32 s18, s23, 200704
    buffer_load_dwordx4 a[56:59], v6, s[4:7], s18 offen offset:0 sc1
    s_add_u32 s18, s23, 200704
    buffer_load_dwordx4 a[60:63], v6, s[4:7], s18 offen offset:512 sc1
    s_add_u32 s18, s23, 229376
    buffer_load_dwordx4 a[64:67], v6, s[4:7], s18 offen offset:0 sc1
    s_add_u32 s18, s23, 229376
    buffer_load_dwordx4 a[68:71], v6, s[4:7], s18 offen offset:512 sc1
    s_add_u32 s18, s23, 258048
    buffer_load_dwordx4 a[72:75], v6, s[4:7], s18 offen offset:0 sc1
    s_add_u32 s18, s23, 258048
    buffer_load_dwordx4 a[76:79], v6, s[4:7], s18 offen offset:512 sc1
    s_add_u32 s18, s23, 286720
    buffer_load_dwordx4 a[80:83], v6, s[4:7], s18 offen offset:0 sc1
    s_add_u32 s18, s23, 286720
    buffer_load_dwordx4 a[84:87], v6, s[4:7], s18 offen offset:512 sc1
    s_add_u32 s18, s23, 315392
    buffer_load_dwordx4 a[88:91], v6, s[4:7], s18 offen offset:0 sc1
    s_add_u32 s18, s23, 315392
    buffer_load_dwordx4 a[92:95], v6, s[4:7], s18 offen offset:512 sc1
    s_add_u32 s18, s23, 344064
    buffer_load_dwordx4 a[96:99], v6, s[4:7], s18 offen offset:0 sc1
    s_add_u32 s18, s23, 344064
    buffer_load_dwordx4 a[100:103], v6, s[4:7], s18 offen offset:512 sc1
    s_add_u32 s18, s23, 372736
    buffer_load_dwordx4 a[104:107], v6, s[4:7], s18 offen offset:0 sc1
    s_add_u32 s18, s23, 372736
    buffer_load_dwordx4 a[108:111], v6, s[4:7], s18 offen offset:512 sc1
    s_add_u32 s18, s23, 401408
    buffer_load_dwordx4 a[112:115], v6, s[4:7], s18 offen offset:0 sc1
    s_add_u32 s18, s23, 401408
    buffer_load_dwordx4 a[116:119], v6, s[4:7], s18 offen offset:512 sc1
    s_add_u32 s18, s23, 430080
    buffer_load_dwordx4 a[120:123], v6, s[4:7], s18 offen offset:0 sc1
    s_add_u32 s18, s23, 430080
    buffer_load_dwordx4 a[124:127], v6, s[4:7], s18 offen offset:512 sc1
    s_waitcnt vmcnt(24)
    s_add_u32 s25, s26, 4
    s_lshl_b32 s23, s25, 11
    s_add_u32 s23, s23, s20
    s_lshl_b32 s24, s25, 13
    s_add_u32 s24, s24, s21
    s_add_u32 s18, s23, 0
    buffer_load_dwordx4 a[128:131], v6, s[4:7], s18 offen offset:0 sc1
    s_add_u32 s18, s23, 0
    buffer_load_dwordx4 a[132:135], v6, s[4:7], s18 offen offset:512 sc1
    s_add_u32 s18, s23, 28672
    buffer_load_dwordx4 a[136:139], v6, s[4:7], s18 offen offset:0 sc1
    s_add_u32 s18, s23, 28672
    buffer_load_dwordx4 a[140:143], v6, s[4:7], s18 offen offset:512 sc1
    s_add_u32 s18, s23, 57344
    buffer_load_dwordx4 a[144:147], v6, s[4:7], s18 offen offset:0 sc1
    s_add_u32 s18, s23, 57344
    buffer_load_dwordx4 a[148:151], v6, s[4:7], s18 offen offset:512 sc1
    s_add_u32 s18, s23, 86016
    buffer_load_dwordx4 a[152:155], v6, s[4:7], s18 offen offset:0 sc1
    s_add_u32 s18, s23, 86016
    buffer_load_dwordx4 a[156:159], v6, s[4:7], s18 offen offset:512 sc1
    s_add_u32 s18, s23, 114688
    buffer_load_dwordx4 a[160:163], v6, s[4:7], s18 offen offset:0 sc1
    s_add_u32 s18, s23, 114688
    buffer_load_dwordx4 a[164:167], v6, s[4:7], s18 offen offset:512 sc1
    s_add_u32 s18, s23, 143360
    buffer_load_dwordx4 a[168:171], v6, s[4:7], s18 offen offset:0 sc1
    s_add_u32 s18, s23, 143360
    buffer_load_dwordx4 a[172:175], v6, s[4:7], s18 offen offset:512 sc1
    s_add_u32 s18, s23, 172032
    buffer_load_dwordx4 a[176:179], v6, s[4:7], s18 offen offset:0 sc1
    s_add_u32 s18, s23, 172032
    buffer_load_dwordx4 a[180:183], v6, s[4:7], s18 offen offset:512 sc1
    s_add_u32 s18, s23, 200704
    buffer_load_dwordx4 a[184:187], v6, s[4:7], s18 offen offset:0 sc1
    s_add_u32 s18, s23, 200704
    buffer_load_dwordx4 a[188:191], v6, s[4:7], s18 offen offset:512 sc1
    s_add_u32 s18, s23, 229376
    buffer_load_dwordx4 a[192:195], v6, s[4:7], s18 offen offset:0 sc1
    s_add_u32 s18, s23, 229376
    buffer_load_dwordx4 a[196:199], v6, s[4:7], s18 offen offset:512 sc1
    s_add_u32 s18, s23, 258048
    buffer_load_dwordx4 a[200:203], v6, s[4:7], s18 offen offset:0 sc1
    s_add_u32 s18, s23, 258048
    buffer_load_dwordx4 a[204:207], v6, s[4:7], s18 offen offset:512 sc1
    s_add_u32 s18, s23, 286720
    buffer_load_dwordx4 a[208:211], v6, s[4:7], s18 offen offset:0 sc1
    s_add_u32 s18, s23, 286720
    buffer_load_dwordx4 a[212:215], v6, s[4:7], s18 offen offset:512 sc1
    s_add_u32 s18, s23, 315392
    buffer_load_dwordx4 a[216:219], v6, s[4:7], s18 offen offset:0 sc1
    s_add_u32 s18, s23, 315392
    buffer_load_dwordx4 a[220:223], v6, s[4:7], s18 offen offset:512 sc1
    s_add_u32 s18, s23, 344064
    buffer_load_dwordx4 a[224:227], v6, s[4:7], s18 offen offset:0 sc1
    s_add_u32 s18, s23, 344064
    buffer_load_dwordx4 a[228:231], v6, s[4:7], s18 offen offset:512 sc1
    s_add_u32 s18, s23, 372736
    buffer_load_dwordx4 a[232:235], v6, s[4:7], s18 offen offset:0 sc1
    s_add_u32 s18, s23, 372736
    buffer_load_dwordx4 a[236:239], v6, s[4:7], s18 offen offset:512 sc1
    s_add_u32 s18, s23, 401408
    buffer_load_dwordx4 a[240:243], v6, s[4:7], s18 offen offset:0 sc1
    s_add_u32 s18, s23, 401408
    buffer_load_dwordx4 a[244:247], v6, s[4:7], s18 offen offset:512 sc1
    s_add_u32 s18, s23, 430080
    buffer_load_dwordx4 a[248:251], v6, s[4:7], s18 offen offset:0 sc1
    s_add_u32 s18, s23, 430080
    buffer_load_dwordx4 a[252:255], v6, s[4:7], s18 offen offset:512 sc1
    s_waitcnt vmcnt(24)
    s_add_u32 s25, s26, 8
    s_lshl_b32 s23, s25, 11
    s_add_u32 s23, s23, s20
    s_lshl_b32 s24, s25, 13
    s_add_u32 s24, s24, s21
    s_add_u32 s18, s23, 0
    buffer_load_dwordx4 v[96:99], v6, s[4:7], s18 offen offset:0 sc1
    s_add_u32 s18, s23, 0
    buffer_load_dwordx4 v[100:103], v6, s[4:7], s18 offen offset:512 sc1
    s_add_u32 s18, s23, 28672
    buffer_load_dwordx4 v[104:107], v6, s[4:7], s18 offen offset:0 sc1
    s_add_u32 s18, s23, 28672
    buffer_load_dwordx4 v[108:111], v6, s[4:7], s18 offen offset:512 sc1
    s_add_u32 s18, s23, 57344
    buffer_load_dwordx4 v[112:115], v6, s[4:7], s18 offen offset:0 sc1
    s_add_u32 s18, s23, 57344
    buffer_load_dwordx4 v[116:119], v6, s[4:7], s18 offen offset:512 sc1
    s_add_u32 s18, s23, 86016
    buffer_load_dwordx4 v[120:123], v6, s[4:7], s18 offen offset:0 sc1
    s_add_u32 s18, s23, 86016
    buffer_load_dwordx4 v[124:127], v6, s[4:7], s18 offen offset:512 sc1
    s_add_u32 s18, s23, 114688
    buffer_load_dwordx4 v[128:131], v6, s[4:7], s18 offen offset:0 sc1
    s_add_u32 s18, s23, 114688
    buffer_load_dwordx4 v[132:135], v6, s[4:7], s18 offen offset:512 sc1
    s_add_u32 s18, s23, 143360
    buffer_load_dwordx4 v[136:139], v6, s[4:7], s18 offen offset:0 sc1
    s_add_u32 s18, s23, 143360
    buffer_load_dwordx4 v[140:143], v6, s[4:7], s18 offen offset:512 sc1
    s_add_u32 s18, s23, 172032
    buffer_load_dwordx4 v[144:147], v6, s[4:7], s18 offen offset:0 sc1
    s_add_u32 s18, s23, 172032
    buffer_load_dwordx4 v[148:151], v6, s[4:7], s18 offen offset:512 sc1
    s_add_u32 s18, s23, 200704
    buffer_load_dwordx4 v[152:155], v6, s[4:7], s18 offen offset:0 sc1
    s_add_u32 s18, s23, 200704
    buffer_load_dwordx4 v[156:159], v6, s[4:7], s18 offen offset:512 sc1
    s_add_u32 s18, s23, 229376
    buffer_load_dwordx4 v[160:163], v6, s[4:7], s18 offen offset:0 sc1
    s_add_u32 s18, s23, 229376
    buffer_load_dwordx4 v[164:167], v6, s[4:7], s18 offen offset:512 sc1
    s_add_u32 s18, s23, 258048
    buffer_load_dwordx4 v[168:171], v6, s[4:7], s18 offen offset:0 sc1
    s_add_u32 s18, s23, 258048
    buffer_load_dwordx4 v[172:175], v6, s[4:7], s18 offen offset:512 sc1
    s_add_u32 s18, s23, 286720
    buffer_load_dwordx4 v[176:179], v6, s[4:7], s18 offen offset:0 sc1
    s_add_u32 s18, s23, 286720
    buffer_load_dwordx4 v[180:183], v6, s[4:7], s18 offen offset:512 sc1
    s_add_u32 s18, s23, 315392
    buffer_load_dwordx4 v[184:187], v6, s[4:7], s18 offen offset:0 sc1
    s_add_u32 s18, s23, 315392
    buffer_load_dwordx4 v[188:191], v6, s[4:7], s18 offen offset:512 sc1
    s_add_u32 s18, s23, 344064
    buffer_load_dwordx4 v[192:195], v6, s[4:7], s18 offen offset:0 sc1
    s_add_u32 s18, s23, 344064
    buffer_load_dwordx4 v[196:199], v6, s[4:7], s18 offen offset:512 sc1
    s_add_u32 s18, s23, 372736
    buffer_load_dwordx4 v[200:203], v6, s[4:7], s18 offen offset:0 sc1
    s_add_u32 s18, s23, 372736
    buffer_load_dwordx4 v[204:207], v6, s[4:7], s18 offen offset:512 sc1
    s_add_u32 s18, s23, 401408
    buffer_load_dwordx4 v[208:211], v6, s[4:7], s18 offen offset:0 sc1
    s_add_u32 s18, s23, 401408
    buffer_load_dwordx4 v[212:215], v6, s[4:7], s18 offen offset:512 sc1
    s_add_u32 s18, s23, 430080
    buffer_load_dwordx4 v[216:219], v6, s[4:7], s18 offen offset:0 sc1
    s_add_u32 s18, s23, 430080
    buffer_load_dwordx4 v[220:223], v6, s[4:7], s18 offen offset:512 sc1
    s_waitcnt vmcnt(24)
    s_waitcnt vmcnt(0)
    s_lshl_b32 s93, s3, 2
    s_add_u32 s93, s93, 90974208
    s_cmp_lg_u32 s87, 0
    s_cbranch_scc1 wsk_98
    s_mov_b32 s90, 0
    v_mov_b32 v10, 0
wge_96:
    buffer_load_dword v11, v10, s[4:7], s93 offen sc1
    s_waitcnt vmcnt(0)
    v_readfirstlane_b32 s92, v11
    s_nop 3
    s_cmp_ge_u32 s92, 16
    s_cbranch_scc1 wok_97
    s_cmp_ge_u32 s92, 1
    s_cbranch_scc1 wnr_99
    s_sleep 16
wnr_99:
    s_sleep 1
    s_add_u32 s90, s90, 1
    s_cmp_lt_u32 s90, 400000
    s_cbranch_scc1 wge_96
    s_branch L_abort
wok_97:
wsk_98:
    s_barrier
    s_cmp_lg_u32 s87, 0
    s_cbranch_scc1 owsk_102
    v_min_u32 v10, 55, v1
    v_lshlrev_b32 v10, 2, v10
    s_lshl_b32 s93, s3, 8
    s_add_u32 s93, s93, 90980352
    s_mov_b32 s90, 0
owp_100:
    buffer_load_dword v11, v10, s[4:7], s93 offen sc1
    s_waitcnt vmcnt(0)
    v_cmp_eq_u32 vcc, 0, v11
    s_cbranch_vccz owok_101
    s_sleep 3
    s_add_u32 s90, s90, 1
    s_cmp_lt_u32 s90, 400000
    s_cbranch_scc1 owp_100
    s_branch L_abort
owok_101:
owsk_102:
    s_barrier
    s_mul_i32 s16, s3, 40960
    s_add_u32 s16, s16, 84430848
    s_mul_i32 s17, s26, 10240
    s_add_u32 s16, s16, s17
    s_add_u32 m0, s17, 0
    s_add_u32 s18, s16, 0
    buffer_load_dwordx4 v2, s[4:7], s18 offen sc1 lds
    s_add_u32 m0, s17, 1024
    s_add_u32 s18, s16, 1024
    buffer_load_dwordx4 v2, s[4:7], s18 offen sc1 lds
    s_add_u32 m0, s17, 2048
    s_add_u32 s18, s16, 2048
    buffer_load_dwordx4 v2, s[4:7], s18 offen sc1 lds
    s_add_u32 m0, s17, 3072
    s_add_u32 s18, s16, 3072
    buffer_load_dwordx4 v2, s[4:7], s18 offen sc1 lds
    s_add_u32 m0, s17, 4096
    s_add_u32 s18, s16, 4096
    buffer_load_dwordx4 v2, s[4:7], s18 offen sc1 lds
    s_add_u32 m0, s17, 5120
    s_add_u32 s18, s16, 5120
    buffer_load_dwordx4 v2, s[4:7], s18 offen sc1 lds
    s_add_u32 m0, s17, 6144
    s_add_u32 s18, s16, 6144
    buffer_load_dwordx4 v2, s[4:7], s18 offen sc1 lds
    s_add_u32 m0, s17, 7168
    s_add_u32 s18, s16, 7168
    buffer_load_dwordx4 v2, s[4:7], s18 offen sc1 lds
    s_add_u32 m0, s17, 8192
    s_add_u32 s18, s16, 8192
    buffer_load_dwordx4 v2, s[4:7], s18 offen sc1 lds
    s_add_u32 m0, s17, 9216
    s_add_u32 s18, s16, 9216
    buffer_load_dwordx4 v2, s[4:7], s18 offen sc1 lds
    s_add_u32 s25, s26, 0
    s_lshl_b32 s23, s25, 11
    s_add_u32 s23, s23, s20
    s_lshl_b32 s24, s25, 13
    s_add_u32 s24, s24, s21
    s_add_u32 s18, s24, 0
    buffer_load_dwordx4 v[32:35], v6, s[4:7], s18 offen offset:0 sc1
    s_add_u32 s18, s24, 0
    buffer_load_dwordx4 v[36:39], v6, s[4:7], s18 offen offset:512 sc1
    s_add_u32 s18, s24, 2048
    buffer_load_dwordx4 v[40:43], v6, s[4:7], s18 offen offset:0 sc1
    s_add_u32 s18, s24, 2048
    buffer_load_dwordx4 v[44:47], v6, s[4:7], s18 offen offset:512 sc1
    s_add_u32 s18, s24, 4096
    buffer_load_dwordx4 v[48:51], v6, s[4:7], s18 offen offset:0 sc1
    s_add_u32 s18, s24, 4096
    buffer_load_dwordx4 v[52:55], v6, s[4:7], s18 offen offset:512 sc1
    s_add_u32 s18, s24, 6144
    buffer_load_dwordx4 v[56:59], v6, s[4:7], s18 offen offset:0 sc1
    s_add_u32 s18, s24, 6144
    buffer_load_dwordx4 v[60:63], v6, s[4:7], s18 offen offset:512 sc1
    s_add_u32 s25, s26, 4
    s_lshl_b32 s23, s25, 11
    s_add_u32 s23, s23, s20
    s_lshl_b32 s24, s25, 13
    s_add_u32 s24, s24, s21
    s_add_u32 s18, s24, 0
    buffer_load_dwordx4 v[64:67], v6, s[4:7], s18 offen offset:0 sc1
    s_add_u32 s18, s24, 0
    buffer_load_dwordx4 v[68:71], v6, s[4:7], s18 offen offset:512 sc1
    s_add_u32 s18, s24, 2048
    buffer_load_dwordx4 v[72:75], v6, s[4:7], s18 offen offset:0 sc1
    s_add_u32 s18, s24, 2048
    buffer_load_dwordx4 v[76:79], v6, s[4:7], s18 offen offset:512 sc1
    s_add_u32 s18, s24, 4096
    buffer_load_dwordx4 v[80:83], v6, s[4:7], s18 offen offset:0 sc1
    s_add_u32 s18, s24, 4096
    buffer_load_dwordx4 v[84:87], v6, s[4:7], s18 offen offset:512 sc1
    s_add_u32 s18, s24, 6144
    buffer_load_dwordx4 v[88:91], v6, s[4:7], s18 offen offset:0 sc1
    s_add_u32 s18, s24, 6144
    buffer_load_dwordx4 v[92:95], v6, s[4:7], s18 offen offset:512 sc1
    v_and_b32 v7, 31, v1
    v_lshlrev_b32 v7, 2, v7
    v_mul_u32_u24 v8, 7232, v4
    v_add_u32 v7, v7, v8
    s_lshl_b32 s18, s26, 7
    s_add_u32 s18, s18, 40960
    v_add_u32 v7, s18, v7
    s_waitcnt vmcnt(16)
    s_barrier
    s_cmp_ge_u32 s26, 2
    s_cbranch_scc1 o3_103
    ds_read_b128 v[224:227], v2 offset:0
    ds_read_b128 v[228:231], v2 offset:1024
    ds_read_b128 v[232:235], v2 offset:2048
    ds_read_b128 v[236:239], v2 offset:3072
    s_waitcnt lgkmcnt(3)
    v_mfma_f32_32x32x16_bf16 v[16:31], v[224:227], a[0:3], 0
    ds_read_b128 v[224:227], v2 offset:4096
    s_waitcnt lgkmcnt(3)
    v_mfma_f32_32x32x16_bf16 v[16:31], v[228:231], a[4:7], v[16:31]
    ds_read_b128 v[228:231], v2 offset:5120
    s_waitcnt lgkmcnt(3)
    v_mfma_f32_32x32x16_bf16 v[16:31], v[232:235], a[8:11], v[16:31]
    ds_read_b128 v[232:235], v2 offset:6144
    s_waitcnt lgkmcnt(3)
    v_mfma_f32_32x32x16_bf16 v[16:31], v[236:239], a[12:15], v[16:31]
    ds_read_b128 v[236:239], v2 offset:7168
    s_waitcnt lgkmcnt(3)
    v_mfma_f32_32x32x16_bf16 v[16:31], v[224:227], a[16:19], v[16:31]
    ds_read_b128 v[224:227], v2 offset:8192
    s_waitcnt lgkmcnt(3)
    v_mfma_f32_32x32x16_bf16 v[16:31], v[228:231], a[20:23], v[16:31]
    ds_read_b128 v[228:231], v2 offset:9216
    s_waitcnt lgkmcnt(3)
    v_mfma_f32_32x32x16_bf16 v[16:31], v[232:235], a[24:27], v[16:31]
    ds_read_b128 v[232:235], v2 offset:10240
    s_waitcnt lgkmcnt(3)
    v_mfma_f32_32x32x16_bf16 v[16:31], v[236:239], a[28:31], v[16:31]
    ds_read_b128 v[236:239], v2 offset:11264
    s_waitcnt lgkmcnt(3)
    v_mfma_f32_32x32x16_bf16 v[16:31], v[224:227], a[32:35], v[16:31]
    ds_read_b128 v[224:227], v2 offset:12288
    s_waitcnt lgkmcnt(3)
    v_mfma_f32_32x32x16_bf16 v[16:31], v[228:231], a[36:39], v[16:31]
    ds_read_b128 v[228:231], v2 offset:13312
    s_waitcnt lgkmcnt(3)
    v_mfma_f32_32x32x16_bf16 v[16:31], v[232:235], a[40:43], v[16:31]
    ds_read_b128 v[232:235], v2 offset:14336
    s_waitcnt lgkmcnt(3)
    v_mfma_f32_32x32x16_bf16 v[16:31], v[236:239], a[44:47], v[16:31]
    ds_read_b128 v[236:239], v2 offset:15360
    s_waitcnt lgkmcnt(3)
    v_mfma_f32_32x32x16_bf16 v[16:31], v[224:227], a[48:51], v[16:31]
    ds_read_b128 v[224:227], v2 offset:16384
    s_waitcnt lgkmcnt(3)
    v_mfma_f32_32x32x16_bf16 v[16:31], v[228:231], a[52:55], v[16:31]
    ds_read_b128 v[228:231], v2 offset:17408
    s_waitcnt lgkmcnt(3)
    v_mfma_f32_32x32x16_bf16 v[16:31], v[232:235], a[56:59], v[16:31]
    ds_read_b128 v[232:235], v2 offset:18432
    s_waitcnt lgkmcnt(3)
    v_mfma_f32_32x32x16_bf16 v[16:31], v[236:239], a[60:63], v[16:31]
    ds_read_b128 v[236:239], v2 offset:19456
    s_waitcnt lgkmcnt(3)
    v_mfma_f32_32x32x16_bf16 v[16:31], v[224:227], a[64:67], v[16:31]
    ds_read_b128 v[224:227], v2 offset:20480
    s_waitcnt lgkmcnt(3)
    v_mfma_f32_32x32x16_bf16 v[16:31], v[228:231], a[68:71], v[16:31]
    ds_read_b128 v[228:231], v2 offset:21504
    s_waitcnt lgkmcnt(3)
    v_mfma_f32_32x32x16_bf16 v[16:31], v[232:235], a[72:75], v[16:31]
    ds_read_b128 v[232:235], v2 offset:22528
    s_waitcnt lgkmcnt(3)
    v_mfma_f32_32x32x16_bf16 v[16:31], v[236:239], a[76:79], v[16:31]
    ds_read_b128 v[236:239], v2 offset:23552
    s_waitcnt lgkmcnt(3)
    v_mfma_f32_32x32x16_bf16 v[16:31], v[224:227], a[80:83], v[16:31]
    ds_read_b128 v[224:227], v2 offset:24576
    s_waitcnt lgkmcnt(3)
    v_mfma_f32_32x32x16_bf16 v[16:31], v[228:231], a[84:87], v[16:31]
    ds_read_b128 v[228:231], v2 offset:25600
    s_waitcnt lgkmcnt(3)
    v_mfma_f32_32x32x16_bf16 v[16:31], v[232:235], a[88:91], v[16:31]
    ds_read_b128 v[232:235], v2 offset:26624
    s_waitcnt lgkmcnt(3)
    v_mfma_f32_32x32x16_bf16 v[16:31], v[236:239], a[92:95], v[16:31]
    ds_read_b128 v[236:239], v2 offset:27648
    s_waitcnt lgkmcnt(3)
    v_mfma_f32_32x32x16_bf16 v[16:31], v[224:227], a[96:99], v[16:31]
    ds_read_b128 v[224:227], v2 offset:28672
    s_waitcnt lgkmcnt(3)
    v_mfma_f32_32x32x16_bf16 v[16:31], v[228:231], a[100:103], v[16:31]
    ds_read_b128 v[228:231], v2 offset:29696
    s_waitcnt lgkmcnt(3)
    v_mfma_f32_32x32x16_bf16 v[16:31], v[232:235], a[104:107], v[16:31]
    ds_read_b128 v[232:235], v2 offset:30720
    s_waitcnt lgkmcnt(3)
    v_mfma_f32_32x32x16_bf16 v[16:31], v[236:239], a[108:111], v[16:31]
    ds_read_b128 v[236:239], v2 offset:31744
    s_waitcnt lgkmcnt(3)
    v_mfma_f32_32x32x16_bf16 v[16:31], v[224:227], a[112:115], v[16:31]
    ds_read_b128 v[224:227], v2 offset:32768
    s_waitcnt lgkmcnt(3)
    v_mfma_f32_32x32x16_bf16 v[16:31], v[228:231], a[116:119], v[16:31]
    ds_read_b128 v[228:231], v2 offset:33792
    s_waitcnt lgkmcnt(3)
    v_mfma_f32_32x32x16_bf16 v[16:31], v[232:235], a[120:123], v[16:31]
    ds_read_b128 v[232:235], v2 offset:34816
    s_waitcnt lgkmcnt(3)
    v_mfma_f32_32x32x16_bf16 v[16:31], v[236:239], a[124:127], v[16:31]
    ds_read_b128 v[236:239], v2 offset:35840
    s_waitcnt vmcnt(8)
    s_waitcnt lgkmcnt(3)
    v_mfma_f32_32x32x16_bf16 v[16:31], v[224:227], v[32:35], v[16:31]
    ds_read_b128 v[224:227], v2 offset:36864
    s_waitcnt lgkmcnt(3)
    v_mfma_f32_32x32x16_bf16 v[16:31], v[228:231], v[36:39], v[16:31]
    ds_read_b128 v[228:231], v2 offset:37888
    s_waitcnt lgkmcnt(3)
    v_mfma_f32_32x32x16_bf16 v[16:31], v[232:235], v[40:43], v[16:31]
    ds_read_b128 v[232:235], v2 offset:38912
    s_waitcnt lgkmcnt(3)
    v_mfma_f32_32x32x16_bf16 v[16:31], v[236:239], v[44:47], v[16:31]
    ds_read_b128 v[236:239], v2 offset:39936
    s_waitcnt lgkmcnt(3)
    v_mfma_f32_32x32x16_bf16 v[16:31], v[224:227], v[48:51], v[16:31]
    ds_read_b128 v[224:227], v2 offset:0
    s_waitcnt lgkmcnt(3)
    v_mfma_f32_32x32x16_bf16 v[16:31], v[228:231], v[52:55], v[16:31]
    ds_read_b128 v[228:231], v2 offset:1024
    s_waitcnt lgkmcnt(3)
    v_mfma_f32_32x32x16_bf16 v[16:31], v[232:235], v[56:59], v[16:31]
    ds_read_b128 v[232:235], v2 offset:2048
    s_waitcnt lgkmcnt(3)
    v_mfma_f32_32x32x16_bf16 v[16:31], v[236:239], v[60:63], v[16:31]
    ds_read_b128 v[236:239], v2 offset:3072
    s_waitcnt lgkmcnt(3)
    v_mfma_f32_32x32x16_bf16 v[240:255], v[224:227], a[128:131], 0
    s_add_u32 s25, s26, 12
    s_lshl_b32 s23, s25, 11
    s_add_u32 s23, s23, s20
    s_lshl_b32 s24, s25, 13
    s_add_u32 s24, s24, s21
    ds_read_b128 v[224:227], v2 offset:4096
    s_waitcnt lgkmcnt(3)
    v_mfma_f32_32x32x16_bf16 v[240:255], v[228:231], a[132:135], v[240:255]
    s_add_u32 s18, s23, 0
    buffer_load_dwordx4 a[0:3], v6, s[4:7], s18 offen offset:0 sc1
    ds_read_b128 v[228:231], v2 offset:5120
    s_waitcnt lgkmcnt(3)
    v_mfma_f32_32x32x16_bf16 v[240:255], v[232:235], a[136:139], v[240:255]
    s_add_u32 s18, s23, 0
    buffer_load_dwordx4 a[4:7], v6, s[4:7], s18 offen offset:512 sc1
    ds_read_b128 v[232:235], v2 offset:6144
    s_waitcnt lgkmcnt(3)
    v_mfma_f32_32x32x16_bf16 v[240:255], v[236:239], a[140:143], v[240:255]
    s_add_u32 s18, s23, 28672
    buffer_load_dwordx4 a[8:11], v6, s[4:7], s18 offen offset:0 sc1
    ds_read_b128 v[236:239], v2 offset:7168
    s_waitcnt lgkmcnt(3)
    v_mfma_f32_32x32x16_bf16 v[240:255], v[224:227], a[144:147], v[240:255]
    v_cvt_pk_bf16_f32 v9, v16, v17
    v_lshlrev_b32 v16, 16, v9
    v_and_b32 v17, 0xffff0000, v9
    s_add_u32 s18, s23, 28672
    buffer_load_dwordx4 a[12:15], v6, s[4:7], s18 offen offset:512 sc1
    ds_read_b128 v[224:227], v2 offset:8192
    s_waitcnt lgkmcnt(3)
    v_mfma_f32_32x32x16_bf16 v[240:255], v[228:231], a[148:151], v[240:255]
    v_cvt_pk_bf16_f32 v9, v18, v19
    v_lshlrev_b32 v18, 16, v9
    v_and_b32 v19, 0xffff0000, v9
    s_add_u32 s18, s23, 57344
    buffer_load_dwordx4 a[16:19], v6, s[4:7], s18 offen offset:0 sc1
    ds_read_b128 v[228:231], v2 offset:9216
    s_waitcnt lgkmcnt(3)
    v_mfma_f32_32x32x16_bf16 v[240:255], v[232:235], a[152:155], v[240:255]
    v_cvt_pk_bf16_f32 v9, v20, v21
    v_lshlrev_b32 v20, 16, v9
    v_and_b32 v21, 0xffff0000, v9
    s_add_u32 s18, s23, 57344
    buffer_load_dwordx4 a[20:23], v6, s[4:7], s18 offen offset:512 sc1
    ds_read_b128 v[232:235], v2 offset:10240
    s_waitcnt lgkmcnt(3)
    v_mfma_f32_32x32x16_bf16 v[240:255], v[236:239], a[156:159], v[240:255]
    v_cvt_pk_bf16_f32 v9, v22, v23
    v_lshlrev_b32 v22, 16, v9
    v_and_b32 v23, 0xffff0000, v9
    s_add_u32 s18, s23, 86016
    buffer_load_dwordx4 a[24:27], v6, s[4:7], s18 offen offset:0 sc1
    ds_read_b128 v[236:239], v2 offset:11264
    s_waitcnt lgkmcnt(3)
    v_mfma_f32_32x32x16_bf16 v[240:255], v[224:227], a[160:163], v[240:255]
    v_cvt_pk_bf16_f32 v9, v24, v25
    v_lshlrev_b32 v24, 16, v9
    v_and_b32 v25, 0xffff0000, v9
    s_add_u32 s18, s23, 86016
    buffer_load_dwordx4 a[28:31], v6, s[4:7], s18 offen offset:512 sc1
    ds_read_b128 v[224:227], v2 offset:12288
    s_waitcnt lgkmcnt(3)
    v_mfma_f32_32x32x16_bf16 v[240:255], v[228:231], a[164:167], v[240:255]
    v_cvt_pk_bf16_f32 v9, v26, v27
    v_lshlrev_b32 v26, 16, v9
    v_and_b32 v27, 0xffff0000, v9
    s_add_u32 s18, s23, 114688
    buffer_load_dwordx4 a[32:35], v6, s[4:7], s18 offen offset:0 sc1
    ds_read_b128 v[228:231], v2 offset:13312
    s_waitcnt lgkmcnt(3)
    v_mfma_f32_32x32x16_bf16 v[240:255], v[232:235], a[168:171], v[240:255]
    v_cvt_pk_bf16_f32 v9, v28, v29
    v_lshlrev_b32 v28, 16, v9
    v_and_b32 v29, 0xffff0000, v9
    s_add_u32 s18, s23, 114688
    buffer_load_dwordx4 a[36:39], v6, s[4:7], s18 offen offset:512 sc1
    ds_read_b128 v[232:235], v2 offset:14336
    s_waitcnt lgkmcnt(3)
    v_mfma_f32_32x32x16_bf16 v[240:255], v[236:239], a[172:175], v[240:255]
    v_cvt_pk_bf16_f32 v9, v30, v31
    v_lshlrev_b32 v30, 16, v9
    v_and_b32 v31, 0xffff0000, v9
    s_add_u32 s18, s23, 143360
    buffer_load_dwordx4 a[40:43], v6, s[4:7], s18 offen offset:0 sc1
    ds_read_b128 v[236:239], v2 offset:15360
    s_waitcnt lgkmcnt(3)
    v_mfma_f32_32x32x16_bf16 v[240:255], v[224:227], a[176:179], v[240:255]
    ds_write_b32 v7, v16 offset:0
    s_add_u32 s18, s23, 143360
    buffer_load_dwordx4 a[44:47], v6, s[4:7], s18 offen offset:512 sc1
    ds_read_b128 v[224:227], v2 offset:16384
    s_waitcnt lgkmcnt(4)
    v_mfma_f32_32x32x16_bf16 v[240:255], v[228:231], a[180:183], v[240:255]
    ds_write_b32 v7, v17 offset:1808
    s_add_u32 s18, s23, 172032
    buffer_load_dwordx4 a[48:51], v6, s[4:7], s18 offen offset:0 sc1
    ds_read_b128 v[228:231], v2 offset:17408
    s_waitcnt lgkmcnt(5)
    v_mfma_f32_32x32x16_bf16 v[240:255], v[232:235], a[184:187], v[240:255]
    ds_write_b32 v7, v18 offset:3616
    s_add_u32 s18, s23, 172032
    buffer_load_dwordx4 a[52:55], v6, s[4:7], s18 offen offset:512 sc1
    ds_read_b128 v[232:235], v2 offset:18432
    s_waitcnt lgkmcnt(6)
    v_mfma_f32_32x32x16_bf16 v[240:255], v[236:239], a[188:191], v[240:255]
    ds_write_b32 v7, v19 offset:5424
    s_add_u32 s18, s23, 200704
    buffer_load_dwordx4 a[56:59], v6, s[4:7], s18 offen offset:0 sc1
    ds_read_b128 v[236:239], v2 offset:19456
    s_waitcnt lgkmcnt(6)
    v_mfma_f32_32x32x16_bf16 v[240:255], v[224:227], a[192:195], v[240:255]
    ds_write_b32 v7, v20 offset:14464
    s_add_u32 s18, s23, 200704
    buffer_load_dwordx4 a[60:63], v6, s[4:7], s18 offen offset:512 sc1
    ds_read_b128 v[224:227], v2 offset:20480
    s_waitcnt lgkmcnt(6)
    v_mfma_f32_32x32x16_bf16 v[240:255], v[228:231], a[196:199], v[240:255]
    ds_write_b32 v7, v21 offset:16272
    s_add_u32 s18, s23, 229376
    buffer_load_dwordx4 a[64:67], v6, s[4:7], s18 offen offset:0 sc1
    ds_read_b128 v[228:231], v2 offset:21504
    s_waitcnt lgkmcnt(6)
    v_mfma_f32_32x32x16_bf16 v[240:255], v[232:235], a[200:203], v[240:255]
    ds_write_b32 v7, v22 offset:18080
    s_add_u32 s18, s23, 229376
    buffer_load_dwordx4 a[68:71], v6, s[4:7], s18 offen offset:512 sc1
    ds_read_b128 v[232:235], v2 offset:22528
    s_waitcnt lgkmcnt(6)
    v_mfma_f32_32x32x16_bf16 v[240:255], v[236:239], a[204:207], v[240:255]
    ds_write_b32 v7, v23 offset:19888
    s_add_u32 s18, s23, 258048
    buffer_load_dwordx4 a[72:75], v6, s[4:7], s18 offen offset:0 sc1
    ds_read_b128 v[236:239], v2 offset:23552
    s_waitcnt lgkmcnt(6)
    v_mfma_f32_32x32x16_bf16 v[240:255], v[224:227], a[208:211], v[240:255]
    ds_write_b32 v7, v24 offset:28928
    s_add_u32 s18, s23, 258048
    buffer_load_dwordx4 a[76:79], v6, s[4:7], s18 offen offset:512 sc1
    ds_read_b128 v[224:227], v2 offset:24576
    s_waitcnt lgkmcnt(6)
    v_mfma_f32_32x32x16_bf16 v[240:255], v[228:231], a[212:215], v[240:255]
    ds_write_b32 v7, v25 offset:30736
    s_add_u32 s18, s23, 286720
    buffer_load_dwordx4 a[80:83], v6, s[4:7], s18 offen offset:0 sc1
    ds_read_b128 v[228:231], v2 offset:25600
    s_waitcnt lgkmcnt(6)
    v_mfma_f32_32x32x16_bf16 v[240:255], v[232:235], a[216:219], v[240:255]
    ds_write_b32 v7, v26 offset:32544
    s_add_u32 s18, s23, 286720
    buffer_load_dwordx4 a[84:87], v6, s[4:7], s18 offen offset:512 sc1
    ds_read_b128 v[232:235], v2 offset:26624
    s_waitcnt lgkmcnt(6)
    v_mfma_f32_32x32x16_bf16 v[240:255], v[236:239], a[220:223], v[240:255]
    ds_write_b32 v7, v27 offset:34352
    s_add_u32 s18, s23, 315392
    buffer_load_dwordx4 a[88:91], v6, s[4:7], s18 offen offset:0 sc1
    ds_read_b128 v[236:239], v2 offset:27648
    s_waitcnt lgkmcnt(6)
    v_mfma_f32_32x32x16_bf16 v[240:255], v[224:227], a[224:227], v[240:255]
    ds_write_b32 v7, v28 offset:43392
    s_add_u32 s18, s23, 315392
    buffer_load_dwordx4 a[92:95], v6, s[4:7], s18 offen offset:512 sc1
    ds_read_b128 v[224:227], v2 offset:28672
    s_waitcnt lgkmcnt(6)
    v_mfma_f32_32x32x16_bf16 v[240:255], v[228:231], a[228:231], v[240:255]
    ds_write_b32 v7, v29 offset:45200
    s_add_u32 s18, s23, 344064
    buffer_load_dwordx4 a[96:99], v6, s[4:7], s18 offen offset:0 sc1
    ds_read_b128 v[228:231], v2 offset:29696
    s_waitcnt lgkmcnt(6)
    v_mfma_f32_32x32x16_bf16 v[240:255], v[232:235], a[232:235], v[240:255]
    ds_write_b32 v7, v30 offset:47008
    s_add_u32 s18, s23, 344064
    buffer_load_dwordx4 a[100:103], v6, s[4:7], s18 offen offset:512 sc1
    ds_read_b128 v[232:235], v2 offset:30720
    s_waitcnt lgkmcnt(6)
    v_mfma_f32_32x32x16_bf16 v[240:255], v[236:239], a[236:239], v[240:255]
    ds_write_b32 v7, v31 offset:48816
    s_add_u32 s18, s23, 372736
    buffer_load_dwordx4 a[104:107], v6, s[4:7], s18 offen offset:0 sc1
    ds_read_b128 v[236:239], v2 offset:31744
    s_waitcnt lgkmcnt(6)
    v_mfma_f32_32x32x16_bf16 v[240:255], v[224:227], a[240:243], v[240:255]
    s_add_u32 s18, s23, 372736
    buffer_load_dwordx4 a[108:111], v6, s[4:7], s18 offen offset:512 sc1
    ds_read_b128 v[224:227], v2 offset:32768
    s_waitcnt lgkmcnt(5)
    v_mfma_f32_32x32x16_bf16 v[240:255], v[228:231], a[244:247], v[240:255]
    s_add_u32 s18, s23, 401408
    buffer_load_dwordx4 a[112:115], v6, s[4:7], s18 offen offset:0 sc1
    ds_read_b128 v[228:231], v2 offset:33792
    s_waitcnt lgkmcnt(4)
    v_mfma_f32_32x32x16_bf16 v[240:255], v[232:235], a[248:251], v[240:255]
    s_add_u32 s18, s23, 401408
    buffer_load_dwordx4 a[116:119], v6, s[4:7], s18 offen offset:512 sc1
    ds_read_b128 v[232:235], v2 offset:34816
    s_waitcnt lgkmcnt(3)
    v_mfma_f32_32x32x16_bf16 v[240:255], v[236:239], a[252:255], v[240:255]
    s_add_u32 s18, s23, 430080
    buffer_load_dwordx4 a[120:123], v6, s[4:7], s18 offen offset:0 sc1
    ds_read_b128 v[236:239], v2 offset:35840
    s_add_u32 s18, s23, 430080
    buffer_load_dwordx4 a[124:127], v6, s[4:7], s18 offen offset:512 sc1
    s_add_u32 s25, s26, 8
    s_lshl_b32 s23, s25, 11
    s_add_u32 s23, s23, s20
    s_lshl_b32 s24, s25, 13
    s_add_u32 s24, s24, s21
    s_add_u32 s18, s24, 0
    buffer_load_dwordx4 v[32:35], v6, s[4:7], s18 offen offset:0 sc1
    s_add_u32 s18, s24, 0
    buffer_load_dwordx4 v[36:39], v6, s[4:7], s18 offen offset:512 sc1
    s_add_u32 s18, s24, 2048
    buffer_load_dwordx4 v[40:43], v6, s[4:7], s18 offen offset:0 sc1
    s_add_u32 s18, s24, 2048
    buffer_load_dwordx4 v[44:47], v6, s[4:7], s18 offen offset:512 sc1
    s_add_u32 s18, s24, 4096
    buffer_load_dwordx4 v[48:51], v6, s[4:7], s18 offen offset:0 sc1
    s_add_u32 s18, s24, 4096
    buffer_load_dwordx4 v[52:55], v6, s[4:7], s18 offen offset:512 sc1
    s_add_u32 s18, s24, 6144
    buffer_load_dwordx4 v[56:59], v6, s[4:7], s18 offen offset:0 sc1
    s_add_u32 s18, s24, 6144
    buffer_load_dwordx4 v[60:63], v6, s[4:7], s18 offen offset:512 sc1
    s_waitcnt vmcnt(40)
    s_waitcnt lgkmcnt(3)
    v_mfma_f32_32x32x16_bf16 v[240:255], v[224:227], v[64:67], v[240:255]
    ds_read_b128 v[224:227], v2 offset:36864
    s_waitcnt lgkmcnt(3)
    v_mfma_f32_32x32x16_bf16 v[240:255], v[228:231], v[68:71], v[240:255]
    ds_read_b128 v[228:231], v2 offset:37888
    s_waitcnt lgkmcnt(3)
    v_mfma_f32_32x32x16_bf16 v[240:255], v[232:235], v[72:75], v[240:255]
    ds_read_b128 v[232:235], v2 offset:38912
    s_waitcnt lgkmcnt(3)
    v_mfma_f32_32x32x16_bf16 v[240:255], v[236:239], v[76:79], v[240:255]
    ds_read_b128 v[236:239], v2 offset:39936
    s_waitcnt lgkmcnt(3)
    v_mfma_f32_32x32x16_bf16 v[240:255], v[224:227], v[80:83], v[240:255]
    ds_read_b128 v[224:227], v2 offset:0
    s_waitcnt lgkmcnt(3)
    v_mfma_f32_32x32x16_bf16 v[240:255], v[228:231], v[84:87], v[240:255]
    ds_read_b128 v[228:231], v2 offset:1024
    s_waitcnt lgkmcnt(3)
    v_mfma_f32_32x32x16_bf16 v[240:255], v[232:235], v[88:91], v[240:255]
    ds_read_b128 v[232:235], v2 offset:2048
    s_waitcnt lgkmcnt(3)
    v_mfma_f32_32x32x16_bf16 v[240:255], v[236:239], v[92:95], v[240:255]
    ds_read_b128 v[236:239], v2 offset:3072
    s_waitcnt lgkmcnt(3)
    v_mfma_f32_32x32x16_bf16 v[16:31], v[224:227], v[96:99], 0
    s_add_u32 s25, s26, 12
    s_lshl_b32 s23, s25, 11
    s_add_u32 s23, s23, s20
    s_lshl_b32 s24, s25, 13
    s_add_u32 s24, s24, s21
    ds_read_b128 v[224:227], v2 offset:4096
    s_waitcnt lgkmcnt(3)
    v_mfma_f32_32x32x16_bf16 v[16:31], v[228:231], v[100:103], v[16:31]
    s_add_u32 s18, s24, 0
    buffer_load_dwordx4 v[64:67], v6, s[4:7], s18 offen offset:0 sc1
    ds_read_b128 v[228:231], v2 offset:5120
    s_waitcnt lgkmcnt(3)
    v_mfma_f32_32x32x16_bf16 v[16:31], v[232:235], v[104:107], v[16:31]
    s_add_u32 s18, s24, 0
    buffer_load_dwordx4 v[68:71], v6, s[4:7], s18 offen offset:512 sc1
    ds_read_b128 v[232:235], v2 offset:6144
    s_waitcnt lgkmcnt(3)
    v_mfma_f32_32x32x16_bf16 v[16:31], v[236:239], v[108:111], v[16:31]
    s_add_u32 s18, s24, 2048
    buffer_load_dwordx4 v[72:75], v6, s[4:7], s18 offen offset:0 sc1
    ds_read_b128 v[236:239], v2 offset:7168
    s_waitcnt lgkmcnt(3)
    v_mfma_f32_32x32x16_bf16 v[16:31], v[224:227], v[112:115], v[16:31]
    v_cvt_pk_bf16_f32 v9, v240, v241
    v_lshlrev_b32 v240, 16, v9
    v_and_b32 v241, 0xffff0000, v9
    s_add_u32 s18, s24, 2048
    buffer_load_dwordx4 v[76:79], v6, s[4:7], s18 offen offset:512 sc1
    ds_read_b128 v[224:227], v2 offset:8192
    s_waitcnt lgkmcnt(3)
    v_mfma_f32_32x32x16_bf16 v[16:31], v[228:231], v[116:119], v[16:31]
    v_cvt_pk_bf16_f32 v9, v242, v243
    v_lshlrev_b32 v242, 16, v9
    v_and_b32 v243, 0xffff0000, v9
    s_add_u32 s18, s24, 4096
    buffer_load_dwordx4 v[80:83], v6, s[4:7], s18 offen offset:0 sc1
    ds_read_b128 v[228:231], v2 offset:9216
    s_waitcnt lgkmcnt(3)
    v_mfma_f32_32x32x16_bf16 v[16:31], v[232:235], v[120:123], v[16:31]
    v_cvt_pk_bf16_f32 v9, v244, v245
    v_lshlrev_b32 v244, 16, v9
    v_and_b32 v245, 0xffff0000, v9
    s_add_u32 s18, s24, 4096
    buffer_load_dwordx4 v[84:87], v6, s[4:7], s18 offen offset:512 sc1
    ds_read_b128 v[232:235], v2 offset:10240
    s_waitcnt lgkmcnt(3)
    v_mfma_f32_32x32x16_bf16 v[16:31], v[236:239], v[124:127], v[16:31]
    v_cvt_pk_bf16_f32 v9, v246, v247
    v_lshlrev_b32 v246, 16, v9
    v_and_b32 v247, 0xffff0000, v9
    s_add_u32 s18, s24, 6144
    buffer_load_dwordx4 v[88:91], v6, s[4:7], s18 offen offset:0 sc1
    ds_read_b128 v[236:239], v2 offset:11264
    s_waitcnt lgkmcnt(3)
    v_mfma_f32_32x32x16_bf16 v[16:31], v[224:227], v[128:131], v[16:31]
    v_cvt_pk_bf16_f32 v9, v248, v249
    v_lshlrev_b32 v248, 16, v9
    v_and_b32 v249, 0xffff0000, v9
    s_add_u32 s18, s24, 6144
    buffer_load_dwordx4 v[92:95], v6, s[4:7], s18 offen offset:512 sc1
    ds_read_b128 v[224:227], v2 offset:12288
    s_waitcnt lgkmcnt(3)
    v_mfma_f32_32x32x16_bf16 v[16:31], v[228:231], v[132:135], v[16:31]
    v_cvt_pk_bf16_f32 v9, v250, v251
    v_lshlrev_b32 v250, 16, v9
    v_and_b32 v251, 0xffff0000, v9
    ds_read_b128 v[228:231], v2 offset:13312
    s_waitcnt lgkmcnt(3)
    v_mfma_f32_32x32x16_bf16 v[16:31], v[232:235], v[136:139], v[16:31]
    v_cvt_pk_bf16_f32 v9, v252, v253
    v_lshlrev_b32 v252, 16, v9
    v_and_b32 v253, 0xffff0000, v9
    ds_read_b128 v[232:235], v2 offset:14336
    s_waitcnt lgkmcnt(3)
    v_mfma_f32_32x32x16_bf16 v[16:31], v[236:239], v[140:143], v[16:31]
    v_cvt_pk_bf16_f32 v9, v254, v255
    v_lshlrev_b32 v254, 16, v9
    v_and_b32 v255, 0xffff0000, v9
    ds_read_b128 v[236:239], v2 offset:15360
    s_waitcnt lgkmcnt(3)
    v_mfma_f32_32x32x16_bf16 v[16:31], v[224:227], v[144:147], v[16:31]
    ds_write_b32 v7, v240 offset:512
    ds_read_b128 v[224:227], v2 offset:16384
    s_waitcnt lgkmcnt(4)
    v_mfma_f32_32x32x16_bf16 v[16:31], v[228:231], v[148:151], v[16:31]
    ds_write_b32 v7, v241 offset:2320
    ds_read_b128 v[228:231], v2 offset:17408
    s_waitcnt lgkmcnt(5)
    v_mfma_f32_32x32x16_bf16 v[16:31], v[232:235], v[152:155], v[16:31]
    ds_write_b32 v7, v242 offset:4128
    ds_read_b128 v[232:235], v2 offset:18432
    s_waitcnt lgkmcnt(6)
    v_mfma_f32_32x32x16_bf16 v[16:31], v[236:239], v[156:159], v[16:31]
    ds_write_b32 v7, v243 offset:5936
    ds_read_b128 v[236:239], v2 offset:19456
    s_waitcnt lgkmcnt(6)
    v_mfma_f32_32x32x16_bf16 v[16:31], v[224:227], v[160:163], v[16:31]
    ds_write_b32 v7, v244 offset:14976
    ds_read_b128 v[224:227], v2 offset:20480
    s_waitcnt lgkmcnt(6)
    v_mfma_f32_32x32x16_bf16 v[16:31], v[228:231], v[164:167], v[16:31]
    ds_write_b32 v7, v245 offset:16784
    ds_read_b128 v[228:231], v2 offset:21504
    s_waitcnt lgkmcnt(6)
    v_mfma_f32_32x32x16_bf16 v[16:31], v[232:235], v[168:171], v[16:31]
    ds_write_b32 v7, v246 offset:18592
    ds_read_b128 v[232:235], v2 offset:22528
    s_waitcnt lgkmcnt(6)
    v_mfma_f32_32x32x16_bf16 v[16:31], v[236:239], v[172:175], v[16:31]
    ds_write_b32 v7, v247 offset:20400
    ds_read_b128 v[236:239], v2 offset:23552
    s_waitcnt lgkmcnt(6)
    v_mfma_f32_32x32x16_bf16 v[16:31], v[224:227], v[176:179], v[16:31]
    ds_write_b32 v7, v248 offset:29440
    ds_read_b128 v[224:227], v2 offset:24576
    s_waitcnt lgkmcnt(6)
    v_mfma_f32_32x32x16_bf16 v[16:31], v[228:231], v[180:183], v[16:31]
    ds_write_b32 v7, v249 offset:31248
    ds_read_b128 v[228:231], v2 offset:25600
    s_waitcnt lgkmcnt(6)
    v_mfma_f32_32x32x16_bf16 v[16:31], v[232:235], v[184:187], v[16:31]
    ds_write_b32 v7, v250 offset:33056
    ds_read_b128 v[232:235], v2 offset:26624
    s_waitcnt lgkmcnt(6)
    v_mfma_f32_32x32x16_bf16 v[16:31], v[236:239], v[188:191], v[16:31]
    ds_write_b32 v7, v251 offset:34864
    ds_read_b128 v[236:239], v2 offset:27648
    s_waitcnt lgkmcnt(6)
    v_mfma_f32_32x32x16_bf16 v[16:31], v[224:227], v[192:195], v[16:31]
    ds_write_b32 v7, v252 offset:43904
    ds_read_b128 v[224:227], v2 offset:28672
    s_waitcnt lgkmcnt(6)
    v_mfma_f32_32x32x16_bf16 v[16:31], v[228:231], v[196:199], v[16:31]
    ds_write_b32 v7, v253 offset:45712
    ds_read_b128 v[228:231], v2 offset:29696
    s_waitcnt lgkmcnt(6)
    v_mfma_f32_32x32x16_bf16 v[16:31], v[232:235], v[200:203], v[16:31]
    ds_write_b32 v7, v254 offset:47520
    ds_read_b128 v[232:235], v2 offset:30720
    s_waitcnt lgkmcnt(6)
    v_mfma_f32_32x32x16_bf16 v[16:31], v[236:239], v[204:207], v[16:31]
    ds_write_b32 v7, v255 offset:49328
    ds_read_b128 v[236:239], v2 offset:31744
    s_waitcnt lgkmcnt(6)
    v_mfma_f32_32x32x16_bf16 v[16:31], v[224:227], v[208:211], v[16:31]
    ds_read_b128 v[224:227], v2 offset:32768
    s_waitcnt lgkmcnt(5)
    v_mfma_f32_32x32x16_bf16 v[16:31], v[228:231], v[212:215], v[16:31]
    ds_read_b128 v[228:231], v2 offset:33792
    s_waitcnt lgkmcnt(4)
    v_mfma_f32_32x32x16_bf16 v[16:31], v[232:235], v[216:219], v[16:31]
    ds_read_b128 v[232:235], v2 offset:34816
    s_waitcnt lgkmcnt(3)
    v_mfma_f32_32x32x16_bf16 v[16:31], v[236:239], v[220:223], v[16:31]
    ds_read_b128 v[236:239], v2 offset:35840
    s_waitcnt vmcnt(8)
    s_waitcnt lgkmcnt(3)
    v_mfma_f32_32x32x16_bf16 v[16:31], v[224:227], v[32:35], v[16:31]
    ds_read_b128 v[224:227], v2 offset:36864
    s_waitcnt lgkmcnt(3)
    v_mfma_f32_32x32x16_bf16 v[16:31], v[228:231], v[36:39], v[16:31]
    ds_read_b128 v[228:231], v2 offset:37888
    s_waitcnt lgkmcnt(3)
    v_mfma_f32_32x32x16_bf16 v[16:31], v[232:235], v[40:43], v[16:31]
    ds_read_b128 v[232:235], v2 offset:38912
    s_waitcnt lgkmcnt(3)
    v_mfma_f32_32x32x16_bf16 v[16:31], v[236:239], v[44:47], v[16:31]
    ds_read_b128 v[236:239], v2 offset:39936
    s_waitcnt lgkmcnt(3)
    v_mfma_f32_32x32x16_bf16 v[16:31], v[224:227], v[48:51], v[16:31]
    ds_read_b128 v[224:227], v2 offset:0
    s_waitcnt lgkmcnt(3)
    v_mfma_f32_32x32x16_bf16 v[16:31], v[228:231], v[52:55], v[16:31]
    ds_read_b128 v[228:231], v2 offset:1024
    s_waitcnt lgkmcnt(3)
    v_mfma_f32_32x32x16_bf16 v[16:31], v[232:235], v[56:59], v[16:31]
    ds_read_b128 v[232:235], v2 offset:2048
    s_waitcnt lgkmcnt(3)
    v_mfma_f32_32x32x16_bf16 v[16:31], v[236:239], v[60:63], v[16:31]
    ds_read_b128 v[236:239], v2 offset:3072
    s_waitcnt vmcnt(16)
    s_waitcnt lgkmcnt(3)
    v_mfma_f32_32x32x16_bf16 v[240:255], v[224:227], a[0:3], 0
    ds_read_b128 v[224:227], v2 offset:4096
    s_waitcnt lgkmcnt(3)
    v_mfma_f32_32x32x16_bf16 v[240:255], v[228:231], a[4:7], v[240:255]
    ds_read_b128 v[228:231], v2 offset:5120
    s_waitcnt lgkmcnt(3)
    v_mfma_f32_32x32x16_bf16 v[240:255], v[232:235], a[8:11], v[240:255]
    ds_read_b128 v[232:235], v2 offset:6144
    s_waitcnt lgkmcnt(3)
    v_mfma_f32_32x32x16_bf16 v[240:255], v[236:239], a[12:15], v[240:255]
    ds_read_b128 v[236:239], v2 offset:7168
    s_waitcnt lgkmcnt(3)
    v_mfma_f32_32x32x16_bf16 v[240:255], v[224:227], a[16:19], v[240:255]
    v_cvt_pk_bf16_f32 v9, v16, v17
    v_lshlrev_b32 v16, 16, v9
    v_and_b32 v17, 0xffff0000, v9
    ds_read_b128 v[224:227], v2 offset:8192
    s_waitcnt lgkmcnt(3)
    v_mfma_f32_32x32x16_bf16 v[240:255], v[228:231], a[20:23], v[240:255]
    v_cvt_pk_bf16_f32 v9, v18, v19
    v_lshlrev_b32 v18, 16, v9
    v_and_b32 v19, 0xffff0000, v9
    ds_read_b128 v[228:231], v2 offset:9216
    s_waitcnt lgkmcnt(3)
    v_mfma_f32_32x32x16_bf16 v[240:255], v[232:235], a[24:27], v[240:255]
    v_cvt_pk_bf16_f32 v9, v20, v21
    v_lshlrev_b32 v20, 16, v9
    v_and_b32 v21, 0xffff0000, v9
    ds_read_b128 v[232:235], v2 offset:10240
    s_waitcnt lgkmcnt(3)
    v_mfma_f32_32x32x16_bf16 v[240:255], v[236:239], a[28:31], v[240:255]
    v_cvt_pk_bf16_f32 v9, v22, v23
    v_lshlrev_b32 v22, 16, v9
    v_and_b32 v23, 0xffff0000, v9
    ds_read_b128 v[236:239], v2 offset:11264
    s_waitcnt lgkmcnt(3)
    v_mfma_f32_32x32x16_bf16 v[240:255], v[224:227], a[32:35], v[240:255]
    v_cvt_pk_bf16_f32 v9, v24, v25
    v_lshlrev_b32 v24, 16, v9
    v_and_b32 v25, 0xffff0000, v9
    ds_read_b128 v[224:227], v2 offset:12288
    s_waitcnt lgkmcnt(3)
    v_mfma_f32_32x32x16_bf16 v[240:255], v[228:231], a[36:39], v[240:255]
    v_cvt_pk_bf16_f32 v9, v26, v27
    v_lshlrev_b32 v26, 16, v9
    v_and_b32 v27, 0xffff0000, v9
    ds_read_b128 v[228:231], v2 offset:13312
    s_waitcnt lgkmcnt(3)
    v_mfma_f32_32x32x16_bf16 v[240:255], v[232:235], a[40:43], v[240:255]
    v_cvt_pk_bf16_f32 v9, v28, v29
    v_lshlrev_b32 v28, 16, v9
    v_and_b32 v29, 0xffff0000, v9
    ds_read_b128 v[232:235], v2 offset:14336
    s_waitcnt lgkmcnt(3)
    v_mfma_f32_32x32x16_bf16 v[240:255], v[236:239], a[44:47], v[240:255]
    v_cvt_pk_bf16_f32 v9, v30, v31
    v_lshlrev_b32 v30, 16, v9
    v_and_b32 v31, 0xffff0000, v9
    ds_read_b128 v[236:239], v2 offset:15360
    s_waitcnt lgkmcnt(3)
    v_mfma_f32_32x32x16_bf16 v[240:255], v[224:227], a[48:51], v[240:255]
    ds_write_b32 v7, v16 offset:1024
    ds_read_b128 v[224:227], v2 offset:16384
    s_waitcnt lgkmcnt(4)
    v_mfma_f32_32x32x16_bf16 v[240:255], v[228:231], a[52:55], v[240:255]
    ds_write_b32 v7, v17 offset:2832
    ds_read_b128 v[228:231], v2 offset:17408
    s_waitcnt lgkmcnt(5)
    v_mfma_f32_32x32x16_bf16 v[240:255], v[232:235], a[56:59], v[240:255]
    ds_write_b32 v7, v18 offset:4640
    ds_read_b128 v[232:235], v2 offset:18432
    s_waitcnt lgkmcnt(6)
    v_mfma_f32_32x32x16_bf16 v[240:255], v[236:239], a[60:63], v[240:255]
    ds_write_b32 v7, v19 offset:6448
    ds_read_b128 v[236:239], v2 offset:19456
    s_waitcnt lgkmcnt(6)
    v_mfma_f32_32x32x16_bf16 v[240:255], v[224:227], a[64:67], v[240:255]
    ds_write_b32 v7, v20 offset:15488
    ds_read_b128 v[224:227], v2 offset:20480
    s_waitcnt lgkmcnt(6)
    v_mfma_f32_32x32x16_bf16 v[240:255], v[228:231], a[68:71], v[240:255]
    ds_write_b32 v7, v21 offset:17296
    ds_read_b128 v[228:231], v2 offset:21504
    s_waitcnt lgkmcnt(6)
    v_mfma_f32_32x32x16_bf16 v[240:255], v[232:235], a[72:75], v[240:255]
    ds_write_b32 v7, v22 offset:19104
    ds_read_b128 v[232:235], v2 offset:22528
    s_waitcnt lgkmcnt(6)
    v_mfma_f32_32x32x16_bf16 v[240:255], v[236:239], a[76:79], v[240:255]
    ds_write_b32 v7, v23 offset:20912
    ds_read_b128 v[236:239], v2 offset:23552
    s_waitcnt lgkmcnt(6)
    v_mfma_f32_32x32x16_bf16 v[240:255], v[224:227], a[80:83], v[240:255]
    ds_write_b32 v7, v24 offset:29952
    ds_read_b128 v[224:227], v2 offset:24576
    s_waitcnt lgkmcnt(6)
    v_mfma_f32_32x32x16_bf16 v[240:255], v[228:231], a[84:87], v[240:255]
    ds_write_b32 v7, v25 offset:31760
    ds_read_b128 v[228:231], v2 offset:25600
    s_waitcnt lgkmcnt(6)
    v_mfma_f32_32x32x16_bf16 v[240:255], v[232:235], a[88:91], v[240:255]
    ds_write_b32 v7, v26 offset:33568
    ds_read_b128 v[232:235], v2 offset:26624
    s_waitcnt lgkmcnt(6)
    v_mfma_f32_32x32x16_bf16 v[240:255], v[236:239], a[92:95], v[240:255]
    ds_write_b32 v7, v27 offset:35376
    ds_read_b128 v[236:239], v2 offset:27648
    s_waitcnt lgkmcnt(6)
    v_mfma_f32_32x32x16_bf16 v[240:255], v[224:227], a[96:99], v[240:255]
    ds_write_b32 v7, v28 offset:44416
    ds_read_b128 v[224:227], v2 offset:28672
    s_waitcnt lgkmcnt(6)
    v_mfma_f32_32x32x16_bf16 v[240:255], v[228:231], a[100:103], v[240:255]
    ds_write_b32 v7, v29 offset:46224
    ds_read_b128 v[228:231], v2 offset:29696
    s_waitcnt lgkmcnt(6)
    v_mfma_f32_32x32x16_bf16 v[240:255], v[232:235], a[104:107], v[240:255]
    ds_write_b32 v7, v30 offset:48032
    ds_read_b128 v[232:235], v2 offset:30720
    s_waitcnt lgkmcnt(6)
    v_mfma_f32_32x32x16_bf16 v[240:255], v[236:239], a[108:111], v[240:255]
    ds_write_b32 v7, v31 offset:49840
    ds_read_b128 v[236:239], v2 offset:31744
    s_waitcnt lgkmcnt(6)
    v_mfma_f32_32x32x16_bf16 v[240:255], v[224:227], a[112:115], v[240:255]
    ds_read_b128 v[224:227], v2 offset:32768
    s_waitcnt lgkmcnt(5)
    v_mfma_f32_32x32x16_bf16 v[240:255], v[228:231], a[116:119], v[240:255]
    ds_read_b128 v[228:231], v2 offset:33792
    s_waitcnt lgkmcnt(4)
    v_mfma_f32_32x32x16_bf16 v[240:255], v[232:235], a[120:123], v[240:255]
    ds_read_b128 v[232:235], v2 offset:34816
    s_waitcnt lgkmcnt(3)
    v_mfma_f32_32x32x16_bf16 v[240:255], v[236:239], a[124:127], v[240:255]
    ds_read_b128 v[236:239], v2 offset:35840
    s_waitcnt vmcnt(0)
    s_waitcnt lgkmcnt(3)
    v_mfma_f32_32x32x16_bf16 v[240:255], v[224:227], v[64:67], v[240:255]
    ds_read_b128 v[224:227], v2 offset:36864
    s_waitcnt lgkmcnt(3)
    v_mfma_f32_32x32x16_bf16 v[240:255], v[228:231], v[68:71], v[240:255]
    ds_read_b128 v[228:231], v2 offset:37888
    s_waitcnt lgkmcnt(3)
    v_mfma_f32_32x32x16_bf16 v[240:255], v[232:235], v[72:75], v[240:255]
    ds_read_b128 v[232:235], v2 offset:38912
    s_waitcnt lgkmcnt(3)
    v_mfma_f32_32x32x16_bf16 v[240:255], v[236:239], v[76:79], v[240:255]
    ds_read_b128 v[236:239], v2 offset:39936
    s_waitcnt lgkmcnt(3)
    v_mfma_f32_32x32x16_bf16 v[240:255], v[224:227], v[80:83], v[240:255]
    s_waitcnt lgkmcnt(2)
    v_mfma_f32_32x32x16_bf16 v[240:255], v[228:231], v[84:87], v[240:255]
    s_waitcnt lgkmcnt(1)
    v_mfma_f32_32x32x16_bf16 v[240:255], v[232:235], v[88:91], v[240:255]
    s_waitcnt lgkmcnt(0)
    v_mfma_f32_32x32x16_bf16 v[240:255], v[236:239], v[92:95], v[240:255]
    s_nop 11
    v_cvt_pk_bf16_f32 v9, v240, v241
    v_lshlrev_b32 v240, 16, v9
    v_and_b32 v241, 0xffff0000, v9
    v_cvt_pk_bf16_f32 v9, v242, v243
    v_lshlrev_b32 v242, 16, v9
    v_and_b32 v243, 0xffff0000, v9
    v_cvt_pk_bf16_f32 v9, v244, v245
    v_lshlrev_b32 v244, 16, v9
    v_and_b32 v245, 0xffff0000, v9
    v_cvt_pk_bf16_f32 v9, v246, v247
    v_lshlrev_b32 v246, 16, v9
    v_and_b32 v247, 0xffff0000, v9
    v_cvt_pk_bf16_f32 v9, v248, v249
    v_lshlrev_b32 v248, 16, v9
    v_and_b32 v249, 0xffff0000, v9
    v_cvt_pk_bf16_f32 v9, v250, v251
    v_lshlrev_b32 v250, 16, v9
    v_and_b32 v251, 0xffff0000, v9
    v_cvt_pk_bf16_f32 v9, v252, v253
    v_lshlrev_b32 v252, 16, v9
    v_and_b32 v253, 0xffff0000, v9
    v_cvt_pk_bf16_f32 v9, v254, v255
    v_lshlrev_b32 v254, 16, v9
    v_and_b32 v255, 0xffff0000, v9
    ds_write_b32 v7, v240 offset:1536
    ds_write_b32 v7, v241 offset:3344
    ds_write_b32 v7, v242 offset:5152
    ds_write_b32 v7, v243 offset:6960
    ds_write_b32 v7, v244 offset:16000
    ds_write_b32 v7, v245 offset:17808
    ds_write_b32 v7, v246 offset:19616
    ds_write_b32 v7, v247 offset:21424
    ds_write_b32 v7, v248 offset:30464
    ds_write_b32 v7, v249 offset:32272
    ds_write_b32 v7, v250 offset:34080
    ds_write_b32 v7, v251 offset:35888
    ds_write_b32 v7, v252 offset:44928
    ds_write_b32 v7, v253 offset:46736
    ds_write_b32 v7, v254 offset:48544
    ds_write_b32 v7, v255 offset:50352
    s_branch oe_104
o3_103:
    ds_read_b128 v[224:227], v2 offset:0
    ds_read_b128 v[228:231], v2 offset:1024
    ds_read_b128 v[232:235], v2 offset:2048
    ds_read_b128 v[236:239], v2 offset:3072
    s_waitcnt lgkmcnt(3)
    v_mfma_f32_32x32x16_bf16 v[16:31], v[224:227], a[0:3], 0
    ds_read_b128 v[224:227], v2 offset:4096
    s_waitcnt lgkmcnt(3)
    v_mfma_f32_32x32x16_bf16 v[16:31], v[228:231], a[4:7], v[16:31]
    ds_read_b128 v[228:231], v2 offset:5120
    s_waitcnt lgkmcnt(3)
    v_mfma_f32_32x32x16_bf16 v[16:31], v[232:235], a[8:11], v[16:31]
    ds_read_b128 v[232:235], v2 offset:6144
    s_waitcnt lgkmcnt(3)
    v_mfma_f32_32x32x16_bf16 v[16:31], v[236:239], a[12:15], v[16:31]
    ds_read_b128 v[236:239], v2 offset:7168
    s_waitcnt lgkmcnt(3)
    v_mfma_f32_32x32x16_bf16 v[16:31], v[224:227], a[16:19], v[16:31]
    ds_read_b128 v[224:227], v2 offset:8192
    s_waitcnt lgkmcnt(3)
    v_mfma_f32_32x32x16_bf16 v[16:31], v[228:231], a[20:23], v[16:31]
    ds_read_b128 v[228:231], v2 offset:9216
    s_waitcnt lgkmcnt(3)
    v_mfma_f32_32x32x16_bf16 v[16:31], v[232:235], a[24:27], v[16:31]
    ds_read_b128 v[232:235], v2 offset:10240
    s_waitcnt lgkmcnt(3)
    v_mfma_f32_32x32x16_bf16 v[16:31], v[236:239], a[28:31], v[16:31]
    ds_read_b128 v[236:239], v2 offset:11264
    s_waitcnt lgkmcnt(3)
    v_mfma_f32_32x32x16_bf16 v[16:31], v[224:227], a[32:35], v[16:31]
    ds_read_b128 v[224:227], v2 offset:12288
    s_waitcnt lgkmcnt(3)
    v_mfma_f32_32x32x16_bf16 v[16:31], v[228:231], a[36:39], v[16:31]
    ds_read_b128 v[228:231], v2 offset:13312
    s_waitcnt lgkmcnt(3)
    v_mfma_f32_32x32x16_bf16 v[16:31], v[232:235], a[40:43], v[16:31]
    ds_read_b128 v[232:235], v2 offset:14336
    s_waitcnt lgkmcnt(3)
    v_mfma_f32_32x32x16_bf16 v[16:31], v[236:239], a[44:47], v[16:31]
    ds_read_b128 v[236:239], v2 offset:15360
    s_waitcnt lgkmcnt(3)
    v_mfma_f32_32x32x16_bf16 v[16:31], v[224:227], a[48:51], v[16:31]
    ds_read_b128 v[224:227], v2 offset:16384
    s_waitcnt lgkmcnt(3)
    v_mfma_f32_32x32x16_bf16 v[16:31], v[228:231], a[52:55], v[16:31]
    ds_read_b128 v[228:231], v2 offset:17408
    s_waitcnt lgkmcnt(3)
    v_mfma_f32_32x32x16_bf16 v[16:31], v[232:235], a[56:59], v[16:31]
    ds_read_b128 v[232:235], v2 offset:18432
    s_waitcnt lgkmcnt(3)
    v_mfma_f32_32x32x16_bf16 v[16:31], v[236:239], a[60:63], v[16:31]
    ds_read_b128 v[236:239], v2 offset:19456
    s_waitcnt lgkmcnt(3)
    v_mfma_f32_32x32x16_bf16 v[16:31], v[224:227], a[64:67], v[16:31]
    ds_read_b128 v[224:227], v2 offset:20480
    s_waitcnt lgkmcnt(3)
    v_mfma_f32_32x32x16_bf16 v[16:31], v[228:231], a[68:71], v[16:31]
    ds_read_b128 v[228:231], v2 offset:21504
    s_waitcnt lgkmcnt(3)
    v_mfma_f32_32x32x16_bf16 v[16:31], v[232:235], a[72:75], v[16:31]
    ds_read_b128 v[232:235], v2 offset:22528
    s_waitcnt lgkmcnt(3)
    v_mfma_f32_32x32x16_bf16 v[16:31], v[236:239], a[76:79], v[16:31]
    ds_read_b128 v[236:239], v2 offset:23552
    s_waitcnt lgkmcnt(3)
    v_mfma_f32_32x32x16_bf16 v[16:31], v[224:227], a[80:83], v[16:31]
    ds_read_b128 v[224:227], v2 offset:24576
    s_waitcnt lgkmcnt(3)
    v_mfma_f32_32x32x16_bf16 v[16:31], v[228:231], a[84:87], v[16:31]
    ds_read_b128 v[228:231], v2 offset:25600
    s_waitcnt lgkmcnt(3)
    v_mfma_f32_32x32x16_bf16 v[16:31], v[232:235], a[88:91], v[16:31]
    ds_read_b128 v[232:235], v2 offset:26624
    s_waitcnt lgkmcnt(3)
    v_mfma_f32_32x32x16_bf16 v[16:31], v[236:239], a[92:95], v[16:31]
    ds_read_b128 v[236:239], v2 offset:27648
    s_waitcnt lgkmcnt(3)
    v_mfma_f32_32x32x16_bf16 v[16:31], v[224:227], a[96:99], v[16:31]
    ds_read_b128 v[224:227], v2 offset:28672
    s_waitcnt lgkmcnt(3)
    v_mfma_f32_32x32x16_bf16 v[16:31], v[228:231], a[100:103], v[16:31]
    ds_read_b128 v[228:231], v2 offset:29696
    s_waitcnt lgkmcnt(3)
    v_mfma_f32_32x32x16_bf16 v[16:31], v[232:235], a[104:107], v[16:31]
    ds_read_b128 v[232:235], v2 offset:30720
    s_waitcnt lgkmcnt(3)
    v_mfma_f32_32x32x16_bf16 v[16:31], v[236:239], a[108:111], v[16:31]
    ds_read_b128 v[236:239], v2 offset:31744
    s_waitcnt lgkmcnt(3)
    v_mfma_f32_32x32x16_bf16 v[16:31], v[224:227], a[112:115], v[16:31]
    ds_read_b128 v[224:227], v2 offset:32768
    s_waitcnt lgkmcnt(3)
    v_mfma_f32_32x32x16_bf16 v[16:31], v[228:231], a[116:119], v[16:31]
    ds_read_b128 v[228:231], v2 offset:33792
    s_waitcnt lgkmcnt(3)
    v_mfma_f32_32x32x16_bf16 v[16:31], v[232:235], a[120:123], v[16:31]
    ds_read_b128 v[232:235], v2 offset:34816
    s_waitcnt lgkmcnt(3)
    v_mfma_f32_32x32x16_bf16 v[16:31], v[236:239], a[124:127], v[16:31]
    ds_read_b128 v[236:239], v2 offset:35840
    s_waitcnt vmcnt(8)
    s_waitcnt lgkmcnt(3)
    v_mfma_f32_32x32x16_bf16 v[16:31], v[224:227], v[32:35], v[16:31]
    ds_read_b128 v[224:227], v2 offset:36864
    s_waitcnt lgkmcnt(3)
    v_mfma_f32_32x32x16_bf16 v[16:31], v[228:231], v[36:39], v[16:31]
    ds_read_b128 v[228:231], v2 offset:37888
    s_waitcnt lgkmcnt(3)
    v_mfma_f32_32x32x16_bf16 v[16:31], v[232:235], v[40:43], v[16:31]
    ds_read_b128 v[232:235], v2 offset:38912
    s_waitcnt lgkmcnt(3)
    v_mfma_f32_32x32x16_bf16 v[16:31], v[236:239], v[44:47], v[16:31]
    ds_read_b128 v[236:239], v2 offset:39936
    s_waitcnt lgkmcnt(3)
    v_mfma_f32_32x32x16_bf16 v[16:31], v[224:227], v[48:51], v[16:31]
    ds_read_b128 v[224:227], v2 offset:0
    s_waitcnt lgkmcnt(3)
    v_mfma_f32_32x32x16_bf16 v[16:31], v[228:231], v[52:55], v[16:31]
    ds_read_b128 v[228:231], v2 offset:1024
    s_waitcnt lgkmcnt(3)
    v_mfma_f32_32x32x16_bf16 v[16:31], v[232:235], v[56:59], v[16:31]
    ds_read_b128 v[232:235], v2 offset:2048
    s_waitcnt lgkmcnt(3)
    v_mfma_f32_32x32x16_bf16 v[16:31], v[236:239], v[60:63], v[16:31]
    ds_read_b128 v[236:239], v2 offset:3072
    s_waitcnt lgkmcnt(3)
    v_mfma_f32_32x32x16_bf16 v[240:255], v[224:227], a[128:131], 0
    s_add_u32 s25, s26, 8
    s_lshl_b32 s23, s25, 11
    s_add_u32 s23, s23, s20
    s_lshl_b32 s24, s25, 13
    s_add_u32 s24, s24, s21
    ds_read_b128 v[224:227], v2 offset:4096
    s_waitcnt lgkmcnt(3)
    v_mfma_f32_32x32x16_bf16 v[240:255], v[228:231], a[132:135], v[240:255]
    s_add_u32 s18, s24, 0
    buffer_load_dwordx4 v[32:35], v6, s[4:7], s18 offen offset:0 sc1
    ds_read_b128 v[228:231], v2 offset:5120
    s_waitcnt lgkmcnt(3)
    v_mfma_f32_32x32x16_bf16 v[240:255], v[232:235], a[136:139], v[240:255]
    s_add_u32 s18, s24, 0
    buffer_load_dwordx4 v[36:39], v6, s[4:7], s18 offen offset:512 sc1
    ds_read_b128 v[232:235], v2 offset:6144
    s_waitcnt lgkmcnt(3)
    v_mfma_f32_32x32x16_bf16 v[240:255], v[236:239], a[140:143], v[240:255]
    s_add_u32 s18, s24, 2048
    buffer_load_dwordx4 v[40:43], v6, s[4:7], s18 offen offset:0 sc1
    ds_read_b128 v[236:239], v2 offset:7168
    s_waitcnt lgkmcnt(3)
    v_mfma_f32_32x32x16_bf16 v[240:255], v[224:227], a[144:147], v[240:255]
    v_cvt_pk_bf16_f32 v9, v16, v17
    v_lshlrev_b32 v16, 16, v9
    v_and_b32 v17, 0xffff0000, v9
    s_add_u32 s18, s24, 2048
    buffer_load_dwordx4 v[44:47], v6, s[4:7], s18 offen offset:512 sc1
    ds_read_b128 v[224:227], v2 offset:8192
    s_waitcnt lgkmcnt(3)
    v_mfma_f32_32x32x16_bf16 v[240:255], v[228:231], a[148:151], v[240:255]
    v_cvt_pk_bf16_f32 v9, v18, v19
    v_lshlrev_b32 v18, 16, v9
    v_and_b32 v19, 0xffff0000, v9
    s_add_u32 s18, s24, 4096
    buffer_load_dwordx4 v[48:51], v6, s[4:7], s18 offen offset:0 sc1
    ds_read_b128 v[228:231], v2 offset:9216
    s_waitcnt lgkmcnt(3)
    v_mfma_f32_32x32x16_bf16 v[240:255], v[232:235], a[152:155], v[240:255]
    v_cvt_pk_bf16_f32 v9, v20, v21
    v_lshlrev_b32 v20, 16, v9
    v_and_b32 v21, 0xffff0000, v9
    s_add_u32 s18, s24, 4096
    buffer_load_dwordx4 v[52:55], v6, s[4:7], s18 offen offset:512 sc1
    ds_read_b128 v[232:235], v2 offset:10240
    s_waitcnt lgkmcnt(3)
    v_mfma_f32_32x32x16_bf16 v[240:255], v[236:239], a[156:159], v[240:255]
    v_cvt_pk_bf16_f32 v9, v22, v23
    v_lshlrev_b32 v22, 16, v9
    v_and_b32 v23, 0xffff0000, v9
    s_add_u32 s18, s24, 6144
    buffer_load_dwordx4 v[56:59], v6, s[4:7], s18 offen offset:0 sc1
    ds_read_b128 v[236:239], v2 offset:11264
    s_waitcnt lgkmcnt(3)
    v_mfma_f32_32x32x16_bf16 v[240:255], v[224:227], a[160:163], v[240:255]
    v_cvt_pk_bf16_f32 v9, v24, v25
    v_lshlrev_b32 v24, 16, v9
    v_and_b32 v25, 0xffff0000, v9
    s_add_u32 s18, s24, 6144
    buffer_load_dwordx4 v[60:63], v6, s[4:7], s18 offen offset:512 sc1
    ds_read_b128 v[224:227], v2 offset:12288
    s_waitcnt lgkmcnt(3)
    v_mfma_f32_32x32x16_bf16 v[240:255], v[228:231], a[164:167], v[240:255]
    v_cvt_pk_bf16_f32 v9, v26, v27
    v_lshlrev_b32 v26, 16, v9
    v_and_b32 v27, 0xffff0000, v9
    ds_read_b128 v[228:231], v2 offset:13312
    s_waitcnt lgkmcnt(3)
    v_mfma_f32_32x32x16_bf16 v[240:255], v[232:235], a[168:171], v[240:255]
    v_cvt_pk_bf16_f32 v9, v28, v29
    v_lshlrev_b32 v28, 16, v9
    v_and_b32 v29, 0xffff0000, v9
    ds_read_b128 v[232:235], v2 offset:14336
    s_waitcnt lgkmcnt(3)
    v_mfma_f32_32x32x16_bf16 v[240:255], v[236:239], a[172:175], v[240:255]
    v_cvt_pk_bf16_f32 v9, v30, v31
    v_lshlrev_b32 v30, 16, v9
    v_and_b32 v31, 0xffff0000, v9
    ds_read_b128 v[236:239], v2 offset:15360
    s_waitcnt lgkmcnt(3)
    v_mfma_f32_32x32x16_bf16 v[240:255], v[224:227], a[176:179], v[240:255]
    ds_write_b32 v7, v16 offset:0
    ds_read_b128 v[224:227], v2 offset:16384
    s_waitcnt lgkmcnt(4)
    v_mfma_f32_32x32x16_bf16 v[240:255], v[228:231], a[180:183], v[240:255]
    ds_write_b32 v7, v17 offset:1808
    ds_read_b128 v[228:231], v2 offset:17408
    s_waitcnt lgkmcnt(5)
    v_mfma_f32_32x32x16_bf16 v[240:255], v[232:235], a[184:187], v[240:255]
    ds_write_b32 v7, v18 offset:3616
    ds_read_b128 v[232:235], v2 offset:18432
    s_waitcnt lgkmcnt(6)
    v_mfma_f32_32x32x16_bf16 v[240:255], v[236:239], a[188:191], v[240:255]
    ds_write_b32 v7, v19 offset:5424
    ds_read_b128 v[236:239], v2 offset:19456
    s_waitcnt lgkmcnt(6)
    v_mfma_f32_32x32x16_bf16 v[240:255], v[224:227], a[192:195], v[240:255]
    ds_write_b32 v7, v20 offset:14464
    ds_read_b128 v[224:227], v2 offset:20480
    s_waitcnt lgkmcnt(6)
    v_mfma_f32_32x32x16_bf16 v[240:255], v[228:231], a[196:199], v[240:255]
    ds_write_b32 v7, v21 offset:16272
    ds_read_b128 v[228:231], v2 offset:21504
    s_waitcnt lgkmcnt(6)
    v_mfma_f32_32x32x16_bf16 v[240:255], v[232:235], a[200:203], v[240:255]
    ds_write_b32 v7, v22 offset:18080
    ds_read_b128 v[232:235], v2 offset:22528
    s_waitcnt lgkmcnt(6)
    v_mfma_f32_32x32x16_bf16 v[240:255], v[236:239], a[204:207], v[240:255]
    ds_write_b32 v7, v23 offset:19888
    ds_read_b128 v[236:239], v2 offset:23552
    s_waitcnt lgkmcnt(6)
    v_mfma_f32_32x32x16_bf16 v[240:255], v[224:227], a[208:211], v[240:255]
    ds_write_b32 v7, v24 offset:28928
    ds_read_b128 v[224:227], v2 offset:24576
    s_waitcnt lgkmcnt(6)
    v_mfma_f32_32x32x16_bf16 v[240:255], v[228:231], a[212:215], v[240:255]
    ds_write_b32 v7, v25 offset:30736
    ds_read_b128 v[228:231], v2 offset:25600
    s_waitcnt lgkmcnt(6)
    v_mfma_f32_32x32x16_bf16 v[240:255], v[232:235], a[216:219], v[240:255]
    ds_write_b32 v7, v26 offset:32544
    ds_read_b128 v[232:235], v2 offset:26624
    s_waitcnt lgkmcnt(6)
    v_mfma_f32_32x32x16_bf16 v[240:255], v[236:239], a[220:223], v[240:255]
    ds_write_b32 v7, v27 offset:34352
    ds_read_b128 v[236:239], v2 offset:27648
    s_waitcnt lgkmcnt(6)
    v_mfma_f32_32x32x16_bf16 v[240:255], v[224:227], a[224:227], v[240:255]
    ds_write_b32 v7, v28 offset:43392
    ds_read_b128 v[224:227], v2 offset:28672
    s_waitcnt lgkmcnt(6)
    v_mfma_f32_32x32x16_bf16 v[240:255], v[228:231], a[228:231], v[240:255]
    ds_write_b32 v7, v29 offset:45200
    ds_read_b128 v[228:231], v2 offset:29696
    s_waitcnt lgkmcnt(6)
    v_mfma_f32_32x32x16_bf16 v[240:255], v[232:235], a[232:235], v[240:255]
    ds_write_b32 v7, v30 offset:47008
    ds_read_b128 v[232:235], v2 offset:30720
    s_waitcnt lgkmcnt(6)
    v_mfma_f32_32x32x16_bf16 v[240:255], v[236:239], a[236:239], v[240:255]
    ds_write_b32 v7, v31 offset:48816
    ds_read_b128 v[236:239], v2 offset:31744
    s_waitcnt lgkmcnt(6)
    v_mfma_f32_32x32x16_bf16 v[240:255], v[224:227], a[240:243], v[240:255]
    ds_read_b128 v[224:227], v2 offset:32768
    s_waitcnt lgkmcnt(5)
    v_mfma_f32_32x32x16_bf16 v[240:255], v[228:231], a[244:247], v[240:255]
    ds_read_b128 v[228:231], v2 offset:33792
    s_waitcnt lgkmcnt(4)
    v_mfma_f32_32x32x16_bf16 v[240:255], v[232:235], a[248:251], v[240:255]
    ds_read_b128 v[232:235], v2 offset:34816
    s_waitcnt lgkmcnt(3)
    v_mfma_f32_32x32x16_bf16 v[240:255], v[236:239], a[252:255], v[240:255]
    ds_read_b128 v[236:239], v2 offset:35840
    s_waitcnt vmcnt(8)
    s_waitcnt lgkmcnt(3)
    v_mfma_f32_32x32x16_bf16 v[240:255], v[224:227], v[64:67], v[240:255]
    ds_read_b128 v[224:227], v2 offset:36864
    s_waitcnt lgkmcnt(3)
    v_mfma_f32_32x32x16_bf16 v[240:255], v[228:231], v[68:71], v[240:255]
    ds_read_b128 v[228:231], v2 offset:37888
    s_waitcnt lgkmcnt(3)
    v_mfma_f32_32x32x16_bf16 v[240:255], v[232:235], v[72:75], v[240:255]
    ds_read_b128 v[232:235], v2 offset:38912
    s_waitcnt lgkmcnt(3)
    v_mfma_f32_32x32x16_bf16 v[240:255], v[236:239], v[76:79], v[240:255]
    ds_read_b128 v[236:239], v2 offset:39936
    s_waitcnt lgkmcnt(3)
    v_mfma_f32_32x32x16_bf16 v[240:255], v[224:227], v[80:83], v[240:255]
    ds_read_b128 v[224:227], v2 offset:0
    s_waitcnt lgkmcnt(3)
    v_mfma_f32_32x32x16_bf16 v[240:255], v[228:231], v[84:87], v[240:255]
    ds_read_b128 v[228:231], v2 offset:1024
    s_waitcnt lgkmcnt(3)
    v_mfma_f32_32x32x16_bf16 v[240:255], v[232:235], v[88:91], v[240:255]
    ds_read_b128 v[232:235], v2 offset:2048
    s_waitcnt lgkmcnt(3)
    v_mfma_f32_32x32x16_bf16 v[240:255], v[236:239], v[92:95], v[240:255]
    ds_read_b128 v[236:239], v2 offset:3072
    s_waitcnt lgkmcnt(3)
    v_mfma_f32_32x32x16_bf16 v[16:31], v[224:227], v[96:99], 0
    ds_read_b128 v[224:227], v2 offset:4096
    s_waitcnt lgkmcnt(3)
    v_mfma_f32_32x32x16_bf16 v[16:31], v[228:231], v[100:103], v[16:31]
    ds_read_b128 v[228:231], v2 offset:5120
    s_waitcnt lgkmcnt(3)
    v_mfma_f32_32x32x16_bf16 v[16:31], v[232:235], v[104:107], v[16:31]
    ds_read_b128 v[232:235], v2 offset:6144
    s_waitcnt lgkmcnt(3)
    v_mfma_f32_32x32x16_bf16 v[16:31], v[236:239], v[108:111], v[16:31]
    ds_read_b128 v[236:239], v2 offset:7168
    s_waitcnt lgkmcnt(3)
    v_mfma_f32_32x32x16_bf16 v[16:31], v[224:227], v[112:115], v[16:31]
    v_cvt_pk_bf16_f32 v9, v240, v241
    v_lshlrev_b32 v240, 16, v9
    v_and_b32 v241, 0xffff0000, v9
    ds_read_b128 v[224:227], v2 offset:8192
    s_waitcnt lgkmcnt(3)
    v_mfma_f32_32x32x16_bf16 v[16:31], v[228:231], v[116:119], v[16:31]
    v_cvt_pk_bf16_f32 v9, v242, v243
    v_lshlrev_b32 v242, 16, v9
    v_and_b32 v243, 0xffff0000, v9
    ds_read_b128 v[228:231], v2 offset:9216
    s_waitcnt lgkmcnt(3)
    v_mfma_f32_32x32x16_bf16 v[16:31], v[232:235], v[120:123], v[16:31]
    v_cvt_pk_bf16_f32 v9, v244, v245
    v_lshlrev_b32 v244, 16, v9
    v_and_b32 v245, 0xffff0000, v9
    ds_read_b128 v[232:235], v2 offset:10240
    s_waitcnt lgkmcnt(3)
    v_mfma_f32_32x32x16_bf16 v[16:31], v[236:239], v[124:127], v[16:31]
    v_cvt_pk_bf16_f32 v9, v246, v247
    v_lshlrev_b32 v246, 16, v9
    v_and_b32 v247, 0xffff0000, v9
    ds_read_b128 v[236:239], v2 offset:11264
    s_waitcnt lgkmcnt(3)
    v_mfma_f32_32x32x16_bf16 v[16:31], v[224:227], v[128:131], v[16:31]
    v_cvt_pk_bf16_f32 v9, v248, v249
    v_lshlrev_b32 v248, 16, v9
    v_and_b32 v249, 0xffff0000, v9
    ds_read_b128 v[224:227], v2 offset:12288
    s_waitcnt lgkmcnt(3)
    v_mfma_f32_32x32x16_bf16 v[16:31], v[228:231], v[132:135], v[16:31]
    v_cvt_pk_bf16_f32 v9, v250, v251
    v_lshlrev_b32 v250, 16, v9
    v_and_b32 v251, 0xffff0000, v9
    ds_read_b128 v[228:231], v2 offset:13312
    s_waitcnt lgkmcnt(3)
    v_mfma_f32_32x32x16_bf16 v[16:31], v[232:235], v[136:139], v[16:31]
    v_cvt_pk_bf16_f32 v9, v252, v253
    v_lshlrev_b32 v252, 16, v9
    v_and_b32 v253, 0xffff0000, v9
    ds_read_b128 v[232:235], v2 offset:14336
    s_waitcnt lgkmcnt(3)
    v_mfma_f32_32x32x16_bf16 v[16:31], v[236:239], v[140:143], v[16:31]
    v_cvt_pk_bf16_f32 v9, v254, v255
    v_lshlrev_b32 v254, 16, v9
    v_and_b32 v255, 0xffff0000, v9
    ds_read_b128 v[236:239], v2 offset:15360
    s_waitcnt lgkmcnt(3)
    v_mfma_f32_32x32x16_bf16 v[16:31], v[224:227], v[144:147], v[16:31]
    ds_write_b32 v7, v240 offset:512
    ds_read_b128 v[224:227], v2 offset:16384
    s_waitcnt lgkmcnt(4)
    v_mfma_f32_32x32x16_bf16 v[16:31], v[228:231], v[148:151], v[16:31]
    ds_write_b32 v7, v241 offset:2320
    ds_read_b128 v[228:231], v2 offset:17408
    s_waitcnt lgkmcnt(5)
    v_mfma_f32_32x32x16_bf16 v[16:31], v[232:235], v[152:155], v[16:31]
    ds_write_b32 v7, v242 offset:4128
    ds_read_b128 v[232:235], v2 offset:18432
    s_waitcnt lgkmcnt(6)
    v_mfma_f32_32x32x16_bf16 v[16:31], v[236:239], v[156:159], v[16:31]
    ds_write_b32 v7, v243 offset:5936
    ds_read_b128 v[236:239], v2 offset:19456
    s_waitcnt lgkmcnt(6)
    v_mfma_f32_32x32x16_bf16 v[16:31], v[224:227], v[160:163], v[16:31]
    ds_write_b32 v7, v244 offset:14976
    ds_read_b128 v[224:227], v2 offset:20480
    s_waitcnt lgkmcnt(6)
    v_mfma_f32_32x32x16_bf16 v[16:31], v[228:231], v[164:167], v[16:31]
    ds_write_b32 v7, v245 offset:16784
    ds_read_b128 v[228:231], v2 offset:21504
    s_waitcnt lgkmcnt(6)
    v_mfma_f32_32x32x16_bf16 v[16:31], v[232:235], v[168:171], v[16:31]
    ds_write_b32 v7, v246 offset:18592
    ds_read_b128 v[232:235], v2 offset:22528
    s_waitcnt lgkmcnt(6)
    v_mfma_f32_32x32x16_bf16 v[16:31], v[236:239], v[172:175], v[16:31]
    ds_write_b32 v7, v247 offset:20400
    ds_read_b128 v[236:239], v2 offset:23552
    s_waitcnt lgkmcnt(6)
    v_mfma_f32_32x32x16_bf16 v[16:31], v[224:227], v[176:179], v[16:31]
    ds_write_b32 v7, v248 offset:29440
    ds_read_b128 v[224:227], v2 offset:24576
    s_waitcnt lgkmcnt(6)
    v_mfma_f32_32x32x16_bf16 v[16:31], v[228:231], v[180:183], v[16:31]
    ds_write_b32 v7, v249 offset:31248
    ds_read_b128 v[228:231], v2 offset:25600
    s_waitcnt lgkmcnt(6)
    v_mfma_f32_32x32x16_bf16 v[16:31], v[232:235], v[184:187], v[16:31]
    ds_write_b32 v7, v250 offset:33056
    ds_read_b128 v[232:235], v2 offset:26624
    s_waitcnt lgkmcnt(6)
    v_mfma_f32_32x32x16_bf16 v[16:31], v[236:239], v[188:191], v[16:31]
    ds_write_b32 v7, v251 offset:34864
    ds_read_b128 v[236:239], v2 offset:27648
    s_waitcnt lgkmcnt(6)
    v_mfma_f32_32x32x16_bf16 v[16:31], v[224:227], v[192:195], v[16:31]
    ds_write_b32 v7, v252 offset:43904
    ds_read_b128 v[224:227], v2 offset:28672
    s_waitcnt lgkmcnt(6)
    v_mfma_f32_32x32x16_bf16 v[16:31], v[228:231], v[196:199], v[16:31]
    ds_write_b32 v7, v253 offset:45712
    ds_read_b128 v[228:231], v2 offset:29696
    s_waitcnt lgkmcnt(6)
    v_mfma_f32_32x32x16_bf16 v[16:31], v[232:235], v[200:203], v[16:31]
    ds_write_b32 v7, v254 offset:47520
    ds_read_b128 v[232:235], v2 offset:30720
    s_waitcnt lgkmcnt(6)
    v_mfma_f32_32x32x16_bf16 v[16:31], v[236:239], v[204:207], v[16:31]
    ds_write_b32 v7, v255 offset:49328
    ds_read_b128 v[236:239], v2 offset:31744
    s_waitcnt lgkmcnt(6)
    v_mfma_f32_32x32x16_bf16 v[16:31], v[224:227], v[208:211], v[16:31]
    ds_read_b128 v[224:227], v2 offset:32768
    s_waitcnt lgkmcnt(5)
    v_mfma_f32_32x32x16_bf16 v[16:31], v[228:231], v[212:215], v[16:31]
    ds_read_b128 v[228:231], v2 offset:33792
    s_waitcnt lgkmcnt(4)
    v_mfma_f32_32x32x16_bf16 v[16:31], v[232:235], v[216:219], v[16:31]
    ds_read_b128 v[232:235], v2 offset:34816
    s_waitcnt lgkmcnt(3)
    v_mfma_f32_32x32x16_bf16 v[16:31], v[236:239], v[220:223], v[16:31]
    ds_read_b128 v[236:239], v2 offset:35840
    s_waitcnt vmcnt(0)
    s_waitcnt lgkmcnt(3)
    v_mfma_f32_32x32x16_bf16 v[16:31], v[224:227], v[32:35], v[16:31]
    ds_read_b128 v[224:227], v2 offset:36864
    s_waitcnt lgkmcnt(3)
    v_mfma_f32_32x32x16_bf16 v[16:31], v[228:231], v[36:39], v[16:31]
    ds_read_b128 v[228:231], v2 offset:37888
    s_waitcnt lgkmcnt(3)
    v_mfma_f32_32x32x16_bf16 v[16:31], v[232:235], v[40:43], v[16:31]
    ds_read_b128 v[232:235], v2 offset:38912
    s_waitcnt lgkmcnt(3)
    v_mfma_f32_32x32x16_bf16 v[16:31], v[236:239], v[44:47], v[16:31]
    ds_read_b128 v[236:239], v2 offset:39936
    s_waitcnt lgkmcnt(3)
    v_mfma_f32_32x32x16_bf16 v[16:31], v[224:227], v[48:51], v[16:31]
    s_waitcnt lgkmcnt(2)
    v_mfma_f32_32x32x16_bf16 v[16:31], v[228:231], v[52:55], v[16:31]
    s_waitcnt lgkmcnt(1)
    v_mfma_f32_32x32x16_bf16 v[16:31], v[232:235], v[56:59], v[16:31]
    s_waitcnt lgkmcnt(0)
    v_mfma_f32_32x32x16_bf16 v[16:31], v[236:239], v[60:63], v[16:31]
    s_nop 11
    v_cvt_pk_bf16_f32 v9, v16, v17
    v_lshlrev_b32 v16, 16, v9
    v_and_b32 v17, 0xffff0000, v9
    v_cvt_pk_bf16_f32 v9, v18, v19
    v_lshlrev_b32 v18, 16, v9
    v_and_b32 v19, 0xffff0000, v9
    v_cvt_pk_bf16_f32 v9, v20, v21
    v_lshlrev_b32 v20, 16, v9
    v_and_b32 v21, 0xffff0000, v9
    v_cvt_pk_bf16_f32 v9, v22, v23
    v_lshlrev_b32 v22, 16, v9
    v_and_b32 v23, 0xffff0000, v9
    v_cvt_pk_bf16_f32 v9, v24, v25
    v_lshlrev_b32 v24, 16, v9
    v_and_b32 v25, 0xffff0000, v9
    v_cvt_pk_bf16_f32 v9, v26, v27
    v_lshlrev_b32 v26, 16, v9
    v_and_b32 v27, 0xffff0000, v9
    v_cvt_pk_bf16_f32 v9, v28, v29
    v_lshlrev_b32 v28, 16, v9
    v_and_b32 v29, 0xffff0000, v9
    v_cvt_pk_bf16_f32 v9, v30, v31
    v_lshlrev_b32 v30, 16, v9
    v_and_b32 v31, 0xffff0000, v9
    ds_write_b32 v7, v16 offset:1024
    ds_write_b32 v7, v17 offset:2832
    ds_write_b32 v7, v18 offset:4640
    ds_write_b32 v7, v19 offset:6448
    ds_write_b32 v7, v20 offset:15488
    ds_write_b32 v7, v21 offset:17296
    ds_write_b32 v7, v22 offset:19104
    ds_write_b32 v7, v23 offset:20912
    ds_write_b32 v7, v24 offset:29952
    ds_write_b32 v7, v25 offset:31760
    ds_write_b32 v7, v26 offset:33568
    ds_write_b32 v7, v27 offset:35376
    ds_write_b32 v7, v28 offset:44416
    ds_write_b32 v7, v29 offset:46224
    ds_write_b32 v7, v30 offset:48032
    ds_write_b32 v7, v31 offset:49840
oe_104:
    s_waitcnt lgkmcnt(0)
    s_barrier
    v_min_u32 v3, 55, v1
    v_lshrrev_b32 v4, 1, v3
    v_lshlrev_b32 v4, 4, v4
    v_and_b32 v5, 1, v3
    v_lshl_add_u32 v4, v5, 2, v4
    v_mul_u32_u24 v4, 2, v4
    v_lshlrev_b32 v5, 1, v4
    v_add_u32 v6, 128000, v5
    ds_read_b128 v[40:43], v6 offset:0
    ds_read_b128 v[44:47], v6 offset:32
    ds_read_b128 v[56:59], v6 offset:1792
    ds_read_b128 v[60:63], v6 offset:1824
    ds_read_b128 v[48:51], v6 offset:3584
    ds_read_b128 v[52:55], v6 offset:3616
    ds_read_b128 v[64:67], v6 offset:5376
    ds_read_b128 v[68:71], v6 offset:5408
    v_add_u32 v6, 135168, v4
    ds_read_b64 v[80:81], v6
    ds_read_b64 v[82:83], v6 offset:16
    s_mov_b32 s22, -1
    s_mov_b32 s23, 0x00ffffff
    s_waitcnt lgkmcnt(0)
    v_lshlrev_b32 v72, 16, v80
    v_and_b32 v73, 0xffff0000, v80
    v_lshlrev_b32 v74, 16, v81
    v_and_b32 v75, 0xffff0000, v81
    v_lshlrev_b32 v76, 16, v82
    v_and_b32 v77, 0xffff0000, v82
    v_lshlrev_b32 v78, 16, v83
    v_and_b32 v79, 0xffff0000, v83
    v_add_f32 v48, 1.0, v48
    v_add_f32 v49, 1.0, v49
    v_cvt_pk_bf16_f32 v6, v48, v49
    v_lshlrev_b32 v48, 16, v6
    v_and_b32 v49, 0xffff0000, v6
    v_add_f32 v50, 1.0, v50
    v_add_f32 v51, 1.0, v51
    v_cvt_pk_bf16_f32 v6, v50, v51
    v_lshlrev_b32 v50, 16, v6
    v_and_b32 v51, 0xffff0000, v6
    v_add_f32 v52, 1.0, v52
    v_add_f32 v53, 1.0, v53
    v_cvt_pk_bf16_f32 v6, v52, v53
    v_lshlrev_b32 v52, 16, v6
    v_and_b32 v53, 0xffff0000, v6
    v_add_f32 v54, 1.0, v54
    v_add_f32 v55, 1.0, v55
    v_cvt_pk_bf16_f32 v6, v54, v55
    v_lshlrev_b32 v54, 16, v6
    v_and_b32 v55, 0xffff0000, v6
    s_mov_b32 s16, s76
    s_mov_b32 s17, 0
orow_105:
    s_add_u32 s18, s16, s17
    s_lshl_b32 s19, s3, 5
    s_add_u32 s19, s19, s18
    s_mul_i32 s24, s19, 896
    s_mul_i32 s25, s18, 1808
    v_add_u32 v6, s25, v5
    s_mul_i32 s25, s18, 896
    s_add_u32 s25, s25, 99328
    v_add_u32 v34, s25, v4
    ds_read_b64 v[8:9], v34 offset:0
    ds_read_b64 v[10:11], v34 offset:16
    ds_read_b128 v[16:19], v6 offset:40960
    ds_read_b128 v[20:23], v6 offset:40992
    ds_read_b64 v[12:13], v34 offset:896
    ds_read_b64 v[14:15], v34 offset:912
    ds_read_b128 v[24:27], v6 offset:42768
    ds_read_b128 v[28:31], v6 offset:42800
    s_waitcnt lgkmcnt(0)
    v_mul_f32 v16, v16, v40
    v_mul_f32 v17, v17, v41
    v_cvt_pk_bf16_f32 v7, v16, v17
    v_lshlrev_b32 v16, 16, v7
    v_and_b32 v17, 0xffff0000, v7
    v_lshlrev_b32 v32, 16, v8
    v_and_b32 v33, 0xffff0000, v8
    v_add_f32 v16, v16, v32
    v_add_f32 v17, v17, v33
    v_cvt_pk_bf16_f32 v7, v16, v17
    v_lshlrev_b32 v16, 16, v7
    v_and_b32 v17, 0xffff0000, v7
    v_mul_f32 v18, v18, v42
    v_mul_f32 v19, v19, v43
    v_cvt_pk_bf16_f32 v7, v18, v19
    v_lshlrev_b32 v18, 16, v7
    v_and_b32 v19, 0xffff0000, v7
    v_lshlrev_b32 v32, 16, v9
    v_and_b32 v33, 0xffff0000, v9
    v_add_f32 v18, v18, v32
    v_add_f32 v19, v19, v33
    v_cvt_pk_bf16_f32 v7, v18, v19
    v_lshlrev_b32 v18, 16, v7
    v_and_b32 v19, 0xffff0000, v7
    v_mul_f32 v20, v20, v44
    v_mul_f32 v21, v21, v45
    v_cvt_pk_bf16_f32 v7, v20, v21
    v_lshlrev_b32 v20, 16, v7
    v_and_b32 v21, 0xffff0000, v7
    v_lshlrev_b32 v32, 16, v10
    v_and_b32 v33, 0xffff0000, v10
    v_add_f32 v20, v20, v32
    v_add_f32 v21, v21, v33
    v_cvt_pk_bf16_f32 v7, v20, v21
    v_lshlrev_b32 v20, 16, v7
    v_and_b32 v21, 0xffff0000, v7
    v_mul_f32 v22, v22, v46
    v_mul_f32 v23, v23, v47
    v_cvt_pk_bf16_f32 v7, v22, v23
    v_lshlrev_b32 v22, 16, v7
    v_and_b32 v23, 0xffff0000, v7
    v_lshlrev_b32 v32, 16, v11
    v_and_b32 v33, 0xffff0000, v11
    v_add_f32 v22, v22, v32
    v_add_f32 v23, v23, v33
    v_cvt_pk_bf16_f32 v7, v22, v23
    v_lshlrev_b32 v22, 16, v7
    v_and_b32 v23, 0xffff0000, v7
    v_cndmask_b32 v16, 0, v16, s[22:23]
    v_mov_b32 v84, v16
    v_cndmask_b32 v17, 0, v17, s[22:23]
    v_mov_b32 v85, v17
    v_cndmask_b32 v18, 0, v18, s[22:23]
    v_mov_b32 v86, v18
    v_cndmask_b32 v19, 0, v19, s[22:23]
    v_mov_b32 v87, v19
    v_cndmask_b32 v20, 0, v20, s[22:23]
    v_mov_b32 v88, v20
    v_cndmask_b32 v21, 0, v21, s[22:23]
    v_mov_b32 v89, v21
    v_cndmask_b32 v22, 0, v22, s[22:23]
    v_mov_b32 v90, v22
    v_cndmask_b32 v23, 0, v23, s[22:23]
    v_mov_b32 v91, v23
    v_mul_f32 v24, v24, v40
    v_mul_f32 v25, v25, v41
    v_cvt_pk_bf16_f32 v7, v24, v25
    v_lshlrev_b32 v24, 16, v7
    v_and_b32 v25, 0xffff0000, v7
    v_lshlrev_b32 v32, 16, v12
    v_and_b32 v33, 0xffff0000, v12
    v_add_f32 v24, v24, v32
    v_add_f32 v25, v25, v33
    v_cvt_pk_bf16_f32 v7, v24, v25
    v_lshlrev_b32 v24, 16, v7
    v_and_b32 v25, 0xffff0000, v7
    v_mul_f32 v26, v26, v42
    v_mul_f32 v27, v27, v43
    v_cvt_pk_bf16_f32 v7, v26, v27
    v_lshlrev_b32 v26, 16, v7
    v_and_b32 v27, 0xffff0000, v7
    v_lshlrev_b32 v32, 16, v13
    v_and_b32 v33, 0xffff0000, v13
    v_add_f32 v26, v26, v32
    v_add_f32 v27, v27, v33
    v_cvt_pk_bf16_f32 v7, v26, v27
    v_lshlrev_b32 v26, 16, v7
    v_and_b32 v27, 0xffff0000, v7
    v_mul_f32 v28, v28, v44
    v_mul_f32 v29, v29, v45
    v_cvt_pk_bf16_f32 v7, v28, v29
    v_lshlrev_b32 v28, 16, v7
    v_and_b32 v29, 0xffff0000, v7
    v_lshlrev_b32 v32, 16, v14
    v_and_b32 v33, 0xffff0000, v14
    v_add_f32 v28, v28, v32
    v_add_f32 v29, v29, v33
    v_cvt_pk_bf16_f32 v7, v28, v29
    v_lshlrev_b32 v28, 16, v7
    v_and_b32 v29, 0xffff0000, v7
    v_mul_f32 v30, v30, v46
    v_mul_f32 v31, v31, v47
    v_cvt_pk_bf16_f32 v7, v30, v31
    v_lshlrev_b32 v30, 16, v7
    v_and_b32 v31, 0xffff0000, v7
    v_lshlrev_b32 v32, 16, v15
    v_and_b32 v33, 0xffff0000, v15
    v_add_f32 v30, v30, v32
    v_add_f32 v31, v31, v33
    v_cvt_pk_bf16_f32 v7, v30, v31
    v_lshlrev_b32 v30, 16, v7
    v_and_b32 v31, 0xffff0000, v7
    v_cndmask_b32 v24, 0, v24, s[22:23]
    v_mov_b32 v92, v24
    v_cndmask_b32 v25, 0, v25, s[22:23]
    v_mov_b32 v93, v25
    v_cndmask_b32 v26, 0, v26, s[22:23]
    v_mov_b32 v94, v26
    v_cndmask_b32 v27, 0, v27, s[22:23]
    v_mov_b32 v95, v27
    v_cndmask_b32 v28, 0, v28, s[22:23]
    v_mov_b32 v96, v28
    v_cndmask_b32 v29, 0, v29, s[22:23]
    v_mov_b32 v97, v29
    v_cndmask_b32 v30, 0, v30, s[22:23]
    v_mov_b32 v98, v30
    v_cndmask_b32 v31, 0, v31, s[22:23]
    v_mov_b32 v99, v31
    v_add_f32 v32, v16, v17
    v_add_f32 v32, v32, v18
    v_add_f32 v32, v32, v19
    v_add_f32 v32, v32, v20
    v_add_f32 v32, v32, v21
    v_add_f32 v32, v32, v22
    v_add_f32 v32, v32, v23
    v_add_f32 v33, v24, v25
    v_add_f32 v33, v33, v26
    v_add_f32 v33, v33, v27
    v_add_f32 v33, v33, v28
    v_add_f32 v33, v33, v29
    v_add_f32 v33, v33, v30
    v_add_f32 v33, v33, v31
    s_nop 1
    v_add_f32_dpp v32, v32, v32 quad_perm:[1,0,3,2] row_mask:0xf bank_mask:0xf
    v_add_f32_dpp v33, v33, v33 quad_perm:[1,0,3,2] row_mask:0xf bank_mask:0xf
    s_nop 1
    v_add_f32_dpp v32, v32, v32 quad_perm:[2,3,0,1] row_mask:0xf bank_mask:0xf
    v_add_f32_dpp v33, v33, v33 quad_perm:[2,3,0,1] row_mask:0xf bank_mask:0xf
    s_nop 1
    v_add_f32_dpp v32, v32, v32 row_half_mirror row_mask:0xf bank_mask:0xf
    v_add_f32_dpp v33, v33, v33 row_half_mirror row_mask:0xf bank_mask:0xf
    s_nop 1
    v_add_f32_dpp v32, v32, v32 row_mirror row_mask:0xf bank_mask:0xf
    v_add_f32_dpp v33, v33, v33 row_mirror row_mask:0xf bank_mask:0xf
    v_mov_b32 v100, v32
    v_mov_b32 v101, v33
    s_nop 1
    v_permlane16_swap_b32 v32, v100
    v_permlane16_swap_b32 v33, v101
    s_nop 1
    v_add_f32 v32, v32, v100
    v_add_f32 v33, v33, v101
    v_mov_b32 v100, v32
    v_mov_b32 v101, v33
    s_nop 1
    v_permlane32_swap_b32 v32, v100
    v_permlane32_swap_b32 v33, v101
    s_nop 1
    v_add_f32 v32, v32, v100
    v_add_f32 v33, v33, v101
    s_mov_b32 s20, 0x3b124925
    v_mul_f32 v32, s20, v32
    v_mul_f32 v33, s20, v33
    v_sub_f32 v100, v16, v32
    v_mul_f32 v34, v100, v100
    v_sub_f32 v100, v17, v32
    v_fmac_f32 v34, v100, v100
    v_sub_f32 v100, v18, v32
    v_fmac_f32 v34, v100, v100
    v_sub_f32 v100, v19, v32
    v_fmac_f32 v34, v100, v100
    v_sub_f32 v100, v20, v32
    v_fmac_f32 v34, v100, v100
    v_sub_f32 v100, v21, v32
    v_fmac_f32 v34, v100, v100
    v_sub_f32 v100, v22, v32
    v_fmac_f32 v34, v100, v100
    v_sub_f32 v100, v23, v32
    v_fmac_f32 v34, v100, v100
    v_cndmask_b32 v34, 0, v34, s[22:23]
    v_sub_f32 v100, v24, v33
    v_mul_f32 v35, v100, v100
    v_sub_f32 v100, v25, v33
    v_fmac_f32 v35, v100, v100
    v_sub_f32 v100, v26, v33
    v_fmac_f32 v35, v100, v100
    v_sub_f32 v100, v27, v33
    v_fmac_f32 v35, v100, v100
    v_sub_f32 v100, v28, v33
    v_fmac_f32 v35, v100, v100
    v_sub_f32 v100, v29, v33
    v_fmac_f32 v35, v100, v100
    v_sub_f32 v100, v30, v33
    v_fmac_f32 v35, v100, v100
    v_sub_f32 v100, v31, v33
    v_fmac_f32 v35, v100, v100
    v_cndmask_b32 v35, 0, v35, s[22:23]
    s_nop 1
    v_add_f32_dpp v34, v34, v34 quad_perm:[1,0,3,2] row_mask:0xf bank_mask:0xf
    v_add_f32_dpp v35, v35, v35 quad_perm:[1,0,3,2] row_mask:0xf bank_mask:0xf
    s_nop 1
    v_add_f32_dpp v34, v34, v34 quad_perm:[2,3,0,1] row_mask:0xf bank_mask:0xf
    v_add_f32_dpp v35, v35, v35 quad_perm:[2,3,0,1] row_mask:0xf bank_mask:0xf
    s_nop 1
    v_add_f32_dpp v34, v34, v34 row_half_mirror row_mask:0xf bank_mask:0xf
    v_add_f32_dpp v35, v35, v35 row_half_mirror row_mask:0xf bank_mask:0xf
    s_nop 1
    v_add_f32_dpp v34, v34, v34 row_mirror row_mask:0xf bank_mask:0xf
    v_add_f32_dpp v35, v35, v35 row_mirror row_mask:0xf bank_mask:0xf
    v_mov_b32 v100, v34
    v_mov_b32 v101, v35
    s_nop 1
    v_permlane16_swap_b32 v34, v100
    v_permlane16_swap_b32 v35, v101
    s_nop 1
    v_add_f32 v34, v34, v100
    v_add_f32 v35, v35, v101
    v_mov_b32 v100, v34
    v_mov_b32 v101, v35
    s_nop 1
    v_permlane32_swap_b32 v34, v100
    v_permlane32_swap_b32 v35, v101
    s_nop 1
    v_add_f32 v34, v34, v100
    v_add_f32 v35, v35, v101
    v_mul_f32 v34, s20, v34
    v_cvt_pk_bf16_f32 v100, v32, v34
    v_lshlrev_b32 v32, 16, v100
    v_and_b32 v34, 0xffff0000, v100
    v_add_f32 v34, 0x3727c5ac, v34
    v_cvt_pk_bf16_f32 v100, v34, v34
    v_lshlrev_b32 v34, 16, v100
    v_sqrt_f32 v34, v34
    s_nop 0
    v_cvt_pk_bf16_f32 v100, v34, v34
    v_lshlrev_b32 v34, 16, v100
    v_rcp_f32 v34, v34
    s_nop 0
    v_mul_f32 v35, s20, v35
    v_cvt_pk_bf16_f32 v100, v33, v35
    v_lshlrev_b32 v33, 16, v100
    v_and_b32 v35, 0xffff0000, v100
    v_add_f32 v35, 0x3727c5ac, v35
    v_cvt_pk_bf16_f32 v100, v35, v35
    v_lshlrev_b32 v35, 16, v100
    v_sqrt_f32 v35, v35
    s_nop 0
    v_cvt_pk_bf16_f32 v100, v35, v35
    v_lshlrev_b32 v35, 16, v100
    v_rcp_f32 v35, v35
    s_nop 0
    v_sub_f32 v16, v16, v32
    v_sub_f32 v17, v17, v32
    v_cvt_pk_bf16_f32 v100, v16, v17
    v_lshlrev_b32 v16, 16, v100
    v_and_b32 v17, 0xffff0000, v100
    v_mul_f32 v16, v16, v34
    v_mul_f32 v17, v17, v34
    v_cvt_pk_bf16_f32 v100, v16, v17
    v_lshlrev_b32 v16, 16, v100
    v_and_b32 v17, 0xffff0000, v100
    v_mul_f32 v16, v16, v48
    v_mul_f32 v17, v17, v49
    v_cvt_pk_bf16_f32 v100, v16, v17
    v_lshlrev_b32 v16, 16, v100
    v_and_b32 v17, 0xffff0000, v100
    v_add_f32 v16, v16, v56
    v_add_f32 v17, v17, v57
    v_sub_f32 v18, v18, v32
    v_sub_f32 v19, v19, v32
    v_cvt_pk_bf16_f32 v100, v18, v19
    v_lshlrev_b32 v18, 16, v100
    v_and_b32 v19, 0xffff0000, v100
    v_mul_f32 v18, v18, v34
    v_mul_f32 v19, v19, v34
    v_cvt_pk_bf16_f32 v100, v18, v19
    v_lshlrev_b32 v18, 16, v100
    v_and_b32 v19, 0xffff0000, v100
    v_mul_f32 v18, v18, v50
    v_mul_f32 v19, v19, v51
    v_cvt_pk_bf16_f32 v100, v18, v19
    v_lshlrev_b32 v18, 16, v100
    v_and_b32 v19, 0xffff0000, v100
    v_add_f32 v18, v18, v58
    v_add_f32 v19, v19, v59
    v_sub_f32 v20, v20, v32
    v_sub_f32 v21, v21, v32
    v_cvt_pk_bf16_f32 v100, v20, v21
    v_lshlrev_b32 v20, 16, v100
    v_and_b32 v21, 0xffff0000, v100
    v_mul_f32 v20, v20, v34
    v_mul_f32 v21, v21, v34
    v_cvt_pk_bf16_f32 v100, v20, v21
    v_lshlrev_b32 v20, 16, v100
    v_and_b32 v21, 0xffff0000, v100
    v_mul_f32 v20, v20, v52
    v_mul_f32 v21, v21, v53
    v_cvt_pk_bf16_f32 v100, v20, v21
    v_lshlrev_b32 v20, 16, v100
    v_and_b32 v21, 0xffff0000, v100
    v_add_f32 v20, v20, v60
    v_add_f32 v21, v21, v61
    v_sub_f32 v22, v22, v32
    v_sub_f32 v23, v23, v32
    v_cvt_pk_bf16_f32 v100, v22, v23
    v_lshlrev_b32 v22, 16, v100
    v_and_b32 v23, 0xffff0000, v100
    v_mul_f32 v22, v22, v34
    v_mul_f32 v23, v23, v34
    v_cvt_pk_bf16_f32 v100, v22, v23
    v_lshlrev_b32 v22, 16, v100
    v_and_b32 v23, 0xffff0000, v100
    v_mul_f32 v22, v22, v54
    v_mul_f32 v23, v23, v55
    v_cvt_pk_bf16_f32 v100, v22, v23
    v_lshlrev_b32 v22, 16, v100
    v_and_b32 v23, 0xffff0000, v100
    v_add_f32 v22, v22, v62
    v_add_f32 v23, v23, v63
    v_sub_f32 v24, v24, v33
    v_sub_f32 v25, v25, v33
    v_cvt_pk_bf16_f32 v100, v24, v25
    v_lshlrev_b32 v24, 16, v100
    v_and_b32 v25, 0xffff0000, v100
    v_mul_f32 v24, v24, v35
    v_mul_f32 v25, v25, v35
    v_cvt_pk_bf16_f32 v100, v24, v25
    v_lshlrev_b32 v24, 16, v100
    v_and_b32 v25, 0xffff0000, v100
    v_mul_f32 v24, v24, v48
    v_mul_f32 v25, v25, v49
    v_cvt_pk_bf16_f32 v100, v24, v25
    v_lshlrev_b32 v24, 16, v100
    v_and_b32 v25, 0xffff0000, v100
    v_add_f32 v24, v24, v56
    v_add_f32 v25, v25, v57
    v_sub_f32 v26, v26, v33
    v_sub_f32 v27, v27, v33
    v_cvt_pk_bf16_f32 v100, v26, v27
    v_lshlrev_b32 v26, 16, v100
    v_and_b32 v27, 0xffff0000, v100
    v_mul_f32 v26, v26, v35
    v_mul_f32 v27, v27, v35
    v_cvt_pk_bf16_f32 v100, v26, v27
    v_lshlrev_b32 v26, 16, v100
    v_and_b32 v27, 0xffff0000, v100
    v_mul_f32 v26, v26, v50
    v_mul_f32 v27, v27, v51
    v_cvt_pk_bf16_f32 v100, v26, v27
    v_lshlrev_b32 v26, 16, v100
    v_and_b32 v27, 0xffff0000, v100
    v_add_f32 v26, v26, v58
    v_add_f32 v27, v27, v59
    v_sub_f32 v28, v28, v33
    v_sub_f32 v29, v29, v33
    v_cvt_pk_bf16_f32 v100, v28, v29
    v_lshlrev_b32 v28, 16, v100
    v_and_b32 v29, 0xffff0000, v100
    v_mul_f32 v28, v28, v35
    v_mul_f32 v29, v29, v35
    v_cvt_pk_bf16_f32 v100, v28, v29
    v_lshlrev_b32 v28, 16, v100
    v_and_b32 v29, 0xffff0000, v100
    v_mul_f32 v28, v28, v52
    v_mul_f32 v29, v29, v53
    v_cvt_pk_bf16_f32 v100, v28, v29
    v_lshlrev_b32 v28, 16, v100
    v_and_b32 v29, 0xffff0000, v100
    v_add_f32 v28, v28, v60
    v_add_f32 v29, v29, v61
    v_sub_f32 v30, v30, v33
    v_sub_f32 v31, v31, v33
    v_cvt_pk_bf16_f32 v100, v30, v31
    v_lshlrev_b32 v30, 16, v100
    v_and_b32 v31, 0xffff0000, v100
    v_mul_f32 v30, v30, v35
    v_mul_f32 v31, v31, v35
    v_cvt_pk_bf16_f32 v100, v30, v31
    v_lshlrev_b32 v30, 16, v100
    v_and_b32 v31, 0xffff0000, v100
    v_mul_f32 v30, v30, v54
    v_mul_f32 v31, v31, v55
    v_cvt_pk_bf16_f32 v100, v30, v31
    v_lshlrev_b32 v30, 16, v100
    v_and_b32 v31, 0xffff0000, v100
    v_add_f32 v30, v30, v62
    v_add_f32 v31, v31, v63
    v_cvt_pk_bf16_f32 v7, v16, v17
    v_lshlrev_b32 v16, 16, v7
    v_and_b32 v17, 0xffff0000, v7
    v_cvt_pk_bf16_f32 v7, v18, v19
    v_lshlrev_b32 v18, 16, v7
    v_and_b32 v19, 0xffff0000, v7
    v_cvt_pk_bf16_f32 v7, v20, v21
    v_lshlrev_b32 v20, 16, v7
    v_and_b32 v21, 0xffff0000, v7
    v_cvt_pk_bf16_f32 v7, v22, v23
    v_lshlrev_b32 v22, 16, v7
    v_and_b32 v23, 0xffff0000, v7
    v_mul_f32 v32, v16, v72
    v_fmac_f32 v32, v17, v73
    v_fmac_f32 v32, v18, v74
    v_fmac_f32 v32, v19, v75
    v_fmac_f32 v32, v20, v76
    v_fmac_f32 v32, v21, v77
    v_fmac_f32 v32, v22, v78
    v_fmac_f32 v32, v23, v79
    v_cndmask_b32 v32, 0, v32, s[22:23]
    v_cvt_pk_bf16_f32 v7, v24, v25
    v_lshlrev_b32 v24, 16, v7
    v_and_b32 v25, 0xffff0000, v7
    v_cvt_pk_bf16_f32 v7, v26, v27
    v_lshlrev_b32 v26, 16, v7
    v_and_b32 v27, 0xffff0000, v7
    v_cvt_pk_bf16_f32 v7, v28, v29
    v_lshlrev_b32 v28, 16, v7
    v_and_b32 v29, 0xffff0000, v7
    v_cvt_pk_bf16_f32 v7, v30, v31
    v_lshlrev_b32 v30, 16, v7
    v_and_b32 v31, 0xffff0000, v7
    v_mul_f32 v33, v24, v72
    v_fmac_f32 v33, v25, v73
    v_fmac_f32 v33, v26, v74
    v_fmac_f32 v33, v27, v75
    v_fmac_f32 v33, v28, v76
    v_fmac_f32 v33, v29, v77
    v_fmac_f32 v33, v30, v78
    v_fmac_f32 v33, v31, v79
    v_cndmask_b32 v33, 0, v33, s[22:23]
    s_nop 1
    v_add_f32_dpp v32, v32, v32 quad_perm:[1,0,3,2] row_mask:0xf bank_mask:0xf
    v_add_f32_dpp v33, v33, v33 quad_perm:[1,0,3,2] row_mask:0xf bank_mask:0xf
    s_nop 1
    v_add_f32_dpp v32, v32, v32 quad_perm:[2,3,0,1] row_mask:0xf bank_mask:0xf
    v_add_f32_dpp v33, v33, v33 quad_perm:[2,3,0,1] row_mask:0xf bank_mask:0xf
    s_nop 1
    v_add_f32_dpp v32, v32, v32 row_half_mirror row_mask:0xf bank_mask:0xf
    v_add_f32_dpp v33, v33, v33 row_half_mirror row_mask:0xf bank_mask:0xf
    s_nop 1
    v_add_f32_dpp v32, v32, v32 row_mirror row_mask:0xf bank_mask:0xf
    v_add_f32_dpp v33, v33, v33 row_mirror row_mask:0xf bank_mask:0xf
    v_mov_b32 v100, v32
    v_mov_b32 v101, v33
    s_nop 1
    v_permlane16_swap_b32 v32, v100
    v_permlane16_swap_b32 v33, v101
    s_nop 1
    v_add_f32 v32, v32, v100
    v_add_f32 v33, v33, v101
    v_mov_b32 v100, v32
    v_mov_b32 v101, v33
    s_nop 1
    v_permlane32_swap_b32 v32, v100
    v_permlane32_swap_b32 v33, v101
    s_nop 1
    v_add_f32 v32, v32, v100
    v_add_f32 v33, v33, v101
    v_cvt_pk_bf16_f32 v7, v32, v33
    v_lshlrev_b32 v32, 16, v7
    v_and_b32 v33, 0xffff0000, v7
    s_mov_b64 exec, s[22:23]
    v_cvt_pk_bf16_f32 v108, v16, v17
    v_cvt_pk_bf16_f32 v112, v84, v85
    v_cvt_pk_bf16_f32 v109, v18, v19
    v_cvt_pk_bf16_f32 v113, v86, v87
    v_cvt_pk_bf16_f32 v110, v20, v21
    v_cvt_pk_bf16_f32 v114, v88, v89
    v_cvt_pk_bf16_f32 v111, v22, v23
    v_cvt_pk_bf16_f32 v115, v90, v91
    s_add_u32 s25, s24, 87072768
    buffer_store_dwordx2 v[108:109], v4, s[4:7], s25 offen sc1
    buffer_store_dwordx2 v[110:111], v4, s[4:7], s25 offen offset:16 sc1
    s_add_u32 s25, s24, 88907776
    buffer_store_dwordx2 v[112:113], v4, s[4:7], s25 offen sc1
    buffer_store_dwordx2 v[114:115], v4, s[4:7], s25 offen offset:16 sc1
    v_mul_f32 v16, v16, v64
    v_mul_f32 v17, v17, v65
    v_cvt_pk_bf16_f32 v7, v16, v17
    v_lshlrev_b32 v16, 16, v7
    v_and_b32 v17, 0xffff0000, v7
    v_add_f32 v16, v16, v84
    v_add_f32 v17, v17, v85
    v_mul_f32 v18, v18, v66
    v_mul_f32 v19, v19, v67
    v_cvt_pk_bf16_f32 v7, v18, v19
    v_lshlrev_b32 v18, 16, v7
    v_and_b32 v19, 0xffff0000, v7
    v_add_f32 v18, v18, v86
    v_add_f32 v19, v19, v87
    v_mul_f32 v20, v20, v68
    v_mul_f32 v21, v21, v69
    v_cvt_pk_bf16_f32 v7, v20, v21
    v_lshlrev_b32 v20, 16, v7
    v_and_b32 v21, 0xffff0000, v7
    v_add_f32 v20, v20, v88
    v_add_f32 v21, v21, v89
    v_mul_f32 v22, v22, v70
    v_mul_f32 v23, v23, v71
    v_cvt_pk_bf16_f32 v7, v22, v23
    v_lshlrev_b32 v22, 16, v7
    v_and_b32 v23, 0xffff0000, v7
    v_add_f32 v22, v22, v90
    v_add_f32 v23, v23, v91
    v_cvt_pk_bf16_f32 v124, v16, v17
    v_cvt_pk_bf16_f32 v125, v18, v19
    v_cvt_pk_bf16_f32 v126, v20, v21
    v_cvt_pk_bf16_f32 v127, v22, v23
    buffer_store_dwordx2 v[124:125], v4, s[12:15], s24 offen offset:0 sc1
    buffer_store_dwordx2 v[126:127], v4, s[12:15], s24 offen offset:16 sc1
    v_cvt_pk_bf16_f32 v116, v24, v25
    v_cvt_pk_bf16_f32 v120, v92, v93
    v_cvt_pk_bf16_f32 v117, v26, v27
    v_cvt_pk_bf16_f32 v121, v94, v95
    v_cvt_pk_bf16_f32 v118, v28, v29
    v_cvt_pk_bf16_f32 v122, v96, v97
    v_cvt_pk_bf16_f32 v119, v30, v31
    v_cvt_pk_bf16_f32 v123, v98, v99
    s_add_u32 s25, s24, 87073664
    buffer_store_dwordx2 v[116:117], v4, s[4:7], s25 offen sc1
    buffer_store_dwordx2 v[118:119], v4, s[4:7], s25 offen offset:16 sc1
    s_add_u32 s25, s24, 88908672
    buffer_store_dwordx2 v[120:121], v4, s[4:7], s25 offen sc1
    buffer_store_dwordx2 v[122:123], v4, s[4:7], s25 offen offset:16 sc1
    v_mul_f32 v24, v24, v64
    v_mul_f32 v25, v25, v65
    v_cvt_pk_bf16_f32 v7, v24, v25
    v_lshlrev_b32 v24, 16, v7
    v_and_b32 v25, 0xffff0000, v7
    v_add_f32 v24, v24, v92
    v_add_f32 v25, v25, v93
    v_mul_f32 v26, v26, v66
    v_mul_f32 v27, v27, v67
    v_cvt_pk_bf16_f32 v7, v26, v27
    v_lshlrev_b32 v26, 16, v7
    v_and_b32 v27, 0xffff0000, v7
    v_add_f32 v26, v26, v94
    v_add_f32 v27, v27, v95
    v_mul_f32 v28, v28, v68
    v_mul_f32 v29, v29, v69
    v_cvt_pk_bf16_f32 v7, v28, v29
    v_lshlrev_b32 v28, 16, v7
    v_and_b32 v29, 0xffff0000, v7
    v_add_f32 v28, v28, v96
    v_add_f32 v29, v29, v97
    v_mul_f32 v30, v30, v70
    v_mul_f32 v31, v31, v71
    v_cvt_pk_bf16_f32 v7, v30, v31
    v_lshlrev_b32 v30, 16, v7
    v_and_b32 v31, 0xffff0000, v7
    v_add_f32 v30, v30, v98
    v_add_f32 v31, v31, v99
    v_cvt_pk_bf16_f32 v128, v24, v25
    v_cvt_pk_bf16_f32 v129, v26, v27
    v_cvt_pk_bf16_f32 v130, v28, v29
    v_cvt_pk_bf16_f32 v131, v30, v31
    buffer_store_dwordx2 v[128:129], v4, s[12:15], s24 offen offset:896 sc1
    buffer_store_dwordx2 v[130:131], v4, s[12:15], s24 offen offset:912 sc1
    s_cmp_lg_u32 s77, 2
    s_cbranch_scc1 rbw_106
    s_waitcnt vmcnt(0)
rbw_106:
    s_mov_b64 exec, 1
    s_lshl_b32 s25, s19, 2
    s_add_u32 s25, s25, 87064576
    v_mov_b32 v7, 0
    buffer_store_dwordx2 v[32:33], v7, s[4:7], s25 offen sc1
    s_mov_b64 exec, -1
    s_add_u32 s17, s17, 2
    s_cmp_lt_u32 s17, s77
    s_cbranch_scc1 orow_105
    s_cmp_ge_u32 s3, 56
    s_cbranch_scc1 tailsig_107
    s_mov_b32 s93, 90974720
    s_waitcnt vmcnt(0)
    s_barrier
    s_cmp_lg_u32 s87, 0
    s_cbranch_scc1 sig_108
    v_mov_b32 v250, 0
    v_mov_b32 v251, 1
    s_mov_b64 exec, 1
    buffer_atomic_add v251, v250, s[4:7], s93 offen
    s_mov_b64 exec, -1
sig_108:
tailsig_107:
L_moe:
    s_cmp_ge_u32 s84, 58
    s_cbranch_scc1 L_done
    s_mov_b32 s59, 0
L_moe_round:
    s_barrier
    s_mov_b32 s58, 256
    s_cmp_eq_u32 s59, 0
    s_cselect_b32 s58, 224, s58
    s_cmp_ge_u32 s84, 56
    s_cbranch_scc1 nopf_109
    s_mov_b32 s3, s84
    s_load_dwordx2 s[8:9], s[0:1], 72
    s_waitcnt lgkmcnt(0)
    s_and_b32 s9, s9, 0xffff
    s_mov_b32 s10, 1605632
    s_mov_b32 s11, 0x20000
    s_load_dwordx2 s[12:13], s[0:1], 80
    s_waitcnt lgkmcnt(0)
    s_and_b32 s13, s13, 0xffff
    s_mov_b32 s14, 1605632
    s_mov_b32 s15, 0x20000
    s_load_dwordx2 s[28:29], s[0:1], 88
    s_waitcnt lgkmcnt(0)
    s_and_b32 s29, s29, 0xffff
    s_mov_b32 s30, 1605632
    s_mov_b32 s31, 0x20000
    v_and_b32 v4, 15, v0
    v_lshrrev_b32 v5, 4, v0
    v_mul_u32_u24 v6, 100352, v5
    v_lshl_add_u32 v6, v4, 2, v6
    s_lshl_b32 s18, s3, 6
    s_add_u32 s19, s18, 0
    buffer_load_dword v32, v6, s[8:11], s19 offen
    buffer_load_dword v64, v6, s[12:15], s19 offen
    s_add_u32 s19, s18, 3584
    buffer_load_dword v33, v6, s[8:11], s19 offen
    buffer_load_dword v65, v6, s[12:15], s19 offen
    s_add_u32 s19, s18, 7168
    buffer_load_dword v34, v6, s[8:11], s19 offen
    buffer_load_dword v66, v6, s[12:15], s19 offen
    s_add_u32 s19, s18, 10752
    buffer_load_dword v35, v6, s[8:11], s19 offen
    buffer_load_dword v67, v6, s[12:15], s19 offen
    s_add_u32 s19, s18, 14336
    buffer_load_dword v36, v6, s[8:11], s19 offen
    buffer_load_dword v68, v6, s[12:15], s19 offen
    s_add_u32 s19, s18, 17920
    buffer_load_dword v37, v6, s[8:11], s19 offen
    buffer_load_dword v69, v6, s[12:15], s19 offen
    s_add_u32 s19, s18, 21504
    buffer_load_dword v38, v6, s[8:11], s19 offen
    buffer_load_dword v70, v6, s[12:15], s19 offen
    s_add_u32 s19, s18, 25088
    buffer_load_dword v39, v6, s[8:11], s19 offen
    buffer_load_dword v71, v6, s[12:15], s19 offen
    s_add_u32 s19, s18, 28672
    buffer_load_dword v40, v6, s[8:11], s19 offen
    buffer_load_dword v72, v6, s[12:15], s19 offen
    s_add_u32 s19, s18, 32256
    buffer_load_dword v41, v6, s[8:11], s19 offen
    buffer_load_dword v73, v6, s[12:15], s19 offen
    s_add_u32 s19, s18, 35840
    buffer_load_dword v42, v6, s[8:11], s19 offen
    buffer_load_dword v74, v6, s[12:15], s19 offen
    s_add_u32 s19, s18, 39424
    buffer_load_dword v43, v6, s[8:11], s19 offen
    buffer_load_dword v75, v6, s[12:15], s19 offen
    s_add_u32 s19, s18, 43008
    buffer_load_dword v44, v6, s[8:11], s19 offen
    buffer_load_dword v76, v6, s[12:15], s19 offen
    s_add_u32 s19, s18, 46592
    buffer_load_dword v45, v6, s[8:11], s19 offen
    buffer_load_dword v77, v6, s[12:15], s19 offen
    s_add_u32 s19, s18, 50176
    buffer_load_dword v46, v6, s[8:11], s19 offen
    buffer_load_dword v78, v6, s[12:15], s19 offen
    s_add_u32 s19, s18, 53760
    buffer_load_dword v47, v6, s[8:11], s19 offen
    buffer_load_dword v79, v6, s[12:15], s19 offen
    s_add_u32 s19, s18, 57344
    buffer_load_dword v48, v6, s[8:11], s19 offen
    buffer_load_dword v80, v6, s[12:15], s19 offen
    s_add_u32 s19, s18, 60928
    buffer_load_dword v49, v6, s[8:11], s19 offen
    buffer_load_dword v81, v6, s[12:15], s19 offen
    s_add_u32 s19, s18, 64512
    buffer_load_dword v50, v6, s[8:11], s19 offen
    buffer_load_dword v82, v6, s[12:15], s19 offen
    s_add_u32 s19, s18, 68096
    buffer_load_dword v51, v6, s[8:11], s19 offen
    buffer_load_dword v83, v6, s[12:15], s19 offen
    s_add_u32 s19, s18, 71680
    buffer_load_dword v52, v6, s[8:11], s19 offen
    buffer_load_dword v84, v6, s[12:15], s19 offen
    s_waitcnt vmcnt(30)
    s_add_u32 s19, s18, 75264
    buffer_load_dword v53, v6, s[8:11], s19 offen
    buffer_load_dword v85, v6, s[12:15], s19 offen
    s_add_u32 s19, s18, 78848
    buffer_load_dword v54, v6, s[8:11], s19 offen
    buffer_load_dword v86, v6, s[12:15], s19 offen
    s_add_u32 s19, s18, 82432
    buffer_load_dword v55, v6, s[8:11], s19 offen
    buffer_load_dword v87, v6, s[12:15], s19 offen
    s_add_u32 s19, s18, 86016
    buffer_load_dword v56, v6, s[8:11], s19 offen
    buffer_load_dword v88, v6, s[12:15], s19 offen
    s_add_u32 s19, s18, 89600
    buffer_load_dword v57, v6, s[8:11], s19 offen
    buffer_load_dword v89, v6, s[12:15], s19 offen
    s_add_u32 s19, s18, 93184
    buffer_load_dword v58, v6, s[8:11], s19 offen
    buffer_load_dword v90, v6, s[12:15], s19 offen
    s_add_u32 s19, s18, 96768
    buffer_load_dword v59, v6, s[8:11], s19 offen
    buffer_load_dword v91, v6, s[12:15], s19 offen
    v_min_u32 v3, 223, v0
    v_lshlrev_b32 v3, 2, v3
    s_mul_i32 s18, s3, 28672
    s_waitcnt vmcnt(24)
    s_add_u32 s19, s18, 0
    buffer_load_dword v160, v3, s[28:31], s19 offen
    s_add_u32 s19, s18, 896
    buffer_load_dword v161, v3, s[28:31], s19 offen
    s_add_u32 s19, s18, 1792
    buffer_load_dword v162, v3, s[28:31], s19 offen
    s_add_u32 s19, s18, 2688
    buffer_load_dword v163, v3, s[28:31], s19 offen
    s_add_u32 s19, s18, 3584
    buffer_load_dword v164, v3, s[28:31], s19 offen
    s_add_u32 s19, s18, 4480
    buffer_load_dword v165, v3, s[28:31], s19 offen
    s_add_u32 s19, s18, 5376
    buffer_load_dword v166, v3, s[28:31], s19 offen
    s_add_u32 s19, s18, 6272
    buffer_load_dword v167, v3, s[28:31], s19 offen
    s_add_u32 s19, s18, 7168
    buffer_load_dword v168, v3, s[28:31], s19 offen
    s_add_u32 s19, s18, 8064
    buffer_load_dword v169, v3, s[28:31], s19 offen
    s_add_u32 s19, s18, 8960
    buffer_load_dword v170, v3, s[28:31], s19 offen
    s_add_u32 s19, s18, 9856
    buffer_load_dword v171, v3, s[28:31], s19 offen
    s_add_u32 s19, s18, 10752
    buffer_load_dword v172, v3, s[28:31], s19 offen
    s_add_u32 s19, s18, 11648
    buffer_load_dword v173, v3, s[28:31], s19 offen
    s_add_u32 s19, s18, 12544
    buffer_load_dword v174, v3, s[28:31], s19 offen
    s_add_u32 s19, s18, 13440
    buffer_load_dword v175, v3, s[28:31], s19 offen
    s_add_u32 s19, s18, 14336
    buffer_load_dword v176, v3, s[28:31], s19 offen
    s_add_u32 s19, s18, 15232
    buffer_load_dword v177, v3, s[28:31], s19 offen
    s_add_u32 s19, s18, 16128
    buffer_load_dword v178, v3, s[28:31], s19 offen
    s_add_u32 s19, s18, 17024
    buffer_load_dword v179, v3, s[28:31], s19 offen
    s_add_u32 s19, s18, 17920
    buffer_load_dword v180, v3, s[28:31], s19 offen
    s_add_u32 s19, s18, 18816
    buffer_load_dword v181, v3, s[28:31], s19 offen
    s_add_u32 s19, s18, 19712
    buffer_load_dword v182, v3, s[28:31], s19 offen
    s_add_u32 s19, s18, 20608
    buffer_load_dword v183, v3, s[28:31], s19 offen
    s_add_u32 s19, s18, 21504
    buffer_load_dword v184, v3, s[28:31], s19 offen
    s_add_u32 s19, s18, 22400
    buffer_load_dword v185, v3, s[28:31], s19 offen
    s_add_u32 s19, s18, 23296
    buffer_load_dword v186, v3, s[28:31], s19 offen
    s_add_u32 s19, s18, 24192
    buffer_load_dword v187, v3, s[28:31], s19 offen
    s_add_u32 s19, s18, 25088
    buffer_load_dword v188, v3, s[28:31], s19 offen
    s_add_u32 s19, s18, 25984
    buffer_load_dword v189, v3, s[28:31], s19 offen
    s_add_u32 s19, s18, 26880
    buffer_load_dword v190, v3, s[28:31], s19 offen
    s_add_u32 s19, s18, 27776
    buffer_load_dword v191, v3, s[28:31], s19 offen
    s_waitcnt vmcnt(0)
nopf_109:
    s_mov_b32 s91, 90974720
    s_cmp_lg_u32 s87, 0
    s_cbranch_scc1 wsk_112
    s_mov_b32 s90, 0
    v_mov_b32 v250, 0
wge_110:
    buffer_load_dword v251, v250, s[4:7], s91 offen sc1
    s_waitcnt vmcnt(0)
    v_readfirstlane_b32 s92, v251
    s_nop 3
    s_cmp_ge_u32 s92, 56
    s_cbranch_scc1 wok_111
    s_cmp_ge_u32 s92, 52
    s_cbranch_scc1 wnr_113
    s_sleep 64
wnr_113:
    s_sleep 4
    s_add_u32 s90, s90, 1
    s_cmp_lt_u32 s90, 400000
    s_cbranch_scc1 wge_110
    s_branch L_abort
wok_111:
wsk_112:
    s_barrier
    s_cmp_ge_u32 s84, 56
    s_cbranch_scc1 L_moe2
    s_mov_b32 s3, s84
    v_lshlrev_b32 v2, 5, v0
    s_mov_b32 s16, 87064576
    buffer_load_dwordx4 v[8:11], v2, s[4:7], s16 offen sc1
    buffer_load_dwordx4 v[12:15], v2, s[4:7], s16 offen offset:16 sc1
    v_lshlrev_b32 v3, 3, v0
    s_waitcnt vmcnt(0)
    v_cmp_le_u32 vcc, s58, v0
    v_mov_b32 v19, 0xff800000
    s_nop 0
    v_cndmask_b32 v8, v8, v19, vcc
    v_cndmask_b32 v9, v9, v19, vcc
    v_cndmask_b32 v10, v10, v19, vcc
    v_cndmask_b32 v11, v11, v19, vcc
    v_cndmask_b32 v12, v12, v19, vcc
    v_cndmask_b32 v13, v13, v19, vcc
    v_cndmask_b32 v14, v14, v19, vcc
    v_cndmask_b32 v15, v15, v19, vcc
    v_mov_b32 v16, v8
    v_mov_b32 v17, v3
    v_cmp_gt_f32 vcc, v9, v16
    v_add_u32 v18, 1, v3
    s_nop 0
    v_cndmask_b32 v16, v16, v9, vcc
    v_cndmask_b32 v17, v17, v18, vcc
    v_cmp_gt_f32 vcc, v10, v16
    v_add_u32 v18, 2, v3
    s_nop 0
    v_cndmask_b32 v16, v16, v10, vcc
    v_cndmask_b32 v17, v17, v18, vcc
    v_cmp_gt_f32 vcc, v11, v16
    v_add_u32 v18, 3, v3
    s_nop 0
    v_cndmask_b32 v16, v16, v11, vcc
    v_cndmask_b32 v17, v17, v18, vcc
    v_cmp_gt_f32 vcc, v12, v16
    v_add_u32 v18, 4, v3
    s_nop 0
    v_cndmask_b32 v16, v16, v12, vcc
    v_cndmask_b32 v17, v17, v18, vcc
    v_cmp_gt_f32 vcc, v13, v16
    v_add_u32 v18, 5, v3
    s_nop 0
    v_cndmask_b32 v16, v16, v13, vcc
    v_cndmask_b32 v17, v17, v18, vcc
    v_cmp_gt_f32 vcc, v14, v16
    v_add_u32 v18, 6, v3
    s_nop 0
    v_cndmask_b32 v16, v16, v14, vcc
    v_cndmask_b32 v17, v17, v18, vcc
    v_cmp_gt_f32 vcc, v15, v16
    v_add_u32 v18, 7, v3
    s_nop 0
    v_cndmask_b32 v16, v16, v15, vcc
    v_cndmask_b32 v17, v17, v18, vcc
    s_nop 1
    v_mov_b32_dpp v18, v16 quad_perm:[1,0,3,2] row_mask:0xf bank_mask:0xf
    v_mov_b32_dpp v19, v17 quad_perm:[1,0,3,2] row_mask:0xf bank_mask:0xf
    v_cmp_gt_f32 vcc, v18, v16
    v_cmp_eq_f32 s[44:45], v18, v16
    v_cmp_lt_u32 s[46:47], v19, v17
    s_nop 1
    s_and_b64 s[44:45], s[44:45], s[46:47]
    s_or_b64 vcc, vcc, s[44:45]
    v_cndmask_b32 v16, v16, v18, vcc
    v_cndmask_b32 v17, v17, v19, vcc
    s_nop 1
    v_mov_b32_dpp v18, v16 quad_perm:[2,3,0,1] row_mask:0xf bank_mask:0xf
    v_mov_b32_dpp v19, v17 quad_perm:[2,3,0,1] row_mask:0xf bank_mask:0xf
    v_cmp_gt_f32 vcc, v18, v16
    v_cmp_eq_f32 s[44:45], v18, v16
    v_cmp_lt_u32 s[46:47], v19, v17
    s_nop 1
    s_and_b64 s[44:45], s[44:45], s[46:47]
    s_or_b64 vcc, vcc, s[44:45]
    v_cndmask_b32 v16, v16, v18, vcc
    v_cndmask_b32 v17, v17, v19, vcc
    s_nop 1
    v_mov_b32_dpp v18, v16 row_half_mirror row_mask:0xf bank_mask:0xf
    v_mov_b32_dpp v19, v17 row_half_mirror row_mask:0xf bank_mask:0xf
    v_cmp_gt_f32 vcc, v18, v16
    v_cmp_eq_f32 s[44:45], v18, v16
    v_cmp_lt_u32 s[46:47], v19, v17
    s_nop 1
    s_and_b64 s[44:45], s[44:45], s[46:47]
    s_or_b64 vcc, vcc, s[44:45]
    v_cndmask_b32 v16, v16, v18, vcc
    v_cndmask_b32 v17, v17, v19, vcc
    s_nop 1
    v_mov_b32_dpp v18, v16 row_mirror row_mask:0xf bank_mask:0xf
    v_mov_b32_dpp v19, v17 row_mirror row_mask:0xf bank_mask:0xf
    v_cmp_gt_f32 vcc, v18, v16
    v_cmp_eq_f32 s[44:45], v18, v16
    v_cmp_lt_u32 s[46:47], v19, v17
    s_nop 1
    s_and_b64 s[44:45], s[44:45], s[46:47]
    s_or_b64 vcc, vcc, s[44:45]
    v_cndmask_b32 v16, v16, v18, vcc
    v_cndmask_b32 v17, v17, v19, vcc
    v_mov_b32 v18, v16
    v_mov_b32 v19, v17
    v_mov_b32 v20, v16
    v_mov_b32 v21, v17
    s_nop 1
    v_permlane16_swap_b32 v18, v20
    v_permlane16_swap_b32 v19, v21
    s_nop 1
    v_cmp_gt_f32 vcc, v20, v18
    v_cmp_eq_f32 s[44:45], v20, v18
    v_cmp_lt_u32 s[46:47], v21, v19
    s_nop 1
    s_and_b64 s[44:45], s[44:45], s[46:47]
    s_or_b64 vcc, vcc, s[44:45]
    v_cndmask_b32 v18, v18, v20, vcc
    v_cndmask_b32 v19, v19, v21, vcc
    v_cmp_gt_f32 vcc, v18, v16
    v_cmp_eq_f32 s[44:45], v18, v16
    v_cmp_lt_u32 s[46:47], v19, v17
    s_nop 1
    s_and_b64 s[44:45], s[44:45], s[46:47]
    s_or_b64 vcc, vcc, s[44:45]
    v_cndmask_b32 v16, v16, v18, vcc
    v_cndmask_b32 v17, v17, v19, vcc
    v_mov_b32 v18, v16
    v_mov_b32 v19, v17
    v_mov_b32 v20, v16
    v_mov_b32 v21, v17
    s_nop 1
    v_permlane32_swap_b32 v18, v20
    v_permlane32_swap_b32 v19, v21
    s_nop 1
    v_cmp_gt_f32 vcc, v20, v18
    v_cmp_eq_f32 s[44:45], v20, v18
    v_cmp_lt_u32 s[46:47], v21, v19
    s_nop 1
    s_and_b64 s[44:45], s[44:45], s[46:47]
    s_or_b64 vcc, vcc, s[44:45]
    v_cndmask_b32 v18, v18, v20, vcc
    v_cndmask_b32 v19, v19, v21, vcc
    v_cmp_gt_f32 vcc, v18, v16
    v_cmp_eq_f32 s[44:45], v18, v16
    v_cmp_lt_u32 s[46:47], v19, v17
    s_nop 1
    s_and_b64 s[44:45], s[44:45], s[46:47]
    s_or_b64 vcc, vcc, s[44:45]
    v_cndmask_b32 v16, v16, v18, vcc
    v_cndmask_b32 v17, v17, v19, vcc
    v_lshrrev_b32 v18, 6, v0
    v_lshlrev_b32 v18, 3, v18
    s_barrier
    ds_write_b64 v18, v[16:17]
    s_waitcnt lgkmcnt(0)
    s_barrier
    v_mov_b32 v18, 0
    ds_read_b128 v[20:23], v18
    ds_read_b128 v[24:27], v18 offset:16
    s_waitcnt lgkmcnt(0)
    v_mov_b32 v16, v20
    v_mov_b32 v17, v21
    v_cmp_gt_f32 vcc, v22, v16
    s_nop 1
    v_cndmask_b32 v16, v16, v22, vcc
    v_cndmask_b32 v17, v17, v23, vcc
    v_cmp_gt_f32 vcc, v24, v16
    s_nop 1
    v_cndmask_b32 v16, v16, v24, vcc
    v_cndmask_b32 v17, v17, v25, vcc
    v_cmp_gt_f32 vcc, v26, v16
    s_nop 1
    v_cndmask_b32 v16, v16, v26, vcc
    v_cndmask_b32 v17, v17, v27, vcc
    s_nop 0
    v_readfirstlane_b32 s40, v17
    v_readfirstlane_b32 s42, v16
    s_nop 3
    v_mov_b32 v19, 0xff800000
    v_add_u32 v18, 0, v3
    v_cmp_eq_u32 vcc, s40, v18
    s_nop 1
    v_cndmask_b32 v8, v8, v19, vcc
    v_add_u32 v18, 1, v3
    v_cmp_eq_u32 vcc, s40, v18
    s_nop 1
    v_cndmask_b32 v9, v9, v19, vcc
    v_add_u32 v18, 2, v3
    v_cmp_eq_u32 vcc, s40, v18
    s_nop 1
    v_cndmask_b32 v10, v10, v19, vcc
    v_add_u32 v18, 3, v3
    v_cmp_eq_u32 vcc, s40, v18
    s_nop 1
    v_cndmask_b32 v11, v11, v19, vcc
    v_add_u32 v18, 4, v3
    v_cmp_eq_u32 vcc, s40, v18
    s_nop 1
    v_cndmask_b32 v12, v12, v19, vcc
    v_add_u32 v18, 5, v3
    v_cmp_eq_u32 vcc, s40, v18
    s_nop 1
    v_cndmask_b32 v13, v13, v19, vcc
    v_add_u32 v18, 6, v3
    v_cmp_eq_u32 vcc, s40, v18
    s_nop 1
    v_cndmask_b32 v14, v14, v19, vcc
    v_add_u32 v18, 7, v3
    v_cmp_eq_u32 vcc, s40, v18
    s_nop 1
    v_cndmask_b32 v15, v15, v19, vcc
    v_mov_b32 v16, v8
    v_mov_b32 v17, v3
    v_cmp_gt_f32 vcc, v9, v16
    v_add_u32 v18, 1, v3
    s_nop 0
    v_cndmask_b32 v16, v16, v9, vcc
    v_cndmask_b32 v17, v17, v18, vcc
    v_cmp_gt_f32 vcc, v10, v16
    v_add_u32 v18, 2, v3
    s_nop 0
    v_cndmask_b32 v16, v16, v10, vcc
    v_cndmask_b32 v17, v17, v18, vcc
    v_cmp_gt_f32 vcc, v11, v16
    v_add_u32 v18, 3, v3
    s_nop 0
    v_cndmask_b32 v16, v16, v11, vcc
    v_cndmask_b32 v17, v17, v18, vcc
    v_cmp_gt_f32 vcc, v12, v16
    v_add_u32 v18, 4, v3
    s_nop 0
    v_cndmask_b32 v16, v16, v12, vcc
    v_cndmask_b32 v17, v17, v18, vcc
    v_cmp_gt_f32 vcc, v13, v16
    v_add_u32 v18, 5, v3
    s_nop 0
    v_cndmask_b32 v16, v16, v13, vcc
    v_cndmask_b32 v17, v17, v18, vcc
    v_cmp_gt_f32 vcc, v14, v16
    v_add_u32 v18, 6, v3
    s_nop 0
    v_cndmask_b32 v16, v16, v14, vcc
    v_cndmask_b32 v17, v17, v18, vcc
    v_cmp_gt_f32 vcc, v15, v16
    v_add_u32 v18, 7, v3
    s_nop 0
    v_cndmask_b32 v16, v16, v15, vcc
    v_cndmask_b32 v17, v17, v18, vcc
    s_nop 1
    v_mov_b32_dpp v18, v16 quad_perm:[1,0,3,2] row_mask:0xf bank_mask:0xf
    v_mov_b32_dpp v19, v17 quad_perm:[1,0,3,2] row_mask:0xf bank_mask:0xf
    v_cmp_gt_f32 vcc, v18, v16
    v_cmp_eq_f32 s[44:45], v18, v16
    v_cmp_lt_u32 s[46:47], v19, v17
    s_nop 1
    s_and_b64 s[44:45], s[44:45], s[46:47]
    s_or_b64 vcc, vcc, s[44:45]
    v_cndmask_b32 v16, v16, v18, vcc
    v_cndmask_b32 v17, v17, v19, vcc
    s_nop 1
    v_mov_b32_dpp v18, v16 quad_perm:[2,3,0,1] row_mask:0xf bank_mask:0xf
    v_mov_b32_dpp v19, v17 quad_perm:[2,3,0,1] row_mask:0xf bank_mask:0xf
    v_cmp_gt_f32 vcc, v18, v16
    v_cmp_eq_f32 s[44:45], v18, v16
    v_cmp_lt_u32 s[46:47], v19, v17
    s_nop 1
    s_and_b64 s[44:45], s[44:45], s[46:47]
    s_or_b64 vcc, vcc, s[44:45]
    v_cndmask_b32 v16, v16, v18, vcc
    v_cndmask_b32 v17, v17, v19, vcc
    s_nop 1
    v_mov_b32_dpp v18, v16 row_half_mirror row_mask:0xf bank_mask:0xf
    v_mov_b32_dpp v19, v17 row_half_mirror row_mask:0xf bank_mask:0xf
    v_cmp_gt_f32 vcc, v18, v16
    v_cmp_eq_f32 s[44:45], v18, v16
    v_cmp_lt_u32 s[46:47], v19, v17
    s_nop 1
    s_and_b64 s[44:45], s[44:45], s[46:47]
    s_or_b64 vcc, vcc, s[44:45]
    v_cndmask_b32 v16, v16, v18, vcc
    v_cndmask_b32 v17, v17, v19, vcc
    s_nop 1
    v_mov_b32_dpp v18, v16 row_mirror row_mask:0xf bank_mask:0xf
    v_mov_b32_dpp v19, v17 row_mirror row_mask:0xf bank_mask:0xf
    v_cmp_gt_f32 vcc, v18, v16
    v_cmp_eq_f32 s[44:45], v18, v16
    v_cmp_lt_u32 s[46:47], v19, v17
    s_nop 1
    s_and_b64 s[44:45], s[44:45], s[46:47]
    s_or_b64 vcc, vcc, s[44:45]
    v_cndmask_b32 v16, v16, v18, vcc
    v_cndmask_b32 v17, v17, v19, vcc
    v_mov_b32 v18, v16
    v_mov_b32 v19, v17
    v_mov_b32 v20, v16
    v_mov_b32 v21, v17
    s_nop 1
    v_permlane16_swap_b32 v18, v20
    v_permlane16_swap_b32 v19, v21
    s_nop 1
    v_cmp_gt_f32 vcc, v20, v18
    v_cmp_eq_f32 s[44:45], v20, v18
    v_cmp_lt_u32 s[46:47], v21, v19
    s_nop 1
    s_and_b64 s[44:45], s[44:45], s[46:47]
    s_or_b64 vcc, vcc, s[44:45]
    v_cndmask_b32 v18, v18, v20, vcc
    v_cndmask_b32 v19, v19, v21, vcc
    v_cmp_gt_f32 vcc, v18, v16
    v_cmp_eq_f32 s[44:45], v18, v16
    v_cmp_lt_u32 s[46:47], v19, v17
    s_nop 1
    s_and_b64 s[44:45], s[44:45], s[46:47]
    s_or_b64 vcc, vcc, s[44:45]
    v_cndmask_b32 v16, v16, v18, vcc
    v_cndmask_b32 v17, v17, v19, vcc
    v_mov_b32 v18, v16
    v_mov_b32 v19, v17
    v_mov_b32 v20, v16
    v_mov_b32 v21, v17
    s_nop 1
    v_permlane32_swap_b32 v18, v20
    v_permlane32_swap_b32 v19, v21
    s_nop 1
    v_cmp_gt_f32 vcc, v20, v18
    v_cmp_eq_f32 s[44:45], v20, v18
    v_cmp_lt_u32 s[46:47], v21, v19
    s_nop 1
    s_and_b64 s[44:45], s[44:45], s[46:47]
    s_or_b64 vcc, vcc, s[44:45]
    v_cndmask_b32 v18, v18, v20, vcc
    v_cndmask_b32 v19, v19, v21, vcc
    v_cmp_gt_f32 vcc, v18, v16
    v_cmp_eq_f32 s[44:45], v18, v16
    v_cmp_lt_u32 s[46:47], v19, v17
    s_nop 1
    s_and_b64 s[44:45], s[44:45], s[46:47]
    s_or_b64 vcc, vcc, s[44:45]
    v_cndmask_b32 v16, v16, v18, vcc
    v_cndmask_b32 v17, v17, v19, vcc
    v_lshrrev_b32 v18, 6, v0
    v_lshlrev_b32 v18, 3, v18
    s_barrier
    ds_write_b64 v18, v[16:17]
    s_waitcnt lgkmcnt(0)
    s_barrier
    v_mov_b32 v18, 0
    ds_read_b128 v[20:23], v18
    ds_read_b128 v[24:27], v18 offset:16
    s_waitcnt lgkmcnt(0)
    v_mov_b32 v16, v20
    v_mov_b32 v17, v21
    v_cmp_gt_f32 vcc, v22, v16
    s_nop 1
    v_cndmask_b32 v16, v16, v22, vcc
    v_cndmask_b32 v17, v17, v23, vcc
    v_cmp_gt_f32 vcc, v24, v16
    s_nop 1
    v_cndmask_b32 v16, v16, v24, vcc
    v_cndmask_b32 v17, v17, v25, vcc
    v_cmp_gt_f32 vcc, v26, v16
    s_nop 1
    v_cndmask_b32 v16, v16, v26, vcc
    v_cndmask_b32 v17, v17, v27, vcc
    s_nop 0
    v_readfirstlane_b32 s41, v17
    v_readfirstlane_b32 s43, v16
    s_nop 3
    v_lshlrev_b32 v2, 2, v0
    s_mul_i32 s16, s40, 896
    s_add_u32 s16, s16, 87072768
    s_mul_i32 s17, s41, 896
    s_add_u32 s17, s17, 87072768
    v_min_u32 v3, 223, v0
    v_lshlrev_b32 v3, 2, v3
    buffer_load_dword v8, v3, s[4:7], s16 offen sc1
    buffer_load_dword v9, v3, s[4:7], s17 offen sc1
    v_lshrrev_b32 v5, 4, v0
    s_waitcnt vmcnt(0)
    v_lshlrev_b32 v10, 16, v8
    v_and_b32 v11, 0xffff0000, v8
    v_lshlrev_b32 v12, 16, v9
    v_and_b32 v13, 0xffff0000, v9
    v_lshlrev_b32 v3, 1, v3
    ds_write_b64 v3, v[10:11] offset:1024
    ds_write_b64 v3, v[12:13] offset:2816
    s_waitcnt lgkmcnt(0)
    s_barrier
    v_mul_u32_u24 v7, 112, v5
    ds_read_b128 v[96:99], v7 offset:1024
    ds_read_b128 v[128:131], v7 offset:2816
    ds_read_b128 v[100:103], v7 offset:1040
    ds_read_b128 v[132:135], v7 offset:2832
    ds_read_b128 v[104:107], v7 offset:1056
    ds_read_b128 v[136:139], v7 offset:2848
    ds_read_b128 v[108:111], v7 offset:1072
    ds_read_b128 v[140:143], v7 offset:2864
    ds_read_b128 v[112:115], v7 offset:1088
    ds_read_b128 v[144:147], v7 offset:2880
    ds_read_b128 v[116:119], v7 offset:1104
    ds_read_b128 v[148:151], v7 offset:2896
    ds_read_b128 v[120:123], v7 offset:1120
    ds_read_b128 v[152:155], v7 offset:2912
    s_waitcnt vmcnt(0) lgkmcnt(0)
    v_mov_b32 v16, 0
    v_mov_b32 v17, 0
    v_mov_b32 v18, 0
    v_mov_b32 v19, 0
    v_mov_b32 v20, 0
    v_mov_b32 v21, 0
    v_mov_b32 v22, 0
    v_mov_b32 v23, 0
    v_lshlrev_b32 v14, 16, v32
    v_and_b32 v15, 0xffff0000, v32
    v_fmac_f32 v16, v14, v96
    v_fmac_f32 v17, v15, v96
    v_fmac_f32 v18, v14, v128
    v_fmac_f32 v19, v15, v128
    v_lshlrev_b32 v14, 16, v64
    v_and_b32 v15, 0xffff0000, v64
    v_fmac_f32 v20, v14, v96
    v_fmac_f32 v21, v15, v96
    v_fmac_f32 v22, v14, v128
    v_fmac_f32 v23, v15, v128
    v_lshlrev_b32 v14, 16, v33
    v_and_b32 v15, 0xffff0000, v33
    v_fmac_f32 v16, v14, v97
    v_fmac_f32 v17, v15, v97
    v_fmac_f32 v18, v14, v129
    v_fmac_f32 v19, v15, v129
    v_lshlrev_b32 v14, 16, v65
    v_and_b32 v15, 0xffff0000, v65
    v_fmac_f32 v20, v14, v97
    v_fmac_f32 v21, v15, v97
    v_fmac_f32 v22, v14, v129
    v_fmac_f32 v23, v15, v129
    v_lshlrev_b32 v14, 16, v34
    v_and_b32 v15, 0xffff0000, v34
    v_fmac_f32 v16, v14, v98
    v_fmac_f32 v17, v15, v98
    v_fmac_f32 v18, v14, v130
    v_fmac_f32 v19, v15, v130
    v_lshlrev_b32 v14, 16, v66
    v_and_b32 v15, 0xffff0000, v66
    v_fmac_f32 v20, v14, v98
    v_fmac_f32 v21, v15, v98
    v_fmac_f32 v22, v14, v130
    v_fmac_f32 v23, v15, v130
    v_lshlrev_b32 v14, 16, v35
    v_and_b32 v15, 0xffff0000, v35
    v_fmac_f32 v16, v14, v99
    v_fmac_f32 v17, v15, v99
    v_fmac_f32 v18, v14, v131
    v_fmac_f32 v19, v15, v131
    v_lshlrev_b32 v14, 16, v67
    v_and_b32 v15, 0xffff0000, v67
    v_fmac_f32 v20, v14, v99
    v_fmac_f32 v21, v15, v99
    v_fmac_f32 v22, v14, v131
    v_fmac_f32 v23, v15, v131
    v_lshlrev_b32 v14, 16, v36
    v_and_b32 v15, 0xffff0000, v36
    v_fmac_f32 v16, v14, v100
    v_fmac_f32 v17, v15, v100
    v_fmac_f32 v18, v14, v132
    v_fmac_f32 v19, v15, v132
    v_lshlrev_b32 v14, 16, v68
    v_and_b32 v15, 0xffff0000, v68
    v_fmac_f32 v20, v14, v100
    v_fmac_f32 v21, v15, v100
    v_fmac_f32 v22, v14, v132
    v_fmac_f32 v23, v15, v132
    v_lshlrev_b32 v14, 16, v37
    v_and_b32 v15, 0xffff0000, v37
    v_fmac_f32 v16, v14, v101
    v_fmac_f32 v17, v15, v101
    v_fmac_f32 v18, v14, v133
    v_fmac_f32 v19, v15, v133
    v_lshlrev_b32 v14, 16, v69
    v_and_b32 v15, 0xffff0000, v69
    v_fmac_f32 v20, v14, v101
    v_fmac_f32 v21, v15, v101
    v_fmac_f32 v22, v14, v133
    v_fmac_f32 v23, v15, v133
    v_lshlrev_b32 v14, 16, v38
    v_and_b32 v15, 0xffff0000, v38
    v_fmac_f32 v16, v14, v102
    v_fmac_f32 v17, v15, v102
    v_fmac_f32 v18, v14, v134
    v_fmac_f32 v19, v15, v134
    v_lshlrev_b32 v14, 16, v70
    v_and_b32 v15, 0xffff0000, v70
    v_fmac_f32 v20, v14, v102
    v_fmac_f32 v21, v15, v102
    v_fmac_f32 v22, v14, v134
    v_fmac_f32 v23, v15, v134
    v_lshlrev_b32 v14, 16, v39
    v_and_b32 v15, 0xffff0000, v39
    v_fmac_f32 v16, v14, v103
    v_fmac_f32 v17, v15, v103
    v_fmac_f32 v18, v14, v135
    v_fmac_f32 v19, v15, v135
    v_lshlrev_b32 v14, 16, v71
    v_and_b32 v15, 0xffff0000, v71
    v_fmac_f32 v20, v14, v103
    v_fmac_f32 v21, v15, v103
    v_fmac_f32 v22, v14, v135
    v_fmac_f32 v23, v15, v135
    v_lshlrev_b32 v14, 16, v40
    v_and_b32 v15, 0xffff0000, v40
    v_fmac_f32 v16, v14, v104
    v_fmac_f32 v17, v15, v104
    v_fmac_f32 v18, v14, v136
    v_fmac_f32 v19, v15, v136
    v_lshlrev_b32 v14, 16, v72
    v_and_b32 v15, 0xffff0000, v72
    v_fmac_f32 v20, v14, v104
    v_fmac_f32 v21, v15, v104
    v_fmac_f32 v22, v14, v136
    v_fmac_f32 v23, v15, v136
    v_lshlrev_b32 v14, 16, v41
    v_and_b32 v15, 0xffff0000, v41
    v_fmac_f32 v16, v14, v105
    v_fmac_f32 v17, v15, v105
    v_fmac_f32 v18, v14, v137
    v_fmac_f32 v19, v15, v137
    v_lshlrev_b32 v14, 16, v73
    v_and_b32 v15, 0xffff0000, v73
    v_fmac_f32 v20, v14, v105
    v_fmac_f32 v21, v15, v105
    v_fmac_f32 v22, v14, v137
    v_fmac_f32 v23, v15, v137
    v_lshlrev_b32 v14, 16, v42
    v_and_b32 v15, 0xffff0000, v42
    v_fmac_f32 v16, v14, v106
    v_fmac_f32 v17, v15, v106
    v_fmac_f32 v18, v14, v138
    v_fmac_f32 v19, v15, v138
    v_lshlrev_b32 v14, 16, v74
    v_and_b32 v15, 0xffff0000, v74
    v_fmac_f32 v20, v14, v106
    v_fmac_f32 v21, v15, v106
    v_fmac_f32 v22, v14, v138
    v_fmac_f32 v23, v15, v138
    v_lshlrev_b32 v14, 16, v43
    v_and_b32 v15, 0xffff0000, v43
    v_fmac_f32 v16, v14, v107
    v_fmac_f32 v17, v15, v107
    v_fmac_f32 v18, v14, v139
    v_fmac_f32 v19, v15, v139
    v_lshlrev_b32 v14, 16, v75
    v_and_b32 v15, 0xffff0000, v75
    v_fmac_f32 v20, v14, v107
    v_fmac_f32 v21, v15, v107
    v_fmac_f32 v22, v14, v139
    v_fmac_f32 v23, v15, v139
    v_lshlrev_b32 v14, 16, v44
    v_and_b32 v15, 0xffff0000, v44
    v_fmac_f32 v16, v14, v108
    v_fmac_f32 v17, v15, v108
    v_fmac_f32 v18, v14, v140
    v_fmac_f32 v19, v15, v140
    v_lshlrev_b32 v14, 16, v76
    v_and_b32 v15, 0xffff0000, v76
    v_fmac_f32 v20, v14, v108
    v_fmac_f32 v21, v15, v108
    v_fmac_f32 v22, v14, v140
    v_fmac_f32 v23, v15, v140
    v_lshlrev_b32 v14, 16, v45
    v_and_b32 v15, 0xffff0000, v45
    v_fmac_f32 v16, v14, v109
    v_fmac_f32 v17, v15, v109
    v_fmac_f32 v18, v14, v141
    v_fmac_f32 v19, v15, v141
    v_lshlrev_b32 v14, 16, v77
    v_and_b32 v15, 0xffff0000, v77
    v_fmac_f32 v20, v14, v109
    v_fmac_f32 v21, v15, v109
    v_fmac_f32 v22, v14, v141
    v_fmac_f32 v23, v15, v141
    v_lshlrev_b32 v14, 16, v46
    v_and_b32 v15, 0xffff0000, v46
    v_fmac_f32 v16, v14, v110
    v_fmac_f32 v17, v15, v110
    v_fmac_f32 v18, v14, v142
    v_fmac_f32 v19, v15, v142
    v_lshlrev_b32 v14, 16, v78
    v_and_b32 v15, 0xffff0000, v78
    v_fmac_f32 v20, v14, v110
    v_fmac_f32 v21, v15, v110
    v_fmac_f32 v22, v14, v142
    v_fmac_f32 v23, v15, v142
    v_lshlrev_b32 v14, 16, v47
    v_and_b32 v15, 0xffff0000, v47
    v_fmac_f32 v16, v14, v111
    v_fmac_f32 v17, v15, v111
    v_fmac_f32 v18, v14, v143
    v_fmac_f32 v19, v15, v143
    v_lshlrev_b32 v14, 16, v79
    v_and_b32 v15, 0xffff0000, v79
    v_fmac_f32 v20, v14, v111
    v_fmac_f32 v21, v15, v111
    v_fmac_f32 v22, v14, v143
    v_fmac_f32 v23, v15, v143
    v_lshlrev_b32 v14, 16, v48
    v_and_b32 v15, 0xffff0000, v48
    v_fmac_f32 v16, v14, v112
    v_fmac_f32 v17, v15, v112
    v_fmac_f32 v18, v14, v144
    v_fmac_f32 v19, v15, v144
    v_lshlrev_b32 v14, 16, v80
    v_and_b32 v15, 0xffff0000, v80
    v_fmac_f32 v20, v14, v112
    v_fmac_f32 v21, v15, v112
    v_fmac_f32 v22, v14, v144
    v_fmac_f32 v23, v15, v144
    v_lshlrev_b32 v14, 16, v49
    v_and_b32 v15, 0xffff0000, v49
    v_fmac_f32 v16, v14, v113
    v_fmac_f32 v17, v15, v113
    v_fmac_f32 v18, v14, v145
    v_fmac_f32 v19, v15, v145
    v_lshlrev_b32 v14, 16, v81
    v_and_b32 v15, 0xffff0000, v81
    v_fmac_f32 v20, v14, v113
    v_fmac_f32 v21, v15, v113
    v_fmac_f32 v22, v14, v145
    v_fmac_f32 v23, v15, v145
    v_lshlrev_b32 v14, 16, v50
    v_and_b32 v15, 0xffff0000, v50
    v_fmac_f32 v16, v14, v114
    v_fmac_f32 v17, v15, v114
    v_fmac_f32 v18, v14, v146
    v_fmac_f32 v19, v15, v146
    v_lshlrev_b32 v14, 16, v82
    v_and_b32 v15, 0xffff0000, v82
    v_fmac_f32 v20, v14, v114
    v_fmac_f32 v21, v15, v114
    v_fmac_f32 v22, v14, v146
    v_fmac_f32 v23, v15, v146
    v_lshlrev_b32 v14, 16, v51
    v_and_b32 v15, 0xffff0000, v51
    v_fmac_f32 v16, v14, v115
    v_fmac_f32 v17, v15, v115
    v_fmac_f32 v18, v14, v147
    v_fmac_f32 v19, v15, v147
    v_lshlrev_b32 v14, 16, v83
    v_and_b32 v15, 0xffff0000, v83
    v_fmac_f32 v20, v14, v115
    v_fmac_f32 v21, v15, v115
    v_fmac_f32 v22, v14, v147
    v_fmac_f32 v23, v15, v147
    v_lshlrev_b32 v14, 16, v52
    v_and_b32 v15, 0xffff0000, v52
    v_fmac_f32 v16, v14, v116
    v_fmac_f32 v17, v15, v116
    v_fmac_f32 v18, v14, v148
    v_fmac_f32 v19, v15, v148
    v_lshlrev_b32 v14, 16, v84
    v_and_b32 v15, 0xffff0000, v84
    v_fmac_f32 v20, v14, v116
    v_fmac_f32 v21, v15, v116
    v_fmac_f32 v22, v14, v148
    v_fmac_f32 v23, v15, v148
    v_lshlrev_b32 v14, 16, v53
    v_and_b32 v15, 0xffff0000, v53
    v_fmac_f32 v16, v14, v117
    v_fmac_f32 v17, v15, v117
    v_fmac_f32 v18, v14, v149
    v_fmac_f32 v19, v15, v149
    v_lshlrev_b32 v14, 16, v85
    v_and_b32 v15, 0xffff0000, v85
    v_fmac_f32 v20, v14, v117
    v_fmac_f32 v21, v15, v117
    v_fmac_f32 v22, v14, v149
    v_fmac_f32 v23, v15, v149
    v_lshlrev_b32 v14, 16, v54
    v_and_b32 v15, 0xffff0000, v54
    v_fmac_f32 v16, v14, v118
    v_fmac_f32 v17, v15, v118
    v_fmac_f32 v18, v14, v150
    v_fmac_f32 v19, v15, v150
    v_lshlrev_b32 v14, 16, v86
    v_and_b32 v15, 0xffff0000, v86
    v_fmac_f32 v20, v14, v118
    v_fmac_f32 v21, v15, v118
    v_fmac_f32 v22, v14, v150
    v_fmac_f32 v23, v15, v150
    v_lshlrev_b32 v14, 16, v55
    v_and_b32 v15, 0xffff0000, v55
    v_fmac_f32 v16, v14, v119
    v_fmac_f32 v17, v15, v119
    v_fmac_f32 v18, v14, v151
    v_fmac_f32 v19, v15, v151
    v_lshlrev_b32 v14, 16, v87
    v_and_b32 v15, 0xffff0000, v87
    v_fmac_f32 v20, v14, v119
    v_fmac_f32 v21, v15, v119
    v_fmac_f32 v22, v14, v151
    v_fmac_f32 v23, v15, v151
    v_lshlrev_b32 v14, 16, v56
    v_and_b32 v15, 0xffff0000, v56
    v_fmac_f32 v16, v14, v120
    v_fmac_f32 v17, v15, v120
    v_fmac_f32 v18, v14, v152
    v_fmac_f32 v19, v15, v152
    v_lshlrev_b32 v14, 16, v88
    v_and_b32 v15, 0xffff0000, v88
    v_fmac_f32 v20, v14, v120
    v_fmac_f32 v21, v15, v120
    v_fmac_f32 v22, v14, v152
    v_fmac_f32 v23, v15, v152
    v_lshlrev_b32 v14, 16, v57
    v_and_b32 v15, 0xffff0000, v57
    v_fmac_f32 v16, v14, v121
    v_fmac_f32 v17, v15, v121
    v_fmac_f32 v18, v14, v153
    v_fmac_f32 v19, v15, v153
    v_lshlrev_b32 v14, 16, v89
    v_and_b32 v15, 0xffff0000, v89
    v_fmac_f32 v20, v14, v121
    v_fmac_f32 v21, v15, v121
    v_fmac_f32 v22, v14, v153
    v_fmac_f32 v23, v15, v153
    v_lshlrev_b32 v14, 16, v58
    v_and_b32 v15, 0xffff0000, v58
    v_fmac_f32 v16, v14, v122
    v_fmac_f32 v17, v15, v122
    v_fmac_f32 v18, v14, v154
    v_fmac_f32 v19, v15, v154
    v_lshlrev_b32 v14, 16, v90
    v_and_b32 v15, 0xffff0000, v90
    v_fmac_f32 v20, v14, v122
    v_fmac_f32 v21, v15, v122
    v_fmac_f32 v22, v14, v154
    v_fmac_f32 v23, v15, v154
    v_lshlrev_b32 v14, 16, v59
    v_and_b32 v15, 0xffff0000, v59
    v_fmac_f32 v16, v14, v123
    v_fmac_f32 v17, v15, v123
    v_fmac_f32 v18, v14, v155
    v_fmac_f32 v19, v15, v155
    v_lshlrev_b32 v14, 16, v91
    v_and_b32 v15, 0xffff0000, v91
    v_fmac_f32 v20, v14, v123
    v_fmac_f32 v21, v15, v123
    v_fmac_f32 v22, v14, v155
    v_fmac_f32 v23, v15, v155
    v_lshlrev_b32 v7, 5, v0
    ds_write_b128 v7, v[16:19] offset:8192
    ds_write_b128 v7, v[20:23] offset:8208
    s_waitcnt lgkmcnt(0)
    s_barrier
    v_and_b32 v7, 127, v0
    v_lshlrev_b32 v7, 2, v7
    ds_read_b32 v32, v7 offset:8192
    ds_read_b32 v33, v7 offset:8704
    ds_read_b32 v34, v7 offset:9216
    ds_read_b32 v35, v7 offset:9728
    ds_read_b32 v36, v7 offset:10240
    ds_read_b32 v37, v7 offset:10752
    ds_read_b32 v38, v7 offset:11264
    ds_read_b32 v39, v7 offset:11776
    s_waitcnt lgkmcnt(0)
    ds_read_b32 v40, v7 offset:12288
    ds_read_b32 v41, v7 offset:12800
    ds_read_b32 v42, v7 offset:13312
    ds_read_b32 v43, v7 offset:13824
    ds_read_b32 v44, v7 offset:14336
    ds_read_b32 v45, v7 offset:14848
    ds_read_b32 v46, v7 offset:15360
    ds_read_b32 v47, v7 offset:15872
    s_waitcnt lgkmcnt(0)
    v_add_f32 v32, v32, v40
    v_add_f32 v33, v33, v41
    v_add_f32 v34, v34, v42
    v_add_f32 v35, v35, v43
    v_add_f32 v36, v36, v44
    v_add_f32 v37, v37, v45
    v_add_f32 v38, v38, v46
    v_add_f32 v39, v39, v47
    v_add_f32 v32, v32, v36
    v_add_f32 v33, v33, v37
    v_add_f32 v34, v34, v38
    v_add_f32 v35, v35, v39
    v_add_f32 v32, v32, v34
    v_add_f32 v33, v33, v35
    v_add_f32 v32, v32, v33
    v_cvt_pk_bf16_f32 v14, v32, v32
    v_lshlrev_b32 v32, 16, v14
    s_barrier
    ds_write_b32 v7, v32 offset:16384
    s_waitcnt lgkmcnt(0)
    s_barrier
    v_and_b32 v7, 63, v0
    v_lshrrev_b32 v8, 2, v7
    v_lshlrev_b32 v8, 5, v8
    v_and_b32 v9, 3, v7
    v_lshl_add_u32 v8, v9, 2, v8
    ds_read_b32 v10, v8 offset:16384
    ds_read_b32 v11, v8 offset:16400
    s_waitcnt lgkmcnt(0)
    v_mul_f32 v12, 0xbfb8aa3b, v10
    v_exp_f32 v12, v12
    s_nop 0
    v_add_f32 v12, 1.0, v12
    v_rcp_f32 v12, v12
    s_nop 0
    v_mul_f32 v10, v10, v12
    v_cvt_pk_bf16_f32 v14, v10, v10
    v_lshlrev_b32 v10, 16, v14
    v_mul_f32 v10, v10, v11
    v_cvt_pk_bf16_f32 v14, v10, v10
    v_lshlrev_b32 v10, 16, v14
    v_lshrrev_b32 v8, 2, v7
    v_lshlrev_b32 v8, 1, v8
    v_and_b32 v11, 1, v9
    v_add_u32 v8, v8, v11
    v_lshrrev_b32 v11, 1, v9
    v_lshl_add_u32 v8, v11, 5, v8
    v_lshlrev_b32 v8, 2, v8
    ds_write_b32 v8, v10 offset:17408
    v_min_u32 v3, 223, v0
    v_lshlrev_b32 v3, 2, v3
    s_waitcnt lgkmcnt(0)
    s_barrier
    v_mov_b32 v7, 0
    ds_read_b128 v[96:99], v7 offset:17408
    ds_read_b128 v[128:131], v7 offset:17536
    ds_read_b128 v[100:103], v7 offset:17424
    ds_read_b128 v[132:135], v7 offset:17552
    ds_read_b128 v[104:107], v7 offset:17440
    ds_read_b128 v[136:139], v7 offset:17568
    ds_read_b128 v[108:111], v7 offset:17456
    ds_read_b128 v[140:143], v7 offset:17584
    ds_read_b128 v[112:115], v7 offset:17472
    ds_read_b128 v[144:147], v7 offset:17600
    ds_read_b128 v[116:119], v7 offset:17488
    ds_read_b128 v[148:151], v7 offset:17616
    ds_read_b128 v[120:123], v7 offset:17504
    ds_read_b128 v[152:155], v7 offset:17632
    ds_read_b128 v[124:127], v7 offset:17520
    ds_read_b128 v[156:159], v7 offset:17648
    v_mov_b32 v16, 0
    v_mov_b32 v17, 0
    v_mov_b32 v18, 0
    v_mov_b32 v19, 0
    s_waitcnt vmcnt(0) lgkmcnt(0)
    v_lshlrev_b32 v14, 16, v160
    v_and_b32 v15, 0xffff0000, v160
    v_fmac_f32 v16, v14, v96
    v_fmac_f32 v17, v15, v96
    v_fmac_f32 v18, v14, v128
    v_fmac_f32 v19, v15, v128
    v_lshlrev_b32 v14, 16, v161
    v_and_b32 v15, 0xffff0000, v161
    v_fmac_f32 v16, v14, v97
    v_fmac_f32 v17, v15, v97
    v_fmac_f32 v18, v14, v129
    v_fmac_f32 v19, v15, v129
    v_lshlrev_b32 v14, 16, v162
    v_and_b32 v15, 0xffff0000, v162
    v_fmac_f32 v16, v14, v98
    v_fmac_f32 v17, v15, v98
    v_fmac_f32 v18, v14, v130
    v_fmac_f32 v19, v15, v130
    v_lshlrev_b32 v14, 16, v163
    v_and_b32 v15, 0xffff0000, v163
    v_fmac_f32 v16, v14, v99
    v_fmac_f32 v17, v15, v99
    v_fmac_f32 v18, v14, v131
    v_fmac_f32 v19, v15, v131
    v_lshlrev_b32 v14, 16, v164
    v_and_b32 v15, 0xffff0000, v164
    v_fmac_f32 v16, v14, v100
    v_fmac_f32 v17, v15, v100
    v_fmac_f32 v18, v14, v132
    v_fmac_f32 v19, v15, v132
    v_lshlrev_b32 v14, 16, v165
    v_and_b32 v15, 0xffff0000, v165
    v_fmac_f32 v16, v14, v101
    v_fmac_f32 v17, v15, v101
    v_fmac_f32 v18, v14, v133
    v_fmac_f32 v19, v15, v133
    v_lshlrev_b32 v14, 16, v166
    v_and_b32 v15, 0xffff0000, v166
    v_fmac_f32 v16, v14, v102
    v_fmac_f32 v17, v15, v102
    v_fmac_f32 v18, v14, v134
    v_fmac_f32 v19, v15, v134
    v_lshlrev_b32 v14, 16, v167
    v_and_b32 v15, 0xffff0000, v167
    v_fmac_f32 v16, v14, v103
    v_fmac_f32 v17, v15, v103
    v_fmac_f32 v18, v14, v135
    v_fmac_f32 v19, v15, v135
    v_lshlrev_b32 v14, 16, v168
    v_and_b32 v15, 0xffff0000, v168
    v_fmac_f32 v16, v14, v104
    v_fmac_f32 v17, v15, v104
    v_fmac_f32 v18, v14, v136
    v_fmac_f32 v19, v15, v136
    v_lshlrev_b32 v14, 16, v169
    v_and_b32 v15, 0xffff0000, v169
    v_fmac_f32 v16, v14, v105
    v_fmac_f32 v17, v15, v105
    v_fmac_f32 v18, v14, v137
    v_fmac_f32 v19, v15, v137
    v_lshlrev_b32 v14, 16, v170
    v_and_b32 v15, 0xffff0000, v170
    v_fmac_f32 v16, v14, v106
    v_fmac_f32 v17, v15, v106
    v_fmac_f32 v18, v14, v138
    v_fmac_f32 v19, v15, v138
    v_lshlrev_b32 v14, 16, v171
    v_and_b32 v15, 0xffff0000, v171
    v_fmac_f32 v16, v14, v107
    v_fmac_f32 v17, v15, v107
    v_fmac_f32 v18, v14, v139
    v_fmac_f32 v19, v15, v139
    v_lshlrev_b32 v14, 16, v172
    v_and_b32 v15, 0xffff0000, v172
    v_fmac_f32 v16, v14, v108
    v_fmac_f32 v17, v15, v108
    v_fmac_f32 v18, v14, v140
    v_fmac_f32 v19, v15, v140
    v_lshlrev_b32 v14, 16, v173
    v_and_b32 v15, 0xffff0000, v173
    v_fmac_f32 v16, v14, v109
    v_fmac_f32 v17, v15, v109
    v_fmac_f32 v18, v14, v141
    v_fmac_f32 v19, v15, v141
    v_lshlrev_b32 v14, 16, v174
    v_and_b32 v15, 0xffff0000, v174
    v_fmac_f32 v16, v14, v110
    v_fmac_f32 v17, v15, v110
    v_fmac_f32 v18, v14, v142
    v_fmac_f32 v19, v15, v142
    v_lshlrev_b32 v14, 16, v175
    v_and_b32 v15, 0xffff0000, v175
    v_fmac_f32 v16, v14, v111
    v_fmac_f32 v17, v15, v111
    v_fmac_f32 v18, v14, v143
    v_fmac_f32 v19, v15, v143
    v_lshlrev_b32 v14, 16, v176
    v_and_b32 v15, 0xffff0000, v176
    v_fmac_f32 v16, v14, v112
    v_fmac_f32 v17, v15, v112
    v_fmac_f32 v18, v14, v144
    v_fmac_f32 v19, v15, v144
    v_lshlrev_b32 v14, 16, v177
    v_and_b32 v15, 0xffff0000, v177
    v_fmac_f32 v16, v14, v113
    v_fmac_f32 v17, v15, v113
    v_fmac_f32 v18, v14, v145
    v_fmac_f32 v19, v15, v145
    v_lshlrev_b32 v14, 16, v178
    v_and_b32 v15, 0xffff0000, v178
    v_fmac_f32 v16, v14, v114
    v_fmac_f32 v17, v15, v114
    v_fmac_f32 v18, v14, v146
    v_fmac_f32 v19, v15, v146
    v_lshlrev_b32 v14, 16, v179
    v_and_b32 v15, 0xffff0000, v179
    v_fmac_f32 v16, v14, v115
    v_fmac_f32 v17, v15, v115
    v_fmac_f32 v18, v14, v147
    v_fmac_f32 v19, v15, v147
    v_lshlrev_b32 v14, 16, v180
    v_and_b32 v15, 0xffff0000, v180
    v_fmac_f32 v16, v14, v116
    v_fmac_f32 v17, v15, v116
    v_fmac_f32 v18, v14, v148
    v_fmac_f32 v19, v15, v148
    v_lshlrev_b32 v14, 16, v181
    v_and_b32 v15, 0xffff0000, v181
    v_fmac_f32 v16, v14, v117
    v_fmac_f32 v17, v15, v117
    v_fmac_f32 v18, v14, v149
    v_fmac_f32 v19, v15, v149
    v_lshlrev_b32 v14, 16, v182
    v_and_b32 v15, 0xffff0000, v182
    v_fmac_f32 v16, v14, v118
    v_fmac_f32 v17, v15, v118
    v_fmac_f32 v18, v14, v150
    v_fmac_f32 v19, v15, v150
    v_lshlrev_b32 v14, 16, v183
    v_and_b32 v15, 0xffff0000, v183
    v_fmac_f32 v16, v14, v119
    v_fmac_f32 v17, v15, v119
    v_fmac_f32 v18, v14, v151
    v_fmac_f32 v19, v15, v151
    v_lshlrev_b32 v14, 16, v184
    v_and_b32 v15, 0xffff0000, v184
    v_fmac_f32 v16, v14, v120
    v_fmac_f32 v17, v15, v120
    v_fmac_f32 v18, v14, v152
    v_fmac_f32 v19, v15, v152
    v_lshlrev_b32 v14, 16, v185
    v_and_b32 v15, 0xffff0000, v185
    v_fmac_f32 v16, v14, v121
    v_fmac_f32 v17, v15, v121
    v_fmac_f32 v18, v14, v153
    v_fmac_f32 v19, v15, v153
    v_lshlrev_b32 v14, 16, v186
    v_and_b32 v15, 0xffff0000, v186
    v_fmac_f32 v16, v14, v122
    v_fmac_f32 v17, v15, v122
    v_fmac_f32 v18, v14, v154
    v_fmac_f32 v19, v15, v154
    v_lshlrev_b32 v14, 16, v187
    v_and_b32 v15, 0xffff0000, v187
    v_fmac_f32 v16, v14, v123
    v_fmac_f32 v17, v15, v123
    v_fmac_f32 v18, v14, v155
    v_fmac_f32 v19, v15, v155
    v_lshlrev_b32 v14, 16, v188
    v_and_b32 v15, 0xffff0000, v188
    v_fmac_f32 v16, v14, v124
    v_fmac_f32 v17, v15, v124
    v_fmac_f32 v18, v14, v156
    v_fmac_f32 v19, v15, v156
    v_lshlrev_b32 v14, 16, v189
    v_and_b32 v15, 0xffff0000, v189
    v_fmac_f32 v16, v14, v125
    v_fmac_f32 v17, v15, v125
    v_fmac_f32 v18, v14, v157
    v_fmac_f32 v19, v15, v157
    v_lshlrev_b32 v14, 16, v190
    v_and_b32 v15, 0xffff0000, v190
    v_fmac_f32 v16, v14, v126
    v_fmac_f32 v17, v15, v126
    v_fmac_f32 v18, v14, v158
    v_fmac_f32 v19, v15, v158
    v_lshlrev_b32 v14, 16, v191
    v_and_b32 v15, 0xffff0000, v191
    v_fmac_f32 v16, v14, v127
    v_fmac_f32 v17, v15, v127
    v_fmac_f32 v18, v14, v159
    v_fmac_f32 v19, v15, v159
    v_lshlrev_b32 v3, 1, v3
    s_mul_i32 s18, s3, 3584
    s_add_u32 s18, s18, 90742784
    v_cmp_gt_u32 vcc, 224, v0
    s_and_saveexec_b64 s[44:45], vcc
    s_cbranch_execz m1s_114
    buffer_store_dwordx2 v[16:17], v3, s[4:7], s18 offen sc1
    buffer_store_dwordx2 v[18:19], v3, s[4:7], s18 offen offset:1792 sc1
m1s_114:
    s_mov_b64 exec, s[44:45]
    s_mov_b32 s63, s43
    s_lshl_b32 s93, s59, 7
    s_add_u32 s93, s93, 90974784
    s_waitcnt vmcnt(0)
    s_barrier
    s_cmp_lg_u32 s87, 0
    s_cbranch_scc1 sig_115
    v_mov_b32 v250, 0
    v_mov_b32 v251, 1
    s_mov_b64 exec, 1
    buffer_atomic_add v251, v250, s[4:7], s93 offen
    s_mov_b64 exec, -1
sig_115:
    s_branch L_moe_check
L_moe2:
    s_sub_u32 s3, s84, 56
    v_lshlrev_b32 v2, 5, v0
    s_mov_b32 s16, 87064576
    buffer_load_dwordx4 v[8:11], v2, s[4:7], s16 offen sc1
    buffer_load_dwordx4 v[12:15], v2, s[4:7], s16 offen offset:16 sc1
    v_lshlrev_b32 v3, 3, v0
    s_waitcnt vmcnt(0)
    v_cmp_le_u32 vcc, s58, v0
    v_mov_b32 v19, 0xff800000
    s_nop 0
    v_cndmask_b32 v8, v8, v19, vcc
    v_cndmask_b32 v9, v9, v19, vcc
    v_cndmask_b32 v10, v10, v19, vcc
    v_cndmask_b32 v11, v11, v19, vcc
    v_cndmask_b32 v12, v12, v19, vcc
    v_cndmask_b32 v13, v13, v19, vcc
    v_cndmask_b32 v14, v14, v19, vcc
    v_cndmask_b32 v15, v15, v19, vcc
    v_mov_b32 v16, v8
    v_mov_b32 v17, v3
    v_cmp_gt_f32 vcc, v9, v16
    v_add_u32 v18, 1, v3
    s_nop 0
    v_cndmask_b32 v16, v16, v9, vcc
    v_cndmask_b32 v17, v17, v18, vcc
    v_cmp_gt_f32 vcc, v10, v16
    v_add_u32 v18, 2, v3
    s_nop 0
    v_cndmask_b32 v16, v16, v10, vcc
    v_cndmask_b32 v17, v17, v18, vcc
    v_cmp_gt_f32 vcc, v11, v16
    v_add_u32 v18, 3, v3
    s_nop 0
    v_cndmask_b32 v16, v16, v11, vcc
    v_cndmask_b32 v17, v17, v18, vcc
    v_cmp_gt_f32 vcc, v12, v16
    v_add_u32 v18, 4, v3
    s_nop 0
    v_cndmask_b32 v16, v16, v12, vcc
    v_cndmask_b32 v17, v17, v18, vcc
    v_cmp_gt_f32 vcc, v13, v16
    v_add_u32 v18, 5, v3
    s_nop 0
    v_cndmask_b32 v16, v16, v13, vcc
    v_cndmask_b32 v17, v17, v18, vcc
    v_cmp_gt_f32 vcc, v14, v16
    v_add_u32 v18, 6, v3
    s_nop 0
    v_cndmask_b32 v16, v16, v14, vcc
    v_cndmask_b32 v17, v17, v18, vcc
    v_cmp_gt_f32 vcc, v15, v16
    v_add_u32 v18, 7, v3
    s_nop 0
    v_cndmask_b32 v16, v16, v15, vcc
    v_cndmask_b32 v17, v17, v18, vcc
    s_nop 1
    v_mov_b32_dpp v18, v16 quad_perm:[1,0,3,2] row_mask:0xf bank_mask:0xf
    v_mov_b32_dpp v19, v17 quad_perm:[1,0,3,2] row_mask:0xf bank_mask:0xf
    v_cmp_gt_f32 vcc, v18, v16
    v_cmp_eq_f32 s[44:45], v18, v16
    v_cmp_lt_u32 s[46:47], v19, v17
    s_nop 1
    s_and_b64 s[44:45], s[44:45], s[46:47]
    s_or_b64 vcc, vcc, s[44:45]
    v_cndmask_b32 v16, v16, v18, vcc
    v_cndmask_b32 v17, v17, v19, vcc
    s_nop 1
    v_mov_b32_dpp v18, v16 quad_perm:[2,3,0,1] row_mask:0xf bank_mask:0xf
    v_mov_b32_dpp v19, v17 quad_perm:[2,3,0,1] row_mask:0xf bank_mask:0xf
    v_cmp_gt_f32 vcc, v18, v16
    v_cmp_eq_f32 s[44:45], v18, v16
    v_cmp_lt_u32 s[46:47], v19, v17
    s_nop 1
    s_and_b64 s[44:45], s[44:45], s[46:47]
    s_or_b64 vcc, vcc, s[44:45]
    v_cndmask_b32 v16, v16, v18, vcc
    v_cndmask_b32 v17, v17, v19, vcc
    s_nop 1
    v_mov_b32_dpp v18, v16 row_half_mirror row_mask:0xf bank_mask:0xf
    v_mov_b32_dpp v19, v17 row_half_mirror row_mask:0xf bank_mask:0xf
    v_cmp_gt_f32 vcc, v18, v16
    v_cmp_eq_f32 s[44:45], v18, v16
    v_cmp_lt_u32 s[46:47], v19, v17
    s_nop 1
    s_and_b64 s[44:45], s[44:45], s[46:47]
    s_or_b64 vcc, vcc, s[44:45]
    v_cndmask_b32 v16, v16, v18, vcc
    v_cndmask_b32 v17, v17, v19, vcc
    s_nop 1
    v_mov_b32_dpp v18, v16 row_mirror row_mask:0xf bank_mask:0xf
    v_mov_b32_dpp v19, v17 row_mirror row_mask:0xf bank_mask:0xf
    v_cmp_gt_f32 vcc, v18, v16
    v_cmp_eq_f32 s[44:45], v18, v16
    v_cmp_lt_u32 s[46:47], v19, v17
    s_nop 1
    s_and_b64 s[44:45], s[44:45], s[46:47]
    s_or_b64 vcc, vcc, s[44:45]
    v_cndmask_b32 v16, v16, v18, vcc
    v_cndmask_b32 v17, v17, v19, vcc
    v_mov_b32 v18, v16
    v_mov_b32 v19, v17
    v_mov_b32 v20, v16
    v_mov_b32 v21, v17
    s_nop 1
    v_permlane16_swap_b32 v18, v20
    v_permlane16_swap_b32 v19, v21
    s_nop 1
    v_cmp_gt_f32 vcc, v20, v18
    v_cmp_eq_f32 s[44:45], v20, v18
    v_cmp_lt_u32 s[46:47], v21, v19
    s_nop 1
    s_and_b64 s[44:45], s[44:45], s[46:47]
    s_or_b64 vcc, vcc, s[44:45]
    v_cndmask_b32 v18, v18, v20, vcc
    v_cndmask_b32 v19, v19, v21, vcc
    v_cmp_gt_f32 vcc, v18, v16
    v_cmp_eq_f32 s[44:45], v18, v16
    v_cmp_lt_u32 s[46:47], v19, v17
    s_nop 1
    s_and_b64 s[44:45], s[44:45], s[46:47]
    s_or_b64 vcc, vcc, s[44:45]
    v_cndmask_b32 v16, v16, v18, vcc
    v_cndmask_b32 v17, v17, v19, vcc
    v_mov_b32 v18, v16
    v_mov_b32 v19, v17
    v_mov_b32 v20, v16
    v_mov_b32 v21, v17
    s_nop 1
    v_permlane32_swap_b32 v18, v20
    v_permlane32_swap_b32 v19, v21
    s_nop 1
    v_cmp_gt_f32 vcc, v20, v18
    v_cmp_eq_f32 s[44:45], v20, v18
    v_cmp_lt_u32 s[46:47], v21, v19
    s_nop 1
    s_and_b64 s[44:45], s[44:45], s[46:47]
    s_or_b64 vcc, vcc, s[44:45]
    v_cndmask_b32 v18, v18, v20, vcc
    v_cndmask_b32 v19, v19, v21, vcc
    v_cmp_gt_f32 vcc, v18, v16
    v_cmp_eq_f32 s[44:45], v18, v16
    v_cmp_lt_u32 s[46:47], v19, v17
    s_nop 1
    s_and_b64 s[44:45], s[44:45], s[46:47]
    s_or_b64 vcc, vcc, s[44:45]
    v_cndmask_b32 v16, v16, v18, vcc
    v_cndmask_b32 v17, v17, v19, vcc
    v_lshrrev_b32 v18, 6, v0
    v_lshlrev_b32 v18, 3, v18
    s_barrier
    ds_write_b64 v18, v[16:17]
    s_waitcnt lgkmcnt(0)
    s_barrier
    v_mov_b32 v18, 0
    ds_read_b128 v[20:23], v18
    ds_read_b128 v[24:27], v18 offset:16
    s_waitcnt lgkmcnt(0)
    v_mov_b32 v16, v20
    v_mov_b32 v17, v21
    v_cmp_gt_f32 vcc, v22, v16
    s_nop 1
    v_cndmask_b32 v16, v16, v22, vcc
    v_cndmask_b32 v17, v17, v23, vcc
    v_cmp_gt_f32 vcc, v24, v16
    s_nop 1
    v_cndmask_b32 v16, v16, v24, vcc
    v_cndmask_b32 v17, v17, v25, vcc
    v_cmp_gt_f32 vcc, v26, v16
    s_nop 1
    v_cndmask_b32 v16, v16, v26, vcc
    v_cndmask_b32 v17, v17, v27, vcc
    s_nop 0
    v_readfirstlane_b32 s40, v17
    v_readfirstlane_b32 s42, v16
    s_nop 3
    v_mov_b32 v19, 0xff800000
    v_add_u32 v18, 0, v3
    v_cmp_eq_u32 vcc, s40, v18
    s_nop 1
    v_cndmask_b32 v8, v8, v19, vcc
    v_add_u32 v18, 1, v3
    v_cmp_eq_u32 vcc, s40, v18
    s_nop 1
    v_cndmask_b32 v9, v9, v19, vcc
    v_add_u32 v18, 2, v3
    v_cmp_eq_u32 vcc, s40, v18
    s_nop 1
    v_cndmask_b32 v10, v10, v19, vcc
    v_add_u32 v18, 3, v3
    v_cmp_eq_u32 vcc, s40, v18
    s_nop 1
    v_cndmask_b32 v11, v11, v19, vcc
    v_add_u32 v18, 4, v3
    v_cmp_eq_u32 vcc, s40, v18
    s_nop 1
    v_cndmask_b32 v12, v12, v19, vcc
    v_add_u32 v18, 5, v3
    v_cmp_eq_u32 vcc, s40, v18
    s_nop 1
    v_cndmask_b32 v13, v13, v19, vcc
    v_add_u32 v18, 6, v3
    v_cmp_eq_u32 vcc, s40, v18
    s_nop 1
    v_cndmask_b32 v14, v14, v19, vcc
    v_add_u32 v18, 7, v3
    v_cmp_eq_u32 vcc, s40, v18
    s_nop 1
    v_cndmask_b32 v15, v15, v19, vcc
    v_mov_b32 v16, v8
    v_mov_b32 v17, v3
    v_cmp_gt_f32 vcc, v9, v16
    v_add_u32 v18, 1, v3
    s_nop 0
    v_cndmask_b32 v16, v16, v9, vcc
    v_cndmask_b32 v17, v17, v18, vcc
    v_cmp_gt_f32 vcc, v10, v16
    v_add_u32 v18, 2, v3
    s_nop 0
    v_cndmask_b32 v16, v16, v10, vcc
    v_cndmask_b32 v17, v17, v18, vcc
    v_cmp_gt_f32 vcc, v11, v16
    v_add_u32 v18, 3, v3
    s_nop 0
    v_cndmask_b32 v16, v16, v11, vcc
    v_cndmask_b32 v17, v17, v18, vcc
    v_cmp_gt_f32 vcc, v12, v16
    v_add_u32 v18, 4, v3
    s_nop 0
    v_cndmask_b32 v16, v16, v12, vcc
    v_cndmask_b32 v17, v17, v18, vcc
    v_cmp_gt_f32 vcc, v13, v16
    v_add_u32 v18, 5, v3
    s_nop 0
    v_cndmask_b32 v16, v16, v13, vcc
    v_cndmask_b32 v17, v17, v18, vcc
    v_cmp_gt_f32 vcc, v14, v16
    v_add_u32 v18, 6, v3
    s_nop 0
    v_cndmask_b32 v16, v16, v14, vcc
    v_cndmask_b32 v17, v17, v18, vcc
    v_cmp_gt_f32 vcc, v15, v16
    v_add_u32 v18, 7, v3
    s_nop 0
    v_cndmask_b32 v16, v16, v15, vcc
    v_cndmask_b32 v17, v17, v18, vcc
    s_nop 1
    v_mov_b32_dpp v18, v16 quad_perm:[1,0,3,2] row_mask:0xf bank_mask:0xf
    v_mov_b32_dpp v19, v17 quad_perm:[1,0,3,2] row_mask:0xf bank_mask:0xf
    v_cmp_gt_f32 vcc, v18, v16
    v_cmp_eq_f32 s[44:45], v18, v16
    v_cmp_lt_u32 s[46:47], v19, v17
    s_nop 1
    s_and_b64 s[44:45], s[44:45], s[46:47]
    s_or_b64 vcc, vcc, s[44:45]
    v_cndmask_b32 v16, v16, v18, vcc
    v_cndmask_b32 v17, v17, v19, vcc
    s_nop 1
    v_mov_b32_dpp v18, v16 quad_perm:[2,3,0,1] row_mask:0xf bank_mask:0xf
    v_mov_b32_dpp v19, v17 quad_perm:[2,3,0,1] row_mask:0xf bank_mask:0xf
    v_cmp_gt_f32 vcc, v18, v16
    v_cmp_eq_f32 s[44:45], v18, v16
    v_cmp_lt_u32 s[46:47], v19, v17
    s_nop 1
    s_and_b64 s[44:45], s[44:45], s[46:47]
    s_or_b64 vcc, vcc, s[44:45]
    v_cndmask_b32 v16, v16, v18, vcc
    v_cndmask_b32 v17, v17, v19, vcc
    s_nop 1
    v_mov_b32_dpp v18, v16 row_half_mirror row_mask:0xf bank_mask:0xf
    v_mov_b32_dpp v19, v17 row_half_mirror row_mask:0xf bank_mask:0xf
    v_cmp_gt_f32 vcc, v18, v16
    v_cmp_eq_f32 s[44:45], v18, v16
    v_cmp_lt_u32 s[46:47], v19, v17
    s_nop 1
    s_and_b64 s[44:45], s[44:45], s[46:47]
    s_or_b64 vcc, vcc, s[44:45]
    v_cndmask_b32 v16, v16, v18, vcc
    v_cndmask_b32 v17, v17, v19, vcc
    s_nop 1
    v_mov_b32_dpp v18, v16 row_mirror row_mask:0xf bank_mask:0xf
    v_mov_b32_dpp v19, v17 row_mirror row_mask:0xf bank_mask:0xf
    v_cmp_gt_f32 vcc, v18, v16
    v_cmp_eq_f32 s[44:45], v18, v16
    v_cmp_lt_u32 s[46:47], v19, v17
    s_nop 1
    s_and_b64 s[44:45], s[44:45], s[46:47]
    s_or_b64 vcc, vcc, s[44:45]
    v_cndmask_b32 v16, v16, v18, vcc
    v_cndmask_b32 v17, v17, v19, vcc
    v_mov_b32 v18, v16
    v_mov_b32 v19, v17
    v_mov_b32 v20, v16
    v_mov_b32 v21, v17
    s_nop 1
    v_permlane16_swap_b32 v18, v20
    v_permlane16_swap_b32 v19, v21
    s_nop 1
    v_cmp_gt_f32 vcc, v20, v18
    v_cmp_eq_f32 s[44:45], v20, v18
    v_cmp_lt_u32 s[46:47], v21, v19
    s_nop 1
    s_and_b64 s[44:45], s[44:45], s[46:47]
    s_or_b64 vcc, vcc, s[44:45]
    v_cndmask_b32 v18, v18, v20, vcc
    v_cndmask_b32 v19, v19, v21, vcc
    v_cmp_gt_f32 vcc, v18, v16
    v_cmp_eq_f32 s[44:45], v18, v16
    v_cmp_lt_u32 s[46:47], v19, v17
    s_nop 1
    s_and_b64 s[44:45], s[44:45], s[46:47]
    s_or_b64 vcc, vcc, s[44:45]
    v_cndmask_b32 v16, v16, v18, vcc
    v_cndmask_b32 v17, v17, v19, vcc
    v_mov_b32 v18, v16
    v_mov_b32 v19, v17
    v_mov_b32 v20, v16
    v_mov_b32 v21, v17
    s_nop 1
    v_permlane32_swap_b32 v18, v20
    v_permlane32_swap_b32 v19, v21
    s_nop 1
    v_cmp_gt_f32 vcc, v20, v18
    v_cmp_eq_f32 s[44:45], v20, v18
    v_cmp_lt_u32 s[46:47], v21, v19
    s_nop 1
    s_and_b64 s[44:45], s[44:45], s[46:47]
    s_or_b64 vcc, vcc, s[44:45]
    v_cndmask_b32 v18, v18, v20, vcc
    v_cndmask_b32 v19, v19, v21, vcc
    v_cmp_gt_f32 vcc, v18, v16
    v_cmp_eq_f32 s[44:45], v18, v16
    v_cmp_lt_u32 s[46:47], v19, v17
    s_nop 1
    s_and_b64 s[44:45], s[44:45], s[46:47]
    s_or_b64 vcc, vcc, s[44:45]
    v_cndmask_b32 v16, v16, v18, vcc
    v_cndmask_b32 v17, v17, v19, vcc
    v_lshrrev_b32 v18, 6, v0
    v_lshlrev_b32 v18, 3, v18
    s_barrier
    ds_write_b64 v18, v[16:17]
    s_waitcnt lgkmcnt(0)
    s_barrier
    v_mov_b32 v18, 0
    ds_read_b128 v[20:23], v18
    ds_read_b128 v[24:27], v18 offset:16
    s_waitcnt lgkmcnt(0)
    v_mov_b32 v16, v20
    v_mov_b32 v17, v21
    v_cmp_gt_f32 vcc, v22, v16
    s_nop 1
    v_cndmask_b32 v16, v16, v22, vcc
    v_cndmask_b32 v17, v17, v23, vcc
    v_cmp_gt_f32 vcc, v24, v16
    s_nop 1
    v_cndmask_b32 v16, v16, v24, vcc
    v_cndmask_b32 v17, v17, v25, vcc
    v_cmp_gt_f32 vcc, v26, v16
    s_nop 1
    v_cndmask_b32 v16, v16, v26, vcc
    v_cndmask_b32 v17, v17, v27, vcc
    s_nop 0
    v_readfirstlane_b32 s41, v17
    v_readfirstlane_b32 s43, v16
    s_nop 3
    s_load_dwordx2 s[12:13], s[0:1], 112
    s_waitcnt lgkmcnt(0)
    s_and_b32 s13, s13, 0xffff
    s_mov_b32 s14, 1835008
    s_mov_b32 s15, 0x20000
    s_cmp_eq_u32 s59, 0
    s_cbranch_scc1 norest_116
    s_cmp_eq_u32 s3, 0
    s_cselect_b32 s62, s60, s61
    s_cmp_eq_u32 s62, s40
    s_cbranch_scc1 norest_116
    s_cmp_eq_u32 s62, s41
    s_cbranch_scc1 norest_116
    v_min_u32 v3, 223, v0
    v_lshlrev_b32 v4, 3, v3
    v_lshlrev_b32 v5, 2, v3
    s_mul_i32 s19, s62, 896
    s_add_u32 s20, s19, 87072768
    buffer_load_dword v8, v5, s[4:7], s20 offen sc1
    s_add_u32 s20, s19, 88907776
    buffer_load_dword v9, v5, s[4:7], s20 offen sc1
    s_mov_b32 s20, 87061248
    buffer_load_dwordx2 v[10:11], v4, s[4:7], s20 offen sc1
    s_waitcnt vmcnt(0)
    v_lshlrev_b32 v32, 16, v8
    v_and_b32 v33, 0xffff0000, v8
    v_mul_f32 v32, v32, v10
    v_mul_f32 v33, v33, v11
    v_cvt_pk_bf16_f32 v14, v32, v33
    v_lshlrev_b32 v32, 16, v14
    v_and_b32 v33, 0xffff0000, v14
    v_lshlrev_b32 v14, 16, v9
    v_and_b32 v15, 0xffff0000, v9
    v_add_f32 v32, v32, v14
    v_add_f32 v33, v33, v15
    v_cvt_pk_bf16_f32 v32, v32, v33
    v_cmp_gt_u32 vcc, 224, v0
    s_and_saveexec_b64 s[44:45], vcc
    s_cbranch_execz mrs_117
    buffer_store_dword v32, v5, s[12:15], s19 offen sc1
mrs_117:
    s_mov_b64 exec, s[44:45]
norest_116:
    s_mov_b32 s60, s40
    s_mov_b32 s61, s41
    s_mov_b32 s63, s43
    s_cmp_eq_u32 s3, 0
    s_cselect_b32 s40, s40, s41
    s_cselect_b32 s42, s42, s43
    v_min_u32 v3, 223, v0
    v_lshlrev_b32 v4, 3, v3
    v_lshlrev_b32 v5, 2, v3
    s_mul_i32 s19, s40, 896
    s_add_u32 s20, s19, 87072768
    buffer_load_dword v8, v5, s[4:7], s20 offen sc1
    s_add_u32 s20, s19, 88907776
    buffer_load_dword v9, v5, s[4:7], s20 offen sc1
    s_mov_b32 s20, 87061248
    buffer_load_dwordx2 v[10:11], v4, s[4:7], s20 offen sc1
    v_mov_b32 v12, s42
    v_mul_f32 v12, 0xbfb8aa3b, v12
    v_exp_f32 v12, v12
    s_nop 0
    v_add_f32 v12, 1.0, v12
    v_rcp_f32 v12, v12
    s_nop 0
    v_cvt_pk_bf16_f32 v14, v12, v12
    v_lshlrev_b32 v12, 16, v14
    s_waitcnt vmcnt(0)
    s_lshl_b32 s93, s59, 7
    s_add_u32 s93, s93, 90974784
    s_cmp_lg_u32 s87, 0
    s_cbranch_scc1 wsk_120
    s_mov_b32 s90, 0
    v_mov_b32 v250, 0
wge_118:
    buffer_load_dword v251, v250, s[4:7], s93 offen sc1
    s_waitcnt vmcnt(0)
    v_readfirstlane_b32 s92, v251
    s_nop 3
    s_cmp_ge_u32 s92, 56
    s_cbranch_scc1 wok_119
    s_sleep 1
    s_add_u32 s90, s90, 1
    s_cmp_lt_u32 s90, 400000
    s_cbranch_scc1 wge_118
    s_branch L_abort
wok_119:
wsk_120:
    s_barrier
    s_mul_i32 s18, s3, 1792
    s_add_u32 s18, s18, 90742784
    buffer_load_dwordx2 v[32:33], v4, s[4:7], s18 offen sc1
    s_add_u32 s18, s18, 3584
    buffer_load_dwordx2 v[34:35], v4, s[4:7], s18 offen sc1
    s_add_u32 s18, s18, 3584
    buffer_load_dwordx2 v[36:37], v4, s[4:7], s18 offen sc1
    s_add_u32 s18, s18, 3584
    buffer_load_dwordx2 v[38:39], v4, s[4:7], s18 offen sc1
    s_add_u32 s18, s18, 3584
    buffer_load_dwordx2 v[40:41], v4, s[4:7], s18 offen sc1
    s_add_u32 s18, s18, 3584
    buffer_load_dwordx2 v[42:43], v4, s[4:7], s18 offen sc1
    s_add_u32 s18, s18, 3584
    buffer_load_dwordx2 v[44:45], v4, s[4:7], s18 offen sc1
    s_add_u32 s18, s18, 3584
    buffer_load_dwordx2 v[46:47], v4, s[4:7], s18 offen sc1
    s_add_u32 s18, s18, 3584
    buffer_load_dwordx2 v[48:49], v4, s[4:7], s18 offen sc1
    s_add_u32 s18, s18, 3584
    buffer_load_dwordx2 v[50:51], v4, s[4:7], s18 offen sc1
    s_add_u32 s18, s18, 3584
    buffer_load_dwordx2 v[52:53], v4, s[4:7], s18 offen sc1
    s_add_u32 s18, s18, 3584
    buffer_load_dwordx2 v[54:55], v4, s[4:7], s18 offen sc1
    s_add_u32 s18, s18, 3584
    buffer_load_dwordx2 v[56:57], v4, s[4:7], s18 offen sc1
    s_add_u32 s18, s18, 3584
    buffer_load_dwordx2 v[58:59], v4, s[4:7], s18 offen sc1
    s_add_u32 s18, s18, 3584
    buffer_load_dwordx2 v[60:61], v4, s[4:7], s18 offen sc1
    s_add_u32 s18, s18, 3584
    buffer_load_dwordx2 v[62:63], v4, s[4:7], s18 offen sc1
    s_add_u32 s18, s18, 3584
    buffer_load_dwordx2 v[64:65], v4, s[4:7], s18 offen sc1
    s_add_u32 s18, s18, 3584
    buffer_load_dwordx2 v[66:67], v4, s[4:7], s18 offen sc1
    s_add_u32 s18, s18, 3584
    buffer_load_dwordx2 v[68:69], v4, s[4:7], s18 offen sc1
    s_add_u32 s18, s18, 3584
    buffer_load_dwordx2 v[70:71], v4, s[4:7], s18 offen sc1
    s_add_u32 s18, s18, 3584
    buffer_load_dwordx2 v[72:73], v4, s[4:7], s18 offen sc1
    s_add_u32 s18, s18, 3584
    buffer_load_dwordx2 v[74:75], v4, s[4:7], s18 offen sc1
    s_add_u32 s18, s18, 3584
    buffer_load_dwordx2 v[76:77], v4, s[4:7], s18 offen sc1
    s_add_u32 s18, s18, 3584
    buffer_load_dwordx2 v[78:79], v4, s[4:7], s18 offen sc1
    s_add_u32 s18, s18, 3584
    buffer_load_dwordx2 v[80:81], v4, s[4:7], s18 offen sc1
    s_add_u32 s18, s18, 3584
    buffer_load_dwordx2 v[82:83], v4, s[4:7], s18 offen sc1
    s_add_u32 s18, s18, 3584
    buffer_load_dwordx2 v[84:85], v4, s[4:7], s18 offen sc1
    s_add_u32 s18, s18, 3584
    buffer_load_dwordx2 v[86:87], v4, s[4:7], s18 offen sc1
    s_add_u32 s18, s18, 3584
    buffer_load_dwordx2 v[88:89], v4, s[4:7], s18 offen sc1
    s_add_u32 s18, s18, 3584
    buffer_load_dwordx2 v[90:91], v4, s[4:7], s18 offen sc1
    s_add_u32 s18, s18, 3584
    buffer_load_dwordx2 v[92:93], v4, s[4:7], s18 offen sc1
    s_add_u32 s18, s18, 3584
    buffer_load_dwordx2 v[94:95], v4, s[4:7], s18 offen sc1
    s_add_u32 s18, s18, 3584
    buffer_load_dwordx2 v[96:97], v4, s[4:7], s18 offen sc1
    s_add_u32 s18, s18, 3584
    buffer_load_dwordx2 v[98:99], v4, s[4:7], s18 offen sc1
    s_add_u32 s18, s18, 3584
    buffer_load_dwordx2 v[100:101], v4, s[4:7], s18 offen sc1
    s_add_u32 s18, s18, 3584
    buffer_load_dwordx2 v[102:103], v4, s[4:7], s18 offen sc1
    s_add_u32 s18, s18, 3584
    buffer_load_dwordx2 v[104:105], v4, s[4:7], s18 offen sc1
    s_add_u32 s18, s18, 3584
    buffer_load_dwordx2 v[106:107], v4, s[4:7], s18 offen sc1
    s_add_u32 s18, s18, 3584
    buffer_load_dwordx2 v[108:109], v4, s[4:7], s18 offen sc1
    s_add_u32 s18, s18, 3584
    buffer_load_dwordx2 v[110:111], v4, s[4:7], s18 offen sc1
    s_add_u32 s18, s18, 3584
    buffer_load_dwordx2 v[112:113], v4, s[4:7], s18 offen sc1
    s_add_u32 s18, s18, 3584
    buffer_load_dwordx2 v[114:115], v4, s[4:7], s18 offen sc1
    s_add_u32 s18, s18, 3584
    buffer_load_dwordx2 v[116:117], v4, s[4:7], s18 offen sc1
    s_add_u32 s18, s18, 3584
    buffer_load_dwordx2 v[118:119], v4, s[4:7], s18 offen sc1
    s_add_u32 s18, s18, 3584
    buffer_load_dwordx2 v[120:121], v4, s[4:7], s18 offen sc1
    s_add_u32 s18, s18, 3584
    buffer_load_dwordx2 v[122:123], v4, s[4:7], s18 offen sc1
    s_add_u32 s18, s18, 3584
    buffer_load_dwordx2 v[124:125], v4, s[4:7], s18 offen sc1
    s_add_u32 s18, s18, 3584
    buffer_load_dwordx2 v[126:127], v4, s[4:7], s18 offen sc1
    s_add_u32 s18, s18, 3584
    buffer_load_dwordx2 v[128:129], v4, s[4:7], s18 offen sc1
    s_add_u32 s18, s18, 3584
    buffer_load_dwordx2 v[130:131], v4, s[4:7], s18 offen sc1
    s_add_u32 s18, s18, 3584
    buffer_load_dwordx2 v[132:133], v4, s[4:7], s18 offen sc1
    s_add_u32 s18, s18, 3584
    buffer_load_dwordx2 v[134:135], v4, s[4:7], s18 offen sc1
    s_add_u32 s18, s18, 3584
    buffer_load_dwordx2 v[136:137], v4, s[4:7], s18 offen sc1
    s_add_u32 s18, s18, 3584
    buffer_load_dwordx2 v[138:139], v4, s[4:7], s18 offen sc1
    s_add_u32 s18, s18, 3584
    buffer_load_dwordx2 v[140:141], v4, s[4:7], s18 offen sc1
    s_add_u32 s18, s18, 3584
    buffer_load_dwordx2 v[142:143], v4, s[4:7], s18 offen sc1
    s_add_u32 s18, s18, 3584
    s_waitcnt vmcnt(0)
    v_pk_add_f32 v[32:33], v[32:33], v[88:89]
    v_pk_add_f32 v[34:35], v[34:35], v[90:91]
    v_pk_add_f32 v[36:37], v[36:37], v[92:93]
    v_pk_add_f32 v[38:39], v[38:39], v[94:95]
    v_pk_add_f32 v[40:41], v[40:41], v[96:97]
    v_pk_add_f32 v[42:43], v[42:43], v[98:99]
    v_pk_add_f32 v[44:45], v[44:45], v[100:101]
    v_pk_add_f32 v[46:47], v[46:47], v[102:103]
    v_pk_add_f32 v[48:49], v[48:49], v[104:105]
    v_pk_add_f32 v[50:51], v[50:51], v[106:107]
    v_pk_add_f32 v[52:53], v[52:53], v[108:109]
    v_pk_add_f32 v[54:55], v[54:55], v[110:111]
    v_pk_add_f32 v[56:57], v[56:57], v[112:113]
    v_pk_add_f32 v[58:59], v[58:59], v[114:115]
    v_pk_add_f32 v[60:61], v[60:61], v[116:117]
    v_pk_add_f32 v[62:63], v[62:63], v[118:119]
    v_pk_add_f32 v[64:65], v[64:65], v[120:121]
    v_pk_add_f32 v[66:67], v[66:67], v[122:123]
    v_pk_add_f32 v[68:69], v[68:69], v[124:125]
    v_pk_add_f32 v[70:71], v[70:71], v[126:127]
    v_pk_add_f32 v[72:73], v[72:73], v[128:129]
    v_pk_add_f32 v[74:75], v[74:75], v[130:131]
    v_pk_add_f32 v[76:77], v[76:77], v[132:133]
    v_pk_add_f32 v[78:79], v[78:79], v[134:135]
    v_pk_add_f32 v[80:81], v[80:81], v[136:137]
    v_pk_add_f32 v[82:83], v[82:83], v[138:139]
    v_pk_add_f32 v[84:85], v[84:85], v[140:141]
    v_pk_add_f32 v[86:87], v[86:87], v[142:143]
    v_pk_add_f32 v[32:33], v[32:33], v[60:61]
    v_pk_add_f32 v[34:35], v[34:35], v[62:63]
    v_pk_add_f32 v[36:37], v[36:37], v[64:65]
    v_pk_add_f32 v[38:39], v[38:39], v[66:67]
    v_pk_add_f32 v[40:41], v[40:41], v[68:69]
    v_pk_add_f32 v[42:43], v[42:43], v[70:71]
    v_pk_add_f32 v[44:45], v[44:45], v[72:73]
    v_pk_add_f32 v[46:47], v[46:47], v[74:75]
    v_pk_add_f32 v[48:49], v[48:49], v[76:77]
    v_pk_add_f32 v[50:51], v[50:51], v[78:79]
    v_pk_add_f32 v[52:53], v[52:53], v[80:81]
    v_pk_add_f32 v[54:55], v[54:55], v[82:83]
    v_pk_add_f32 v[56:57], v[56:57], v[84:85]
    v_pk_add_f32 v[58:59], v[58:59], v[86:87]
    v_pk_add_f32 v[32:33], v[32:33], v[46:47]
    v_pk_add_f32 v[34:35], v[34:35], v[48:49]
    v_pk_add_f32 v[36:37], v[36:37], v[50:51]
    v_pk_add_f32 v[38:39], v[38:39], v[52:53]
    v_pk_add_f32 v[40:41], v[40:41], v[54:55]
    v_pk_add_f32 v[42:43], v[42:43], v[56:57]
    v_pk_add_f32 v[44:45], v[44:45], v[58:59]
    v_pk_add_f32 v[32:33], v[32:33], v[34:35]
    v_pk_add_f32 v[32:33], v[32:33], v[36:37]
    v_pk_add_f32 v[32:33], v[32:33], v[38:39]
    v_pk_add_f32 v[32:33], v[32:33], v[40:41]
    v_pk_add_f32 v[32:33], v[32:33], v[42:43]
    v_pk_add_f32 v[32:33], v[32:33], v[44:45]
    v_cvt_pk_bf16_f32 v14, v32, v33
    v_lshlrev_b32 v32, 16, v14
    v_and_b32 v33, 0xffff0000, v14
    v_mul_f32 v32, v32, v12
    v_mul_f32 v33, v33, v12
    v_cvt_pk_bf16_f32 v14, v32, v33
    v_lshlrev_b32 v32, 16, v14
    v_and_b32 v33, 0xffff0000, v14
    v_lshlrev_b32 v14, 16, v8
    v_and_b32 v15, 0xffff0000, v8
    v_add_f32 v32, v32, v14
    v_add_f32 v33, v33, v15
    v_cvt_pk_bf16_f32 v14, v32, v33
    v_lshlrev_b32 v32, 16, v14
    v_and_b32 v33, 0xffff0000, v14
    v_mul_f32 v32, v32, v10
    v_mul_f32 v33, v33, v11
    v_cvt_pk_bf16_f32 v14, v32, v33
    v_lshlrev_b32 v32, 16, v14
    v_and_b32 v33, 0xffff0000, v14
    v_lshlrev_b32 v14, 16, v9
    v_and_b32 v15, 0xffff0000, v9
    v_add_f32 v32, v32, v14
    v_add_f32 v33, v33, v15
    v_cvt_pk_bf16_f32 v32, v32, v33
    v_cmp_gt_u32 vcc, 224, v0
    s_and_saveexec_b64 s[44:45], vcc
    s_cbranch_execz m2s_121
    buffer_store_dword v32, v5, s[12:15], s19 offen sc1
m2s_121:
    s_mov_b64 exec, s[44:45]
L_moe_check:
    s_cmp_lg_u32 s59, 0
    s_cbranch_scc1 L_done
    v_and_b32 v2, 63, v0
    v_lshlrev_b32 v2, 4, v2
    s_mov_b32 s16, 87071744
    s_mov_b32 s90, 0
rbp_122:
    buffer_load_dwordx4 v[8:11], v2, s[4:7], s16 offen sc1
    s_waitcnt vmcnt(0)
    v_max3_u32 v12, v8, v9, v10
    v_max_u32 v12, v12, v11
    v_cmp_eq_u32 vcc, -1, v12
    s_cbranch_vccz rbo_123
    v_readfirstlane_b32 s17, v8
    s_nop 3
    s_cmp_lg_u32 s17, -1
    s_cbranch_scc1 rbs_124
    s_sleep 24
rbs_124:
    s_sleep 2
    s_add_u32 s90, s90, 1
    s_cmp_lt_u32 s90, 400000
    s_cbranch_scc1 rbp_122
    s_branch L_abort
rbo_123:
    v_max3_f32 v8, v8, v9, v10
    v_max_f32 v8, v8, v11
    v_cmp_lt_f32 vcc, s63, v8
    s_cbranch_vccz L_done
    s_mov_b32 s59, 1
    s_branch L_moe_round
L_R_entry:
    s_and_b32 s93, s84, 15
    s_lshl_b32 s93, s93, 6
    s_cmp_ge_u32 s84, 128
    s_cselect_b32 s93, 1024, s93
    s_add_u32 s93, s93, 90976256
    s_waitcnt vmcnt(0)
    s_barrier
    s_cmp_lg_u32 s87, 0
    s_cbranch_scc1 sig_125
    v_mov_b32 v250, 0
    v_mov_b32 v251, 1
    s_mov_b64 exec, 1
    buffer_atomic_add v251, v250, s[4:7], s93 offen
    s_mov_b64 exec, -1
sig_125:
    s_cmp_ge_u32 s75, 256
    s_cbranch_scc1 noln_126
    s_mov_b32 s91, 64
    s_cmp_lg_u32 s87, 0
    s_cbranch_scc1 wsk_129
    s_load_dwordx2 s[96:97], s[0:1], 120
    s_waitcnt lgkmcnt(0)
    s_mov_b32 s90, 0
    v_mov_b32 v60, s91
wge_127:
    global_load_dword v61, v60, s[96:97] sc1
    s_waitcnt vmcnt(0)
    v_readfirstlane_b32 s92, v61
    s_nop 3
    s_cmp_ge_u32 s92, 14
    s_cbranch_scc1 wok_128
    s_sleep 2
    s_add_u32 s90, s90, 1
    s_cmp_lt_u32 s90, 400000
    s_cbranch_scc1 wge_127
    s_branch L_abort
wok_128:
wsk_129:
    s_barrier
    s_mov_b32 s3, s75
    v_and_b32 v1, 63, v0
    v_lshrrev_b32 v2, 6, v0
    s_nop 0
    v_readfirstlane_b32 s16, v2
    v_min_u32 v3, 55, v1
    v_lshrrev_b32 v4, 1, v3
    v_lshlrev_b32 v4, 4, v4
    v_and_b32 v5, 1, v3
    v_lshl_add_u32 v4, v5, 2, v4
    v_mul_u32_u24 v4, 2, v4
    v_lshlrev_b32 v5, 1, v4
    s_mov_b32 s21, 87054080
    buffer_load_dwordx4 v[40:43], v5, s[4:7], s21 offen sc1
    buffer_load_dwordx4 v[44:47], v5, s[4:7], s21 offen offset:32 sc1
    s_mov_b32 s21, 87052288
    buffer_load_dwordx4 v[48:51], v5, s[4:7], s21 offen sc1
    buffer_load_dwordx4 v[52:55], v5, s[4:7], s21 offen offset:32 sc1
    s_lshl_b32 s17, s3, 3
    s_lshl_b32 s16, s16, 1
    s_add_u32 s17, s17, s16
    s_mul_i32 s18, s17, 896
    v_accvgpr_read_b32 v8, a248
    v_accvgpr_read_b32 v9, a249
    v_accvgpr_read_b32 v10, a250
    v_accvgpr_read_b32 v11, a251
    v_accvgpr_read_b32 v12, a252
    v_accvgpr_read_b32 v13, a253
    v_accvgpr_read_b32 v14, a254
    v_accvgpr_read_b32 v15, a255
    s_mov_b32 s22, -1
    s_mov_b32 s23, 0x00ffffff
    s_waitcnt vmcnt(0)
    v_lshlrev_b32 v16, 16, v8
    v_and_b32 v17, 0xffff0000, v8
    v_lshlrev_b32 v18, 16, v9
    v_and_b32 v19, 0xffff0000, v9
    v_lshlrev_b32 v20, 16, v10
    v_and_b32 v21, 0xffff0000, v10
    v_lshlrev_b32 v22, 16, v11
    v_and_b32 v23, 0xffff0000, v11
    v_cndmask_b32 v16, 0, v16, s[22:23]
    v_cndmask_b32 v17, 0, v17, s[22:23]
    v_cndmask_b32 v18, 0, v18, s[22:23]
    v_cndmask_b32 v19, 0, v19, s[22:23]
    v_cndmask_b32 v20, 0, v20, s[22:23]
    v_cndmask_b32 v21, 0, v21, s[22:23]
    v_cndmask_b32 v22, 0, v22, s[22:23]
    v_cndmask_b32 v23, 0, v23, s[22:23]
    v_lshlrev_b32 v24, 16, v12
    v_and_b32 v25, 0xffff0000, v12
    v_lshlrev_b32 v26, 16, v13
    v_and_b32 v27, 0xffff0000, v13
    v_lshlrev_b32 v28, 16, v14
    v_and_b32 v29, 0xffff0000, v14
    v_lshlrev_b32 v30, 16, v15
    v_and_b32 v31, 0xffff0000, v15
    v_cndmask_b32 v24, 0, v24, s[22:23]
    v_cndmask_b32 v25, 0, v25, s[22:23]
    v_cndmask_b32 v26, 0, v26, s[22:23]
    v_cndmask_b32 v27, 0, v27, s[22:23]
    v_cndmask_b32 v28, 0, v28, s[22:23]
    v_cndmask_b32 v29, 0, v29, s[22:23]
    v_cndmask_b32 v30, 0, v30, s[22:23]
    v_cndmask_b32 v31, 0, v31, s[22:23]
    v_add_f32 v40, 1.0, v40
    v_add_f32 v41, 1.0, v41
    v_cvt_pk_bf16_f32 v6, v40, v41
    v_lshlrev_b32 v40, 16, v6
    v_and_b32 v41, 0xffff0000, v6
    v_add_f32 v42, 1.0, v42
    v_add_f32 v43, 1.0, v43
    v_cvt_pk_bf16_f32 v6, v42, v43
    v_lshlrev_b32 v42, 16, v6
    v_and_b32 v43, 0xffff0000, v6
    v_add_f32 v44, 1.0, v44
    v_add_f32 v45, 1.0, v45
    v_cvt_pk_bf16_f32 v6, v44, v45
    v_lshlrev_b32 v44, 16, v6
    v_and_b32 v45, 0xffff0000, v6
    v_add_f32 v46, 1.0, v46
    v_add_f32 v47, 1.0, v47
    v_cvt_pk_bf16_f32 v6, v46, v47
    v_lshlrev_b32 v46, 16, v6
    v_and_b32 v47, 0xffff0000, v6
    v_add_f32 v32, v16, v17
    v_add_f32 v32, v32, v18
    v_add_f32 v32, v32, v19
    v_add_f32 v32, v32, v20
    v_add_f32 v32, v32, v21
    v_add_f32 v32, v32, v22
    v_add_f32 v32, v32, v23
    v_add_f32 v33, v24, v25
    v_add_f32 v33, v33, v26
    v_add_f32 v33, v33, v27
    v_add_f32 v33, v33, v28
    v_add_f32 v33, v33, v29
    v_add_f32 v33, v33, v30
    v_add_f32 v33, v33, v31
    s_nop 1
    v_add_f32_dpp v32, v32, v32 quad_perm:[1,0,3,2] row_mask:0xf bank_mask:0xf
    v_add_f32_dpp v33, v33, v33 quad_perm:[1,0,3,2] row_mask:0xf bank_mask:0xf
    s_nop 1
    v_add_f32_dpp v32, v32, v32 quad_perm:[2,3,0,1] row_mask:0xf bank_mask:0xf
    v_add_f32_dpp v33, v33, v33 quad_perm:[2,3,0,1] row_mask:0xf bank_mask:0xf
    s_nop 1
    v_add_f32_dpp v32, v32, v32 row_half_mirror row_mask:0xf bank_mask:0xf
    v_add_f32_dpp v33, v33, v33 row_half_mirror row_mask:0xf bank_mask:0xf
    s_nop 1
    v_add_f32_dpp v32, v32, v32 row_mirror row_mask:0xf bank_mask:0xf
    v_add_f32_dpp v33, v33, v33 row_mirror row_mask:0xf bank_mask:0xf
    v_mov_b32 v56, v32
    v_mov_b32 v57, v33
    s_nop 1
    v_permlane16_swap_b32 v32, v56
    v_permlane16_swap_b32 v33, v57
    s_nop 1
    v_add_f32 v32, v32, v56
    v_add_f32 v33, v33, v57
    v_mov_b32 v56, v32
    v_mov_b32 v57, v33
    s_nop 1
    v_permlane32_swap_b32 v32, v56
    v_permlane32_swap_b32 v33, v57
    s_nop 1
    v_add_f32 v32, v32, v56
    v_add_f32 v33, v33, v57
    s_mov_b32 s20, 0x3b124925
    v_mul_f32 v32, s20, v32
    v_mul_f32 v33, s20, v33
    v_sub_f32 v56, v16, v32
    v_mul_f32 v34, v56, v56
    v_sub_f32 v56, v17, v32
    v_fmac_f32 v34, v56, v56
    v_sub_f32 v56, v18, v32
    v_fmac_f32 v34, v56, v56
    v_sub_f32 v56, v19, v32
    v_fmac_f32 v34, v56, v56
    v_sub_f32 v56, v20, v32
    v_fmac_f32 v34, v56, v56
    v_sub_f32 v56, v21, v32
    v_fmac_f32 v34, v56, v56
    v_sub_f32 v56, v22, v32
    v_fmac_f32 v34, v56, v56
    v_sub_f32 v56, v23, v32
    v_fmac_f32 v34, v56, v56
    v_cndmask_b32 v34, 0, v34, s[22:23]
    v_sub_f32 v56, v24, v33
    v_mul_f32 v35, v56, v56
    v_sub_f32 v56, v25, v33
    v_fmac_f32 v35, v56, v56
    v_sub_f32 v56, v26, v33
    v_fmac_f32 v35, v56, v56
    v_sub_f32 v56, v27, v33
    v_fmac_f32 v35, v56, v56
    v_sub_f32 v56, v28, v33
    v_fmac_f32 v35, v56, v56
    v_sub_f32 v56, v29, v33
    v_fmac_f32 v35, v56, v56
    v_sub_f32 v56, v30, v33
    v_fmac_f32 v35, v56, v56
    v_sub_f32 v56, v31, v33
    v_fmac_f32 v35, v56, v56
    v_cndmask_b32 v35, 0, v35, s[22:23]
    s_nop 1
    v_add_f32_dpp v34, v34, v34 quad_perm:[1,0,3,2] row_mask:0xf bank_mask:0xf
    v_add_f32_dpp v35, v35, v35 quad_perm:[1,0,3,2] row_mask:0xf bank_mask:0xf
    s_nop 1
    v_add_f32_dpp v34, v34, v34 quad_perm:[2,3,0,1] row_mask:0xf bank_mask:0xf
    v_add_f32_dpp v35, v35, v35 quad_perm:[2,3,0,1] row_mask:0xf bank_mask:0xf
    s_nop 1
    v_add_f32_dpp v34, v34, v34 row_half_mirror row_mask:0xf bank_mask:0xf
    v_add_f32_dpp v35, v35, v35 row_half_mirror row_mask:0xf bank_mask:0xf
    s_nop 1
    v_add_f32_dpp v34, v34, v34 row_mirror row_mask:0xf bank_mask:0xf
    v_add_f32_dpp v35, v35, v35 row_mirror row_mask:0xf bank_mask:0xf
    v_mov_b32 v56, v34
    v_mov_b32 v57, v35
    s_nop 1
    v_permlane16_swap_b32 v34, v56
    v_permlane16_swap_b32 v35, v57
    s_nop 1
    v_add_f32 v34, v34, v56
    v_add_f32 v35, v35, v57
    v_mov_b32 v56, v34
    v_mov_b32 v57, v35
    s_nop 1
    v_permlane32_swap_b32 v34, v56
    v_permlane32_swap_b32 v35, v57
    s_nop 1
    v_add_f32 v34, v34, v56
    v_add_f32 v35, v35, v57
    v_mul_f32 v34, s20, v34
    v_cvt_pk_bf16_f32 v56, v32, v34
    v_lshlrev_b32 v32, 16, v56
    v_and_b32 v34, 0xffff0000, v56
    v_add_f32 v34, 0x3727c5ac, v34
    v_cvt_pk_bf16_f32 v56, v34, v34
    v_lshlrev_b32 v34, 16, v56
    v_sqrt_f32 v34, v34
    s_nop 0
    v_cvt_pk_bf16_f32 v56, v34, v34
    v_lshlrev_b32 v34, 16, v56
    v_rcp_f32 v34, v34
    s_nop 0
    v_mul_f32 v35, s20, v35
    v_cvt_pk_bf16_f32 v56, v33, v35
    v_lshlrev_b32 v33, 16, v56
    v_and_b32 v35, 0xffff0000, v56
    v_add_f32 v35, 0x3727c5ac, v35
    v_cvt_pk_bf16_f32 v56, v35, v35
    v_lshlrev_b32 v35, 16, v56
    v_sqrt_f32 v35, v35
    s_nop 0
    v_cvt_pk_bf16_f32 v56, v35, v35
    v_lshlrev_b32 v35, 16, v56
    v_rcp_f32 v35, v35
    s_nop 0
    v_sub_f32 v16, v16, v32
    v_sub_f32 v17, v17, v32
    v_cvt_pk_bf16_f32 v56, v16, v17
    v_lshlrev_b32 v16, 16, v56
    v_and_b32 v17, 0xffff0000, v56
    v_mul_f32 v16, v16, v34
    v_mul_f32 v17, v17, v34
    v_cvt_pk_bf16_f32 v56, v16, v17
    v_lshlrev_b32 v16, 16, v56
    v_and_b32 v17, 0xffff0000, v56
    v_mul_f32 v16, v16, v40
    v_mul_f32 v17, v17, v41
    v_cvt_pk_bf16_f32 v56, v16, v17
    v_lshlrev_b32 v16, 16, v56
    v_and_b32 v17, 0xffff0000, v56
    v_add_f32 v16, v16, v48
    v_add_f32 v17, v17, v49
    v_sub_f32 v18, v18, v32
    v_sub_f32 v19, v19, v32
    v_cvt_pk_bf16_f32 v56, v18, v19
    v_lshlrev_b32 v18, 16, v56
    v_and_b32 v19, 0xffff0000, v56
    v_mul_f32 v18, v18, v34
    v_mul_f32 v19, v19, v34
    v_cvt_pk_bf16_f32 v56, v18, v19
    v_lshlrev_b32 v18, 16, v56
    v_and_b32 v19, 0xffff0000, v56
    v_mul_f32 v18, v18, v42
    v_mul_f32 v19, v19, v43
    v_cvt_pk_bf16_f32 v56, v18, v19
    v_lshlrev_b32 v18, 16, v56
    v_and_b32 v19, 0xffff0000, v56
    v_add_f32 v18, v18, v50
    v_add_f32 v19, v19, v51
    v_sub_f32 v20, v20, v32
    v_sub_f32 v21, v21, v32
    v_cvt_pk_bf16_f32 v56, v20, v21
    v_lshlrev_b32 v20, 16, v56
    v_and_b32 v21, 0xffff0000, v56
    v_mul_f32 v20, v20, v34
    v_mul_f32 v21, v21, v34
    v_cvt_pk_bf16_f32 v56, v20, v21
    v_lshlrev_b32 v20, 16, v56
    v_and_b32 v21, 0xffff0000, v56
    v_mul_f32 v20, v20, v44
    v_mul_f32 v21, v21, v45
    v_cvt_pk_bf16_f32 v56, v20, v21
    v_lshlrev_b32 v20, 16, v56
    v_and_b32 v21, 0xffff0000, v56
    v_add_f32 v20, v20, v52
    v_add_f32 v21, v21, v53
    v_sub_f32 v22, v22, v32
    v_sub_f32 v23, v23, v32
    v_cvt_pk_bf16_f32 v56, v22, v23
    v_lshlrev_b32 v22, 16, v56
    v_and_b32 v23, 0xffff0000, v56
    v_mul_f32 v22, v22, v34
    v_mul_f32 v23, v23, v34
    v_cvt_pk_bf16_f32 v56, v22, v23
    v_lshlrev_b32 v22, 16, v56
    v_and_b32 v23, 0xffff0000, v56
    v_mul_f32 v22, v22, v46
    v_mul_f32 v23, v23, v47
    v_cvt_pk_bf16_f32 v56, v22, v23
    v_lshlrev_b32 v22, 16, v56
    v_and_b32 v23, 0xffff0000, v56
    v_add_f32 v22, v22, v54
    v_add_f32 v23, v23, v55
    v_sub_f32 v24, v24, v33
    v_sub_f32 v25, v25, v33
    v_cvt_pk_bf16_f32 v56, v24, v25
    v_lshlrev_b32 v24, 16, v56
    v_and_b32 v25, 0xffff0000, v56
    v_mul_f32 v24, v24, v35
    v_mul_f32 v25, v25, v35
    v_cvt_pk_bf16_f32 v56, v24, v25
    v_lshlrev_b32 v24, 16, v56
    v_and_b32 v25, 0xffff0000, v56
    v_mul_f32 v24, v24, v40
    v_mul_f32 v25, v25, v41
    v_cvt_pk_bf16_f32 v56, v24, v25
    v_lshlrev_b32 v24, 16, v56
    v_and_b32 v25, 0xffff0000, v56
    v_add_f32 v24, v24, v48
    v_add_f32 v25, v25, v49
    v_sub_f32 v26, v26, v33
    v_sub_f32 v27, v27, v33
    v_cvt_pk_bf16_f32 v56, v26, v27
    v_lshlrev_b32 v26, 16, v56
    v_and_b32 v27, 0xffff0000, v56
    v_mul_f32 v26, v26, v35
    v_mul_f32 v27, v27, v35
    v_cvt_pk_bf16_f32 v56, v26, v27
    v_lshlrev_b32 v26, 16, v56
    v_and_b32 v27, 0xffff0000, v56
    v_mul_f32 v26, v26, v42
    v_mul_f32 v27, v27, v43
    v_cvt_pk_bf16_f32 v56, v26, v27
    v_lshlrev_b32 v26, 16, v56
    v_and_b32 v27, 0xffff0000, v56
    v_add_f32 v26, v26, v50
    v_add_f32 v27, v27, v51
    v_sub_f32 v28, v28, v33
    v_sub_f32 v29, v29, v33
    v_cvt_pk_bf16_f32 v56, v28, v29
    v_lshlrev_b32 v28, 16, v56
    v_and_b32 v29, 0xffff0000, v56
    v_mul_f32 v28, v28, v35
    v_mul_f32 v29, v29, v35
    v_cvt_pk_bf16_f32 v56, v28, v29
    v_lshlrev_b32 v28, 16, v56
    v_and_b32 v29, 0xffff0000, v56
    v_mul_f32 v28, v28, v44
    v_mul_f32 v29, v29, v45
    v_cvt_pk_bf16_f32 v56, v28, v29
    v_lshlrev_b32 v28, 16, v56
    v_and_b32 v29, 0xffff0000, v56
    v_add_f32 v28, v28, v52
    v_add_f32 v29, v29, v53
    v_sub_f32 v30, v30, v33
    v_sub_f32 v31, v31, v33
    v_cvt_pk_bf16_f32 v56, v30, v31
    v_lshlrev_b32 v30, 16, v56
    v_and_b32 v31, 0xffff0000, v56
    v_mul_f32 v30, v30, v35
    v_mul_f32 v31, v31, v35
    v_cvt_pk_bf16_f32 v56, v30, v31
    v_lshlrev_b32 v30, 16, v56
    v_and_b32 v31, 0xffff0000, v56
    v_mul_f32 v30, v30, v46
    v_mul_f32 v31, v31, v47
    v_cvt_pk_bf16_f32 v56, v30, v31
    v_lshlrev_b32 v30, 16, v56
    v_and_b32 v31, 0xffff0000, v56
    v_add_f32 v30, v30, v54
    v_add_f32 v31, v31, v55
    s_lshr_b32 s18, s17, 5
    s_mul_i32 s18, s18, 28672
    s_and_b32 s19, s17, 31
    s_lshl_b32 s19, s19, 4
    s_add_u32 s18, s18, s19
    s_add_u32 s18, s18, 12845056
    v_lshlrev_b32 v6, 9, v3
    s_mov_b64 exec, s[22:23]
    v_cvt_pk_bf16_f32 v8, v16, v17
    v_cvt_pk_bf16_f32 v9, v18, v19
    v_cvt_pk_bf16_f32 v10, v20, v21
    v_cvt_pk_bf16_f32 v11, v22, v23
    buffer_store_dwordx4 v[8:11], v6, s[4:7], s18 offen offset:0 sc1
    v_cvt_pk_bf16_f32 v12, v24, v25
    v_cvt_pk_bf16_f32 v13, v26, v27
    v_cvt_pk_bf16_f32 v14, v28, v29
    v_cvt_pk_bf16_f32 v15, v30, v31
    buffer_store_dwordx4 v[12:15], v6, s[4:7], s18 offen offset:16 sc1
    s_mov_b64 exec, -1
    s_lshr_b32 s93, s75, 4
    s_lshl_b32 s93, s93, 6
    s_add_u32 s93, s93, 90975232
    s_waitcnt vmcnt(0)
    s_barrier
    s_cmp_lg_u32 s87, 0
    s_cbranch_scc1 sig_130
    v_mov_b32 v250, 0
    v_mov_b32 v251, 1
    s_mov_b64 exec, 1
    buffer_atomic_add v251, v250, s[4:7], s93 offen
    s_mov_b64 exec, -1
sig_130:
noln_126:
    s_load_dwordx2 s[20:21], s[0:1], 120
    s_load_dwordx2 s[22:23], s[0:1], 8
    s_waitcnt lgkmcnt(0)
    s_mov_b32 s8, s88
    s_mov_b32 s9, s87
    v_lshlrev_b32 v2, 4, v0
    v_mov_b32 v4, 0
    v_mov_b32 v5, 0
    v_mov_b32 v6, 0
    v_mov_b32 v7, 0
    ds_write_b128 v2, v[4:7] offset:0
    ds_write_b128 v2, v[4:7] offset:4096
    ds_write_b128 v2, v[4:7] offset:8192
    ds_write_b128 v2, v[4:7] offset:12288
    ds_write_b128 v2, v[4:7] offset:16384
    ds_write_b128 v2, v[4:7] offset:20480
    ds_write_b128 v2, v[4:7] offset:24576
    ds_write_b128 v2, v[4:7] offset:28672
    s_waitcnt lgkmcnt(0)
    ds_write_b128 v2, v[4:7] offset:32768
    ds_write_b128 v2, v[4:7] offset:36864
    ds_write_b128 v2, v[4:7] offset:40960
    ds_write_b128 v2, v[4:7] offset:45056
    ds_write_b128 v2, v[4:7] offset:49152
    ds_write_b128 v2, v[4:7] offset:53248
    ds_write_b128 v2, v[4:7] offset:57344
    v_add_u32 v2, 61440, v2
    ds_write_b128 v2, v[4:7] offset:0
    s_waitcnt lgkmcnt(0)
    ds_write_b128 v2, v[4:7] offset:4096
    ds_write_b128 v2, v[4:7] offset:8192
    ds_write_b128 v2, v[4:7] offset:12288
    ds_write_b128 v2, v[4:7] offset:16384
    ds_write_b128 v2, v[4:7] offset:20480
    ds_write_b128 v2, v[4:7] offset:24576
    ds_write_b128 v2, v[4:7] offset:28672
    ds_write_b128 v2, v[4:7] offset:32768
    s_waitcnt lgkmcnt(0)
    ds_write_b128 v2, v[4:7] offset:36864
    ds_write_b128 v2, v[4:7] offset:40960
    ds_write_b128 v2, v[4:7] offset:45056
    ds_write_b128 v2, v[4:7] offset:49152
    ds_write_b128 v2, v[4:7] offset:53248
    ds_write_b128 v2, v[4:7] offset:57344
    v_add_u32 v2, 61440, v2
    ds_write_b128 v2, v[4:7] offset:0
    ds_write_b128 v2, v[4:7] offset:4096
    s_waitcnt lgkmcnt(0)
    ds_write_b128 v2, v[4:7] offset:8192
    ds_write_b128 v2, v[4:7] offset:12288
    ds_write_b128 v2, v[4:7] offset:16384
    ds_write_b128 v2, v[4:7] offset:20480
    ds_write_b128 v2, v[4:7] offset:24576
    ds_write_b128 v2, v[4:7] offset:28672
    ds_write_b128 v2, v[4:7] offset:32768
    ds_write_b128 v2, v[4:7] offset:36864
    s_waitcnt lgkmcnt(0)
    s_waitcnt lgkmcnt(0)
    s_barrier
    s_cmp_ge_u32 s8, 16
    s_cbranch_scc1 L_V_role
    s_lshl_b32 s93, s8, 6
    s_add_u32 s93, s93, 90976256
    s_cmp_lg_u32 s87, 0
    s_cbranch_scc1 wsk_133
    s_mov_b32 s90, 0
    v_mov_b32 v100, 0
wge_131:
    buffer_load_dword v101, v100, s[4:7], s93 offen sc1
    s_waitcnt vmcnt(0)
    v_readfirstlane_b32 s92, v101
    s_nop 3
    s_cmp_ge_u32 s92, 8
    s_cbranch_scc1 wok_132
    s_sleep 2
    s_add_u32 s90, s90, 1
    s_cmp_lt_u32 s90, 400000
    s_cbranch_scc1 wge_131
    s_branch L_abort
wok_132:
wsk_133:
    s_barrier
    v_and_b32 v119, 63, v0
    v_lshlrev_b32 v0, 4, v119
    v_bfe_u32 v2, v119, 3, 1
    v_mov_b32 v1, 0x44444444
    s_mov_b32 s12, 0xaaaaaaaa
    v_mul_lo_u32 v2, v2, s12
    v_or_b32 v1, v1, v2
    s_lshl_b32 s12, s9, 1
    s_add_u32 s12, s12, 0
    s_cmp_ge_u32 s12, 7
    s_cselect_b32 s16, 7, 0
    s_sub_u32 s12, s12, s16
    s_lshl_b32 s40, s12, 10
    s_lshl_b32 s12, s9, 1
    s_add_u32 s12, s12, 1
    s_cmp_ge_u32 s12, 7
    s_cselect_b32 s16, 7, 0
    s_sub_u32 s12, s12, s16
    s_lshl_b32 s41, s12, 10
    s_lshl_b32 s12, s9, 1
    s_add_u32 s12, s12, 2
    s_cmp_ge_u32 s12, 7
    s_cselect_b32 s16, 7, 0
    s_sub_u32 s12, s12, s16
    s_lshl_b32 s42, s12, 10
    s_lshl_b32 s12, s9, 1
    s_add_u32 s12, s12, 3
    s_cmp_ge_u32 s12, 7
    s_cselect_b32 s16, 7, 0
    s_sub_u32 s12, s12, s16
    s_lshl_b32 s43, s12, 10
    s_lshl_b32 s12, s9, 1
    s_add_u32 s12, s12, 4
    s_cmp_ge_u32 s12, 7
    s_cselect_b32 s16, 7, 0
    s_sub_u32 s12, s12, s16
    s_lshl_b32 s44, s12, 10
    s_lshl_b32 s12, s9, 1
    s_add_u32 s12, s12, 5
    s_cmp_ge_u32 s12, 7
    s_cselect_b32 s16, 7, 0
    s_sub_u32 s12, s12, s16
    s_lshl_b32 s45, s12, 10
    s_lshl_b32 s12, s9, 1
    s_add_u32 s12, s12, 6
    s_cmp_ge_u32 s12, 7
    s_cselect_b32 s16, 7, 0
    s_sub_u32 s12, s12, s16
    s_lshl_b32 s46, s12, 10
    v_add_u32 v108, s40, v0
    v_add_u32 v109, s41, v0
    s_mul_i32 s12, s9, 4352
    s_add_u32 s12, s12, 8192
    v_lshrrev_b32 v2, 4, v119
    v_mul_u32_u24 v2, 1088, v2
    v_and_b32 v3, 15, v119
    v_lshl_add_u32 v110, v3, 3, v2
    v_add_u32 v110, s12, v110
    v_and_b32 v2, 3, v119
    v_mul_u32_u24 v111, 1088, v2
    v_bfe_u32 v2, v119, 5, 1
    v_lshl_add_u32 v111, v2, 7, v111
    v_bfe_u32 v2, v119, 4, 1
    v_lshl_add_u32 v111, v2, 5, v111
    v_bfe_u32 v2, v119, 2, 2
    v_lshl_add_u32 v111, v2, 3, v111
    v_add_u32 v111, s12, v111
    v_lshrrev_b32 v2, 4, v119
    s_mul_i32 s12, s9, 14
    v_add_u32 v2, s12, v2
    v_lshlrev_b32 v112, 9, v2
    v_bfe_u32 v3, v119, 3, 1
    v_lshl_add_u32 v112, v3, 8, v112
    v_bfe_u32 v3, v119, 1, 1
    v_lshl_add_u32 v112, v3, 7, v112
    v_bfe_u32 v3, v119, 2, 1
    v_lshl_add_u32 v112, v3, 6, v112
    v_bfe_u32 v3, v119, 0, 1
    v_lshl_add_u32 v112, v3, 5, v112
    v_add_u32 v112, 32768, v112
    v_lshlrev_b32 v113, 7, v2
    v_and_b32 v3, 7, v119
    v_lshl_add_u32 v113, v3, 4, v113
    v_bfe_u32 v2, v119, 4, 1
    v_lshlrev_b32 v2, 2, v2
    v_lshrrev_b32 v3, 5, v119
    v_add_u32 v2, v2, v3
    v_mul_u32_u24 v114, 768, v2
    v_and_b32 v3, 15, v119
    v_lshl_add_u32 v114, v3, 4, v114
    s_lshl_b32 s12, s9, 2
    s_add_u32 s12, s12, 25600
    v_add_u32 v114, s12, v114
    s_and_b32 s12, s9, 1
    s_lshl_b32 s12, s12, 2
    v_lshrrev_b32 v2, 4, v119
    v_add_u32 v2, s12, v2
    v_mul_u32_u24 v115, 768, v2
    v_lshl_add_u32 v115, v3, 4, v115
    v_add_u32 v115, 25600, v115
    s_lshl_b32 s12, s8, 9
    v_lshlrev_b32 v116, 6, v2
    v_and_b32 v60, 15, v119
    v_lshl_add_u32 v116, v60, 2, v116
    v_add_u32 v116, s12, v116
    v_lshlrev_b32 v117, 5, v2
    v_bfe_u32 v60, v119, 2, 1
    v_lshl_add_u32 v117, v60, 4, v117
    v_bfe_u32 v60, v119, 1, 1
    v_lshl_add_u32 v117, v60, 2, v117
    s_lshr_b32 s12, s8, 1
    s_lshl_b32 s12, s12, 8
    s_and_b32 s16, s8, 1
    s_lshl_b32 s16, s16, 3
    s_add_u32 s12, s12, s16
    s_add_u32 s12, s12, 8192
    v_add_u32 v117, s12, v117
    s_mul_i32 s12, s9, 7168
    v_add_u32 v118, s12, v0
    s_add_u32 s35, s12, 32768
    s_mov_b32 s28, 0x00550055
    s_mov_b32 s29, 0x00550055
    s_mov_b32 s30, 0x00ff00ff
    s_mov_b32 s31, 0x00ff00ff
    s_mov_b32 s34, 0x3db8aa3b
    s_lshl_b32 s12, s8, 2
    s_add_u32 s12, s12, s9
    s_mul_i32 s12, s12, 100352
    s_add_u32 s12, s12, 0
    s_lshl_b32 s16, s40, 1
    s_add_u32 s16, s16, s12
    buffer_load_dwordx4 a[0:3], v0, s[4:7], s16 offen offset:0 sc1
    buffer_load_dwordx4 a[4:7], v0, s[4:7], s16 offen offset:1024 sc1
    s_lshl_b32 s16, s41, 1
    s_add_u32 s16, s16, s12
    buffer_load_dwordx4 a[8:11], v0, s[4:7], s16 offen offset:0 sc1
    buffer_load_dwordx4 a[12:15], v0, s[4:7], s16 offen offset:1024 sc1
    s_lshl_b32 s16, s42, 1
    s_add_u32 s16, s16, s12
    buffer_load_dwordx4 a[16:19], v0, s[4:7], s16 offen offset:0 sc1
    buffer_load_dwordx4 a[20:23], v0, s[4:7], s16 offen offset:1024 sc1
    s_lshl_b32 s16, s43, 1
    s_add_u32 s16, s16, s12
    buffer_load_dwordx4 a[24:27], v0, s[4:7], s16 offen offset:0 sc1
    buffer_load_dwordx4 a[28:31], v0, s[4:7], s16 offen offset:1024 sc1
    s_lshl_b32 s16, s44, 1
    s_add_u32 s16, s16, s12
    buffer_load_dwordx4 a[32:35], v0, s[4:7], s16 offen offset:0 sc1
    buffer_load_dwordx4 a[36:39], v0, s[4:7], s16 offen offset:1024 sc1
    s_lshl_b32 s16, s45, 1
    s_add_u32 s16, s16, s12
    buffer_load_dwordx4 a[40:43], v0, s[4:7], s16 offen offset:0 sc1
    buffer_load_dwordx4 a[44:47], v0, s[4:7], s16 offen offset:1024 sc1
    s_lshl_b32 s16, s46, 1
    s_add_u32 s16, s16, s12
    buffer_load_dwordx4 a[48:51], v0, s[4:7], s16 offen offset:0 sc1
    buffer_load_dwordx4 a[52:55], v0, s[4:7], s16 offen offset:1024 sc1
    s_add_u32 s12, s12, 14336
    s_lshl_b32 s16, s40, 1
    s_add_u32 s16, s16, s12
    buffer_load_dwordx4 a[56:59], v0, s[4:7], s16 offen offset:0 sc1
    buffer_load_dwordx4 a[60:63], v0, s[4:7], s16 offen offset:1024 sc1
    s_lshl_b32 s16, s41, 1
    s_add_u32 s16, s16, s12
    buffer_load_dwordx4 a[64:67], v0, s[4:7], s16 offen offset:0 sc1
    buffer_load_dwordx4 a[68:71], v0, s[4:7], s16 offen offset:1024 sc1
    s_lshl_b32 s16, s42, 1
    s_add_u32 s16, s16, s12
    buffer_load_dwordx4 a[72:75], v0, s[4:7], s16 offen offset:0 sc1
    buffer_load_dwordx4 a[76:79], v0, s[4:7], s16 offen offset:1024 sc1
    s_lshl_b32 s16, s43, 1
    s_add_u32 s16, s16, s12
    buffer_load_dwordx4 a[80:83], v0, s[4:7], s16 offen offset:0 sc1
    buffer_load_dwordx4 a[84:87], v0, s[4:7], s16 offen offset:1024 sc1
    s_lshl_b32 s16, s44, 1
    s_add_u32 s16, s16, s12
    buffer_load_dwordx4 a[88:91], v0, s[4:7], s16 offen offset:0 sc1
    buffer_load_dwordx4 a[92:95], v0, s[4:7], s16 offen offset:1024 sc1
    s_lshl_b32 s16, s45, 1
    s_add_u32 s16, s16, s12
    buffer_load_dwordx4 a[96:99], v0, s[4:7], s16 offen offset:0 sc1
    buffer_load_dwordx4 a[100:103], v0, s[4:7], s16 offen offset:1024 sc1
    s_lshl_b32 s16, s46, 1
    s_add_u32 s16, s16, s12
    buffer_load_dwordx4 a[104:107], v0, s[4:7], s16 offen offset:0 sc1
    buffer_load_dwordx4 a[108:111], v0, s[4:7], s16 offen offset:1024 sc1
    s_add_u32 s12, s12, 14336
    s_lshl_b32 s16, s40, 1
    s_add_u32 s16, s16, s12
    buffer_load_dwordx4 a[112:115], v0, s[4:7], s16 offen offset:0 sc1
    buffer_load_dwordx4 a[116:119], v0, s[4:7], s16 offen offset:1024 sc1
    s_lshl_b32 s16, s41, 1
    s_add_u32 s16, s16, s12
    buffer_load_dwordx4 a[120:123], v0, s[4:7], s16 offen offset:0 sc1
    buffer_load_dwordx4 a[124:127], v0, s[4:7], s16 offen offset:1024 sc1
    s_waitcnt vmcnt(16)
    s_lshl_b32 s16, s42, 1
    s_add_u32 s16, s16, s12
    buffer_load_dwordx4 a[128:131], v0, s[4:7], s16 offen offset:0 sc1
    buffer_load_dwordx4 a[132:135], v0, s[4:7], s16 offen offset:1024 sc1
    s_lshl_b32 s16, s43, 1
    s_add_u32 s16, s16, s12
    buffer_load_dwordx4 a[136:139], v0, s[4:7], s16 offen offset:0 sc1
    buffer_load_dwordx4 a[140:143], v0, s[4:7], s16 offen offset:1024 sc1
    s_lshl_b32 s16, s44, 1
    s_add_u32 s16, s16, s12
    buffer_load_dwordx4 a[144:147], v0, s[4:7], s16 offen offset:0 sc1
    buffer_load_dwordx4 a[148:151], v0, s[4:7], s16 offen offset:1024 sc1
    s_lshl_b32 s16, s45, 1
    s_add_u32 s16, s16, s12
    buffer_load_dwordx4 a[152:155], v0, s[4:7], s16 offen offset:0 sc1
    buffer_load_dwordx4 a[156:159], v0, s[4:7], s16 offen offset:1024 sc1
    s_lshl_b32 s16, s46, 1
    s_add_u32 s16, s16, s12
    buffer_load_dwordx4 a[160:163], v0, s[4:7], s16 offen offset:0 sc1
    buffer_load_dwordx4 a[164:167], v0, s[4:7], s16 offen offset:1024 sc1
    s_add_u32 s12, s12, 14336
    s_lshl_b32 s16, s40, 1
    s_add_u32 s16, s16, s12
    buffer_load_dwordx4 a[168:171], v0, s[4:7], s16 offen offset:0 sc1
    buffer_load_dwordx4 a[172:175], v0, s[4:7], s16 offen offset:1024 sc1
    s_lshl_b32 s16, s41, 1
    s_add_u32 s16, s16, s12
    buffer_load_dwordx4 a[176:179], v0, s[4:7], s16 offen offset:0 sc1
    buffer_load_dwordx4 a[180:183], v0, s[4:7], s16 offen offset:1024 sc1
    s_lshl_b32 s16, s42, 1
    s_add_u32 s16, s16, s12
    buffer_load_dwordx4 a[184:187], v0, s[4:7], s16 offen offset:0 sc1
    buffer_load_dwordx4 a[188:191], v0, s[4:7], s16 offen offset:1024 sc1
    s_lshl_b32 s16, s43, 1
    s_add_u32 s16, s16, s12
    buffer_load_dwordx4 a[192:195], v0, s[4:7], s16 offen offset:0 sc1
    buffer_load_dwordx4 a[196:199], v0, s[4:7], s16 offen offset:1024 sc1
    s_lshl_b32 s16, s44, 1
    s_add_u32 s16, s16, s12
    buffer_load_dwordx4 a[200:203], v0, s[4:7], s16 offen offset:0 sc1
    buffer_load_dwordx4 a[204:207], v0, s[4:7], s16 offen offset:1024 sc1
    s_lshl_b32 s16, s45, 1
    s_add_u32 s16, s16, s12
    buffer_load_dwordx4 a[208:211], v0, s[4:7], s16 offen offset:0 sc1
    buffer_load_dwordx4 a[212:215], v0, s[4:7], s16 offen offset:1024 sc1
    s_lshl_b32 s16, s46, 1
    s_add_u32 s16, s16, s12
    buffer_load_dwordx4 a[216:219], v0, s[4:7], s16 offen offset:0 sc1
    buffer_load_dwordx4 a[220:223], v0, s[4:7], s16 offen offset:1024 sc1
    s_add_u32 s12, s12, 14336
    s_lshl_b32 s16, s40, 1
    s_add_u32 s16, s16, s12
    buffer_load_dwordx4 a[224:227], v0, s[4:7], s16 offen offset:0 sc1
    buffer_load_dwordx4 a[228:231], v0, s[4:7], s16 offen offset:1024 sc1
    s_lshl_b32 s16, s41, 1
    s_add_u32 s16, s16, s12
    buffer_load_dwordx4 a[232:235], v0, s[4:7], s16 offen offset:0 sc1
    buffer_load_dwordx4 a[236:239], v0, s[4:7], s16 offen offset:1024 sc1
    s_lshl_b32 s16, s42, 1
    s_add_u32 s16, s16, s12
    buffer_load_dwordx4 a[240:243], v0, s[4:7], s16 offen offset:0 sc1
    buffer_load_dwordx4 a[244:247], v0, s[4:7], s16 offen offset:1024 sc1
    s_lshl_b32 s16, s43, 1
    s_add_u32 s16, s16, s12
    buffer_load_dwordx4 a[248:251], v0, s[4:7], s16 offen offset:0 sc1
    buffer_load_dwordx4 a[252:255], v0, s[4:7], s16 offen offset:1024 sc1
    s_waitcnt vmcnt(16)
    s_lshl_b32 s16, s44, 1
    s_add_u32 s16, s16, s12
    buffer_load_dwordx4 v[120:123], v0, s[4:7], s16 offen offset:0 sc1
    buffer_load_dwordx4 v[124:127], v0, s[4:7], s16 offen offset:1024 sc1
    s_lshl_b32 s16, s45, 1
    s_add_u32 s16, s16, s12
    buffer_load_dwordx4 v[128:131], v0, s[4:7], s16 offen offset:0 sc1
    buffer_load_dwordx4 v[132:135], v0, s[4:7], s16 offen offset:1024 sc1
    s_lshl_b32 s16, s46, 1
    s_add_u32 s16, s16, s12
    buffer_load_dwordx4 v[136:139], v0, s[4:7], s16 offen offset:0 sc1
    buffer_load_dwordx4 v[140:143], v0, s[4:7], s16 offen offset:1024 sc1
    s_add_u32 s12, s12, 14336
    s_lshl_b32 s16, s40, 1
    s_add_u32 s16, s16, s12
    buffer_load_dwordx4 v[144:147], v0, s[4:7], s16 offen offset:0 sc1
    buffer_load_dwordx4 v[148:151], v0, s[4:7], s16 offen offset:1024 sc1
    s_lshl_b32 s16, s41, 1
    s_add_u32 s16, s16, s12
    buffer_load_dwordx4 v[152:155], v0, s[4:7], s16 offen offset:0 sc1
    buffer_load_dwordx4 v[156:159], v0, s[4:7], s16 offen offset:1024 sc1
    s_lshl_b32 s16, s42, 1
    s_add_u32 s16, s16, s12
    buffer_load_dwordx4 v[160:163], v0, s[4:7], s16 offen offset:0 sc1
    buffer_load_dwordx4 v[164:167], v0, s[4:7], s16 offen offset:1024 sc1
    s_lshl_b32 s16, s43, 1
    s_add_u32 s16, s16, s12
    buffer_load_dwordx4 v[168:171], v0, s[4:7], s16 offen offset:0 sc1
    buffer_load_dwordx4 v[172:175], v0, s[4:7], s16 offen offset:1024 sc1
    s_lshl_b32 s16, s44, 1
    s_add_u32 s16, s16, s12
    buffer_load_dwordx4 v[176:179], v0, s[4:7], s16 offen offset:0 sc1
    buffer_load_dwordx4 v[180:183], v0, s[4:7], s16 offen offset:1024 sc1
    s_lshl_b32 s16, s45, 1
    s_add_u32 s16, s16, s12
    buffer_load_dwordx4 v[184:187], v0, s[4:7], s16 offen offset:0 sc1
    buffer_load_dwordx4 v[188:191], v0, s[4:7], s16 offen offset:1024 sc1
    s_lshl_b32 s16, s46, 1
    s_add_u32 s16, s16, s12
    buffer_load_dwordx4 v[192:195], v0, s[4:7], s16 offen offset:0 sc1
    buffer_load_dwordx4 v[196:199], v0, s[4:7], s16 offen offset:1024 sc1
    s_add_u32 s12, s12, 14336
    s_lshl_b32 s16, s40, 1
    s_add_u32 s16, s16, s12
    buffer_load_dwordx4 v[200:203], v0, s[4:7], s16 offen offset:0 sc1
    buffer_load_dwordx4 v[204:207], v0, s[4:7], s16 offen offset:1024 sc1
    s_lshl_b32 s16, s41, 1
    s_add_u32 s16, s16, s12
    buffer_load_dwordx4 v[208:211], v0, s[4:7], s16 offen offset:0 sc1
    buffer_load_dwordx4 v[212:215], v0, s[4:7], s16 offen offset:1024 sc1
    s_lshl_b32 s16, s42, 1
    s_add_u32 s16, s16, s12
    buffer_load_dwordx4 v[216:219], v0, s[4:7], s16 offen offset:0 sc1
    buffer_load_dwordx4 v[220:223], v0, s[4:7], s16 offen offset:1024 sc1
    s_lshl_b32 s16, s43, 1
    s_add_u32 s16, s16, s12
    buffer_load_dwordx4 v[224:227], v0, s[4:7], s16 offen offset:0 sc1
    buffer_load_dwordx4 v[228:231], v0, s[4:7], s16 offen offset:1024 sc1
    s_lshl_b32 s16, s44, 1
    s_add_u32 s16, s16, s12
    buffer_load_dwordx4 v[232:235], v0, s[4:7], s16 offen offset:0 sc1
    buffer_load_dwordx4 v[236:239], v0, s[4:7], s16 offen offset:1024 sc1
    s_lshl_b32 s16, s45, 1
    s_add_u32 s16, s16, s12
    buffer_load_dwordx4 v[240:243], v0, s[4:7], s16 offen offset:0 sc1
    buffer_load_dwordx4 v[244:247], v0, s[4:7], s16 offen offset:1024 sc1
    s_waitcnt vmcnt(16)
    s_lshl_b32 s16, s46, 1
    s_add_u32 s16, s16, s12
    buffer_load_dwordx4 v[248:251], v0, s[4:7], s16 offen offset:0 sc1
    buffer_load_dwordx4 v[252:255], v0, s[4:7], s16 offen offset:1024 sc1
    s_add_u32 s12, s12, 14336
    s_mov_b32 s91, 90975232
    s_cmp_lg_u32 s87, 0
    s_cbranch_scc1 wsk_136
    s_mov_b32 s90, 0
    v_mov_b32 v100, 0
wge_134:
    buffer_load_dword v101, v100, s[4:7], s91 offen sc1
    s_waitcnt vmcnt(0)
    v_readfirstlane_b32 s92, v101
    s_nop 3
    s_cmp_ge_u32 s92, 16
    s_cbranch_scc1 wok_135
    s_sleep 2
    s_add_u32 s90, s90, 1
    s_cmp_lt_u32 s90, 400000
    s_cbranch_scc1 wge_134
    s_branch L_abort
wok_135:
wsk_136:
    s_barrier
    s_mov_b32 s91, 90975296
    s_cmp_lg_u32 s87, 0
    s_cbranch_scc1 wsk_139
    s_mov_b32 s90, 0
    v_mov_b32 v100, 0
wge_137:
    buffer_load_dword v101, v100, s[4:7], s91 offen sc1
    s_waitcnt vmcnt(0)
    v_readfirstlane_b32 s92, v101
    s_nop 3
    s_cmp_ge_u32 s92, 16
    s_cbranch_scc1 wok_138
    s_sleep 2
    s_add_u32 s90, s90, 1
    s_cmp_lt_u32 s90, 400000
    s_cbranch_scc1 wge_137
    s_branch L_abort
wok_138:
wsk_139:
    s_barrier
    s_mov_b32 s15, 12845056
    s_mov_b32 m0, s35
    s_add_u32 s12, s15, 4096
    buffer_load_dwordx4 v118, s[4:7], s15 offen offset:0 sc1 lds
    buffer_load_dwordx4 v118, s[4:7], s15 offen offset:1024 sc1 lds
    buffer_load_dwordx4 v118, s[4:7], s15 offen offset:2048 sc1 lds
    buffer_load_dwordx4 v118, s[4:7], s15 offen offset:3072 sc1 lds
    s_add_u32 m0, s35, 4096
    s_nop 0
    buffer_load_dwordx4 v118, s[4:7], s12 offen offset:0 sc1 lds
    buffer_load_dwordx4 v118, s[4:7], s12 offen offset:1024 sc1 lds
    buffer_load_dwordx4 v118, s[4:7], s12 offen offset:2048 sc1 lds
    s_add_u32 s15, s15, 28672
    s_mov_b32 s13, 44044288
    s_mov_b32 s14, 44511232
    s_mov_b32 s10, 0
    s_add_u32 s17, s8, 16
    s_mul_i32 s17, s17, 28672
    s_add_u32 s17, s17, 14684160
    s_mov_b32 s19, 52506624
    s_lshr_b32 s12, s8, 1
    s_and_b32 s18, s8, 1
    s_add_u32 s18, s18, 1
    s_cmp_eq_u32 s12, s9
    s_cselect_b32 s18, s18, 0
    s_cmp_lt_u32 s8, 7
    s_cselect_b32 s18, s18, 0
    s_mov_b32 s79, 0
    s_mov_b32 s72, s18
    s_cmp_eq_u32 s8, 8
    s_cselect_b32 s72, 3, s72
    s_mov_b32 s76, -1
    s_cmp_eq_u32 s9, 3
    s_cselect_b32 s77, 0, -1
    s_waitcnt vmcnt(0)
L_S_loop:
    v_mov_b64 v[32:33], 0
    v_mov_b64 v[34:35], 0
    v_mov_b64 v[36:37], 0
    v_mov_b64 v[38:39], 0
    v_mov_b64 v[40:41], 0
    v_mov_b64 v[42:43], 0
    v_mov_b64 v[44:45], 0
    v_mov_b64 v[46:47], 0
    v_mov_b64 v[48:49], 0
    v_mov_b64 v[50:51], 0
    v_mov_b64 v[52:53], 0
    v_mov_b64 v[54:55], 0
    v_mov_b64 v[56:57], 0
    v_mov_b64 v[58:59], 0
    v_mov_b64 v[96:97], 0
    v_mov_b64 v[98:99], 0
    v_mov_b64 v[100:101], 0
    v_mov_b64 v[102:103], 0
    v_mov_b64 v[104:105], 0
    v_mov_b64 v[106:107], 0
    s_mov_b32 s11, 0
    buffer_load_dwordx4 v[4:7], v108, s[4:7], s13 offen sc1
    buffer_load_dwordx4 v[8:11], v109, s[4:7], s13 offen sc1
    buffer_load_dwordx4 v[4:7], v108, s[4:7], s13 offen sc1
    buffer_load_dwordx4 v[8:11], v109, s[4:7], s13 offen sc1
poll_140:
    s_waitcnt vmcnt(2)
    v_max3_u32 v2, v4, v5, v6
    v_max_u32 v2, v2, v7
    v_max3_u32 v3, v8, v9, v10
    v_max_u32 v3, v3, v11
    v_max_u32 v2, v2, v3
    v_cmp_eq_u32 vcc, -1, v2
    s_cbranch_vccz polld_141
    buffer_load_dwordx4 v[4:7], v108, s[4:7], s13 offen sc1
    buffer_load_dwordx4 v[8:11], v109, s[4:7], s13 offen sc1
    s_add_u32 s11, s11, 1
    s_cmp_lt_u32 s11, 400000
    s_cbranch_scc1 poll_140
    s_branch L_abort
polld_141:
    ds_write_b128 v108, v[4:7] offset:0
    ds_write_b128 v109, v[8:11] offset:0
    v_smfmac_f32_16x16x64_bf16 v[32:35], v[4:7], a[0:7], v1
    v_smfmac_f32_16x16x64_bf16 v[36:39], v[4:7], a[56:63], v1
    v_smfmac_f32_16x16x64_bf16 v[40:43], v[4:7], a[112:119], v1
    v_smfmac_f32_16x16x64_bf16 v[44:47], v[4:7], a[168:175], v1
    v_smfmac_f32_16x16x64_bf16 v[48:51], v[4:7], a[224:231], v1
    v_smfmac_f32_16x16x64_bf16 v[52:55], v[4:7], v[144:151], v1
    v_smfmac_f32_16x16x64_bf16 v[56:59], v[4:7], v[200:207], v1
    v_smfmac_f32_16x16x64_bf16 v[32:35], v[8:11], a[8:15], v1
    v_smfmac_f32_16x16x64_bf16 v[36:39], v[8:11], a[64:71], v1
    v_smfmac_f32_16x16x64_bf16 v[40:43], v[8:11], a[120:127], v1
    v_smfmac_f32_16x16x64_bf16 v[44:47], v[8:11], a[176:183], v1
    v_smfmac_f32_16x16x64_bf16 v[48:51], v[8:11], a[232:239], v1
    s_waitcnt lgkmcnt(0)
    s_barrier
    v_add_u32 v119, s42, v0
    ds_read_b128 v[12:15], v119 offset:0
    v_smfmac_f32_16x16x64_bf16 v[52:55], v[8:11], v[152:159], v1
    v_add_u32 v2, s43, v0
    ds_read_b128 v[16:19], v2 offset:0
    v_smfmac_f32_16x16x64_bf16 v[56:59], v[8:11], v[208:215], v1
    v_add_u32 v119, s44, v0
    ds_read_b128 v[20:23], v119 offset:0
    v_add_u32 v2, s45, v0
    ds_read_b128 v[24:27], v2 offset:0
    v_add_u32 v119, s46, v0
    ds_read_b128 v[28:31], v119 offset:0
    s_waitcnt lgkmcnt(4)
    v_smfmac_f32_16x16x64_bf16 v[56:59], v[12:15], v[216:223], v1
    s_waitcnt lgkmcnt(3)
    v_smfmac_f32_16x16x64_bf16 v[56:59], v[16:19], v[224:231], v1
    ds_read_b128 v[84:87], v112 offset:6144
    s_waitcnt lgkmcnt(3)
    v_smfmac_f32_16x16x64_bf16 v[56:59], v[20:23], v[232:239], v1
    ds_read_b128 v[88:91], v112 offset:6160
    s_waitcnt lgkmcnt(3)
    v_smfmac_f32_16x16x64_bf16 v[56:59], v[24:27], v[240:247], v1
    ds_read_b128 v[92:95], v113 offset:1536
    s_waitcnt lgkmcnt(3)
    v_smfmac_f32_16x16x64_bf16 v[56:59], v[28:31], v[248:255], v1
    v_smfmac_f32_16x16x64_bf16 v[32:35], v[12:15], a[16:23], v1
    v_smfmac_f32_16x16x64_bf16 v[32:35], v[16:19], a[24:31], v1
    v_smfmac_f32_16x16x64_bf16 v[32:35], v[20:23], a[32:39], v1
    s_nop 4
    v_cvt_pk_bf16_f32 v60, v56, v57
    v_cvt_pk_bf16_f32 v61, v58, v59
    v_smfmac_f32_16x16x64_bf16 v[32:35], v[24:27], a[40:47], v1
    ds_write_b64 v110, v[60:61] offset:768
    v_smfmac_f32_16x16x64_bf16 v[32:35], v[28:31], a[48:55], v1
    ds_read_b64_tr_b16 v[68:69], v111 offset:768
    ds_read_b64_tr_b16 v[70:71], v111 offset:832
    v_smfmac_f32_16x16x64_bf16 v[36:39], v[12:15], a[72:79], v1
    ds_read_b128 v[72:75], v112 offset:0
    v_smfmac_f32_16x16x64_bf16 v[36:39], v[16:19], a[80:87], v1
    ds_read_b128 v[76:79], v112 offset:16
    v_smfmac_f32_16x16x64_bf16 v[36:39], v[20:23], a[88:95], v1
    s_nop 0
    v_cvt_pk_bf16_f32 v60, v32, v33
    v_cvt_pk_bf16_f32 v61, v34, v35
    v_lshlrev_b32 v2, 3, v0
    s_lshl_b32 s16, s9, 13
    s_add_u32 s12, s10, 1
    s_lshr_b32 s12, s12, 2
    s_cmp_lt_u32 s12, s79
    s_cselect_b64 s[92:93], s[76:77], 0
    s_add_u32 s12, s17, s16
    s_mov_b64 exec, s[92:93]
    buffer_load_dword v3, v2, s[4:7], s12 offen sc1
    s_mov_b64 exec, -1
    s_cmp_lg_u32 s72, 0
    s_cbranch_scc1 L_S_side
L_S_side_ret:
    v_smfmac_f32_16x16x64_bf16 v[36:39], v[24:27], a[96:103], v1
    ds_write_b64 v110, v[60:61] offset:0
    s_waitcnt lgkmcnt(3)
    v_mfma_f32_16x16x32_bf16 v[96:99], v[68:71], v[84:87], v[96:99]
    v_mfma_f32_16x16x32_bf16 v[100:103], v[68:71], v[88:91], v[100:103]
    v_mfma_f32_16x16x32_bf16 v[104:107], v[68:71], v[92:95], v[104:107]
    v_smfmac_f32_16x16x64_bf16 v[36:39], v[28:31], a[104:111], v1
    ds_read_b128 v[80:83], v113 offset:0
    v_smfmac_f32_16x16x64_bf16 v[40:43], v[12:15], a[128:135], v1
    ds_read_b128 v[84:87], v112 offset:2048
    v_smfmac_f32_16x16x64_bf16 v[40:43], v[16:19], a[136:143], v1
    ds_read_b128 v[88:91], v112 offset:2064
    v_smfmac_f32_16x16x64_bf16 v[40:43], v[20:23], a[144:151], v1
    s_nop 1
    v_cvt_pk_bf16_f32 v62, v36, v37
    v_cvt_pk_bf16_f32 v63, v38, v39
    v_smfmac_f32_16x16x64_bf16 v[40:43], v[24:27], a[152:159], v1
    ds_write_b64 v110, v[62:63] offset:128
    v_smfmac_f32_16x16x64_bf16 v[40:43], v[28:31], a[160:167], v1
    ds_read_b64_tr_b16 v[64:65], v111 offset:0
    ds_read_b64_tr_b16 v[66:67], v111 offset:64
    v_smfmac_f32_16x16x64_bf16 v[44:47], v[12:15], a[184:191], v1
    ds_read_b128 v[92:95], v113 offset:512
    v_smfmac_f32_16x16x64_bf16 v[44:47], v[16:19], a[192:199], v1
    v_smfmac_f32_16x16x64_bf16 v[44:47], v[20:23], a[200:207], v1
    s_nop 1
    v_cvt_pk_bf16_f32 v60, v40, v41
    v_cvt_pk_bf16_f32 v61, v42, v43
    v_smfmac_f32_16x16x64_bf16 v[44:47], v[24:27], a[208:215], v1
    ds_write_b64 v110, v[60:61] offset:256
    s_waitcnt lgkmcnt(2)
    v_mfma_f32_16x16x32_bf16 v[96:99], v[64:67], v[72:75], v[96:99]
    v_mfma_f32_16x16x32_bf16 v[100:103], v[64:67], v[76:79], v[100:103]
    v_mfma_f32_16x16x32_bf16 v[104:107], v[64:67], v[80:83], v[104:107]
    v_smfmac_f32_16x16x64_bf16 v[44:47], v[28:31], a[216:223], v1
    ds_read_b128 v[72:75], v112 offset:4096
    v_smfmac_f32_16x16x64_bf16 v[48:51], v[12:15], a[240:247], v1
    ds_read_b128 v[76:79], v112 offset:4112
    v_smfmac_f32_16x16x64_bf16 v[48:51], v[16:19], a[248:255], v1
    ds_read_b128 v[80:83], v113 offset:1024
    v_smfmac_f32_16x16x64_bf16 v[48:51], v[20:23], v[120:127], v1
    s_nop 1
    v_cvt_pk_bf16_f32 v62, v44, v45
    v_cvt_pk_bf16_f32 v63, v46, v47
    v_smfmac_f32_16x16x64_bf16 v[48:51], v[24:27], v[128:135], v1
    ds_write_b64 v110, v[62:63] offset:384
    v_smfmac_f32_16x16x64_bf16 v[48:51], v[28:31], v[136:143], v1
    ds_read_b64_tr_b16 v[68:69], v111 offset:256
    ds_read_b64_tr_b16 v[70:71], v111 offset:320
    v_smfmac_f32_16x16x64_bf16 v[52:55], v[12:15], v[160:167], v1
    v_smfmac_f32_16x16x64_bf16 v[52:55], v[16:19], v[168:175], v1
    v_smfmac_f32_16x16x64_bf16 v[52:55], v[20:23], v[176:183], v1
    s_nop 2
    v_cvt_pk_bf16_f32 v60, v48, v49
    v_cvt_pk_bf16_f32 v61, v50, v51
    v_smfmac_f32_16x16x64_bf16 v[52:55], v[24:27], v[184:191], v1
    ds_write_b64 v110, v[60:61] offset:512
    s_waitcnt lgkmcnt(1)
    v_mfma_f32_16x16x32_bf16 v[96:99], v[68:71], v[84:87], v[96:99]
    v_mfma_f32_16x16x32_bf16 v[100:103], v[68:71], v[88:91], v[100:103]
    v_mfma_f32_16x16x32_bf16 v[104:107], v[68:71], v[92:95], v[104:107]
    v_smfmac_f32_16x16x64_bf16 v[52:55], v[28:31], v[192:199], v1
    s_nop 7
    v_cvt_pk_bf16_f32 v62, v52, v53
    v_cvt_pk_bf16_f32 v63, v54, v55
    ds_write_b64 v110, v[62:63] offset:640
    ds_read_b64_tr_b16 v[64:65], v111 offset:512
    ds_read_b64_tr_b16 v[66:67], v111 offset:576
    s_waitcnt lgkmcnt(0)
    v_mfma_f32_16x16x32_bf16 v[96:99], v[64:67], v[72:75], v[96:99]
    v_mfma_f32_16x16x32_bf16 v[100:103], v[64:67], v[76:79], v[100:103]
    v_mfma_f32_16x16x32_bf16 v[104:107], v[64:67], v[80:83], v[104:107]
    s_nop 7
    v_permlane32_swap_b32 v96, v97
    v_permlane32_swap_b32 v98, v99
    v_permlane32_swap_b32 v100, v101
    v_permlane32_swap_b32 v102, v103
    v_permlane32_swap_b32 v104, v105
    v_permlane32_swap_b32 v106, v107
    v_add_f32 v96, v96, v97
    v_add_f32 v98, v98, v99
    ds_write2st64_b32 v114, v96, v98 offset0:0 offset1:6
    v_add_f32 v100, v100, v101
    v_add_f32 v102, v102, v103
    ds_write2st64_b32 v114, v100, v102 offset0:1 offset1:7
    v_add_f32 v104, v104, v105
    v_add_f32 v106, v106, v107
    ds_write2st64_b32 v114, v104, v106 offset0:2 offset1:8
    s_waitcnt lgkmcnt(0)
    s_barrier
    s_cmp_ge_u32 s9, 2
    s_cbranch_scc1 nosm_142
    ds_read_b128 v[32:35], v115
    ds_read_b128 v[36:39], v115 offset:256
    ds_read_b128 v[40:43], v115 offset:512
    v_mov_b32 v45, 0xff800000
    v_mov_b32 v47, 0x44250000
    s_waitcnt lgkmcnt(2)
    v_pk_add_f32 v[32:33], v[32:33], v[34:35]
    s_waitcnt lgkmcnt(1)
    v_pk_add_f32 v[36:37], v[36:37], v[38:39]
    s_waitcnt lgkmcnt(0)
    v_pk_add_f32 v[40:41], v[40:41], v[42:43]
    v_add_f32 v32, v32, v33
    v_add_f32 v36, v36, v37
    v_add_f32 v40, v40, v41
    v_max3_f32 v44, |v32|, |v36|, |v40|
    v_cndmask_b32 v40, v45, v40, s[30:31]
    v_cmp_ngt_f32 vcc, v47, v44
    s_cbranch_vccnz smslow_144
    v_mul_f32 v32, s34, v32
    v_mul_f32 v36, s34, v36
    v_mul_f32 v40, s34, v40
smexp_145:
    v_exp_f32 v32, v32
    v_exp_f32 v36, v36
    v_exp_f32 v40, v40
    v_add_f32 v46, v32, v36
    v_add_f32 v46, v46, v40
    s_nop 1
    v_add_f32_dpp v46, v46, v46 quad_perm:[1,0,3,2] row_mask:0xf bank_mask:0xf
    s_nop 1
    v_add_f32_dpp v46, v46, v46 quad_perm:[2,3,0,1] row_mask:0xf bank_mask:0xf
    s_nop 1
    v_add_f32_dpp v46, v46, v46 row_half_mirror row_mask:0xf bank_mask:0xf
    s_nop 1
    v_add_f32_dpp v46, v46, v46 row_mirror row_mask:0xf bank_mask:0xf
    v_rcp_f32 v46, v46
    s_nop 0
    v_mul_f32 v40, v40, v46
    v_mul_f32 v32, v32, v46
    v_mul_f32 v36, v36, v46
    v_mov_b32_dpp v47, v40 quad_perm:[1,0,3,2] row_mask:0xf bank_mask:0xf
    v_cvt_pk_bf16_f32 v32, v32, v36
    v_cvt_pk_bf16_f32 v40, v40, v47
    s_cmp_lg_u32 s83, 0
    s_cbranch_scc1 msl_146
    buffer_store_dword v32, v116, s[4:7], s14 offen
    s_mov_b64 exec, s[28:29]
    buffer_store_dword v40, v117, s[4:7], s14 offen
    s_mov_b64 exec, -1
    s_branch mse_147
msl_146:
    buffer_store_dword v32, v116, s[4:7], s14 offen sc1
    s_mov_b64 exec, s[28:29]
    buffer_store_dword v40, v117, s[4:7], s14 offen sc1
    s_mov_b64 exec, -1
mse_147:
    s_branch nosm_142
smslow_144:
    v_max3_f32 v44, v32, v36, v40
    s_nop 1
    v_max_f32_dpp v44, v44, v44 quad_perm:[1,0,3,2] row_mask:0xf bank_mask:0xf
    s_nop 1
    v_max_f32_dpp v44, v44, v44 quad_perm:[2,3,0,1] row_mask:0xf bank_mask:0xf
    s_nop 1
    v_max_f32_dpp v44, v44, v44 row_half_mirror row_mask:0xf bank_mask:0xf
    s_nop 1
    v_max_f32_dpp v44, v44, v44 row_mirror row_mask:0xf bank_mask:0xf
    v_mul_f32 v44, s34, v44
    v_fma_f32 v32, v32, s34, -v44
    v_fma_f32 v36, v36, s34, -v44
    v_fma_f32 v40, v40, s34, -v44
    s_branch smexp_145
nosm_142:
    s_barrier
    s_add_u32 s12, s10, 3
    s_lshr_b32 s12, s12, 2
    s_min_u32 s12, s12, 15
    s_cmp_lt_u32 s12, 2
    s_cbranch_scc1 hok_148
    s_mov_b32 s11, 0
hpoll_149:
    s_cmp_lt_u32 s12, s79
    s_cbranch_scc1 hok_148
    v_lshrrev_b32 v2, 4, v0
    v_and_b32 v2, 15, v2
    v_lshlrev_b32 v2, 6, v2
    s_mov_b32 s16, 90972160
    buffer_load_dword v3, v2, s[4:7], s16 offen sc1
    s_waitcnt vmcnt(0)
    v_cmp_gt_u32 vcc, 64, v3
    s_nop 1
    s_or_b32 s16, vcc_lo, 0x10000
    s_ff1_i32_b32 s79, s16
    s_add_u32 s11, s11, 1
    s_cmp_lt_u32 s11, 50000
    s_cbranch_scc1 hpoll_149
    s_branch L_abort
hok_148:
    s_mov_b32 m0, s35
    s_add_u32 s12, s15, 4096
    buffer_load_dwordx4 v118, s[4:7], s15 offen offset:0 sc1 lds
    buffer_load_dwordx4 v118, s[4:7], s15 offen offset:1024 sc1 lds
    buffer_load_dwordx4 v118, s[4:7], s15 offen offset:2048 sc1 lds
    buffer_load_dwordx4 v118, s[4:7], s15 offen offset:3072 sc1 lds
    s_add_u32 m0, s35, 4096
    s_nop 0
    buffer_load_dwordx4 v118, s[4:7], s12 offen offset:0 sc1 lds
    buffer_load_dwordx4 v118, s[4:7], s12 offen offset:1024 sc1 lds
    buffer_load_dwordx4 v118, s[4:7], s12 offen offset:2048 sc1 lds
    s_add_u32 s15, s15, 28672
    s_add_u32 s17, s17, 458752
    s_add_u32 s19, s19, 7168
    s_cmp_ge_u32 s79, 16
    s_cbranch_scc1 zrok_150
    v_lshrrev_b32 v2, 4, v0
    v_and_b32 v2, 15, v2
    v_lshlrev_b32 v2, 6, v2
    s_mov_b32 s16, 90972160
    buffer_load_dword v3, v2, s[4:7], s16 offen sc1
    s_waitcnt vmcnt(0)
    v_cmp_gt_u32 vcc, 64, v3
    s_nop 1
    s_or_b32 s16, vcc_lo, 0x10000
    s_ff1_i32_b32 s79, s16
zrok_150:
    s_add_u32 s13, s13, 7168
    s_add_u32 s14, s14, 10240
    s_add_u32 s10, s10, 1
    s_cmp_lt_u32 s10, 63
    s_cbranch_scc1 L_S_loop
    s_branch L_done
L_S_side:
    s_cmp_eq_u32 s72, 2
    s_cbranch_scc1 sd2_151
    s_cmp_eq_u32 s72, 3
    s_cbranch_scc1 sd3_152
    buffer_store_dwordx4 v[4:7], v108, s[4:7], s19 offen sc1
    s_branch L_S_side_ret
sd2_151:
    buffer_store_dwordx4 v[8:11], v109, s[4:7], s19 offen sc1
    s_branch L_S_side_ret
sd3_152:
    v_lshlrev_b32 v2, 3, v0
    s_lshl_b32 s16, s9, 13
    s_add_u32 s12, s15, s16
    s_add_u32 s12, s12, 28672
    s_mov_b64 exec, s[76:77]
    buffer_load_dword v3, v2, s[4:7], s12 offen sc1
    s_mov_b64 exec, -1
    s_branch L_S_side_ret
L_V_role:
    s_sub_u32 s8, s8, 16
    s_mov_b32 s91, 90977280
    s_cmp_lg_u32 s87, 0
    s_cbranch_scc1 wsk_155
    s_mov_b32 s90, 0
    v_mov_b32 v100, 0
wge_153:
    buffer_load_dword v101, v100, s[4:7], s91 offen sc1
    s_waitcnt vmcnt(0)
    v_readfirstlane_b32 s92, v101
    s_nop 3
    s_cmp_ge_u32 s92, 128
    s_cbranch_scc1 wok_154
    s_sleep 2
    s_add_u32 s90, s90, 1
    s_cmp_lt_u32 s90, 400000
    s_cbranch_scc1 wge_153
    s_branch L_abort
wok_154:
wsk_155:
    s_barrier
    v_and_b32 v0, 63, v0
    v_lshlrev_b32 v2, 4, v0
    v_bfe_u32 v4, v0, 3, 1
    v_mov_b32 v1, 0x44444444
    s_mov_b32 s12, 0xaaaaaaaa
    v_mul_lo_u32 v4, v4, s12
    v_or_b32 v1, v1, v4
    s_lshl_b32 s12, s9, 1
    s_add_u32 s12, s12, 0
    s_cmp_ge_u32 s12, 7
    s_cselect_b32 s16, 7, 0
    s_sub_u32 s12, s12, s16
    s_lshl_b32 s40, s12, 10
    s_lshl_b32 s12, s9, 1
    s_add_u32 s12, s12, 1
    s_cmp_ge_u32 s12, 7
    s_cselect_b32 s16, 7, 0
    s_sub_u32 s12, s12, s16
    s_lshl_b32 s41, s12, 10
    s_lshl_b32 s12, s9, 1
    s_add_u32 s12, s12, 2
    s_cmp_ge_u32 s12, 7
    s_cselect_b32 s16, 7, 0
    s_sub_u32 s12, s12, s16
    s_lshl_b32 s42, s12, 10
    s_lshl_b32 s12, s9, 1
    s_add_u32 s12, s12, 3
    s_cmp_ge_u32 s12, 7
    s_cselect_b32 s16, 7, 0
    s_sub_u32 s12, s12, s16
    s_lshl_b32 s43, s12, 10
    s_lshl_b32 s12, s9, 1
    s_add_u32 s12, s12, 4
    s_cmp_ge_u32 s12, 7
    s_cselect_b32 s16, 7, 0
    s_sub_u32 s12, s12, s16
    s_lshl_b32 s44, s12, 10
    s_lshl_b32 s12, s9, 1
    s_add_u32 s12, s12, 5
    s_cmp_ge_u32 s12, 7
    s_cselect_b32 s16, 7, 0
    s_sub_u32 s12, s12, s16
    s_lshl_b32 s45, s12, 10
    s_lshl_b32 s12, s9, 1
    s_add_u32 s12, s12, 6
    s_cmp_ge_u32 s12, 7
    s_cselect_b32 s16, 7, 0
    s_sub_u32 s12, s12, s16
    s_lshl_b32 s46, s12, 10
    v_add_u32 v142, s40, v2
    v_add_u32 v143, s41, v2
    s_mul_i32 s12, s9, 28672
    s_add_u32 s12, s12, 16384
    v_add_u32 v144, s12, v2
    s_mul_i32 s12, s9, 114688
    s_lshl_b32 s16, s8, 11
    s_add_u32 s12, s12, s16
    v_add_u32 v145, s12, v2
    s_lshl_b32 s12, s9, 11
    v_bfe_u32 v4, v0, 3, 1
    v_lshlrev_b32 v146, 9, v4
    v_and_b32 v5, 7, v0
    v_lshl_add_u32 v146, v5, 6, v146
    v_lshrrev_b32 v4, 4, v0
    v_lshl_add_u32 v146, v4, 4, v146
    v_add_u32 v146, s12, v146
    v_lshrrev_b32 v4, 5, v0
    v_lshlrev_b32 v147, 8, v4
    v_lshl_add_u32 v147, v5, 5, v147
    v_bfe_u32 v4, v0, 4, 1
    v_lshl_add_u32 v147, v4, 4, v147
    s_lshl_b32 s12, s9, 9
    s_add_u32 s12, s12, 8192
    v_add_u32 v147, s12, v147
    v_lshlrev_b32 v152, 7, v0
    s_lshl_b32 s12, s9, 11
    v_add_u32 v4, s12, v152
    s_lshl_b32 s12, s9, 9
    s_add_u32 s12, s12, 6144
    v_add_u32 v152, s12, v152
    v_cmp_gt_u32 vcc, 16, v0
    s_nop 1
    v_cndmask_b32 v152, v152, v4, vcc
    v_bfe_u32 v4, v0, 2, 1
    v_lshlrev_b32 v153, 8, v4
    v_bfe_u32 v4, v0, 1, 1
    v_lshl_add_u32 v153, v4, 3, v153
    v_and_b32 v4, 1, v0
    v_lshl_add_u32 v153, v4, 7, v153
    s_lshl_b32 s12, s9, 9
    s_add_u32 s12, s12, 8308
    v_add_u32 v153, s12, v153
    v_lshrrev_b32 v4, 4, v0
    v_mul_u32_u24 v154, 28672, v4
    v_bfe_u32 v4, v0, 3, 1
    v_lshl_add_u32 v154, v4, 10, v154
    v_and_b32 v4, 7, v0
    v_lshl_add_u32 v154, v4, 7, v154
    s_mul_i32 s12, s9, 114688
    s_lshl_b32 s16, s8, 11
    s_add_u32 s12, s12, s16
    v_add_u32 v154, s12, v154
    s_lshl_b32 s12, s9, 11
    s_add_u32 s12, s12, 8192
    v_add_u32 v148, s12, v2
    v_and_b32 v4, 1, v0
    v_lshlrev_b32 v4, 1, v4
    v_bfe_u32 v5, v0, 4, 1
    v_add_u32 v4, v4, v5
    v_bfe_u32 v5, v0, 1, 3
    v_lshrrev_b32 v52, 5, v0
    v_lshlrev_b32 v149, 8, v4
    v_lshl_add_u32 v149, v5, 4, v149
    v_lshl_add_u32 v149, v52, 10, v149
    v_add_u32 v149, 8192, v149
    s_lshl_b32 s12, s8, 9
    v_lshlrev_b32 v150, 3, v0
    v_add_u32 v150, s12, v150
    s_cmp_lg_u32 s9, 0
    s_cbranch_scc1 m0skip_156
    v_mul_u32_u24 v54, 896, v5
    v_lshl_add_u32 v54, v52, 5, v54
    v_lshl_add_u32 v54, v4, 3, v54
    s_lshl_b32 s12, s8, 6
    v_add_u32 v54, s12, v54
    s_mov_b32 s24, s22
    s_and_b32 s25, s23, 0xffff
    s_mov_b32 s26, 7168
    s_mov_b32 s27, 0x20000
    buffer_load_dwordx2 v[36:37], v54, s[24:27], 0 offen
    s_waitcnt vmcnt(0)
    s_mov_b32 s12, 44044288
    s_cmp_lg_u32 s83, 0
    s_cbranch_scc1 msl_157
    buffer_store_dwordx2 v[36:37], v150, s[4:7], s12 offen
    s_branch mse_158
msl_157:
    buffer_store_dwordx2 v[36:37], v150, s[4:7], s12 offen sc1
mse_158:
m0skip_156:
    s_lshl_b32 s12, s8, 3
    s_lshl_b32 s16, s9, 1
    s_add_u32 s12, s12, s16
    s_lshl_b32 s12, s12, 10
    v_add_u32 v151, s12, v2
    s_mov_b32 s32, 0x00ff00ff
    s_mov_b32 s33, 0x00ff00ff
    s_lshl_b32 s12, s8, 2
    s_add_u32 s12, s12, s9
    s_mul_i32 s12, s12, 114688
    s_add_u32 s12, s12, 6422528
    s_mul_i32 s16, s9, 28672
    s_add_u32 s16, s16, 16384
    buffer_load_dwordx4 a[0:3], v2, s[4:7], s12 offen offset:0 sc1
    buffer_load_dwordx4 a[4:7], v2, s[4:7], s12 offen offset:1024 sc1
    s_add_u32 s12, s12, 2048
    buffer_load_dwordx4 a[8:11], v2, s[4:7], s12 offen offset:0 sc1
    buffer_load_dwordx4 a[12:15], v2, s[4:7], s12 offen offset:1024 sc1
    s_add_u32 s12, s12, 2048
    buffer_load_dwordx4 a[16:19], v2, s[4:7], s12 offen offset:0 sc1
    buffer_load_dwordx4 a[20:23], v2, s[4:7], s12 offen offset:1024 sc1
    s_add_u32 s12, s12, 2048
    buffer_load_dwordx4 a[24:27], v2, s[4:7], s12 offen offset:0 sc1
    buffer_load_dwordx4 a[28:31], v2, s[4:7], s12 offen offset:1024 sc1
    s_add_u32 s12, s12, 2048
    buffer_load_dwordx4 a[32:35], v2, s[4:7], s12 offen offset:0 sc1
    buffer_load_dwordx4 a[36:39], v2, s[4:7], s12 offen offset:1024 sc1
    s_add_u32 s12, s12, 2048
    buffer_load_dwordx4 a[40:43], v2, s[4:7], s12 offen offset:0 sc1
    buffer_load_dwordx4 a[44:47], v2, s[4:7], s12 offen offset:1024 sc1
    s_add_u32 s12, s12, 2048
    buffer_load_dwordx4 a[48:51], v2, s[4:7], s12 offen offset:0 sc1
    buffer_load_dwordx4 a[52:55], v2, s[4:7], s12 offen offset:1024 sc1
    s_add_u32 s12, s12, 2048
    buffer_load_dwordx4 a[56:59], v2, s[4:7], s12 offen offset:0 sc1
    buffer_load_dwordx4 a[60:63], v2, s[4:7], s12 offen offset:1024 sc1
    s_add_u32 s12, s12, 2048
    buffer_load_dwordx4 a[64:67], v2, s[4:7], s12 offen offset:0 sc1
    buffer_load_dwordx4 a[68:71], v2, s[4:7], s12 offen offset:1024 sc1
    s_add_u32 s12, s12, 2048
    buffer_load_dwordx4 a[72:75], v2, s[4:7], s12 offen offset:0 sc1
    buffer_load_dwordx4 a[76:79], v2, s[4:7], s12 offen offset:1024 sc1
    s_add_u32 s12, s12, 2048
    buffer_load_dwordx4 a[80:83], v2, s[4:7], s12 offen offset:0 sc1
    buffer_load_dwordx4 a[84:87], v2, s[4:7], s12 offen offset:1024 sc1
    s_add_u32 s12, s12, 2048
    buffer_load_dwordx4 a[88:91], v2, s[4:7], s12 offen offset:0 sc1
    buffer_load_dwordx4 a[92:95], v2, s[4:7], s12 offen offset:1024 sc1
    s_add_u32 s12, s12, 2048
    buffer_load_dwordx4 a[96:99], v2, s[4:7], s12 offen offset:0 sc1
    buffer_load_dwordx4 a[100:103], v2, s[4:7], s12 offen offset:1024 sc1
    s_add_u32 s12, s12, 2048
    buffer_load_dwordx4 a[104:107], v2, s[4:7], s12 offen offset:0 sc1
    buffer_load_dwordx4 a[108:111], v2, s[4:7], s12 offen offset:1024 sc1
    s_add_u32 s12, s12, 2048
    buffer_load_dwordx4 a[112:115], v2, s[4:7], s12 offen offset:0 sc1
    buffer_load_dwordx4 a[116:119], v2, s[4:7], s12 offen offset:1024 sc1
    s_add_u32 s12, s12, 2048
    buffer_load_dwordx4 a[120:123], v2, s[4:7], s12 offen offset:0 sc1
    buffer_load_dwordx4 a[124:127], v2, s[4:7], s12 offen offset:1024 sc1
    s_add_u32 s12, s12, 2048
    s_waitcnt vmcnt(16)
    buffer_load_dwordx4 a[128:131], v2, s[4:7], s12 offen offset:0 sc1
    buffer_load_dwordx4 a[132:135], v2, s[4:7], s12 offen offset:1024 sc1
    s_add_u32 s12, s12, 2048
    buffer_load_dwordx4 a[136:139], v2, s[4:7], s12 offen offset:0 sc1
    buffer_load_dwordx4 a[140:143], v2, s[4:7], s12 offen offset:1024 sc1
    s_add_u32 s12, s12, 2048
    buffer_load_dwordx4 a[144:147], v2, s[4:7], s12 offen offset:0 sc1
    buffer_load_dwordx4 a[148:151], v2, s[4:7], s12 offen offset:1024 sc1
    s_add_u32 s12, s12, 2048
    buffer_load_dwordx4 a[152:155], v2, s[4:7], s12 offen offset:0 sc1
    buffer_load_dwordx4 a[156:159], v2, s[4:7], s12 offen offset:1024 sc1
    s_add_u32 s12, s12, 2048
    buffer_load_dwordx4 a[160:163], v2, s[4:7], s12 offen offset:0 sc1
    buffer_load_dwordx4 a[164:167], v2, s[4:7], s12 offen offset:1024 sc1
    s_add_u32 s12, s12, 2048
    s_add_u32 m0, s16, 0
    s_nop 0
    buffer_load_dwordx4 v2, s[4:7], s12 offen offset:0 sc1 lds
    buffer_load_dwordx4 v2, s[4:7], s12 offen offset:1024 sc1 lds
    s_add_u32 s12, s12, 2048
    s_add_u32 m0, s16, 2048
    s_nop 0
    buffer_load_dwordx4 v2, s[4:7], s12 offen offset:0 sc1 lds
    buffer_load_dwordx4 v2, s[4:7], s12 offen offset:1024 sc1 lds
    s_add_u32 s12, s12, 2048
    s_add_u32 m0, s16, 4096
    s_nop 0
    buffer_load_dwordx4 v2, s[4:7], s12 offen offset:0 sc1 lds
    buffer_load_dwordx4 v2, s[4:7], s12 offen offset:1024 sc1 lds
    s_add_u32 s12, s12, 2048
    s_add_u32 m0, s16, 6144
    s_nop 0
    buffer_load_dwordx4 v2, s[4:7], s12 offen offset:0 sc1 lds
    buffer_load_dwordx4 v2, s[4:7], s12 offen offset:1024 sc1 lds
    s_add_u32 s12, s12, 2048
    s_add_u32 m0, s16, 8192
    s_nop 0
    buffer_load_dwordx4 v2, s[4:7], s12 offen offset:0 sc1 lds
    buffer_load_dwordx4 v2, s[4:7], s12 offen offset:1024 sc1 lds
    s_add_u32 s12, s12, 2048
    s_add_u32 m0, s16, 10240
    s_nop 0
    buffer_load_dwordx4 v2, s[4:7], s12 offen offset:0 sc1 lds
    buffer_load_dwordx4 v2, s[4:7], s12 offen offset:1024 sc1 lds
    s_add_u32 s12, s12, 2048
    s_add_u32 m0, s16, 12288
    s_nop 0
    buffer_load_dwordx4 v2, s[4:7], s12 offen offset:0 sc1 lds
    buffer_load_dwordx4 v2, s[4:7], s12 offen offset:1024 sc1 lds
    s_add_u32 s12, s12, 2048
    buffer_load_dwordx4 a[168:171], v2, s[4:7], s12 offen offset:0 sc1
    buffer_load_dwordx4 a[172:175], v2, s[4:7], s12 offen offset:1024 sc1
    s_add_u32 s12, s12, 2048
    buffer_load_dwordx4 a[176:179], v2, s[4:7], s12 offen offset:0 sc1
    buffer_load_dwordx4 a[180:183], v2, s[4:7], s12 offen offset:1024 sc1
    s_add_u32 s12, s12, 2048
    buffer_load_dwordx4 a[184:187], v2, s[4:7], s12 offen offset:0 sc1
    buffer_load_dwordx4 a[188:191], v2, s[4:7], s12 offen offset:1024 sc1
    s_add_u32 s12, s12, 2048
    buffer_load_dwordx4 a[192:195], v2, s[4:7], s12 offen offset:0 sc1
    buffer_load_dwordx4 a[196:199], v2, s[4:7], s12 offen offset:1024 sc1
    s_add_u32 s12, s12, 2048
    s_waitcnt vmcnt(16)
    buffer_load_dwordx4 a[200:203], v2, s[4:7], s12 offen offset:0 sc1
    buffer_load_dwordx4 a[204:207], v2, s[4:7], s12 offen offset:1024 sc1
    s_add_u32 s12, s12, 2048
    buffer_load_dwordx4 a[208:211], v2, s[4:7], s12 offen offset:0 sc1
    buffer_load_dwordx4 a[212:215], v2, s[4:7], s12 offen offset:1024 sc1
    s_add_u32 s12, s12, 2048
    buffer_load_dwordx4 a[216:219], v2, s[4:7], s12 offen offset:0 sc1
    buffer_load_dwordx4 a[220:223], v2, s[4:7], s12 offen offset:1024 sc1
    s_add_u32 s12, s12, 2048
    buffer_load_dwordx4 a[224:227], v2, s[4:7], s12 offen offset:0 sc1
    buffer_load_dwordx4 a[228:231], v2, s[4:7], s12 offen offset:1024 sc1
    s_add_u32 s12, s12, 2048
    buffer_load_dwordx4 a[232:235], v2, s[4:7], s12 offen offset:0 sc1
    buffer_load_dwordx4 a[236:239], v2, s[4:7], s12 offen offset:1024 sc1
    s_add_u32 s12, s12, 2048
    buffer_load_dwordx4 a[240:243], v2, s[4:7], s12 offen offset:0 sc1
    buffer_load_dwordx4 a[244:247], v2, s[4:7], s12 offen offset:1024 sc1
    s_add_u32 s12, s12, 2048
    buffer_load_dwordx4 a[248:251], v2, s[4:7], s12 offen offset:0 sc1
    buffer_load_dwordx4 a[252:255], v2, s[4:7], s12 offen offset:1024 sc1
    s_add_u32 s12, s12, 2048
    buffer_load_dwordx4 v[176:179], v2, s[4:7], s12 offen offset:0 sc1
    buffer_load_dwordx4 v[180:183], v2, s[4:7], s12 offen offset:1024 sc1
    s_add_u32 s12, s12, 2048
    buffer_load_dwordx4 v[184:187], v2, s[4:7], s12 offen offset:0 sc1
    buffer_load_dwordx4 v[188:191], v2, s[4:7], s12 offen offset:1024 sc1
    s_add_u32 s12, s12, 2048
    buffer_load_dwordx4 v[192:195], v2, s[4:7], s12 offen offset:0 sc1
    buffer_load_dwordx4 v[196:199], v2, s[4:7], s12 offen offset:1024 sc1
    s_add_u32 s12, s12, 2048
    buffer_load_dwordx4 v[200:203], v2, s[4:7], s12 offen offset:0 sc1
    buffer_load_dwordx4 v[204:207], v2, s[4:7], s12 offen offset:1024 sc1
    s_add_u32 s12, s12, 2048
    buffer_load_dwordx4 v[208:211], v2, s[4:7], s12 offen offset:0 sc1
    buffer_load_dwordx4 v[212:215], v2, s[4:7], s12 offen offset:1024 sc1
    s_add_u32 s12, s12, 2048
    buffer_load_dwordx4 v[216:219], v2, s[4:7], s12 offen offset:0 sc1
    buffer_load_dwordx4 v[220:223], v2, s[4:7], s12 offen offset:1024 sc1
    s_add_u32 s12, s12, 2048
    buffer_load_dwordx4 v[224:227], v2, s[4:7], s12 offen offset:0 sc1
    buffer_load_dwordx4 v[228:231], v2, s[4:7], s12 offen offset:1024 sc1
    s_add_u32 s12, s12, 2048
    buffer_load_dwordx4 v[232:235], v2, s[4:7], s12 offen offset:0 sc1
    buffer_load_dwordx4 v[236:239], v2, s[4:7], s12 offen offset:1024 sc1
    s_add_u32 s12, s12, 2048
    buffer_load_dwordx4 v[240:243], v2, s[4:7], s12 offen offset:0 sc1
    buffer_load_dwordx4 v[244:247], v2, s[4:7], s12 offen offset:1024 sc1
    s_add_u32 s12, s12, 2048
    s_waitcnt vmcnt(16)
    buffer_load_dwordx4 v[248:251], v2, s[4:7], s12 offen offset:0 sc1
    buffer_load_dwordx4 v[252:255], v2, s[4:7], s12 offen offset:1024 sc1
    s_add_u32 s12, s12, 2048
    s_add_u32 m0, s16, 14336
    s_nop 0
    buffer_load_dwordx4 v2, s[4:7], s12 offen offset:0 sc1 lds
    buffer_load_dwordx4 v2, s[4:7], s12 offen offset:1024 sc1 lds
    s_add_u32 s12, s12, 2048
    s_add_u32 m0, s16, 16384
    s_nop 0
    buffer_load_dwordx4 v2, s[4:7], s12 offen offset:0 sc1 lds
    buffer_load_dwordx4 v2, s[4:7], s12 offen offset:1024 sc1 lds
    s_add_u32 s12, s12, 2048
    s_add_u32 m0, s16, 18432
    s_nop 0
    buffer_load_dwordx4 v2, s[4:7], s12 offen offset:0 sc1 lds
    buffer_load_dwordx4 v2, s[4:7], s12 offen offset:1024 sc1 lds
    s_add_u32 s12, s12, 2048
    s_add_u32 m0, s16, 20480
    s_nop 0
    buffer_load_dwordx4 v2, s[4:7], s12 offen offset:0 sc1 lds
    buffer_load_dwordx4 v2, s[4:7], s12 offen offset:1024 sc1 lds
    s_add_u32 s12, s12, 2048
    s_add_u32 m0, s16, 22528
    s_nop 0
    buffer_load_dwordx4 v2, s[4:7], s12 offen offset:0 sc1 lds
    buffer_load_dwordx4 v2, s[4:7], s12 offen offset:1024 sc1 lds
    s_add_u32 s12, s12, 2048
    s_add_u32 m0, s16, 24576
    s_nop 0
    buffer_load_dwordx4 v2, s[4:7], s12 offen offset:0 sc1 lds
    buffer_load_dwordx4 v2, s[4:7], s12 offen offset:1024 sc1 lds
    s_add_u32 s12, s12, 2048
    s_add_u32 m0, s16, 26624
    s_nop 0
    buffer_load_dwordx4 v2, s[4:7], s12 offen offset:0 sc1 lds
    buffer_load_dwordx4 v2, s[4:7], s12 offen offset:1024 sc1 lds
    s_add_u32 s12, s12, 2048
    s_mov_b32 s13, 44044288
    s_mov_b32 s14, 44511232
    s_mov_b32 s17, 14684160
    s_mov_b32 s18, 45166592
    s_mov_b32 s19, 52506624
    s_mov_b32 s79, 0
    s_mov_b32 s10, 0
    s_waitcnt vmcnt(0)
    s_barrier
L_V_loop:
    s_mov_b32 s11, 0
    buffer_load_dwordx4 v[96:99], v142, s[4:7], s13 offen sc1
    buffer_load_dwordx4 v[100:103], v143, s[4:7], s13 offen sc1
poll_159:
    s_waitcnt vmcnt(0)
    v_max3_u32 v4, v96, v97, v98
    v_max_u32 v4, v4, v99
    v_max3_u32 v5, v100, v101, v102
    v_max_u32 v5, v5, v103
    v_max_u32 v4, v4, v5
    v_cmp_eq_u32 vcc, -1, v4
    s_cbranch_vccz polld_160
    buffer_load_dwordx4 v[96:99], v142, s[4:7], s13 offen sc1
    buffer_load_dwordx4 v[100:103], v143, s[4:7], s13 offen sc1
    s_add_u32 s11, s11, 1
    s_cmp_lt_u32 s11, 400000
    s_cbranch_scc1 poll_159
    s_branch L_abort
polld_160:
    ds_write_b128 v142, v[96:99] offset:0
    ds_write_b128 v143, v[100:103] offset:0
    v_mov_b64 v[36:37], 0
    v_mov_b64 v[38:39], 0
    v_mov_b64 v[40:41], 0
    v_mov_b64 v[42:43], 0
    v_mov_b64 v[44:45], 0
    v_mov_b64 v[46:47], 0
    v_mov_b64 v[48:49], 0
    v_mov_b64 v[50:51], 0
    s_waitcnt vmcnt(0) lgkmcnt(0)
    s_barrier
    ds_read_b128 v[8:11], v2 offset:0
    ds_read_b128 v[12:15], v2 offset:1024
    ds_read_b128 v[16:19], v2 offset:2048
    ds_read_b128 v[20:23], v2 offset:3072
    ds_read_b128 v[24:27], v2 offset:4096
    ds_read_b128 v[28:31], v2 offset:5120
    ds_read_b128 v[32:35], v2 offset:6144
    s_cmp_eq_u32 s10, 0
    s_cbranch_scc1 nopub_161
    s_sub_u32 s12, s18, 114688
    buffer_store_dwordx4 v[56:59], v151, s[4:7], s12 offen offset:0 sc1
    buffer_store_dwordx4 v[60:63], v151, s[4:7], s12 offen offset:1024 sc1
    s_cmp_lt_u32 s10, 2
    s_cbranch_scc1 nofl_162
    s_sub_u32 s12, s10, 2
    s_lshl_b32 s16, s12, 8
    s_add_u32 s16, s16, 90980352
    s_lshl_b32 s12, s8, 2
    s_add_u32 s12, s12, s9
    s_lshl_b32 s12, s12, 2
    s_add_u32 s16, s16, s12
    v_mov_b32 v4, 0
    v_mov_b32 v5, 1
    s_mov_b64 exec, 1
    buffer_store_dword v5, v4, s[4:7], s16 offen sc1
    s_mov_b64 exec, -1
nofl_162:
    s_cmp_lg_u32 s9, 0
    s_cbranch_scc1 nopub_161
nopub_161:
    s_lshr_b32 s12, s10, 2
    s_min_u32 s12, s12, 15
    s_cmp_lt_u32 s12, s79
    s_cbranch_scc1 zok_163
    s_mov_b32 s11, 0
zpoll_164:
    v_and_b32 v4, 15, v0
    v_lshlrev_b32 v4, 6, v4
    s_mov_b32 s16, 90972160
    buffer_load_dword v5, v4, s[4:7], s16 offen sc1
    s_waitcnt vmcnt(0)
    v_cmp_gt_u32 vcc, 64, v5
    s_nop 1
    s_or_b32 s16, vcc_lo, 0x10000
    s_ff1_i32_b32 s79, s16
    s_cmp_lt_u32 s12, s79
    s_cbranch_scc1 zok_163
    s_sleep 8
    s_add_u32 s11, s11, 1
    s_cmp_lt_u32 s11, 50000
    s_cbranch_scc1 zpoll_164
    s_branch L_abort
zok_163:
    s_mov_b64 exec, 0xfffff
    buffer_load_dword v128, v152, s[4:7], s14 offen sc1
    s_mov_b64 exec, -1
    s_waitcnt lgkmcnt(6)
    v_smfmac_f32_16x16x64_bf16 v[36:39], v[8:11], a[0:7], v1
    s_add_u32 s12, s17, 0
    buffer_load_dwordx4 v[64:67], v145, s[4:7], s12 offen offset:0 sc1
    s_waitcnt lgkmcnt(5)
    v_smfmac_f32_16x16x64_bf16 v[36:39], v[12:15], a[8:15], v1
    s_waitcnt lgkmcnt(4)
    v_smfmac_f32_16x16x64_bf16 v[36:39], v[16:19], a[16:23], v1
    s_add_u32 s12, s17, 0
    buffer_load_dwordx4 v[68:71], v145, s[4:7], s12 offen offset:1024 sc1
    s_waitcnt lgkmcnt(3)
    v_smfmac_f32_16x16x64_bf16 v[36:39], v[20:23], a[24:31], v1
    s_waitcnt lgkmcnt(2)
    v_smfmac_f32_16x16x64_bf16 v[36:39], v[24:27], a[32:39], v1
    s_add_u32 s12, s17, 28672
    buffer_load_dwordx4 v[72:75], v145, s[4:7], s12 offen offset:0 sc1
    s_waitcnt lgkmcnt(1)
    v_smfmac_f32_16x16x64_bf16 v[36:39], v[28:31], a[40:47], v1
    s_waitcnt lgkmcnt(0)
    v_smfmac_f32_16x16x64_bf16 v[36:39], v[32:35], a[48:55], v1
    s_add_u32 s12, s17, 28672
    buffer_load_dwordx4 v[76:79], v145, s[4:7], s12 offen offset:1024 sc1
    v_smfmac_f32_16x16x64_bf16 v[40:43], v[8:11], a[56:63], v1
    v_smfmac_f32_16x16x64_bf16 v[40:43], v[12:15], a[64:71], v1
    s_add_u32 s12, s17, 57344
    buffer_load_dwordx4 v[80:83], v145, s[4:7], s12 offen offset:0 sc1
    v_smfmac_f32_16x16x64_bf16 v[40:43], v[16:19], a[72:79], v1
    v_smfmac_f32_16x16x64_bf16 v[40:43], v[20:23], a[80:87], v1
    s_add_u32 s12, s17, 57344
    buffer_load_dwordx4 v[84:87], v145, s[4:7], s12 offen offset:1024 sc1
    v_smfmac_f32_16x16x64_bf16 v[40:43], v[24:27], a[88:95], v1
    v_smfmac_f32_16x16x64_bf16 v[40:43], v[28:31], a[96:103], v1
    s_add_u32 s12, s17, 86016
    buffer_load_dwordx4 v[88:91], v145, s[4:7], s12 offen offset:0 sc1
    v_smfmac_f32_16x16x64_bf16 v[40:43], v[32:35], a[104:111], v1
    v_smfmac_f32_16x16x64_bf16 v[44:47], v[8:11], a[112:119], v1
    s_add_u32 s12, s17, 86016
    buffer_load_dwordx4 v[92:95], v145, s[4:7], s12 offen offset:1024 sc1
    v_smfmac_f32_16x16x64_bf16 v[44:47], v[12:15], a[120:127], v1
    v_smfmac_f32_16x16x64_bf16 v[44:47], v[16:19], a[128:135], v1
    v_smfmac_f32_16x16x64_bf16 v[44:47], v[20:23], a[136:143], v1
    s_nop 1
    v_permlane32_swap_b32 v36, v40
    v_permlane32_swap_b32 v37, v41
    v_smfmac_f32_16x16x64_bf16 v[44:47], v[24:27], a[144:151], v1
    v_permlane32_swap_b32 v38, v42
    v_permlane32_swap_b32 v39, v43
    ds_read_b128 v[96:99], v144 offset:0
    ds_read_b128 v[100:103], v144 offset:1024
    v_smfmac_f32_16x16x64_bf16 v[44:47], v[28:31], a[152:159], v1
    v_add_f32 v52, v36, v40
    v_add_f32 v53, v37, v41
    ds_read_b128 v[104:107], v144 offset:2048
    ds_read_b128 v[108:111], v144 offset:3072
    v_smfmac_f32_16x16x64_bf16 v[44:47], v[32:35], a[160:167], v1
    v_add_f32 v54, v38, v42
    v_add_f32 v55, v39, v43
    ds_read_b128 v[112:115], v144 offset:4096
    ds_read_b128 v[116:119], v144 offset:5120
    s_waitcnt lgkmcnt(4)
    v_smfmac_f32_16x16x64_bf16 v[48:51], v[8:11], v[96:103], v1
    v_cvt_pk_bf16_f32 v56, v52, v53
    v_cvt_pk_bf16_f32 v57, v54, v55
    ds_read_b128 v[120:123], v144 offset:6144
    ds_read_b128 v[124:127], v144 offset:7168
    s_waitcnt lgkmcnt(4)
    v_smfmac_f32_16x16x64_bf16 v[48:51], v[12:15], v[104:111], v1
    v_mov_b64 v[36:37], 0
    v_mov_b64 v[38:39], 0
    ds_read_b128 v[96:99], v144 offset:8192
    ds_read_b128 v[100:103], v144 offset:9216
    s_waitcnt lgkmcnt(4)
    v_smfmac_f32_16x16x64_bf16 v[48:51], v[16:19], v[112:119], v1
    v_mov_b64 v[40:41], 0
    v_mov_b64 v[42:43], 0
    ds_read_b128 v[104:107], v144 offset:10240
    ds_read_b128 v[108:111], v144 offset:11264
    s_waitcnt lgkmcnt(4)
    v_smfmac_f32_16x16x64_bf16 v[48:51], v[20:23], v[120:127], v1
    ds_read_b128 v[112:115], v144 offset:12288
    ds_read_b128 v[116:119], v144 offset:13312
    s_waitcnt lgkmcnt(4)
    v_smfmac_f32_16x16x64_bf16 v[48:51], v[24:27], v[96:103], v1
    s_waitcnt lgkmcnt(2)
    v_smfmac_f32_16x16x64_bf16 v[48:51], v[28:31], v[104:111], v1
    s_waitcnt lgkmcnt(0)
    v_smfmac_f32_16x16x64_bf16 v[48:51], v[32:35], v[112:119], v1
    v_smfmac_f32_16x16x64_bf16 v[36:39], v[8:11], a[168:175], v1
    v_smfmac_f32_16x16x64_bf16 v[36:39], v[12:15], a[176:183], v1
    v_smfmac_f32_16x16x64_bf16 v[36:39], v[16:19], a[184:191], v1
    v_smfmac_f32_16x16x64_bf16 v[36:39], v[20:23], a[192:199], v1
    s_nop 3
    v_permlane32_swap_b32 v44, v48
    v_permlane32_swap_b32 v45, v49
    v_smfmac_f32_16x16x64_bf16 v[36:39], v[24:27], a[200:207], v1
    v_permlane32_swap_b32 v46, v50
    v_permlane32_swap_b32 v47, v51
    v_smfmac_f32_16x16x64_bf16 v[36:39], v[28:31], a[208:215], v1
    v_add_f32 v52, v44, v48
    v_add_f32 v53, v45, v49
    v_smfmac_f32_16x16x64_bf16 v[36:39], v[32:35], a[216:223], v1
    v_add_f32 v54, v46, v50
    v_add_f32 v55, v47, v51
    v_smfmac_f32_16x16x64_bf16 v[40:43], v[8:11], a[224:231], v1
    v_cvt_pk_bf16_f32 v58, v52, v53
    v_cvt_pk_bf16_f32 v59, v54, v55
    v_smfmac_f32_16x16x64_bf16 v[40:43], v[12:15], a[232:239], v1
    v_mov_b64 v[44:45], 0
    v_mov_b64 v[46:47], 0
    v_smfmac_f32_16x16x64_bf16 v[40:43], v[16:19], a[240:247], v1
    v_mov_b64 v[48:49], 0
    v_mov_b64 v[50:51], 0
    v_smfmac_f32_16x16x64_bf16 v[40:43], v[20:23], a[248:255], v1
    v_smfmac_f32_16x16x64_bf16 v[40:43], v[24:27], v[176:183], v1
    v_smfmac_f32_16x16x64_bf16 v[40:43], v[28:31], v[184:191], v1
    v_smfmac_f32_16x16x64_bf16 v[40:43], v[32:35], v[192:199], v1
    v_smfmac_f32_16x16x64_bf16 v[44:47], v[8:11], v[200:207], v1
    v_smfmac_f32_16x16x64_bf16 v[44:47], v[12:15], v[208:215], v1
    v_smfmac_f32_16x16x64_bf16 v[44:47], v[16:19], v[216:223], v1
    v_smfmac_f32_16x16x64_bf16 v[44:47], v[20:23], v[224:231], v1
    s_nop 3
    v_permlane32_swap_b32 v36, v40
    v_permlane32_swap_b32 v37, v41
    v_smfmac_f32_16x16x64_bf16 v[44:47], v[24:27], v[232:239], v1
    v_permlane32_swap_b32 v38, v42
    v_permlane32_swap_b32 v39, v43
    ds_read_b128 v[96:99], v144 offset:14336
    ds_read_b128 v[100:103], v144 offset:15360
    v_smfmac_f32_16x16x64_bf16 v[44:47], v[28:31], v[240:247], v1
    v_add_f32 v52, v36, v40
    v_add_f32 v53, v37, v41
    ds_read_b128 v[104:107], v144 offset:16384
    ds_read_b128 v[108:111], v144 offset:17408
    v_smfmac_f32_16x16x64_bf16 v[44:47], v[32:35], v[248:255], v1
    v_add_f32 v54, v38, v42
    v_add_f32 v55, v39, v43
    ds_read_b128 v[112:115], v144 offset:18432
    ds_read_b128 v[116:119], v144 offset:19456
    s_waitcnt lgkmcnt(4)
    v_smfmac_f32_16x16x64_bf16 v[48:51], v[8:11], v[96:103], v1
    v_cvt_pk_bf16_f32 v60, v52, v53
    v_cvt_pk_bf16_f32 v61, v54, v55
    ds_read_b128 v[120:123], v144 offset:20480
    ds_read_b128 v[124:127], v144 offset:21504
    s_waitcnt lgkmcnt(4)
    v_smfmac_f32_16x16x64_bf16 v[48:51], v[12:15], v[104:111], v1
    ds_read_b128 v[96:99], v144 offset:22528
    ds_read_b128 v[100:103], v144 offset:23552
    s_waitcnt lgkmcnt(4)
    v_smfmac_f32_16x16x64_bf16 v[48:51], v[16:19], v[112:119], v1
    ds_read_b128 v[104:107], v144 offset:24576
    ds_read_b128 v[108:111], v144 offset:25600
    s_waitcnt lgkmcnt(4)
    v_smfmac_f32_16x16x64_bf16 v[48:51], v[20:23], v[120:127], v1
    ds_read_b128 v[112:115], v144 offset:26624
    ds_read_b128 v[116:119], v144 offset:27648
    s_waitcnt lgkmcnt(4)
    v_smfmac_f32_16x16x64_bf16 v[48:51], v[24:27], v[96:103], v1
    s_waitcnt lgkmcnt(2)
    v_smfmac_f32_16x16x64_bf16 v[48:51], v[28:31], v[104:111], v1
    s_waitcnt lgkmcnt(0)
    v_smfmac_f32_16x16x64_bf16 v[48:51], v[32:35], v[112:119], v1
    s_nop 7
    v_permlane32_swap_b32 v44, v48
    v_permlane32_swap_b32 v45, v49
    v_permlane32_swap_b32 v46, v50
    v_permlane32_swap_b32 v47, v51
    v_add_f32 v52, v44, v48
    v_add_f32 v53, v45, v49
    v_add_f32 v54, v46, v50
    v_add_f32 v55, v47, v51
    v_cvt_pk_bf16_f32 v62, v52, v53
    v_cvt_pk_bf16_f32 v63, v54, v55
    s_cmp_ge_u32 s10, 63
    s_cbranch_scc1 L_V_end
    v_mov_b64 v[36:37], 0
    v_mov_b64 v[38:39], 0
    v_mov_b64 v[40:41], 0
    v_mov_b64 v[42:43], 0
    v_mov_b64 v[44:45], 0
    v_mov_b64 v[46:47], 0
    v_mov_b64 v[48:49], 0
    v_mov_b64 v[50:51], 0
    s_mov_b32 s11, 0
    buffer_load_dwordx4 v[128:131], v146, s[4:7], s14 offen offset:0 sc1
    buffer_load_dwordx4 v[132:135], v146, s[4:7], s14 offen offset:1024 sc1
    buffer_load_dwordx4 v[136:139], v147, s[4:7], s14 offen sc1
poll_165:
    s_waitcnt vmcnt(0)
    v_max3_u32 v4, v128, v129, v130
    v_max3_u32 v4, v4, v131, v132
    v_max_u32 v4, v4, v133
    v_max3_u32 v5, v134, v135, v136
    v_max3_u32 v5, v5, v137, v138
    v_max_u32 v5, v5, v139
    v_max_u32 v4, v4, v5
    v_cmp_eq_u32 vcc, -1, v4
    s_cbranch_vccz polld_166
    buffer_load_dwordx4 v[128:131], v146, s[4:7], s14 offen offset:0 sc1
    buffer_load_dwordx4 v[132:135], v146, s[4:7], s14 offen offset:1024 sc1
    buffer_load_dwordx4 v[136:139], v147, s[4:7], s14 offen sc1
    s_add_u32 s11, s11, 1
    s_cmp_lt_u32 s11, 400000
    s_cbranch_scc1 poll_165
    s_branch L_abort
polld_166:
    v_mfma_f32_16x16x32_bf16 v[36:39], v[64:67], v[128:131], v[36:39]
    v_mfma_f32_16x16x32_bf16 v[44:47], v[72:75], v[128:131], v[44:47]
    v_mfma_f32_16x16x32_bf16 v[36:39], v[80:83], v[132:135], v[36:39]
    v_mfma_f32_16x16x32_bf16 v[44:47], v[88:91], v[132:135], v[44:47]
    v_mfma_f32_16x16x32_bf16 v[36:39], v[56:59], v[136:139], v[36:39]
    v_mfma_f32_16x16x32_bf16 v[40:43], v[68:71], v[128:131], v[40:43]
    v_mfma_f32_16x16x32_bf16 v[48:51], v[76:79], v[128:131], v[48:51]
    v_mfma_f32_16x16x32_bf16 v[40:43], v[84:87], v[132:135], v[40:43]
    v_mfma_f32_16x16x32_bf16 v[48:51], v[92:95], v[132:135], v[48:51]
    v_mfma_f32_16x16x32_bf16 v[40:43], v[60:63], v[136:139], v[40:43]
    s_nop 2
    v_add_f32_dpp v36, v44, v36 row_ror:8 row_mask:0xf bank_mask:0xf
    v_add_f32_dpp v37, v45, v37 row_ror:8 row_mask:0xf bank_mask:0xf
    v_add_f32_dpp v38, v46, v38 row_ror:8 row_mask:0xf bank_mask:0xf
    v_add_f32_dpp v39, v47, v39 row_ror:8 row_mask:0xf bank_mask:0xf
    s_mov_b64 exec, s[32:33]
    ds_write_b128 v148, v[36:39] offset:0
    s_mov_b64 exec, -1
    v_add_f32_dpp v40, v48, v40 row_ror:8 row_mask:0xf bank_mask:0xf
    v_add_f32_dpp v41, v49, v41 row_ror:8 row_mask:0xf bank_mask:0xf
    v_add_f32_dpp v42, v50, v42 row_ror:8 row_mask:0xf bank_mask:0xf
    v_add_f32_dpp v43, v51, v43 row_ror:8 row_mask:0xf bank_mask:0xf
    s_mov_b64 exec, s[32:33]
    ds_write_b128 v148, v[40:43] offset:1024
    s_mov_b64 exec, -1
    s_waitcnt lgkmcnt(0)
    s_barrier
    s_cmp_lg_u32 s9, 0
    s_cbranch_scc1 vnotw0_167
    ds_read_b128 v[36:39], v149 offset:0
    ds_read_b128 v[40:43], v149 offset:2048
    ds_read_b128 v[44:47], v149 offset:4096
    ds_read_b128 v[48:51], v149 offset:6144
    s_waitcnt lgkmcnt(2)
    v_pk_add_f32 v[36:37], v[36:37], v[40:41]
    v_pk_add_f32 v[38:39], v[38:39], v[42:43]
    s_waitcnt lgkmcnt(0)
    v_pk_add_f32 v[44:45], v[44:45], v[48:49]
    v_pk_add_f32 v[46:47], v[46:47], v[50:51]
    v_pk_add_f32 v[36:37], v[36:37], v[44:45]
    v_pk_add_f32 v[38:39], v[38:39], v[46:47]
    v_cvt_pk_bf16_f32 v140, v36, v37
    v_cvt_pk_bf16_f32 v141, v38, v39
    s_add_u32 s12, s13, 7168
    s_cmp_lg_u32 s83, 0
    s_cbranch_scc1 msl_168
    buffer_store_dwordx2 v[140:141], v150, s[4:7], s12 offen
    s_branch mse_169
msl_168:
    buffer_store_dwordx2 v[140:141], v150, s[4:7], s12 offen sc1
mse_169:
    s_cmp_lg_u32 s10, 62
    s_cbranch_scc1 nolast_170
    s_add_u32 s12, s19, 7168
    buffer_store_dwordx2 v[140:141], v150, s[4:7], s12 offen sc1
nolast_170:
vnotw0_167:
    s_barrier
    s_add_u32 s13, s13, 7168
    s_add_u32 s19, s19, 7168
    s_add_u32 s14, s14, 10240
    s_add_u32 s10, s10, 1
    s_add_u32 s18, s18, 114688
    s_cmp_lt_u32 s10, 64
    s_cselect_b32 s12, 458752, 0
    s_add_u32 s17, s17, s12
    s_branch L_V_loop
L_V_end:
    buffer_store_dwordx4 v[56:59], v151, s[4:7], s18 offen offset:0 sc1
    buffer_store_dwordx4 v[60:63], v151, s[4:7], s18 offen offset:1024 sc1
    s_waitcnt vmcnt(0)
    s_mov_b32 s12, 62
    s_lshl_b32 s16, s12, 8
    s_add_u32 s16, s16, 90980352
    s_lshl_b32 s12, s8, 2
    s_add_u32 s12, s12, s9
    s_lshl_b32 s12, s12, 2
    s_add_u32 s16, s16, s12
    v_mov_b32 v4, 0
    v_mov_b32 v5, 1
    s_mov_b64 exec, 1
    buffer_store_dword v5, v4, s[4:7], s16 offen sc1
    s_mov_b64 exec, -1
    s_mov_b32 s12, 63
    s_lshl_b32 s16, s12, 8
    s_add_u32 s16, s16, 90980352
    s_lshl_b32 s12, s8, 2
    s_add_u32 s12, s12, s9
    s_lshl_b32 s12, s12, 2
    s_add_u32 s16, s16, s12
    v_mov_b32 v4, 0
    v_mov_b32 v5, 1
    s_mov_b64 exec, 1
    buffer_store_dword v5, v4, s[4:7], s16 offen sc1
    s_mov_b64 exec, -1
    s_branch L_done
L_abort:
    s_load_dwordx2 s[20:21], s[0:1], 120
    s_waitcnt lgkmcnt(0)
    s_mov_b64 exec, -1
    v_mov_b32 v2, 0xdead
    v_mov_b32 v3, 60
    global_store_dword v3, v2, s[20:21]
L_done:
    s_endpgm
L_code_end:
.section .rodata,"a"
.p2align 6
.amdhsa_kernel k_main_kernel
  .amdhsa_next_free_vgpr 512
  .amdhsa_next_free_sgpr 100
  .amdhsa_accum_offset 256
  .amdhsa_group_segment_fixed_size 0
  .amdhsa_kernarg_size 136
  .amdhsa_user_sgpr_count 2
  .amdhsa_user_sgpr_kernarg_segment_ptr 1
  .amdhsa_system_sgpr_workgroup_id_x 1
.end_amdhsa_kernel
```
